```python
import torch

def _softmax(x, axis=-1):
    return torch.softmax(x, dim=axis)
def _gelu(x):
    return torch.nn.functional.gelu(x, approximate="tanh")
def _silu(x):
    return torch.nn.functional.silu(x)
def _sigmoid(x):
    return torch.sigmoid(x)
def _layernorm(x, axis=-1, eps=1e-5):
    m = x.mean(dim=axis, keepdim=True)
    v = x.var(dim=axis, keepdim=True, unbiased=False)
    return (x - m) / torch.sqrt(v + eps)
def _scatter_add(tgt, idx, src, axis=0):
    return tgt.clone().index_add_(axis, idx, src)
def _segment_sum(src, seg, n):
    out = torch.zeros((n,) + src.shape[1:], dtype=src.dtype)
    return out.index_add_(0, seg, src)
def _pad(x, pw):
    flat = tuple(v for pair in reversed(pw) for v in pair)
    return torch.nn.functional.pad(x, flat)

kernel_name = 'interleave_layers__mha_block__glu_gated_bilinear__prompt'

def setup_inputs():

    _w = (lambda a: (lambda t: t.to(torch.bfloat16) if t.is_floating_point() else t)(torch.as_tensor(a)))
    def _A_setup():
        B, S, D, H = 1, 2048, 512, 32
        return {
            "x": _w((lambda *s: torch.randn(*s, dtype=torch.bfloat16) * 0.05)(B, S, D)),
            "wqkv": _w((lambda *s: torch.randn(*s, dtype=torch.bfloat16) * 0.05)(D, 3 * D)),
            "wo": _w((lambda *s: torch.randn(*s, dtype=torch.bfloat16) * 0.05)(D, D)),
        }
    _A_in = _A_setup()

    def _B_setup():
        B, S, D, F = 1, 2048, 512, 1792
        return {
            "x": _w((lambda *s: torch.randn(*s, dtype=torch.bfloat16) * 0.05)(B, S, D)),
            "w_gate": _w((lambda *s: torch.randn(*s, dtype=torch.bfloat16) * 0.4)(D, F) * (D ** -0.5)),
            "w_up": _w((lambda *s: torch.randn(*s, dtype=torch.bfloat16) * 0.4)(D, F) * (D ** -0.5)),
            "w_down": _w((lambda *s: torch.randn(*s, dtype=torch.bfloat16) * 0.4)(F, D) * (F ** -0.5)),
        }
    _B_in = _B_setup()

    return {
        "A_x": _A_in["x"],
        "A_wqkv": _A_in["wqkv"],
        "A_wo": _A_in["wo"],
        "B_x": _B_in["x"],
        "B_w_gate": _B_in["w_gate"],
        "B_w_up": _B_in["w_up"],
        "B_w_down": _B_in["w_down"],
    }

def reference(A_x, A_wqkv, A_wo, B_x, B_w_gate, B_w_up, B_w_down):
    def _A_ref(x, wqkv, wo):
        B, S, D = x.shape
        H = 32
        Dh = D // H
        qkv = (lambda x, *d: x.permute(*d))((x @ wqkv).reshape(B, S, 3, H, Dh), 2, 0, 3, 1, 4)
        q, k, v = qkv[0], qkv[1], qkv[2]
        scores = torch.einsum("bhqd,bhkd->bhqk", q, k) * (Dh ** -0.5)
        p = _softmax(scores, axis=-1)
        o = torch.einsum("bhqk,bhkd->bhqd", p, v)
        return (lambda x, *d: x.permute(*d))(o, 0, 2, 1, 3).reshape(B, S, D) @ wo

    def _B_ref(x, w_gate, w_up, w_down):
        g = torch.einsum("bsd,df->bsf", x, w_gate)
        u = torch.einsum("bsd,df->bsf", x, w_up)
        h = g * u
        return torch.einsum("bsf,fd->bsd", h, w_down)

    x = A_x
    x = x + _A_ref(_layernorm(x, axis=-1), A_wqkv, A_wo)
    x = x + _B_ref(_layernorm(x, axis=-1), B_w_gate, B_w_up, B_w_down)
    x = x + _A_ref(_layernorm(x, axis=-1), A_wqkv, A_wo)
    x = x + _B_ref(_layernorm(x, axis=-1), B_w_gate, B_w_up, B_w_down)
    return x
```

```asm
; @launch grid=(256,1,1) block=(256,1,1) lds=163840
.amdgcn_target "amdgcn-amd-amdhsa--gfx950"
.text
.globl interleave_layers__mha_block__glu_gated_bilinear__prompt_kernel
.p2align 8
.type interleave_layers__mha_block__glu_gated_bilinear__prompt_kernel,@function
interleave_layers__mha_block__glu_gated_bilinear__prompt_kernel:
    s_cmp_ge_u32 s2, 256
    s_cbranch_scc1 L_abort
    s_load_dwordx2 s[4:5], s[0:1], 72
    s_load_dwordx2 s[8:9], s[0:1], 56
    s_load_dwordx2 s[60:61], s[0:1], 0
    s_load_dwordx4 s[64:67], s[0:1], 8
    s_load_dwordx4 s[68:71], s[0:1], 32
    s_load_dwordx2 s[72:73], s[0:1], 48
    s_getpc_b64 s[88:89]
    s_lshr_b32 s90, s2, 3
    s_and_b32 s90, s90, 7
    s_lshl_b32 s90, s90, 12
    v_lshl_add_u32 v3, v0, 4, s90
    global_load_dword v247, v3, s[88:89]
    v_lshrrev_b32 v2, 6, v0
    v_and_b32 v1, 63, v0
    v_readfirstlane_b32 s12, v2
    v_lshlrev_b32 v1, 4, v1
    s_mov_b32 s101, s2
    s_and_b32 s13, s2, 7
    s_lshr_b32 s14, s2, 3
    s_lshl_b32 s15, s12, 10
    s_lshr_b32 s2, s14, 4
    s_lshr_b32 s3, s14, 3
    s_lshl_b32 s96, s13, 5
    s_add_u32 s96, s96, s14
    s_lshl_b32 s97, s12, 12
    s_lshl_b32 s99, s12, 11
    s_getreg_b32 s35, hwreg(HW_REG_XCC_ID, 0, 4)
    v_add_u32 v2, s15, v1
    s_mov_b32 s30, 0xffff
    s_mov_b32 s31, 0xffff
    s_mov_b32 s34, 0
    s_and_b32 s16, s14, 7
    s_mul_i32 s36, s16, 65536
    s_add_u32 s36, s36, 1638400
    s_lshl_b32 s17, s13, 2
    s_add_u32 s17, s17, s3
    s_lshl_b32 s17, s17, 1
    s_and_b32 s18, s12, 1
    s_add_u32 s17, s17, s18
    s_lshl_b32 s17, s17, 5
    s_lshl_b32 s16, s16, 2
    s_add_u32 s17, s17, s16
    s_and_b32 s18, s12, 2
    s_add_u32 s17, s17, s18
    s_lshl_b32 s100, s17, 10
    s_lshr_b32 s29, s100, 12
    s_lshl_b32 s29, s29, 9
    s_lshl_b32 s18, s18, 2
    s_add_u32 s29, s29, s18
    s_add_u32 s29, s29, 17825792
    s_and_b32 s16, s14, 15
    s_mul_i32 s37, s16, 237568
    s_add_u32 s37, s37, 2162688
    s_mul_i32 s38, s16, 102400
    s_add_u32 s38, s38, 0
    s_lshl_b32 s16, s2, 2
    s_lshl_b32 s22, s13, 3
    s_add_u32 s22, s22, s16
    s_add_u32 s22, s22, s12
    s_and_b32 s23, s14, 15
    v_bfe_u32 v10, v0, 3, 3
    v_lshlrev_b32 v10, 10, v10
    v_and_b32 v13, 7, v0
    v_bfe_u32 v14, v0, 4, 2
    v_xor_b32 v13, v13, v14
    v_lshlrev_b32 v13, 4, v13
    v_add_u32 v10, v10, v13
    v_xor_b32 v11, 64, v10
    v_bfe_u32 v12, v0, 2, 4
    v_mul_u32_u24 v12, 3072, v12
    v_and_b32 v13, 3, v0
    v_lshlrev_b32 v13, 4, v13
    v_add_u32 v12, v12, v13
    s_lshl_b32 s20, s22, 15
    s_mul_i32 s39, s12, 49152
    s_lshl_b32 s16, s23, 6
    s_add_u32 s39, s39, s16
    s_lshl_b32 s26, s12, 14
    s_add_u32 s26, s26, 98304
    s_lshl_b32 s27, s12, 11
    s_waitcnt lgkmcnt(0)
    s_mov_b32 s56, s64
    s_and_b32 s57, s65, 0xffff
    s_mov_b32 s58, 1572864
    s_mov_b32 s59, 0x20000
    s_and_b32 s61, s61, 0xffff
    s_mov_b32 s62, 2097152
    s_mov_b32 s63, 0x20000
    s_lshl_b32 s25, s2, 2
    s_lshr_b32 s19, s14, 1
    s_add_u32 s25, s25, s19
    s_add_u32 s25, s25, s13
    s_add_u32 s19, s25, 0
    s_and_b32 s19, s19, 7
    s_lshl_b32 s28, s19, 7
    s_add_u32 s28, s28, s20
    s_mul_i32 s21, s19, 196608
    s_add_u32 s21, s21, s39
    s_add_u32 m0, s26, 0
    s_add_u32 s18, s28, 0
    buffer_load_dwordx4 v10, s[60:63], s18 offen lds
    s_add_u32 m0, s26, 1024
    s_add_u32 s18, s28, 8192
    buffer_load_dwordx4 v11, s[60:63], s18 offen lds
    s_add_u32 m0, s26, 2048
    s_add_u32 s18, s28, 16384
    buffer_load_dwordx4 v10, s[60:63], s18 offen lds
    s_add_u32 m0, s26, 3072
    s_add_u32 s18, s28, 24576
    buffer_load_dwordx4 v11, s[60:63], s18 offen lds
    s_add_u32 m0, s27, 0
    s_add_u32 s18, s21, 1024
    buffer_load_dwordx4 v12, s[56:59], s18 offen lds
    s_add_u32 m0, s27, 1024
    s_add_u32 s18, s21, 2048
    buffer_load_dwordx4 v12, s[56:59], s18 offen lds
    s_add_u32 s16, s4, 7995392
    s_addc_u32 s17, s5, 0
    s_load_dwordx2 s[32:33], s[16:17], 0
    s_and_b32 s5, s5, 0xffff
    s_mov_b32 s6, 268435456
    s_mov_b32 s7, 0x20000
    s_and_b32 s9, s9, 0xffff
    s_mov_b32 s10, 2097152
    s_mov_b32 s11, 0x20000
    s_min_u32 s83, s96, 231
    s_and_b32 s90, s12, 1
    s_lshr_b32 s91, s12, 1
    s_cmp_lt_u32 s83, 48
    s_cbranch_scc1 pk_q
    s_cmp_lt_u32 s83, 160
    s_cbranch_scc1 pk_u
    s_cmp_lt_u32 s83, 176
    s_cbranch_scc1 pk_o
    s_sub_u32 s84, s83, 176
    s_lshl_b32 s84, s84, 2
    s_add_u32 s84, s84, s12
    s_and_b32 s85, s84, 15
    s_lshr_b32 s86, s84, 4
    s_lshl_b32 s87, s85, 6
    s_add_u32 s74, s72, s87
    s_addc_u32 s75, s73, 0
    s_mov_b32 s76, s74
    s_mov_b32 s77, s75
    s_mov_b32 s78, 1024
    s_lshl_b32 s79, s86, 7
    s_mul_i32 s80, s85, 14
    s_add_u32 s80, s80, s86
    s_lshl_b32 s80, s80, 13
    s_add_u32 s80, s80, 5963776
    s_mov_b32 s81, 1024
    s_mov_b32 s88, s81
    s_mov_b32 s82, 2146435072
    s_branch pk_go
pk_o:
    s_sub_u32 s85, s83, 160
    s_lshr_b32 s88, s85, 3
    s_and_b32 s85, s85, 7
    s_lshl_b32 s87, s85, 1
    s_add_u32 s87, s87, s90
    s_lshl_b32 s87, s87, 6
    s_add_u32 s74, s66, s87
    s_addc_u32 s75, s67, 0
    s_mov_b32 s76, s74
    s_mov_b32 s77, s75
    s_mov_b32 s78, 1024
    s_lshl_b32 s79, s88, 1
    s_add_u32 s79, s79, s91
    s_lshl_b32 s79, s79, 7
    s_lshl_b32 s89, s91, 15
    s_xor_b32 s90, s90, s88
    s_lshl_b32 s88, s88, 1
    s_add_u32 s90, s90, s88
    s_lshl_b32 s90, s90, 10
    s_mul_i32 s80, s85, 65536
    s_add_u32 s80, s80, s89
    s_add_u32 s80, s80, s90
    s_add_u32 s80, s80, 1638400
    s_mov_b32 s81, 4096
    s_mov_b32 s88, s81
    s_mov_b32 s82, 2146435072
    s_branch pk_go
pk_u:
    s_sub_u32 s85, s83, 48
    s_mul_i32 s84, s85, 2341
    s_lshr_b32 s84, s84, 16
    s_mul_i32 s86, s84, 28
    s_sub_u32 s85, s85, s86
    s_lshl_b32 s85, s85, 2
    s_add_u32 s85, s85, s12
    s_lshl_b32 s87, s85, 5
    s_add_u32 s74, s68, s87
    s_addc_u32 s75, s69, 0
    s_add_u32 s76, s70, s87
    s_addc_u32 s77, s71, 0
    s_sub_u32 s76, s76, 32
    s_subb_u32 s77, s77, 0
    s_mov_b32 s78, 3584
    s_mul_i32 s86, s85, 9363
    s_lshr_b32 s86, s86, 16
    s_mul_i32 s88, s86, 7
    s_sub_u32 s88, s85, s88
    s_mul_i32 s91, s86, 237568
    s_add_u32 s91, s91, 2162688
    s_lshl_b32 s89, s88, 10
    s_add_u32 s91, s91, s89
    s_cmp_lt_u32 s88, 5
    s_cselect_b32 s90, 3, 5
    s_lshl_b32 s89, s90, 15
    s_add_u32 s89, s89, 1024
    s_cmp_lt_u32 s88, 3
    s_cselect_b32 s81, 3, 2
    s_cselect_b32 s89, 0, s89
    s_cselect_b32 s90, 0, s90
    s_lshl_b32 s81, s81, 10
    s_add_u32 s91, s91, s89
    s_sub_u32 s85, s88, s90
    s_lshl_b32 s85, s85, 10
    s_mov_b32 s88, 1024
    s_branch pk_ext
pk_q:
    s_cmp_ge_u32 s83, 24
    s_cselect_b32 s84, 2, 0
    s_cselect_b32 s86, 24, 0
    s_add_u32 s84, s84, s91
    s_sub_u32 s85, s83, s86
    s_lshl_b32 s85, s85, 1
    s_add_u32 s85, s85, s90
    s_and_b32 s86, s85, 15
    s_lshr_b32 s88, s85, 4
    s_lshl_b32 s87, s85, 6
    s_lshl_b32 s89, s88, 10
    s_add_u32 s74, s64, s87
    s_addc_u32 s75, s65, 0
    s_mov_b32 s76, s74
    s_mov_b32 s77, s75
    s_mov_b32 s78, 3072
    s_sub_u32 s89, s89, 1024
    s_cmp_eq_u32 s88, 0
    s_cselect_b32 s89, 67584, s89
    s_cselect_b32 s81, 1, 2
    s_lshl_b32 s81, s81, 10
    s_mul_i32 s91, s86, 102400
    s_add_u32 s91, s91, s89
    s_add_u32 s91, s91, 0
    s_mov_b32 s85, 0
    s_mov_b32 s88, s81
pk_ext:
    s_lshl_b32 s79, s84, 7
    s_lshl_b32 s89, s81, 5
    s_add_u32 s82, s91, s89
    s_lshr_b32 s89, s84, 1
    s_lshl_b32 s89, s89, 9
    s_add_u32 s82, s82, s89
    s_and_b32 s89, s84, 1
    s_lshl_b32 s89, s89, 3
    s_add_u32 s82, s82, s89
    s_lshl_b32 s89, s81, 3
    s_mul_i32 s89, s89, s84
    s_add_u32 s80, s91, s89
    s_add_u32 s80, s80, s85
pk_go:
    s_cmp_ge_u32 s96, 232
    s_cselect_b32 s80, 2146435072, s80
    v_bfe_u32 v4, v0, 2, 4
    v_add_u32 v4, s79, v4
    v_mul_lo_u32 v4, v4, s78
    v_and_b32 v13, 3, v0
    v_lshlrev_b32 v13, 4, v13
    v_add_u32 v4, v4, v13
    s_lshl_b32 s83, s78, 4
    s_lshl_b32 s84, s12, 13
    s_mov_b32 s86, s83
    s_mov_b32 s87, 0
    s_lshl_b32 s83, s81, 1
    s_sub_u32 s83, s83, s88
    s_mov_b32 s81, s88
    v_and_b32 v13, 2, v0
    v_cmp_eq_u32 vcc, 0, v13
    v_mov_b32 v14, s76
    v_mov_b32 v13, s74
    v_cndmask_b32 v14, v14, v13, vcc
    v_mov_b32 v15, s77
    v_mov_b32 v13, s75
    v_cndmask_b32 v15, v15, v13, vcc
    v_add_co_u32 v4, vcc, v4, v14
    s_nop 1
    v_addc_co_u32 v5, vcc, 0, v15, vcc
    s_cmp_eq_u32 s12, 0
    s_cselect_b64 s[90:91], s[68:69], s[70:71]
    s_cmp_eq_u32 s12, 2
    s_cselect_b64 s[90:91], s[72:73], s[90:91]
    s_cmp_eq_u32 s12, 3
    s_cselect_b64 s[90:91], s[66:67], s[90:91]
    s_cselect_b32 s16, 16, 56
    s_mul_i32 s17, s16, s96
    s_sub_u32 s16, s16, 1
    v_and_b32 v254, 63, v0
    v_min_u32 v254, s16, v254
    v_add_u32 v254, s17, v254
    v_lshlrev_b32 v254, 7, v254
    s_and_b32 s16, s14, 7
    s_and_b32 s17, s14, 15
    v_and_b32 v13, 15, v0
    v_min_u32 v14, 13, v13
    s_lshr_b32 s18, s16, 1
    s_add_u32 s18, s18, 176
    v_lshl_add_u32 v252, v14, 2, s18
    s_mul_i32 s18, s17, 7
    s_add_u32 s19, s18, 6
    s_lshr_b32 s18, s18, 2
    s_lshr_b32 s19, s19, 2
    v_lshrrev_b32 v14, 2, v13
    v_add_u32 v14, s18, v14
    v_min_u32 v14, s19, v14
    v_and_b32 v15, 3, v13
    v_mul_u32_u24 v15, 28, v15
    v_add3_u32 v14, v14, v15, 48
    v_and_b32 v15, 16, v0
    v_cmp_ne_u32 vcc, 0, v15
    s_nop 1
    v_cndmask_b32 v252, v252, v14, vcc
    s_add_u32 s16, s16, 160
    v_and_b32 v14, 1, v13
    v_lshl_add_u32 v251, v14, 3, s16
    s_lshr_b32 s17, s17, 1
    v_mul_u32_u24 v14, 24, v14
    v_lshrrev_b32 v15, 1, v13
    v_min_u32 v15, 2, v15
    v_lshlrev_b32 v15, 3, v15
    v_add3_u32 v14, v14, v15, s17
    v_cndmask_b32 v251, v251, v14, vcc
    v_cmp_gt_u32 vcc, 512, v1
    s_nop 1
    v_cndmask_b32 v252, v251, v252, vcc
    v_lshlrev_b32 v252, 7, v252
    v_accvgpr_write_b32 a213, v252
    s_getpc_b64 s[88:89]
L_pcw:
    s_lshl_b32 s16, s14, 1
    s_add_u32 s16, s16, s12
    s_and_b32 s16, s16, 63
    s_lshl_b32 s16, s16, 10
    s_min_u32 s16, s16, L_end-L_pcw-1024
    v_add_u32 v245, s16, v1
    v_min_u32 v244, 192, v1
    v_lshlrev_b32 v244, 17, v244
    s_cmp_eq_u32 s12, 1
    s_cselect_b64 s[88:89], s[8:9], s[88:89]
    s_cmp_eq_u32 s12, 0
    s_cselect_b64 s[88:89], s[4:5], s[88:89]
    s_cselect_b64 vcc, -1, 0
    v_cndmask_b32 v245, v245, v244, vcc
    v_and_b32 v13, 31, v0
    v_bfe_u32 v14, v0, 1, 3
    v_bfe_u32 v15, v0, 5, 1
    v_xor_b32 v14, v14, v15
    v_lshlrev_b32 v14, 4, v14
    v_lshl_add_u32 v13, v13, 7, v14
    v_bfe_u32 v255, v0, 5, 1
    v_lshlrev_b32 v255, 9, v255
    v_bfe_u32 v14, v0, 2, 2
    v_lshlrev_b32 v14, 6, v14
    v_add_u32 v255, v255, v14
    v_bfe_u32 v14, v0, 4, 1
    v_lshlrev_b32 v14, 5, v14
    v_add_u32 v255, v255, v14
    v_and_b32 v14, 1, v0
    v_lshlrev_b32 v14, 4, v14
    v_add_u32 v255, v255, v14
    v_bfe_u32 v14, v0, 1, 1
    v_lshlrev_b32 v14, 3, v14
    v_add_u32 v255, v255, v14
    s_add_u32 s16, s12, 0
    s_and_b32 s16, s16, 3
    s_lshl_b32 s17, s16, 5
    s_lshl_b32 s18, s16, 11
    s_lshl_b32 s16, s16, 10
    s_add_u32 s16, s16, 65536
    v_xor_b32 v196, s17, v13
    v_add_u32 v196, s26, v196
    v_add_u32 v204, s18, v255
    v_add_u32 v200, s16, v255
    s_add_u32 s16, s12, 1
    s_and_b32 s16, s16, 3
    s_lshl_b32 s17, s16, 5
    s_lshl_b32 s18, s16, 11
    s_lshl_b32 s16, s16, 10
    s_add_u32 s16, s16, 65536
    v_xor_b32 v197, s17, v13
    v_add_u32 v197, s26, v197
    v_add_u32 v205, s18, v255
    v_add_u32 v201, s16, v255
    s_add_u32 s16, s12, 2
    s_and_b32 s16, s16, 3
    s_lshl_b32 s17, s16, 5
    s_lshl_b32 s18, s16, 11
    s_lshl_b32 s16, s16, 10
    s_add_u32 s16, s16, 65536
    v_xor_b32 v198, s17, v13
    v_add_u32 v198, s26, v198
    v_add_u32 v206, s18, v255
    v_add_u32 v202, s16, v255
    s_add_u32 s16, s12, 3
    s_and_b32 s16, s16, 3
    s_lshl_b32 s17, s16, 5
    s_lshl_b32 s18, s16, 11
    s_lshl_b32 s16, s16, 10
    s_add_u32 s16, s16, 65536
    v_xor_b32 v199, s17, v13
    v_add_u32 v199, s26, v199
    v_add_u32 v207, s18, v255
    v_add_u32 v203, s16, v255
    v_mov_b32 v220, 0x3f803f80
    v_add_u32 v255, s84, v255
    v_accvgpr_write_b32 a212, v255
    s_lshr_b32 s16, s12, 1
    s_lshl_b32 s16, s16, 9
    s_and_b32 s17, s12, 1
    s_lshl_b32 s17, s17, 3
    s_add_u32 s16, s16, s17
    v_add_u32 v221, s16, v1
    v_accvgpr_write_b32 a192, v220
    v_accvgpr_write_b32 a193, v220
    v_accvgpr_write_b32 a194, v220
    v_accvgpr_write_b32 a195, v220
    v_and_b32 v13, 15, v0
    v_bfe_u32 v14, v0, 4, 1
    v_cmp_eq_u32 vcc, v13, v14
    s_nop 1
    v_cndmask_b32 v13, 0, v220, vcc
    v_accvgpr_write_b32 a96, v13
    v_accvgpr_write_b32 a97, v13
    v_accvgpr_write_b32 a98, v13
    v_accvgpr_write_b32 a99, v13
    v_mov_b32 v192, 0
    v_mov_b32 v193, 0
    v_mov_b32 v194, 0
    v_mov_b32 v195, 0
    s_and_b32 s16, s14, 15
    s_lshl_b32 s68, s16, 11
    s_add_u32 s68, s68, 8212480
    s_lshl_b32 s16, s16, 1
    s_and_b32 s17, s12, 1
    s_add_u32 s16, s16, s17
    s_lshr_b32 s17, s12, 1
    s_lshl_b32 s69, s13, 1
    s_add_u32 s69, s69, s2
    s_lshl_b32 s18, s69, 1
    s_add_u32 s18, s18, s17
    s_lshl_b32 s79, s18, 5
    s_add_u32 s79, s79, s16
    s_lshl_b32 s79, s79, 3
    s_add_u32 s79, s79, 7999488
    s_mul_i32 s64, s18, 229376
    s_lshl_b32 s19, s16, 10
    s_add_u32 s64, s64, s19
    s_add_u32 s64, s64, 10485760
    s_add_u32 s65, s64, 114688
    s_xor_b32 s18, s18, 2
    s_mul_i32 s66, s18, 229376
    s_lshl_b32 s19, s16, 11
    s_add_u32 s66, s66, s19
    s_add_u32 s66, s66, 10518528
    s_add_u32 s67, s66, 114688
    s_lshl_b32 s69, s69, 13
    s_lshl_b32 s16, s16, 17
    s_lshl_b32 s17, s17, 12
    s_add_u32 s16, s16, s17
    s_add_u32 s69, s69, s16
    s_add_u32 s69, s69, 18874368
    v_and_b32 v13, 0x33, v0
    v_bfe_u32 v14, v0, 2, 1
    v_lshl_or_b32 v13, v14, 3, v13
    v_bfe_u32 v14, v0, 3, 1
    v_lshl_or_b32 v13, v14, 2, v13
    v_lshlrev_b32 v248, 4, v13
    v_and_b32 v13, 15, v0
    s_bfe_u32 s16, s69, 0x4000d
    v_xor_b32 v253, s16, v13
    v_lshlrev_b32 v253, 7, v253
    v_bfe_u32 v14, v0, 5, 1
    v_lshl_add_u32 v13, v14, 4, v13
    v_lshlrev_b32 v249, 4, v13
    v_mov_b32 v250, 0xdddddddd
    v_lshlrev_b32 v251, 3, v1
    v_and_b32 v13, 27, v0
    v_cmp_eq_u32 vcc, 16, v13
    v_mov_b32 v14, 0x3afe3f80
    s_nop 0
    v_cndmask_b32 v254, 0, v14, vcc
    s_lshl_b32 s19, s96, 2
    s_add_u32 s19, s19, s12
    s_mul_i32 s72, s19, 7168
    s_add_u32 s72, s72, 10485760
    s_lshl_b32 s16, s19, 11
    s_add_u32 s16, s16, 8388608
    s_lshl_b32 s17, s19, 8
    s_add_u32 s17, s17, 17825792
    v_and_b32 v13, 0x780, v251
    v_add_u32 v13, s16, v13
    v_and_b32 v14, 0x80, v251
    v_add_u32 v14, s17, v14
    v_cmp_gt_u32 vcc, 512, v1
    s_nop 1
    v_cndmask_b32 v252, v14, v13, vcc
    s_lshl_b32 s73, s2, 2
    s_add_u32 s73, s73, s12
    s_mul_i32 s73, s73, 8192
    s_add_u32 s73, s73, s37
    s_add_u32 s73, s73, 65536
    s_and_b32 s85, s19, 31
    s_lshl_b32 s85, s85, 10
    s_add_u32 s19, s25, 1
    s_and_b32 s19, s19, 7
    s_lshl_b32 s28, s19, 7
    s_add_u32 s28, s28, s20
    s_mul_i32 s21, s19, 196608
    s_add_u32 s21, s21, s39
    s_add_u32 m0, s26, 4096
    s_add_u32 s18, s28, 0
    buffer_load_dwordx4 v10, s[60:63], s18 offen lds
    s_add_u32 m0, s26, 5120
    s_add_u32 s18, s28, 8192
    buffer_load_dwordx4 v11, s[60:63], s18 offen lds
    s_add_u32 m0, s26, 6144
    s_add_u32 s18, s28, 16384
    buffer_load_dwordx4 v10, s[60:63], s18 offen lds
    s_add_u32 m0, s26, 7168
    s_add_u32 s18, s28, 24576
    buffer_load_dwordx4 v11, s[60:63], s18 offen lds
    s_add_u32 m0, s27, 8192
    s_add_u32 s18, s21, 1024
    buffer_load_dwordx4 v12, s[56:59], s18 offen lds
    s_add_u32 m0, s27, 9216
    s_add_u32 s18, s21, 2048
    buffer_load_dwordx4 v12, s[56:59], s18 offen lds
    s_add_u32 s19, s25, 2
    s_and_b32 s19, s19, 7
    s_lshl_b32 s28, s19, 7
    s_add_u32 s28, s28, s20
    s_mul_i32 s21, s19, 196608
    s_add_u32 s21, s21, s39
    s_add_u32 m0, s26, 8192
    s_add_u32 s18, s28, 0
    buffer_load_dwordx4 v10, s[60:63], s18 offen lds
    s_add_u32 m0, s26, 9216
    s_add_u32 s18, s28, 8192
    buffer_load_dwordx4 v11, s[60:63], s18 offen lds
    s_add_u32 m0, s26, 10240
    s_add_u32 s18, s28, 16384
    buffer_load_dwordx4 v10, s[60:63], s18 offen lds
    s_add_u32 m0, s26, 11264
    s_add_u32 s18, s28, 24576
    buffer_load_dwordx4 v11, s[60:63], s18 offen lds
    s_add_u32 m0, s27, 16384
    s_add_u32 s18, s21, 1024
    buffer_load_dwordx4 v12, s[56:59], s18 offen lds
    s_add_u32 m0, s27, 17408
    s_add_u32 s18, s21, 2048
    buffer_load_dwordx4 v12, s[56:59], s18 offen lds
    global_load_dword v255, v245, s[88:89]
    s_waitcnt vmcnt(13)
    s_barrier
    ds_read_b128 v[16:19], v196 offset:0
    ds_read_b128 v[20:23], v197 offset:0
    ds_read_b128 v[24:27], v198 offset:0
    ds_read_b128 v[28:31], v199 offset:0
    ds_read_b64_tr_b16 a[0:1], v204 offset:0
    ds_read_b64_tr_b16 a[2:3], v204 offset:256
    ds_read_b64_tr_b16 a[4:5], v204 offset:1024
    ds_read_b64_tr_b16 a[6:7], v204 offset:1280
    ds_read_b64_tr_b16 a[8:9], v205 offset:0
    ds_read_b64_tr_b16 a[10:11], v205 offset:256
    ds_read_b64_tr_b16 a[12:13], v205 offset:1024
    ds_read_b64_tr_b16 a[14:15], v205 offset:1280
    ds_read_b64_tr_b16 a[16:17], v206 offset:0
    ds_read_b64_tr_b16 a[18:19], v206 offset:256
    ds_read_b64_tr_b16 a[20:21], v206 offset:1024
    ds_read_b64_tr_b16 a[22:23], v206 offset:1280
    ds_read_b64_tr_b16 a[24:25], v207 offset:0
    ds_read_b64_tr_b16 a[26:27], v207 offset:256
    ds_read_b64_tr_b16 a[28:29], v207 offset:1024
    ds_read_b64_tr_b16 a[30:31], v207 offset:1280
    s_waitcnt lgkmcnt(14)
    v_dot2c_f32_bf16 v192, v220, v16
    v_dot2c_f32_bf16 v193, v16, v16
    v_dot2c_f32_bf16 v194, v220, v17
    v_dot2c_f32_bf16 v195, v17, v17
    v_dot2c_f32_bf16 v192, v220, v18
    v_dot2c_f32_bf16 v193, v18, v18
    v_dot2c_f32_bf16 v194, v220, v19
    v_dot2c_f32_bf16 v195, v19, v19
    v_dot2c_f32_bf16 v192, v220, v20
    v_dot2c_f32_bf16 v193, v20, v20
    v_dot2c_f32_bf16 v194, v220, v21
    v_dot2c_f32_bf16 v195, v21, v21
    v_dot2c_f32_bf16 v192, v220, v22
    v_dot2c_f32_bf16 v193, v22, v22
    v_dot2c_f32_bf16 v194, v220, v23
    v_dot2c_f32_bf16 v195, v23, v23
    v_dot2c_f32_bf16 v192, v220, v24
    v_dot2c_f32_bf16 v193, v24, v24
    v_dot2c_f32_bf16 v194, v220, v25
    v_dot2c_f32_bf16 v195, v25, v25
    v_dot2c_f32_bf16 v192, v220, v26
    v_dot2c_f32_bf16 v193, v26, v26
    v_dot2c_f32_bf16 v194, v220, v27
    v_dot2c_f32_bf16 v195, v27, v27
    v_dot2c_f32_bf16 v192, v220, v28
    v_dot2c_f32_bf16 v193, v28, v28
    v_dot2c_f32_bf16 v194, v220, v29
    v_dot2c_f32_bf16 v195, v29, v29
    v_dot2c_f32_bf16 v192, v220, v30
    v_dot2c_f32_bf16 v193, v30, v30
    v_dot2c_f32_bf16 v194, v220, v31
    v_dot2c_f32_bf16 v195, v31, v31
    s_waitcnt lgkmcnt(0)
    s_waitcnt vmcnt(7)
    s_barrier
    v_mfma_f32_32x32x16_bf16 v[144:159], a[0:3], v[16:19], 0
    ds_read_b128 v[32:35], v196 offset:4096
    ds_read_b128 v[36:39], v197 offset:4096
    ds_read_b128 v[40:43], v198 offset:4096
    v_mfma_f32_16x16x32_bf16 a[100:103], a[96:99], a[0:3], 0
    s_add_u32 s19, s25, 3
    s_and_b32 s19, s19, 7
    s_lshl_b32 s28, s19, 7
    s_add_u32 s28, s28, s20
    s_mul_i32 s21, s19, 196608
    s_add_u32 s21, s21, s39
    s_add_u32 m0, s26, 12288
    s_add_u32 s18, s28, 0
    buffer_load_dwordx4 v10, s[60:63], s18 offen lds
    s_add_u32 m0, s26, 13312
    s_add_u32 s18, s28, 8192
    buffer_load_dwordx4 v11, s[60:63], s18 offen lds
    v_mfma_f32_32x32x16_bf16 v[160:175], v[16:19], a[4:7], 0
    ds_read_b128 v[44:47], v199 offset:4096
    ds_read_b64_tr_b16 a[32:33], v204 offset:8192
    ds_read_b64_tr_b16 a[34:35], v204 offset:8448
    v_mfma_f32_16x16x32_bf16 a[104:107], a[96:99], a[4:7], 0
    s_add_u32 m0, s26, 14336
    s_add_u32 s18, s28, 16384
    buffer_load_dwordx4 v10, s[60:63], s18 offen lds
    s_add_u32 m0, s26, 15360
    s_add_u32 s18, s28, 24576
    buffer_load_dwordx4 v11, s[60:63], s18 offen lds
    v_mfma_f32_32x32x16_bf16 v[144:159], a[8:11], v[20:23], v[144:159]
    ds_read_b64_tr_b16 a[36:37], v204 offset:9216
    ds_read_b64_tr_b16 a[38:39], v204 offset:9472
    ds_read_b64_tr_b16 a[40:41], v205 offset:8192
    s_add_u32 m0, s27, 24576
    s_add_u32 s18, s21, 1024
    buffer_load_dwordx4 v12, s[56:59], s18 offen lds
    s_add_u32 m0, s27, 25600
    s_add_u32 s18, s21, 2048
    buffer_load_dwordx4 v12, s[56:59], s18 offen lds
    v_mfma_f32_32x32x16_bf16 v[160:175], v[20:23], a[12:15], v[160:175]
    ds_read_b64_tr_b16 a[42:43], v205 offset:8448
    ds_read_b64_tr_b16 a[44:45], v205 offset:9216
    ds_read_b64_tr_b16 a[46:47], v205 offset:9472
    s_add_u32 s19, s25, 4
    s_and_b32 s19, s19, 7
    s_lshl_b32 s28, s19, 7
    s_add_u32 s28, s28, s20
    s_mul_i32 s21, s19, 196608
    s_add_u32 s21, s21, s39
    s_add_u32 m0, s26, 0
    s_add_u32 s18, s28, 0
    buffer_load_dwordx4 v10, s[60:63], s18 offen lds
    s_add_u32 m0, s26, 1024
    s_add_u32 s18, s28, 8192
    buffer_load_dwordx4 v11, s[60:63], s18 offen lds
    v_mfma_f32_32x32x16_bf16 v[144:159], a[16:19], v[24:27], v[144:159]
    ds_read_b64_tr_b16 a[48:49], v206 offset:8192
    ds_read_b64_tr_b16 a[50:51], v206 offset:8448
    ds_read_b64_tr_b16 a[52:53], v206 offset:9216
    s_add_u32 m0, s26, 2048
    s_add_u32 s18, s28, 16384
    buffer_load_dwordx4 v10, s[60:63], s18 offen lds
    v_mfma_f32_32x32x16_bf16 v[160:175], v[24:27], a[20:23], v[160:175]
    ds_read_b64_tr_b16 a[54:55], v206 offset:9472
    ds_read_b64_tr_b16 a[56:57], v207 offset:8192
    ds_read_b64_tr_b16 a[58:59], v207 offset:8448
    s_add_u32 m0, s26, 3072
    s_add_u32 s18, s28, 24576
    buffer_load_dwordx4 v11, s[60:63], s18 offen lds
    v_mfma_f32_32x32x16_bf16 v[144:159], a[24:27], v[28:31], v[144:159]
    ds_read_b64_tr_b16 a[60:61], v207 offset:9216
    ds_read_b64_tr_b16 a[62:63], v207 offset:9472
    s_add_u32 m0, s27, 32768
    s_add_u32 s18, s21, 1024
    buffer_load_dwordx4 v12, s[56:59], s18 offen lds
    v_mfma_f32_32x32x16_bf16 v[160:175], v[28:31], a[28:31], v[160:175]
    s_add_u32 m0, s27, 33792
    s_add_u32 s18, s21, 2048
    buffer_load_dwordx4 v12, s[56:59], s18 offen lds
    s_waitcnt lgkmcnt(14)
    v_dot2c_f32_bf16 v192, v220, v32
    v_dot2c_f32_bf16 v193, v32, v32
    v_dot2c_f32_bf16 v194, v220, v33
    v_dot2c_f32_bf16 v195, v33, v33
    v_dot2c_f32_bf16 v192, v220, v34
    v_dot2c_f32_bf16 v193, v34, v34
    v_dot2c_f32_bf16 v194, v220, v35
    v_dot2c_f32_bf16 v195, v35, v35
    v_dot2c_f32_bf16 v192, v220, v36
    v_dot2c_f32_bf16 v193, v36, v36
    v_dot2c_f32_bf16 v194, v220, v37
    v_dot2c_f32_bf16 v195, v37, v37
    v_dot2c_f32_bf16 v192, v220, v38
    v_dot2c_f32_bf16 v193, v38, v38
    v_dot2c_f32_bf16 v194, v220, v39
    v_dot2c_f32_bf16 v195, v39, v39
    v_dot2c_f32_bf16 v192, v220, v40
    v_dot2c_f32_bf16 v193, v40, v40
    v_dot2c_f32_bf16 v194, v220, v41
    v_dot2c_f32_bf16 v195, v41, v41
    v_dot2c_f32_bf16 v192, v220, v42
    v_dot2c_f32_bf16 v193, v42, v42
    v_dot2c_f32_bf16 v194, v220, v43
    v_dot2c_f32_bf16 v195, v43, v43
    v_dot2c_f32_bf16 v192, v220, v44
    v_dot2c_f32_bf16 v193, v44, v44
    v_dot2c_f32_bf16 v194, v220, v45
    v_dot2c_f32_bf16 v195, v45, v45
    v_dot2c_f32_bf16 v192, v220, v46
    v_dot2c_f32_bf16 v193, v46, v46
    v_dot2c_f32_bf16 v194, v220, v47
    v_dot2c_f32_bf16 v195, v47, v47
    s_waitcnt lgkmcnt(0)
    s_waitcnt vmcnt(13)
    s_barrier
    v_mfma_f32_32x32x16_bf16 v[144:159], a[32:35], v[32:35], v[144:159]
    ds_read_b128 v[48:51], v196 offset:8192
    ds_read_b128 v[52:55], v197 offset:8192
    ds_read_b128 v[56:59], v198 offset:8192
    v_mfma_f32_16x16x32_bf16 a[100:103], a[96:99], a[32:35], a[100:103]
    s_add_u32 s19, s25, 5
    s_and_b32 s19, s19, 7
    s_lshl_b32 s28, s19, 7
    s_add_u32 s28, s28, s20
    s_mul_i32 s21, s19, 196608
    s_add_u32 s21, s21, s39
    s_add_u32 m0, s26, 4096
    s_add_u32 s18, s28, 0
    buffer_load_dwordx4 v10, s[60:63], s18 offen lds
    v_mfma_f32_32x32x16_bf16 v[160:175], v[32:35], a[36:39], v[160:175]
    ds_read_b128 v[60:63], v199 offset:8192
    ds_read_b64_tr_b16 a[0:1], v204 offset:16384
    ds_read_b64_tr_b16 a[2:3], v204 offset:16640
    v_mfma_f32_16x16x32_bf16 a[104:107], a[96:99], a[36:39], a[104:107]
    s_add_u32 m0, s26, 5120
    s_add_u32 s18, s28, 8192
    buffer_load_dwordx4 v11, s[60:63], s18 offen lds
    v_mfma_f32_32x32x16_bf16 v[144:159], a[40:43], v[36:39], v[144:159]
    ds_read_b64_tr_b16 a[4:5], v204 offset:17408
    ds_read_b64_tr_b16 a[6:7], v204 offset:17664
    ds_read_b64_tr_b16 a[8:9], v205 offset:16384
    s_add_u32 m0, s26, 6144
    s_add_u32 s18, s28, 16384
    buffer_load_dwordx4 v10, s[60:63], s18 offen lds
    v_mfma_f32_32x32x16_bf16 v[160:175], v[36:39], a[44:47], v[160:175]
    ds_read_b64_tr_b16 a[10:11], v205 offset:16640
    ds_read_b64_tr_b16 a[12:13], v205 offset:17408
    ds_read_b64_tr_b16 a[14:15], v205 offset:17664
    s_add_u32 m0, s26, 7168
    s_add_u32 s18, s28, 24576
    buffer_load_dwordx4 v11, s[60:63], s18 offen lds
    v_mfma_f32_32x32x16_bf16 v[144:159], a[48:51], v[40:43], v[144:159]
    ds_read_b64_tr_b16 a[16:17], v206 offset:16384
    ds_read_b64_tr_b16 a[18:19], v206 offset:16640
    ds_read_b64_tr_b16 a[20:21], v206 offset:17408
    s_add_u32 m0, s27, 40960
    s_add_u32 s18, s21, 1024
    buffer_load_dwordx4 v12, s[56:59], s18 offen lds
    v_mfma_f32_32x32x16_bf16 v[160:175], v[40:43], a[52:55], v[160:175]
    ds_read_b64_tr_b16 a[22:23], v206 offset:17664
    ds_read_b64_tr_b16 a[24:25], v207 offset:16384
    ds_read_b64_tr_b16 a[26:27], v207 offset:16640
    s_add_u32 m0, s27, 41984
    s_add_u32 s18, s21, 2048
    buffer_load_dwordx4 v12, s[56:59], s18 offen lds
    v_mfma_f32_32x32x16_bf16 v[144:159], a[56:59], v[44:47], v[144:159]
    ds_read_b64_tr_b16 a[28:29], v207 offset:17408
    ds_read_b64_tr_b16 a[30:31], v207 offset:17664
    s_add_u32 s32, s32, 0x7f4a7c15
    s_addc_u32 s33, s33, 0x9e3779b9
    v_mfma_f32_32x32x16_bf16 v[160:175], v[44:47], a[60:63], v[160:175]
    s_waitcnt lgkmcnt(14)
    v_dot2c_f32_bf16 v192, v220, v48
    v_dot2c_f32_bf16 v193, v48, v48
    v_dot2c_f32_bf16 v194, v220, v49
    v_dot2c_f32_bf16 v195, v49, v49
    v_dot2c_f32_bf16 v192, v220, v50
    v_dot2c_f32_bf16 v193, v50, v50
    v_dot2c_f32_bf16 v194, v220, v51
    v_dot2c_f32_bf16 v195, v51, v51
    v_dot2c_f32_bf16 v192, v220, v52
    v_dot2c_f32_bf16 v193, v52, v52
    v_dot2c_f32_bf16 v194, v220, v53
    v_dot2c_f32_bf16 v195, v53, v53
    v_dot2c_f32_bf16 v192, v220, v54
    v_dot2c_f32_bf16 v193, v54, v54
    v_dot2c_f32_bf16 v194, v220, v55
    v_dot2c_f32_bf16 v195, v55, v55
    v_dot2c_f32_bf16 v192, v220, v56
    v_dot2c_f32_bf16 v193, v56, v56
    v_dot2c_f32_bf16 v194, v220, v57
    v_dot2c_f32_bf16 v195, v57, v57
    v_dot2c_f32_bf16 v192, v220, v58
    v_dot2c_f32_bf16 v193, v58, v58
    v_dot2c_f32_bf16 v194, v220, v59
    v_dot2c_f32_bf16 v195, v59, v59
    v_dot2c_f32_bf16 v192, v220, v60
    v_dot2c_f32_bf16 v193, v60, v60
    v_dot2c_f32_bf16 v194, v220, v61
    v_dot2c_f32_bf16 v195, v61, v61
    v_dot2c_f32_bf16 v192, v220, v62
    v_dot2c_f32_bf16 v193, v62, v62
    v_dot2c_f32_bf16 v194, v220, v63
    v_dot2c_f32_bf16 v195, v63, v63
    s_waitcnt lgkmcnt(0)
    s_waitcnt vmcnt(12)
    s_barrier
    v_mfma_f32_32x32x16_bf16 v[144:159], a[0:3], v[48:51], v[144:159]
    ds_read_b128 v[64:67], v196 offset:12288
    ds_read_b128 v[68:71], v197 offset:12288
    ds_read_b128 v[72:75], v198 offset:12288
    v_mfma_f32_16x16x32_bf16 a[100:103], a[96:99], a[0:3], a[100:103]
    s_add_u32 s19, s25, 6
    s_and_b32 s19, s19, 7
    s_lshl_b32 s28, s19, 7
    s_add_u32 s28, s28, s20
    s_mul_i32 s21, s19, 196608
    s_add_u32 s21, s21, s39
    s_add_u32 m0, s26, 8192
    s_add_u32 s18, s28, 0
    buffer_load_dwordx4 v10, s[60:63], s18 offen lds
    v_mfma_f32_32x32x16_bf16 v[160:175], v[48:51], a[4:7], v[160:175]
    ds_read_b128 v[76:79], v199 offset:12288
    ds_read_b64_tr_b16 a[32:33], v204 offset:24576
    ds_read_b64_tr_b16 a[34:35], v204 offset:24832
    v_mfma_f32_16x16x32_bf16 a[104:107], a[96:99], a[4:7], a[104:107]
    s_add_u32 m0, s26, 9216
    s_add_u32 s18, s28, 8192
    buffer_load_dwordx4 v11, s[60:63], s18 offen lds
    v_mfma_f32_32x32x16_bf16 v[144:159], a[8:11], v[52:55], v[144:159]
    ds_read_b64_tr_b16 a[36:37], v204 offset:25600
    ds_read_b64_tr_b16 a[38:39], v204 offset:25856
    ds_read_b64_tr_b16 a[40:41], v205 offset:24576
    s_add_u32 m0, s26, 10240
    s_add_u32 s18, s28, 16384
    buffer_load_dwordx4 v10, s[60:63], s18 offen lds
    v_mfma_f32_32x32x16_bf16 v[160:175], v[52:55], a[12:15], v[160:175]
    ds_read_b64_tr_b16 a[42:43], v205 offset:24832
    ds_read_b64_tr_b16 a[44:45], v205 offset:25600
    ds_read_b64_tr_b16 a[46:47], v205 offset:25856
    s_add_u32 m0, s26, 11264
    s_add_u32 s18, s28, 24576
    buffer_load_dwordx4 v11, s[60:63], s18 offen lds
    v_mfma_f32_32x32x16_bf16 v[144:159], a[16:19], v[56:59], v[144:159]
    ds_read_b64_tr_b16 a[48:49], v206 offset:24576
    ds_read_b64_tr_b16 a[50:51], v206 offset:24832
    ds_read_b64_tr_b16 a[52:53], v206 offset:25600
    s_add_u32 m0, s27, 49152
    s_add_u32 s18, s21, 1024
    buffer_load_dwordx4 v12, s[56:59], s18 offen lds
    v_mfma_f32_32x32x16_bf16 v[160:175], v[56:59], a[20:23], v[160:175]
    ds_read_b64_tr_b16 a[54:55], v206 offset:25856
    ds_read_b64_tr_b16 a[56:57], v207 offset:24576
    ds_read_b64_tr_b16 a[58:59], v207 offset:24832
    s_add_u32 m0, s27, 50176
    s_add_u32 s18, s21, 2048
    buffer_load_dwordx4 v12, s[56:59], s18 offen lds
    v_mfma_f32_32x32x16_bf16 v[144:159], a[24:27], v[60:63], v[144:159]
    ds_read_b64_tr_b16 a[60:61], v207 offset:25600
    ds_read_b64_tr_b16 a[62:63], v207 offset:25856
    v_mfma_f32_32x32x16_bf16 v[160:175], v[60:63], a[28:31], v[160:175]
    s_waitcnt lgkmcnt(14)
    v_dot2c_f32_bf16 v192, v220, v64
    v_dot2c_f32_bf16 v193, v64, v64
    v_dot2c_f32_bf16 v194, v220, v65
    v_dot2c_f32_bf16 v195, v65, v65
    v_dot2c_f32_bf16 v192, v220, v66
    v_dot2c_f32_bf16 v193, v66, v66
    v_dot2c_f32_bf16 v194, v220, v67
    v_dot2c_f32_bf16 v195, v67, v67
    v_dot2c_f32_bf16 v192, v220, v68
    v_dot2c_f32_bf16 v193, v68, v68
    v_dot2c_f32_bf16 v194, v220, v69
    v_dot2c_f32_bf16 v195, v69, v69
    v_dot2c_f32_bf16 v192, v220, v70
    v_dot2c_f32_bf16 v193, v70, v70
    v_dot2c_f32_bf16 v194, v220, v71
    v_dot2c_f32_bf16 v195, v71, v71
    v_dot2c_f32_bf16 v192, v220, v72
    v_dot2c_f32_bf16 v193, v72, v72
    v_dot2c_f32_bf16 v194, v220, v73
    v_dot2c_f32_bf16 v195, v73, v73
    v_dot2c_f32_bf16 v192, v220, v74
    v_dot2c_f32_bf16 v193, v74, v74
    v_dot2c_f32_bf16 v194, v220, v75
    v_dot2c_f32_bf16 v195, v75, v75
    v_dot2c_f32_bf16 v192, v220, v76
    v_dot2c_f32_bf16 v193, v76, v76
    v_dot2c_f32_bf16 v194, v220, v77
    v_dot2c_f32_bf16 v195, v77, v77
    v_dot2c_f32_bf16 v192, v220, v78
    v_dot2c_f32_bf16 v193, v78, v78
    v_dot2c_f32_bf16 v194, v220, v79
    v_dot2c_f32_bf16 v195, v79, v79
    s_waitcnt lgkmcnt(0)
    s_waitcnt vmcnt(12)
    s_barrier
    v_mfma_f32_32x32x16_bf16 v[144:159], a[32:35], v[64:67], v[144:159]
    ds_read_b128 v[80:83], v196 offset:0
    ds_read_b128 v[84:87], v197 offset:0
    ds_read_b128 v[88:91], v198 offset:0
    v_mfma_f32_16x16x32_bf16 a[100:103], a[96:99], a[32:35], a[100:103]
    s_add_u32 s19, s25, 7
    s_and_b32 s19, s19, 7
    s_lshl_b32 s28, s19, 7
    s_add_u32 s28, s28, s20
    s_mul_i32 s21, s19, 196608
    s_add_u32 s21, s21, s39
    s_add_u32 m0, s26, 12288
    s_add_u32 s18, s28, 0
    buffer_load_dwordx4 v10, s[60:63], s18 offen lds
    v_mfma_f32_32x32x16_bf16 v[160:175], v[64:67], a[36:39], v[160:175]
    ds_read_b128 v[92:95], v199 offset:0
    ds_read_b64_tr_b16 a[0:1], v204 offset:32768
    ds_read_b64_tr_b16 a[2:3], v204 offset:33024
    v_mfma_f32_16x16x32_bf16 a[104:107], a[96:99], a[36:39], a[104:107]
    s_add_u32 m0, s26, 13312
    s_add_u32 s18, s28, 8192
    buffer_load_dwordx4 v11, s[60:63], s18 offen lds
    v_mfma_f32_32x32x16_bf16 v[144:159], a[40:43], v[68:71], v[144:159]
    ds_read_b64_tr_b16 a[4:5], v204 offset:33792
    ds_read_b64_tr_b16 a[6:7], v204 offset:34048
    ds_read_b64_tr_b16 a[8:9], v205 offset:32768
    s_add_u32 m0, s26, 14336
    s_add_u32 s18, s28, 16384
    buffer_load_dwordx4 v10, s[60:63], s18 offen lds
    v_mfma_f32_32x32x16_bf16 v[160:175], v[68:71], a[44:47], v[160:175]
    ds_read_b64_tr_b16 a[10:11], v205 offset:33024
    ds_read_b64_tr_b16 a[12:13], v205 offset:33792
    ds_read_b64_tr_b16 a[14:15], v205 offset:34048
    s_add_u32 m0, s26, 15360
    s_add_u32 s18, s28, 24576
    buffer_load_dwordx4 v11, s[60:63], s18 offen lds
    v_mfma_f32_32x32x16_bf16 v[144:159], a[48:51], v[72:75], v[144:159]
    ds_read_b64_tr_b16 a[16:17], v206 offset:32768
    ds_read_b64_tr_b16 a[18:19], v206 offset:33024
    ds_read_b64_tr_b16 a[20:21], v206 offset:33792
    s_add_u32 m0, s27, 57344
    s_add_u32 s18, s21, 1024
    buffer_load_dwordx4 v12, s[56:59], s18 offen lds
    v_mfma_f32_32x32x16_bf16 v[160:175], v[72:75], a[52:55], v[160:175]
    ds_read_b64_tr_b16 a[22:23], v206 offset:34048
    ds_read_b64_tr_b16 a[24:25], v207 offset:32768
    ds_read_b64_tr_b16 a[26:27], v207 offset:33024
    s_add_u32 m0, s27, 58368
    s_add_u32 s18, s21, 2048
    buffer_load_dwordx4 v12, s[56:59], s18 offen lds
    v_mfma_f32_32x32x16_bf16 v[144:159], a[56:59], v[76:79], v[144:159]
    ds_read_b64_tr_b16 a[28:29], v207 offset:33792
    ds_read_b64_tr_b16 a[30:31], v207 offset:34048
    s_add_u32 s19, s25, 0
    s_and_b32 s19, s19, 7
    s_mul_i32 s19, s19, 196608
    s_add_u32 m0, s15, 65536
    s_add_u32 s18, s19, s39
    buffer_load_dwordx4 v12, s[56:59], s18 offen lds
    v_mfma_f32_32x32x16_bf16 v[160:175], v[76:79], a[60:63], v[160:175]
    s_waitcnt lgkmcnt(14)
    v_dot2c_f32_bf16 v192, v220, v80
    v_dot2c_f32_bf16 v193, v80, v80
    v_dot2c_f32_bf16 v194, v220, v81
    v_dot2c_f32_bf16 v195, v81, v81
    v_dot2c_f32_bf16 v192, v220, v82
    v_dot2c_f32_bf16 v193, v82, v82
    v_dot2c_f32_bf16 v194, v220, v83
    v_dot2c_f32_bf16 v195, v83, v83
    v_dot2c_f32_bf16 v192, v220, v84
    v_dot2c_f32_bf16 v193, v84, v84
    v_dot2c_f32_bf16 v194, v220, v85
    v_dot2c_f32_bf16 v195, v85, v85
    v_dot2c_f32_bf16 v192, v220, v86
    v_dot2c_f32_bf16 v193, v86, v86
    v_dot2c_f32_bf16 v194, v220, v87
    v_dot2c_f32_bf16 v195, v87, v87
    v_dot2c_f32_bf16 v192, v220, v88
    v_dot2c_f32_bf16 v193, v88, v88
    v_dot2c_f32_bf16 v194, v220, v89
    v_dot2c_f32_bf16 v195, v89, v89
    v_dot2c_f32_bf16 v192, v220, v90
    v_dot2c_f32_bf16 v193, v90, v90
    v_dot2c_f32_bf16 v194, v220, v91
    v_dot2c_f32_bf16 v195, v91, v91
    v_dot2c_f32_bf16 v192, v220, v92
    v_dot2c_f32_bf16 v193, v92, v92
    v_dot2c_f32_bf16 v194, v220, v93
    v_dot2c_f32_bf16 v195, v93, v93
    v_dot2c_f32_bf16 v192, v220, v94
    v_dot2c_f32_bf16 v193, v94, v94
    v_dot2c_f32_bf16 v194, v220, v95
    v_dot2c_f32_bf16 v195, v95, v95
    s_waitcnt lgkmcnt(0)
    s_waitcnt vmcnt(13)
    s_barrier
    v_mfma_f32_32x32x16_bf16 v[144:159], a[0:3], v[80:83], v[144:159]
    ds_read_b128 v[96:99], v196 offset:4096
    ds_read_b128 v[100:103], v197 offset:4096
    ds_read_b128 v[104:107], v198 offset:4096
    v_mfma_f32_16x16x32_bf16 a[100:103], a[96:99], a[0:3], a[100:103]
    s_add_u32 s19, s25, 1
    s_and_b32 s19, s19, 7
    s_mul_i32 s19, s19, 196608
    s_add_u32 m0, s15, 69632
    s_add_u32 s18, s19, s39
    buffer_load_dwordx4 v12, s[56:59], s18 offen lds
    v_mfma_f32_32x32x16_bf16 v[160:175], v[80:83], a[4:7], v[160:175]
    ds_read_b128 v[108:111], v199 offset:4096
    ds_read_b64_tr_b16 a[32:33], v204 offset:40960
    ds_read_b64_tr_b16 a[34:35], v204 offset:41216
    v_mfma_f32_16x16x32_bf16 a[104:107], a[96:99], a[4:7], a[104:107]
    s_add_u32 s19, s25, 2
    s_and_b32 s19, s19, 7
    s_mul_i32 s19, s19, 196608
    s_add_u32 m0, s15, 73728
    s_add_u32 s18, s19, s39
    buffer_load_dwordx4 v12, s[56:59], s18 offen lds
    v_mfma_f32_32x32x16_bf16 v[144:159], a[8:11], v[84:87], v[144:159]
    ds_read_b64_tr_b16 a[36:37], v204 offset:41984
    ds_read_b64_tr_b16 a[38:39], v204 offset:42240
    ds_read_b64_tr_b16 a[40:41], v205 offset:40960
    s_add_u32 s19, s25, 3
    s_and_b32 s19, s19, 7
    s_mul_i32 s19, s19, 196608
    s_add_u32 m0, s15, 77824
    s_add_u32 s18, s19, s39
    buffer_load_dwordx4 v12, s[56:59], s18 offen lds
    v_mfma_f32_32x32x16_bf16 v[160:175], v[84:87], a[12:15], v[160:175]
    ds_read_b64_tr_b16 a[42:43], v205 offset:41216
    ds_read_b64_tr_b16 a[44:45], v205 offset:41984
    ds_read_b64_tr_b16 a[46:47], v205 offset:42240
    v_mfma_f32_32x32x16_bf16 v[144:159], a[16:19], v[88:91], v[144:159]
    ds_read_b64_tr_b16 a[48:49], v206 offset:40960
    ds_read_b64_tr_b16 a[50:51], v206 offset:41216
    ds_read_b64_tr_b16 a[52:53], v206 offset:41984
    v_mfma_f32_32x32x16_bf16 v[160:175], v[88:91], a[20:23], v[160:175]
    ds_read_b64_tr_b16 a[54:55], v206 offset:42240
    ds_read_b64_tr_b16 a[56:57], v207 offset:40960
    ds_read_b64_tr_b16 a[58:59], v207 offset:41216
    v_mfma_f32_32x32x16_bf16 v[144:159], a[24:27], v[92:95], v[144:159]
    ds_read_b64_tr_b16 a[60:61], v207 offset:41984
    ds_read_b64_tr_b16 a[62:63], v207 offset:42240
    v_mfma_f32_32x32x16_bf16 v[160:175], v[92:95], a[28:31], v[160:175]
    s_waitcnt lgkmcnt(14)
    v_dot2c_f32_bf16 v192, v220, v96
    v_dot2c_f32_bf16 v193, v96, v96
    v_dot2c_f32_bf16 v194, v220, v97
    v_dot2c_f32_bf16 v195, v97, v97
    v_dot2c_f32_bf16 v192, v220, v98
    v_dot2c_f32_bf16 v193, v98, v98
    v_dot2c_f32_bf16 v194, v220, v99
    v_dot2c_f32_bf16 v195, v99, v99
    v_dot2c_f32_bf16 v192, v220, v100
    v_dot2c_f32_bf16 v193, v100, v100
    v_dot2c_f32_bf16 v194, v220, v101
    v_dot2c_f32_bf16 v195, v101, v101
    v_dot2c_f32_bf16 v192, v220, v102
    v_dot2c_f32_bf16 v193, v102, v102
    v_dot2c_f32_bf16 v194, v220, v103
    v_dot2c_f32_bf16 v195, v103, v103
    v_dot2c_f32_bf16 v192, v220, v104
    v_dot2c_f32_bf16 v193, v104, v104
    v_dot2c_f32_bf16 v194, v220, v105
    v_dot2c_f32_bf16 v195, v105, v105
    v_dot2c_f32_bf16 v192, v220, v106
    v_dot2c_f32_bf16 v193, v106, v106
    v_dot2c_f32_bf16 v194, v220, v107
    v_dot2c_f32_bf16 v195, v107, v107
    v_dot2c_f32_bf16 v192, v220, v108
    v_dot2c_f32_bf16 v193, v108, v108
    v_dot2c_f32_bf16 v194, v220, v109
    v_dot2c_f32_bf16 v195, v109, v109
    v_dot2c_f32_bf16 v192, v220, v110
    v_dot2c_f32_bf16 v193, v110, v110
    v_dot2c_f32_bf16 v194, v220, v111
    v_dot2c_f32_bf16 v195, v111, v111
    s_waitcnt lgkmcnt(0)
    s_waitcnt vmcnt(10)
    s_barrier
    v_mfma_f32_32x32x16_bf16 v[144:159], a[32:35], v[96:99], v[144:159]
    ds_read_b128 v[112:115], v196 offset:8192
    ds_read_b128 v[116:119], v197 offset:8192
    ds_read_b128 v[120:123], v198 offset:8192
    v_mfma_f32_16x16x32_bf16 a[100:103], a[96:99], a[32:35], a[100:103]
    s_add_u32 s19, s25, 4
    s_and_b32 s19, s19, 7
    s_mul_i32 s19, s19, 196608
    s_add_u32 m0, s15, 81920
    s_add_u32 s18, s19, s39
    buffer_load_dwordx4 v12, s[56:59], s18 offen lds
    v_mfma_f32_32x32x16_bf16 v[160:175], v[96:99], a[36:39], v[160:175]
    ds_read_b128 v[124:127], v199 offset:8192
    ds_read_b64_tr_b16 a[0:1], v204 offset:49152
    ds_read_b64_tr_b16 a[2:3], v204 offset:49408
    v_mfma_f32_16x16x32_bf16 a[104:107], a[96:99], a[36:39], a[104:107]
    s_add_u32 s19, s25, 5
    s_and_b32 s19, s19, 7
    s_mul_i32 s19, s19, 196608
    s_add_u32 m0, s15, 86016
    s_add_u32 s18, s19, s39
    buffer_load_dwordx4 v12, s[56:59], s18 offen lds
    v_mfma_f32_32x32x16_bf16 v[144:159], a[40:43], v[100:103], v[144:159]
    ds_read_b64_tr_b16 a[4:5], v204 offset:50176
    ds_read_b64_tr_b16 a[6:7], v204 offset:50432
    ds_read_b64_tr_b16 a[8:9], v205 offset:49152
    s_add_u32 s19, s25, 6
    s_and_b32 s19, s19, 7
    s_mul_i32 s19, s19, 196608
    s_add_u32 m0, s15, 90112
    s_add_u32 s18, s19, s39
    buffer_load_dwordx4 v12, s[56:59], s18 offen lds
    v_mfma_f32_32x32x16_bf16 v[160:175], v[100:103], a[44:47], v[160:175]
    ds_read_b64_tr_b16 a[10:11], v205 offset:49408
    ds_read_b64_tr_b16 a[12:13], v205 offset:50176
    ds_read_b64_tr_b16 a[14:15], v205 offset:50432
    s_add_u32 s19, s25, 7
    s_and_b32 s19, s19, 7
    s_mul_i32 s19, s19, 196608
    s_add_u32 m0, s15, 94208
    s_add_u32 s18, s19, s39
    buffer_load_dwordx4 v12, s[56:59], s18 offen lds
    v_mfma_f32_32x32x16_bf16 v[144:159], a[48:51], v[104:107], v[144:159]
    ds_read_b64_tr_b16 a[16:17], v206 offset:49152
    ds_read_b64_tr_b16 a[18:19], v206 offset:49408
    ds_read_b64_tr_b16 a[20:21], v206 offset:50176
    s_add_u32 m0, s84, 0
    s_nop 0
    global_load_lds_dwordx4 v[4:5], off
    v_mfma_f32_32x32x16_bf16 v[160:175], v[104:107], a[52:55], v[160:175]
    ds_read_b64_tr_b16 a[22:23], v206 offset:50432
    ds_read_b64_tr_b16 a[24:25], v207 offset:49152
    ds_read_b64_tr_b16 a[26:27], v207 offset:49408
    s_add_u32 m0, s84, 1024
    v_lshl_add_u64 v[4:5], v[4:5], 0, s[86:87]
    global_load_lds_dwordx4 v[4:5], off
    v_mfma_f32_32x32x16_bf16 v[144:159], a[56:59], v[108:111], v[144:159]
    ds_read_b64_tr_b16 a[28:29], v207 offset:50176
    ds_read_b64_tr_b16 a[30:31], v207 offset:50432
    v_mfma_f32_32x32x16_bf16 v[160:175], v[108:111], a[60:63], v[160:175]
    s_waitcnt lgkmcnt(14)
    v_dot2c_f32_bf16 v192, v220, v112
    v_dot2c_f32_bf16 v193, v112, v112
    v_dot2c_f32_bf16 v194, v220, v113
    v_dot2c_f32_bf16 v195, v113, v113
    v_dot2c_f32_bf16 v192, v220, v114
    v_dot2c_f32_bf16 v193, v114, v114
    v_dot2c_f32_bf16 v194, v220, v115
    v_dot2c_f32_bf16 v195, v115, v115
    v_dot2c_f32_bf16 v192, v220, v116
    v_dot2c_f32_bf16 v193, v116, v116
    v_dot2c_f32_bf16 v194, v220, v117
    v_dot2c_f32_bf16 v195, v117, v117
    v_dot2c_f32_bf16 v192, v220, v118
    v_dot2c_f32_bf16 v193, v118, v118
    v_dot2c_f32_bf16 v194, v220, v119
    v_dot2c_f32_bf16 v195, v119, v119
    v_dot2c_f32_bf16 v192, v220, v120
    v_dot2c_f32_bf16 v193, v120, v120
    v_dot2c_f32_bf16 v194, v220, v121
    v_dot2c_f32_bf16 v195, v121, v121
    v_dot2c_f32_bf16 v192, v220, v122
    v_dot2c_f32_bf16 v193, v122, v122
    v_dot2c_f32_bf16 v194, v220, v123
    v_dot2c_f32_bf16 v195, v123, v123
    v_dot2c_f32_bf16 v192, v220, v124
    v_dot2c_f32_bf16 v193, v124, v124
    v_dot2c_f32_bf16 v194, v220, v125
    v_dot2c_f32_bf16 v195, v125, v125
    v_dot2c_f32_bf16 v192, v220, v126
    v_dot2c_f32_bf16 v193, v126, v126
    v_dot2c_f32_bf16 v194, v220, v127
    v_dot2c_f32_bf16 v195, v127, v127
    s_waitcnt lgkmcnt(0)
    s_waitcnt vmcnt(10)
    s_barrier
    v_mfma_f32_32x32x16_bf16 v[144:159], a[0:3], v[112:115], v[144:159]
    ds_read_b128 v[128:131], v196 offset:12288
    ds_read_b128 v[132:135], v197 offset:12288
    ds_read_b128 v[136:139], v198 offset:12288
    v_mfma_f32_16x16x32_bf16 a[100:103], a[96:99], a[0:3], a[100:103]
    s_add_u32 m0, s84, 2048
    v_lshl_add_u64 v[4:5], v[4:5], 0, s[86:87]
    global_load_lds_dwordx4 v[4:5], off
    v_mfma_f32_32x32x16_bf16 v[160:175], v[112:115], a[4:7], v[160:175]
    ds_read_b128 v[140:143], v199 offset:12288
    ds_read_b64_tr_b16 a[32:33], v204 offset:57344
    ds_read_b64_tr_b16 a[34:35], v204 offset:57600
    v_mfma_f32_16x16x32_bf16 a[104:107], a[96:99], a[4:7], a[104:107]
    s_add_u32 m0, s84, 3072
    v_lshl_add_u64 v[4:5], v[4:5], 0, s[86:87]
    global_load_lds_dwordx4 v[4:5], off
    v_mfma_f32_32x32x16_bf16 v[144:159], a[8:11], v[116:119], v[144:159]
    ds_read_b64_tr_b16 a[36:37], v204 offset:58368
    ds_read_b64_tr_b16 a[38:39], v204 offset:58624
    ds_read_b64_tr_b16 a[40:41], v205 offset:57344
    s_add_u32 m0, s84, 4096
    v_lshl_add_u64 v[4:5], v[4:5], 0, s[86:87]
    global_load_lds_dwordx4 v[4:5], off
    v_mfma_f32_32x32x16_bf16 v[160:175], v[116:119], a[12:15], v[160:175]
    ds_read_b64_tr_b16 a[42:43], v205 offset:57600
    ds_read_b64_tr_b16 a[44:45], v205 offset:58368
    ds_read_b64_tr_b16 a[46:47], v205 offset:58624
    s_add_u32 m0, s84, 5120
    v_lshl_add_u64 v[4:5], v[4:5], 0, s[86:87]
    global_load_lds_dwordx4 v[4:5], off
    v_mfma_f32_32x32x16_bf16 v[144:159], a[16:19], v[120:123], v[144:159]
    ds_read_b64_tr_b16 a[48:49], v206 offset:57344
    ds_read_b64_tr_b16 a[50:51], v206 offset:57600
    ds_read_b64_tr_b16 a[52:53], v206 offset:58368
    s_add_u32 m0, s84, 6144
    v_lshl_add_u64 v[4:5], v[4:5], 0, s[86:87]
    global_load_lds_dwordx4 v[4:5], off
    v_mfma_f32_32x32x16_bf16 v[160:175], v[120:123], a[20:23], v[160:175]
    ds_read_b64_tr_b16 a[54:55], v206 offset:58624
    ds_read_b64_tr_b16 a[56:57], v207 offset:57344
    ds_read_b64_tr_b16 a[58:59], v207 offset:57600
    s_add_u32 m0, s84, 7168
    v_lshl_add_u64 v[4:5], v[4:5], 0, s[86:87]
    global_load_lds_dwordx4 v[4:5], off
    v_mfma_f32_32x32x16_bf16 v[144:159], a[24:27], v[124:127], v[144:159]
    ds_read_b64_tr_b16 a[60:61], v207 offset:58368
    ds_read_b64_tr_b16 a[62:63], v207 offset:58624
    v_mfma_f32_32x32x16_bf16 v[160:175], v[124:127], a[28:31], v[160:175]
    s_waitcnt lgkmcnt(14)
    v_dot2c_f32_bf16 v192, v220, v128
    v_dot2c_f32_bf16 v193, v128, v128
    v_dot2c_f32_bf16 v194, v220, v129
    v_dot2c_f32_bf16 v195, v129, v129
    v_dot2c_f32_bf16 v192, v220, v130
    v_dot2c_f32_bf16 v193, v130, v130
    v_dot2c_f32_bf16 v194, v220, v131
    v_dot2c_f32_bf16 v195, v131, v131
    v_dot2c_f32_bf16 v192, v220, v132
    v_dot2c_f32_bf16 v193, v132, v132
    v_dot2c_f32_bf16 v194, v220, v133
    v_dot2c_f32_bf16 v195, v133, v133
    v_dot2c_f32_bf16 v192, v220, v134
    v_dot2c_f32_bf16 v193, v134, v134
    v_dot2c_f32_bf16 v194, v220, v135
    v_dot2c_f32_bf16 v195, v135, v135
    v_dot2c_f32_bf16 v192, v220, v136
    v_dot2c_f32_bf16 v193, v136, v136
    v_dot2c_f32_bf16 v194, v220, v137
    v_dot2c_f32_bf16 v195, v137, v137
    v_dot2c_f32_bf16 v192, v220, v138
    v_dot2c_f32_bf16 v193, v138, v138
    v_dot2c_f32_bf16 v194, v220, v139
    v_dot2c_f32_bf16 v195, v139, v139
    v_dot2c_f32_bf16 v192, v220, v140
    v_dot2c_f32_bf16 v193, v140, v140
    v_dot2c_f32_bf16 v194, v220, v141
    v_dot2c_f32_bf16 v195, v141, v141
    v_dot2c_f32_bf16 v192, v220, v142
    v_dot2c_f32_bf16 v193, v142, v142
    v_dot2c_f32_bf16 v194, v220, v143
    v_dot2c_f32_bf16 v195, v143, v143
    s_waitcnt lgkmcnt(0)
    s_waitcnt vmcnt(8)
    s_barrier
    v_mfma_f32_16x16x32_bf16 a[100:103], a[96:99], a[32:35], a[100:103]
    v_mfma_f32_16x16x32_bf16 a[104:107], a[96:99], a[36:39], a[104:107]
    v_mfma_f32_32x32x16_bf16 v[144:159], a[32:35], v[128:131], v[144:159]
    v_add_f32 v192, v192, v194
    v_add_f32 v193, v193, v195
    v_mov_b32 v194, v192
    v_mov_b32 v195, v193
    s_nop 0
    v_permlane32_swap_b32 v192, v194
    v_permlane32_swap_b32 v193, v195
    v_add_f32 v192, v192, v194
    v_add_f32 v193, v193, v195
    v_accvgpr_read_b32 v206, a100
    v_mfma_f32_32x32x16_bf16 v[160:175], v[128:131], a[36:39], v[160:175]
    v_accvgpr_read_b32 v207, a101
    s_nop 1
    v_permlane16_swap_b32 v206, v207
    v_cvt_pk_bf16_f32 v205, v206, 0
    v_lshlrev_b32 v207, 16, v205
    v_sub_f32 v206, v206, v207
    v_cvt_pk_bf16_f32 v204, v207, v206
    s_mov_b32 exec_hi, 0
    ds_write_b64 v221, v[204:205] offset:40960
    s_mov_b64 exec, -1
    v_accvgpr_read_b32 v210, a104
    v_accvgpr_read_b32 v211, a105
    v_mfma_f32_32x32x16_bf16 v[144:159], a[40:43], v[132:135], v[144:159]
    s_nop 0
    v_permlane16_swap_b32 v210, v211
    v_cvt_pk_bf16_f32 v209, v210, 0
    v_lshlrev_b32 v211, 16, v209
    v_sub_f32 v210, v210, v211
    v_cvt_pk_bf16_f32 v208, v211, v210
    s_mov_b32 exec_hi, 0
    ds_write_b64 v221, v[208:209] offset:41984
    s_mov_b64 exec, -1
    v_mul_f32 v192, 0xbb000000, v192
    v_mul_f32 v193, 0x3b000000, v193
    v_fma_f32 v193, -v192, v192, v193
    v_mfma_f32_32x32x16_bf16 v[160:175], v[132:135], a[44:47], v[160:175]
    v_max_f32 v193, 0, v193
    v_cvt_pk_bf16_f32 v193, v193, 0
    v_lshlrev_b32 v193, 16, v193
    v_add_f32 v193, 0x3727c5ac, v193
    v_cvt_pk_bf16_f32 v193, v193, 0
    v_lshlrev_b32 v193, 16, v193
    v_sqrt_f32 v193, v193
    v_cvt_pk_bf16_f32 v8, v192, v192
    v_cvt_pk_bf16_f32 v193, v193, 0
    v_mfma_f32_32x32x16_bf16 v[144:159], a[48:51], v[136:139], v[144:159]
    v_lshlrev_b32 v193, 16, v193
    v_rcp_f32 v6, v193
    v_mov_b32 v9, 0
    v_mov_b32 v10, v8
    v_mov_b32 v11, 0
    v_cvt_pk_bf16_f32 v224, v6, 0
    s_waitcnt lgkmcnt(0)
    s_barrier
    ds_read_b128 v[204:207], v1 offset:40960
    v_mfma_f32_32x32x16_bf16 v[160:175], v[136:139], a[52:55], v[160:175]
    ds_read_b128 v[208:211], v1 offset:41984
    v_lshlrev_b32 v225, 16, v224
    v_sub_f32 v226, v6, v225
    v_cvt_pk_bf16_f32 v224, v225, v226
    v_mov_b32 v225, 0
    v_mov_b32 v226, 0
    v_mov_b32 v227, 0
    v_cmp_gt_u32 vcc, 512, v1
    v_mov_b32 v228, 0x3f803f80
    v_mfma_f32_32x32x16_bf16 v[144:159], a[56:59], v[140:143], v[144:159]
    v_cndmask_b32 v228, 0, v228, vcc
    v_mov_b32 v229, 0
    v_mov_b32 v230, 0
    v_mov_b32 v231, 0
    v_mul_f32 v7, 0x3eb8aa3b, v6
    v_bfe_u32 v12, v0, 4, 1
    v_lshlrev_b32 v12, 17, v12
    v_and_b32 v13, 15, v0
    v_lshlrev_b32 v13, 4, v13
    v_mfma_f32_32x32x16_bf16 v[160:175], v[140:143], a[60:63], v[160:175]
    v_add_u32 v12, v12, v13
    v_bfe_u32 v13, v0, 5, 1
    v_lshlrev_b32 v13, 8, v13
    v_add_u32 v12, v12, v13
    v_mfma_f32_32x32x16_bf16 v[232:247], v[224:227], v[228:231], 0
    s_lshl_b32 s25, s23, 18
    s_lshl_b32 s17, s22, 11
    s_add_u32 s25, s25, s17
    ds_read_b64_tr_b16 a[64:65], v200 offset:0
    ds_read_b64_tr_b16 a[66:67], v200 offset:256
    ds_read_b64_tr_b16 a[68:69], v200 offset:4096
    ds_read_b64_tr_b16 a[70:71], v200 offset:4352
    ds_read_b64_tr_b16 a[72:73], v200 offset:8192
    ds_read_b64_tr_b16 a[74:75], v200 offset:8448
    ds_read_b64_tr_b16 a[76:77], v200 offset:12288
    ds_read_b64_tr_b16 a[78:79], v200 offset:12544
    s_waitcnt lgkmcnt(8)
    v_mfma_f32_32x32x16_bf16 v[144:159], v[204:207], v[8:11], v[144:159]
    v_mfma_f32_32x32x16_bf16 v[160:175], v[8:11], v[208:211], v[160:175]
    v_bfe_u32 v218, v0, 4, 1
    v_lshl_add_u32 v218, v218, 11, v249
    s_mul_i32 s19, s12, 6144
    s_add_u32 s19, s19, 114688
    v_add_u32 v212, s19, v1
    v_add_u32 v213, s19, v218
    s_lshr_b32 s19, s12, 1
    s_mul_i32 s19, s19, 12288
    s_and_b32 s16, s12, 1
    s_lshl_b32 s16, s16, 10
    s_add_u32 s18, s16, 114688
    s_add_u32 s17, s18, s19
    v_add_u32 v214, s17, v1
    s_sub_u32 s18, s18, s19
    v_add_u32 v215, s18, v1
    s_add_u32 s17, s17, s16
    v_add_u32 v216, s17, v248
    v_add_u32 v217, s17, v249
    s_waitcnt lgkmcnt(6)
    v_mfma_f32_32x32x16_bf16 v[176:191], a[64:67], v[16:19], 0
    ds_read_b64_tr_b16 a[80:81], v200 offset:16384
    ds_read_b64_tr_b16 a[82:83], v200 offset:16640
    v_mfma_f32_16x16x32_bf16 a[108:111], a[96:99], a[64:67], 0
    v_mul_f32 v144, v144, v6
    v_mul_f32 v145, v145, v6
    v_cvt_pk_bf16_f32 v192, v144, v145
    v_mul_f32 v146, v146, v6
    v_mul_f32 v147, v147, v6
    s_waitcnt lgkmcnt(6)
    v_mfma_f32_32x32x16_bf16 v[176:191], a[68:71], v[32:35], v[176:191]
    ds_read_b64_tr_b16 a[84:85], v200 offset:20480
    ds_read_b64_tr_b16 a[86:87], v200 offset:20736
    v_mfma_f32_16x16x32_bf16 a[108:111], a[96:99], a[68:71], a[108:111]
    v_cvt_pk_bf16_f32 v193, v146, v147
    v_mul_f32 v148, v148, v6
    v_mul_f32 v149, v149, v6
    v_cvt_pk_bf16_f32 v194, v148, v149
    v_mul_f32 v150, v150, v6
    s_waitcnt lgkmcnt(6)
    v_mfma_f32_32x32x16_bf16 v[176:191], a[72:75], v[48:51], v[176:191]
    ds_read_b64_tr_b16 a[88:89], v200 offset:24576
    ds_read_b64_tr_b16 a[90:91], v200 offset:24832
    v_mfma_f32_16x16x32_bf16 a[108:111], a[96:99], a[72:75], a[108:111]
    v_mul_f32 v151, v151, v6
    v_cvt_pk_bf16_f32 v195, v150, v151
    s_add_u32 s18, s25, 18874368
    buffer_store_dwordx4 v[192:195], v1, s[4:7], s18 offen sc1
    v_mul_f32 v152, v152, v6
    s_waitcnt lgkmcnt(6)
    v_mfma_f32_32x32x16_bf16 v[176:191], a[76:79], v[64:67], v[176:191]
    ds_read_b64_tr_b16 a[92:93], v200 offset:28672
    ds_read_b64_tr_b16 a[94:95], v200 offset:28928
    v_mfma_f32_16x16x32_bf16 a[108:111], a[96:99], a[76:79], a[108:111]
    v_mul_f32 v153, v153, v6
    v_cvt_pk_bf16_f32 v196, v152, v153
    v_mul_f32 v154, v154, v6
    v_mul_f32 v155, v155, v6
    v_cvt_pk_bf16_f32 v197, v154, v155
    s_waitcnt lgkmcnt(6)
    v_mfma_f32_32x32x16_bf16 v[176:191], a[80:83], v[80:83], v[176:191]
    ds_read_b64_tr_b16 a[64:65], v201 offset:0
    ds_read_b64_tr_b16 a[66:67], v201 offset:256
    v_mfma_f32_16x16x32_bf16 a[108:111], a[96:99], a[80:83], a[108:111]
    v_mul_f32 v156, v156, v6
    v_mul_f32 v157, v157, v6
    v_cvt_pk_bf16_f32 v198, v156, v157
    v_mul_f32 v158, v158, v6
    v_mul_f32 v159, v159, v6
    s_waitcnt lgkmcnt(6)
    v_mfma_f32_32x32x16_bf16 v[176:191], a[84:87], v[96:99], v[176:191]
    ds_read_b64_tr_b16 a[68:69], v202 offset:0
    ds_read_b64_tr_b16 a[70:71], v202 offset:256
    v_mfma_f32_16x16x32_bf16 a[108:111], a[96:99], a[84:87], a[108:111]
    v_cvt_pk_bf16_f32 v199, v158, v159
    s_add_u32 s18, s25, 19005440
    buffer_store_dwordx4 v[196:199], v1, s[4:7], s18 offen sc1
    s_add_u32 s18, s25, 18875392
    v_mul_f32 v160, v160, v232
    s_waitcnt lgkmcnt(6)
    v_mfma_f32_32x32x16_bf16 v[176:191], a[88:91], v[112:115], v[176:191]
    ds_read_b64_tr_b16 a[72:73], v203 offset:0
    ds_read_b64_tr_b16 a[74:75], v203 offset:256
    v_mfma_f32_16x16x32_bf16 a[108:111], a[96:99], a[88:91], a[108:111]
    v_mul_f32 v161, v161, v233
    v_cvt_pk_bf16_f32 v204, v160, v161
    v_mul_f32 v162, v162, v234
    v_mul_f32 v163, v163, v235
    v_cvt_pk_bf16_f32 v205, v162, v163
    s_waitcnt lgkmcnt(6)
    v_mfma_f32_32x32x16_bf16 v[176:191], a[92:95], v[128:131], v[176:191]
    ds_read_b64_tr_b16 a[76:77], v201 offset:4096
    ds_read_b64_tr_b16 a[78:79], v201 offset:4352
    v_mfma_f32_16x16x32_bf16 a[108:111], a[96:99], a[92:95], a[108:111]
    v_mul_f32 v164, v164, v236
    v_mul_f32 v165, v165, v237
    v_cvt_pk_bf16_f32 v206, v164, v165
    v_mul_f32 v166, v166, v238
    v_mul_f32 v167, v167, v239
    s_waitcnt lgkmcnt(6)
    v_mfma_f32_32x32x16_bf16 v[176:191], a[64:67], v[20:23], v[176:191]
    ds_read_b64_tr_b16 a[80:81], v202 offset:4096
    ds_read_b64_tr_b16 a[82:83], v202 offset:4352
    v_cvt_pk_bf16_f32 v207, v166, v167
    buffer_store_dwordx4 v[204:207], v12, s[4:7], s18 offen offset:0 sc1
    v_mul_f32 v168, v168, v240
    v_mul_f32 v169, v169, v241
    v_cvt_pk_bf16_f32 v208, v168, v169
    s_waitcnt lgkmcnt(6)
    v_mfma_f32_32x32x16_bf16 v[176:191], a[68:71], v[24:27], v[176:191]
    ds_read_b64_tr_b16 a[84:85], v203 offset:4096
    ds_read_b64_tr_b16 a[86:87], v203 offset:4352
    v_mul_f32 v170, v170, v242
    v_mul_f32 v171, v171, v243
    v_cvt_pk_bf16_f32 v209, v170, v171
    v_mul_f32 v172, v172, v244
    v_mul_f32 v173, v173, v245
    s_waitcnt lgkmcnt(6)
    v_mfma_f32_32x32x16_bf16 v[176:191], a[72:75], v[28:31], v[176:191]
    ds_read_b64_tr_b16 a[88:89], v201 offset:8192
    ds_read_b64_tr_b16 a[90:91], v201 offset:8448
    v_cvt_pk_bf16_f32 v210, v172, v173
    v_mul_f32 v174, v174, v246
    v_mul_f32 v175, v175, v247
    v_cvt_pk_bf16_f32 v211, v174, v175
    buffer_store_dwordx4 v[208:211], v12, s[4:7], s18 offen offset:512 sc1
    s_waitcnt lgkmcnt(6)
    v_mfma_f32_32x32x16_bf16 v[176:191], a[76:79], v[36:39], v[176:191]
    ds_read_b64_tr_b16 a[92:93], v202 offset:8192
    ds_read_b64_tr_b16 a[94:95], v202 offset:8448
    ds_write_b128 v212, v[192:195]
    ds_write_b128 v212, v[196:199] offset:2048
    ds_write_b128 v213, v[204:207] offset:1024
    ds_write_b128 v213, v[208:211] offset:1536
    s_waitcnt lgkmcnt(10)
    v_mfma_f32_32x32x16_bf16 v[176:191], a[80:83], v[40:43], v[176:191]
    ds_read_b64_tr_b16 a[64:65], v203 offset:8192
    ds_read_b64_tr_b16 a[66:67], v203 offset:8448
    v_accvgpr_read_b32 v242, a108
    v_accvgpr_read_b32 v243, a109
    s_nop 1
    v_permlane16_swap_b32 v242, v243
    v_cvt_pk_bf16_f32 v241, v242, 0
    v_lshlrev_b32 v243, 16, v241
    s_waitcnt lgkmcnt(10)
    v_mfma_f32_32x32x16_bf16 v[176:191], a[84:87], v[44:47], v[176:191]
    ds_read_b64_tr_b16 a[68:69], v201 offset:12288
    ds_read_b64_tr_b16 a[70:71], v201 offset:12544
    v_sub_f32 v242, v242, v243
    v_cvt_pk_bf16_f32 v240, v243, v242
    s_mov_b32 exec_hi, 0
    ds_write_b64 v221, v[240:241] offset:43008
    s_mov_b64 exec, -1
    s_waitcnt lgkmcnt(10)
    v_mfma_f32_32x32x16_bf16 v[176:191], a[88:91], v[52:55], v[176:191]
    ds_read_b64_tr_b16 a[72:73], v202 offset:12288
    ds_read_b64_tr_b16 a[74:75], v202 offset:12544
    s_waitcnt lgkmcnt(10)
    v_mfma_f32_32x32x16_bf16 v[176:191], a[92:95], v[56:59], v[176:191]
    ds_read_b64_tr_b16 a[76:77], v203 offset:12288
    ds_read_b64_tr_b16 a[78:79], v203 offset:12544
    s_waitcnt lgkmcnt(6)
    v_mfma_f32_32x32x16_bf16 v[176:191], a[64:67], v[60:63], v[176:191]
    ds_read_b64_tr_b16 a[80:81], v201 offset:16384
    ds_read_b64_tr_b16 a[82:83], v201 offset:16640
    s_waitcnt lgkmcnt(6)
    v_mfma_f32_32x32x16_bf16 v[176:191], a[68:71], v[68:71], v[176:191]
    ds_read_b64_tr_b16 a[84:85], v202 offset:16384
    ds_read_b64_tr_b16 a[86:87], v202 offset:16640
    s_waitcnt lgkmcnt(6)
    v_mfma_f32_32x32x16_bf16 v[176:191], a[72:75], v[72:75], v[176:191]
    ds_read_b64_tr_b16 a[88:89], v203 offset:16384
    ds_read_b64_tr_b16 a[90:91], v203 offset:16640
    s_waitcnt lgkmcnt(6)
    v_mfma_f32_32x32x16_bf16 v[176:191], a[76:79], v[76:79], v[176:191]
    ds_read_b64_tr_b16 a[92:93], v201 offset:20480
    ds_read_b64_tr_b16 a[94:95], v201 offset:20736
    s_waitcnt lgkmcnt(6)
    v_mfma_f32_32x32x16_bf16 v[176:191], a[80:83], v[84:87], v[176:191]
    ds_read_b64_tr_b16 a[64:65], v202 offset:20480
    ds_read_b64_tr_b16 a[66:67], v202 offset:20736
    s_waitcnt lgkmcnt(6)
    v_mfma_f32_32x32x16_bf16 v[176:191], a[84:87], v[88:91], v[176:191]
    ds_read_b64_tr_b16 a[68:69], v203 offset:20480
    ds_read_b64_tr_b16 a[70:71], v203 offset:20736
    s_waitcnt lgkmcnt(6)
    v_mfma_f32_32x32x16_bf16 v[176:191], a[88:91], v[92:95], v[176:191]
    ds_read_b64_tr_b16 a[72:73], v201 offset:24576
    ds_read_b64_tr_b16 a[74:75], v201 offset:24832
    s_waitcnt lgkmcnt(6)
    v_mfma_f32_32x32x16_bf16 v[176:191], a[92:95], v[100:103], v[176:191]
    ds_read_b64_tr_b16 a[76:77], v202 offset:24576
    ds_read_b64_tr_b16 a[78:79], v202 offset:24832
    s_waitcnt lgkmcnt(6)
    v_mfma_f32_32x32x16_bf16 v[176:191], a[64:67], v[104:107], v[176:191]
    ds_read_b64_tr_b16 a[80:81], v203 offset:24576
    ds_read_b64_tr_b16 a[82:83], v203 offset:24832
    s_waitcnt lgkmcnt(6)
    v_mfma_f32_32x32x16_bf16 v[176:191], a[68:71], v[108:111], v[176:191]
    ds_read_b64_tr_b16 a[84:85], v201 offset:28672
    ds_read_b64_tr_b16 a[86:87], v201 offset:28928
    s_waitcnt lgkmcnt(6)
    v_mfma_f32_32x32x16_bf16 v[176:191], a[72:75], v[116:119], v[176:191]
    ds_read_b64_tr_b16 a[88:89], v202 offset:28672
    ds_read_b64_tr_b16 a[90:91], v202 offset:28928
    s_waitcnt lgkmcnt(6)
    v_mfma_f32_32x32x16_bf16 v[176:191], a[76:79], v[120:123], v[176:191]
    ds_read_b64_tr_b16 a[92:93], v203 offset:28672
    ds_read_b64_tr_b16 a[94:95], v203 offset:28928
    s_waitcnt lgkmcnt(6)
    v_mfma_f32_32x32x16_bf16 v[176:191], a[80:83], v[124:127], v[176:191]
    s_waitcnt lgkmcnt(4)
    v_mfma_f32_32x32x16_bf16 v[176:191], a[84:87], v[132:135], v[176:191]
    s_waitcnt lgkmcnt(0)
    s_lshl_b32 s41, s23, 4
    s_lshr_b32 s17, s22, 2
    s_add_u32 s41, s41, s17
    s_lshl_b32 s41, s41, 7
    s_add_u32 s41, s41, 8212480
    v_mov_b32 v13, 0
    v_mov_b32 v14, s32
    v_mov_b32 v15, s33
    s_waitcnt vmcnt(0)
    s_barrier
    s_cmp_lg_u32 s12, 0
    s_cbranch_scc1 pw_1
    s_mov_b64 exec, 1
    buffer_store_dwordx2 v[14:15], v13, s[4:7], s41 offen sc1
    s_mov_b64 exec, -1
pw_1:
    ds_read_b128 v[240:243], v1 offset:43008
    v_mfma_f32_32x32x16_bf16 v[176:191], a[88:91], v[136:139], v[176:191]
    v_mfma_f32_32x32x16_bf16 v[176:191], a[92:95], v[140:143], v[176:191]
    s_waitcnt lgkmcnt(0)
    v_mfma_f32_32x32x16_bf16 v[176:191], v[240:243], v[8:11], v[176:191]
    v_mov_b32 v224, 0
    s_nop 1
    v_mfma_f32_32x32x16_bf16 v[16:31], v[228:231], v[224:227], 0
    v_mfma_f32_32x32x16_bf16 v[32:47], v[228:231], v[224:227], 0
    v_mfma_f32_32x32x16_bf16 v[48:63], v[228:231], v[224:227], 0
    v_mfma_f32_32x32x16_bf16 v[64:79], v[228:231], v[224:227], 0
    v_mov_b32 v224, v254
    s_nop 3
    v_mul_f32 v176, v176, v7
    v_mul_f32 v177, v177, v7
    v_cvt_pk_bf16_f32 v232, v176, v177
    v_mfma_f32_32x32x16_bf16 v[80:95], v[228:231], v[224:227], 0
    v_mul_f32 v178, v178, v7
    v_mul_f32 v179, v179, v7
    v_cvt_pk_bf16_f32 v233, v178, v179
    v_mfma_f32_32x32x16_bf16 v[96:111], v[228:231], v[224:227], 0
    v_mul_f32 v180, v180, v7
    v_mul_f32 v181, v181, v7
    v_cvt_pk_bf16_f32 v234, v180, v181
    v_mfma_f32_32x32x16_bf16 v[112:127], v[228:231], v[224:227], 0
    v_mul_f32 v182, v182, v7
    v_mul_f32 v183, v183, v7
    v_cvt_pk_bf16_f32 v235, v182, v183
    v_mfma_f32_32x32x16_bf16 v[128:143], v[228:231], v[224:227], 0
    ds_write_b128 v212, v[232:235] offset:4096
    v_mul_f32 v184, v184, v7
    v_mul_f32 v185, v185, v7
    v_cvt_pk_bf16_f32 v236, v184, v185
    v_mfma_f32_32x32x16_bf16 v[144:159], v[228:231], v[224:227], 0
    v_mul_f32 v186, v186, v7
    v_mul_f32 v187, v187, v7
    v_cvt_pk_bf16_f32 v237, v186, v187
    v_mfma_f32_32x32x16_bf16 v[160:175], v[228:231], v[224:227], 0
    v_mul_f32 v188, v188, v7
    v_mul_f32 v189, v189, v7
    v_cvt_pk_bf16_f32 v238, v188, v189
    v_mul_f32 v190, v190, v7
    v_mul_f32 v191, v191, v7
    v_cvt_pk_bf16_f32 v239, v190, v191
    ds_write_b128 v212, v[236:239] offset:5120
    s_waitcnt lgkmcnt(0)
    s_barrier
    ds_read_b128 v[80:83], v216
    ds_read_b128 a[224:227], v214 offset:4096
    ds_read_b128 a[228:231], v214 offset:10240
    ds_read_b128 a[232:235], v215 offset:16384
    ds_read_b128 a[236:239], v215 offset:22528
    s_mov_b64 exec, s[30:31]
    ds_read_b128 v[84:87], v217 offset:1024
    ds_read_b128 v[88:91], v217 offset:1536
    ds_read_b128 v[96:99], v217 offset:7168
    ds_read_b128 v[100:103], v217 offset:7680
    s_mov_b64 exec, -1
    ds_read_b128 v[92:95], v216 offset:6144
    s_waitcnt lgkmcnt(8)
    v_mfma_f32_32x32x16_bf16 v[176:191], v[80:83], a[224:227], 0
    s_waitcnt lgkmcnt(7)
    v_mfma_f32_32x32x16_bf16 v[192:207], v[80:83], a[228:231], 0
    s_waitcnt lgkmcnt(6)
    v_mfma_f32_32x32x16_bf16 v[208:223], v[80:83], a[232:235], 0
    s_nop 7
    v_exp_f32 v176, v176
    v_exp_f32 v177, v177
    v_exp_f32 v178, v178
    v_exp_f32 v179, v179
    v_exp_f32 v180, v180
    v_exp_f32 v181, v181
    s_waitcnt lgkmcnt(5)
    v_mfma_f32_32x32x16_bf16 v[224:239], v[80:83], a[236:239], 0
    v_exp_f32 v182, v182
    v_exp_f32 v183, v183
    v_exp_f32 v184, v184
    v_exp_f32 v185, v185
    s_waitcnt lgkmcnt(1)
    v_smfmac_f32_32x32x32_bf16 v[16:31], v[84:87], v[176:183], v250
    buffer_load_dwordx2 v[10:11], v253, s[4:7], s68 offen sc1
    v_exp_f32 v186, v186
    v_exp_f32 v187, v187
    v_exp_f32 v188, v188
    v_exp_f32 v189, v189
    v_exp_f32 v190, v190
    v_exp_f32 v191, v191
    v_exp_f32 v192, v192
    v_exp_f32 v193, v193
    v_smfmac_f32_32x32x32_bf16 v[16:31], v[88:91], v[184:191], v250
    v_exp_f32 v194, v194
    v_exp_f32 v195, v195
    v_exp_f32 v196, v196
    v_exp_f32 v197, v197
    s_waitcnt lgkmcnt(0)
    v_mfma_f32_32x32x16_bf16 v[176:191], v[92:95], a[224:227], 0
    v_exp_f32 v198, v198
    v_exp_f32 v199, v199
    v_exp_f32 v200, v200
    v_exp_f32 v201, v201
    v_smfmac_f32_32x32x32_bf16 v[32:47], v[84:87], v[192:199], v250
    v_exp_f32 v202, v202
    v_exp_f32 v203, v203
    v_exp_f32 v204, v204
    v_exp_f32 v205, v205
    v_exp_f32 v206, v206
    v_exp_f32 v207, v207
    v_exp_f32 v208, v208
    v_exp_f32 v209, v209
    v_smfmac_f32_32x32x32_bf16 v[32:47], v[88:91], v[200:207], v250
    v_exp_f32 v210, v210
    v_exp_f32 v211, v211
    v_exp_f32 v212, v212
    v_exp_f32 v213, v213
    v_mfma_f32_32x32x16_bf16 v[192:207], v[92:95], a[228:231], 0
    v_exp_f32 v214, v214
    v_exp_f32 v215, v215
    v_exp_f32 v216, v216
    v_exp_f32 v217, v217
    v_smfmac_f32_32x32x32_bf16 v[48:63], v[84:87], v[208:215], v250
    s_waitcnt vmcnt(0)
    v_cmp_ne_u64 vcc, s[32:33], v[10:11]
    s_nop 0
    s_and_b32 s19, vcc_lo, 0xe
    s_cbranch_scc1 ap_2
apok_3:
    s_xor_b32 s24, s69, 8192
    buffer_load_dwordx4 v[104:107], v248, s[4:7], s24 offen offset:0 sc1
    buffer_load_dwordx4 v[116:119], v248, s[4:7], s24 offen offset:2048 sc1
    s_mov_b64 exec, s[30:31]
    buffer_load_dwordx4 v[108:111], v249, s[4:7], s24 offen offset:1024 sc1
    buffer_load_dwordx4 v[112:115], v249, s[4:7], s24 offen offset:1536 sc1
    buffer_load_dwordx4 v[120:123], v249, s[4:7], s24 offen offset:3072 sc1
    buffer_load_dwordx4 v[124:127], v249, s[4:7], s24 offen offset:3584 sc1
    s_mov_b64 exec, -1
    v_exp_f32 v218, v218
    v_exp_f32 v219, v219
    v_exp_f32 v220, v220
    v_exp_f32 v221, v221
    v_exp_f32 v222, v222
    v_exp_f32 v223, v223
    v_exp_f32 v224, v224
    v_exp_f32 v225, v225
    v_smfmac_f32_32x32x32_bf16 v[48:63], v[88:91], v[216:223], v250
    v_exp_f32 v226, v226
    v_exp_f32 v227, v227
    v_exp_f32 v228, v228
    v_exp_f32 v229, v229
    v_mfma_f32_32x32x16_bf16 v[208:223], v[92:95], a[232:235], 0
    v_exp_f32 v230, v230
    v_exp_f32 v231, v231
    v_exp_f32 v232, v232
    v_exp_f32 v233, v233
    v_smfmac_f32_32x32x32_bf16 v[64:79], v[84:87], v[224:231], v250
    s_xor_b32 s24, s69, 16384
    buffer_load_dwordx4 v[128:131], v248, s[4:7], s24 offen offset:0 sc1
    buffer_load_dwordx4 v[140:143], v248, s[4:7], s24 offen offset:2048 sc1
    s_mov_b64 exec, s[30:31]
    buffer_load_dwordx4 v[132:135], v249, s[4:7], s24 offen offset:1024 sc1
    buffer_load_dwordx4 v[136:139], v249, s[4:7], s24 offen offset:1536 sc1
    buffer_load_dwordx4 v[144:147], v249, s[4:7], s24 offen offset:3072 sc1
    buffer_load_dwordx4 v[148:151], v249, s[4:7], s24 offen offset:3584 sc1
    s_mov_b64 exec, -1
    v_exp_f32 v234, v234
    v_exp_f32 v235, v235
    v_exp_f32 v236, v236
    v_exp_f32 v237, v237
    v_exp_f32 v238, v238
    v_exp_f32 v239, v239
    v_exp_f32 v176, v176
    v_exp_f32 v177, v177
    v_smfmac_f32_32x32x32_bf16 v[64:79], v[88:91], v[232:239], v250
    v_exp_f32 v178, v178
    v_exp_f32 v179, v179
    v_exp_f32 v180, v180
    v_exp_f32 v181, v181
    v_mfma_f32_32x32x16_bf16 v[224:239], v[92:95], a[236:239], 0
    v_exp_f32 v182, v182
    v_exp_f32 v183, v183
    v_exp_f32 v184, v184
    v_exp_f32 v185, v185
    v_smfmac_f32_32x32x32_bf16 v[16:31], v[96:99], v[176:183], v250
    s_xor_b32 s24, s69, 24576
    buffer_load_dwordx4 v[152:155], v248, s[4:7], s24 offen offset:0 sc1
    buffer_load_dwordx4 v[164:167], v248, s[4:7], s24 offen offset:2048 sc1
    s_mov_b64 exec, s[30:31]
    buffer_load_dwordx4 v[156:159], v249, s[4:7], s24 offen offset:1024 sc1
    buffer_load_dwordx4 v[160:163], v249, s[4:7], s24 offen offset:1536 sc1
    buffer_load_dwordx4 v[168:171], v249, s[4:7], s24 offen offset:3072 sc1
    buffer_load_dwordx4 v[172:175], v249, s[4:7], s24 offen offset:3584 sc1
    s_mov_b64 exec, -1
    v_exp_f32 v186, v186
    v_exp_f32 v187, v187
    v_exp_f32 v188, v188
    v_exp_f32 v189, v189
    v_exp_f32 v190, v190
    v_exp_f32 v191, v191
    v_exp_f32 v192, v192
    v_exp_f32 v193, v193
    v_smfmac_f32_32x32x32_bf16 v[16:31], v[100:103], v[184:191], v250
    v_exp_f32 v194, v194
    v_exp_f32 v195, v195
    v_exp_f32 v196, v196
    v_exp_f32 v197, v197
    v_exp_f32 v198, v198
    v_exp_f32 v199, v199
    v_exp_f32 v200, v200
    v_exp_f32 v201, v201
    v_smfmac_f32_32x32x32_bf16 v[32:47], v[96:99], v[192:199], v250
    v_accvgpr_read_b32 v4, a212
    ds_read_b64_tr_b16 a[160:161], v4 offset:0
    ds_read_b64_tr_b16 a[162:163], v4 offset:256
    ds_read_b64_tr_b16 a[164:165], v4 offset:1024
    ds_read_b64_tr_b16 a[166:167], v4 offset:1280
    ds_read_b64_tr_b16 a[168:169], v4 offset:2048
    ds_read_b64_tr_b16 a[170:171], v4 offset:2304
    ds_read_b64_tr_b16 a[172:173], v4 offset:3072
    ds_read_b64_tr_b16 a[174:175], v4 offset:3328
    ds_read_b64_tr_b16 a[176:177], v4 offset:4096
    ds_read_b64_tr_b16 a[178:179], v4 offset:4352
    ds_read_b64_tr_b16 a[180:181], v4 offset:5120
    ds_read_b64_tr_b16 a[182:183], v4 offset:5376
    ds_read_b64_tr_b16 a[184:185], v4 offset:6144
    ds_read_b64_tr_b16 a[186:187], v4 offset:6400
    ds_read_b64_tr_b16 a[188:189], v4 offset:7168
    ds_read_b64_tr_b16 a[190:191], v4 offset:7424
    v_exp_f32 v202, v202
    v_exp_f32 v203, v203
    v_exp_f32 v204, v204
    v_exp_f32 v205, v205
    v_exp_f32 v206, v206
    v_exp_f32 v207, v207
    s_waitcnt lgkmcnt(14)
    v_mfma_f32_32x32x16_bf16 a[196:211], a[192:195], a[160:163], 0
    v_exp_f32 v208, v208
    v_exp_f32 v209, v209
    v_smfmac_f32_32x32x32_bf16 v[32:47], v[100:103], v[200:207], v250
    v_exp_f32 v210, v210
    v_exp_f32 v211, v211
    s_waitcnt lgkmcnt(12)
    v_mfma_f32_32x32x16_bf16 a[196:211], a[192:195], a[164:167], a[196:211]
    v_exp_f32 v212, v212
    v_exp_f32 v213, v213
    v_exp_f32 v214, v214
    v_exp_f32 v215, v215
    s_waitcnt lgkmcnt(10)
    v_mfma_f32_32x32x16_bf16 a[196:211], a[192:195], a[168:171], a[196:211]
    v_exp_f32 v216, v216
    v_exp_f32 v217, v217
    v_smfmac_f32_32x32x32_bf16 v[48:63], v[96:99], v[208:215], v250
    v_exp_f32 v218, v218
    v_exp_f32 v219, v219
    v_exp_f32 v220, v220
    s_waitcnt lgkmcnt(8)
    v_mfma_f32_32x32x16_bf16 a[196:211], a[192:195], a[172:175], a[196:211]
    v_exp_f32 v221, v221
    v_exp_f32 v222, v222
    v_exp_f32 v223, v223
    s_waitcnt lgkmcnt(6)
    v_mfma_f32_32x32x16_bf16 a[196:211], a[192:195], a[176:179], a[196:211]
    v_exp_f32 v224, v224
    v_exp_f32 v225, v225
    v_smfmac_f32_32x32x32_bf16 v[48:63], v[100:103], v[216:223], v250
    v_exp_f32 v226, v226
    v_exp_f32 v227, v227
    s_waitcnt lgkmcnt(4)
    v_mfma_f32_32x32x16_bf16 a[196:211], a[192:195], a[180:183], a[196:211]
    v_exp_f32 v228, v228
    v_exp_f32 v229, v229
    v_exp_f32 v230, v230
    v_exp_f32 v231, v231
    s_waitcnt lgkmcnt(2)
    v_mfma_f32_32x32x16_bf16 a[196:211], a[192:195], a[184:187], a[196:211]
    v_exp_f32 v232, v232
    v_exp_f32 v233, v233
    v_smfmac_f32_32x32x32_bf16 v[64:79], v[96:99], v[224:231], v250
    v_exp_f32 v234, v234
    v_exp_f32 v235, v235
    v_exp_f32 v236, v236
    s_waitcnt lgkmcnt(0)
    v_mfma_f32_32x32x16_bf16 a[196:211], a[192:195], a[188:191], a[196:211]
    v_exp_f32 v237, v237
    v_exp_f32 v238, v238
    v_exp_f32 v239, v239
    s_nop 1
    v_smfmac_f32_32x32x32_bf16 v[64:79], v[100:103], v[232:239], v250
    s_waitcnt vmcnt(12)
    v_mfma_f32_32x32x16_bf16 v[176:191], v[104:107], a[224:227], 0
    v_mfma_f32_32x32x16_bf16 v[192:207], v[104:107], a[228:231], 0
    v_mfma_f32_32x32x16_bf16 v[208:223], v[104:107], a[232:235], 0
    s_nop 9
    v_exp_f32 v176, v176
    v_exp_f32 v177, v177
    v_exp_f32 v178, v178
    v_exp_f32 v179, v179
    v_exp_f32 v180, v180
    v_exp_f32 v181, v181
    v_mfma_f32_32x32x16_bf16 v[224:239], v[104:107], a[236:239], 0
    v_exp_f32 v182, v182
    v_exp_f32 v183, v183
    v_exp_f32 v184, v184
    v_exp_f32 v185, v185
    v_smfmac_f32_32x32x32_bf16 v[16:31], v[108:111], v[176:183], v250
    v_exp_f32 v186, v186
    v_exp_f32 v187, v187
    v_exp_f32 v188, v188
    v_exp_f32 v189, v189
    v_exp_f32 v190, v190
    v_exp_f32 v191, v191
    v_exp_f32 v192, v192
    v_exp_f32 v193, v193
    v_smfmac_f32_32x32x32_bf16 v[16:31], v[112:115], v[184:191], v250
    v_exp_f32 v194, v194
    v_exp_f32 v195, v195
    v_exp_f32 v196, v196
    v_exp_f32 v197, v197
    v_mfma_f32_32x32x16_bf16 v[176:191], v[116:119], a[224:227], 0
    v_exp_f32 v198, v198
    v_exp_f32 v199, v199
    v_exp_f32 v200, v200
    v_exp_f32 v201, v201
    v_smfmac_f32_32x32x32_bf16 v[32:47], v[108:111], v[192:199], v250
    buffer_load_dwordx2 v[8:9], v253, s[4:7], s68 offen sc1
    s_getpc_b64 s[90:91]
pc_4:
    s_min_u32 s40, s85, L_end-pc_4-1024
    s_add_u32 s90, s90, s40
    s_addc_u32 s91, s91, 0
    global_load_dword v5, v1, s[90:91] offset:0
    buffer_store_dwordx4 a[160:163], v1, s[4:7], s80 offen sc1
    s_add_u32 s80, s80, s81
    buffer_store_dwordx4 a[164:167], v1, s[4:7], s80 offen sc1
    s_add_u32 s80, s80, s83
    v_exp_f32 v202, v202
    v_exp_f32 v203, v203
    v_exp_f32 v204, v204
    v_exp_f32 v205, v205
    v_exp_f32 v206, v206
    v_exp_f32 v207, v207
    v_exp_f32 v208, v208
    v_exp_f32 v209, v209
    v_smfmac_f32_32x32x32_bf16 v[32:47], v[112:115], v[200:207], v250
    v_exp_f32 v210, v210
    v_exp_f32 v211, v211
    v_exp_f32 v212, v212
    v_exp_f32 v213, v213
    v_mfma_f32_32x32x16_bf16 v[192:207], v[116:119], a[228:231], 0
    v_exp_f32 v214, v214
    v_exp_f32 v215, v215
    v_exp_f32 v216, v216
    v_exp_f32 v217, v217
    v_smfmac_f32_32x32x32_bf16 v[48:63], v[108:111], v[208:215], v250
    buffer_store_dwordx4 a[168:171], v1, s[4:7], s80 offen sc1
    s_add_u32 s80, s80, s81
    buffer_store_dwordx4 a[172:175], v1, s[4:7], s80 offen sc1
    s_add_u32 s80, s80, s83
    v_exp_f32 v218, v218
    v_exp_f32 v219, v219
    v_exp_f32 v220, v220
    v_exp_f32 v221, v221
    v_exp_f32 v222, v222
    v_exp_f32 v223, v223
    v_exp_f32 v224, v224
    v_exp_f32 v225, v225
    v_smfmac_f32_32x32x32_bf16 v[48:63], v[112:115], v[216:223], v250
    v_exp_f32 v226, v226
    v_exp_f32 v227, v227
    v_exp_f32 v228, v228
    v_exp_f32 v229, v229
    v_mfma_f32_32x32x16_bf16 v[208:223], v[116:119], a[232:235], 0
    v_exp_f32 v230, v230
    v_exp_f32 v231, v231
    v_exp_f32 v232, v232
    v_exp_f32 v233, v233
    v_smfmac_f32_32x32x32_bf16 v[64:79], v[108:111], v[224:231], v250
    buffer_store_dwordx4 a[176:179], v1, s[4:7], s80 offen sc1
    s_add_u32 s80, s80, s81
    buffer_store_dwordx4 a[180:183], v1, s[4:7], s80 offen sc1
    s_add_u32 s80, s80, s83
    v_exp_f32 v234, v234
    v_exp_f32 v235, v235
    v_exp_f32 v236, v236
    v_exp_f32 v237, v237
    v_exp_f32 v238, v238
    v_exp_f32 v239, v239
    v_exp_f32 v176, v176
    v_exp_f32 v177, v177
    v_smfmac_f32_32x32x32_bf16 v[64:79], v[112:115], v[232:239], v250
    v_exp_f32 v178, v178
    v_exp_f32 v179, v179
    v_exp_f32 v180, v180
    v_exp_f32 v181, v181
    v_mfma_f32_32x32x16_bf16 v[224:239], v[116:119], a[236:239], 0
    v_exp_f32 v182, v182
    v_exp_f32 v183, v183
    v_exp_f32 v184, v184
    v_exp_f32 v185, v185
    v_smfmac_f32_32x32x32_bf16 v[16:31], v[120:123], v[176:183], v250
    s_waitcnt vmcnt(7)
    v_cmp_ne_u64 vcc, s[32:33], v[8:9]
    s_nop 0
    s_and_b32 s19, vcc_lo, 0xf0
    s_cbranch_scc1 ap_5
apok_6:
    s_xor_b32 s24, s69, 32768
    buffer_load_dwordx4 v[80:83], v248, s[4:7], s24 offen offset:0 sc1
    buffer_load_dwordx4 v[92:95], v248, s[4:7], s24 offen offset:2048 sc1
    s_mov_b64 exec, s[30:31]
    buffer_load_dwordx4 v[84:87], v249, s[4:7], s24 offen offset:1024 sc1
    buffer_load_dwordx4 v[88:91], v249, s[4:7], s24 offen offset:1536 sc1
    buffer_load_dwordx4 v[96:99], v249, s[4:7], s24 offen offset:3072 sc1
    buffer_load_dwordx4 v[100:103], v249, s[4:7], s24 offen offset:3584 sc1
    s_mov_b64 exec, -1
    buffer_store_dwordx4 a[184:187], v1, s[4:7], s80 offen sc1
    s_add_u32 s80, s80, s81
    buffer_store_dwordx4 a[188:191], v1, s[4:7], s80 offen sc1
    s_add_u32 s80, s80, s83
    v_exp_f32 v186, v186
    v_exp_f32 v187, v187
    v_exp_f32 v188, v188
    v_exp_f32 v189, v189
    v_exp_f32 v190, v190
    v_exp_f32 v191, v191
    v_exp_f32 v192, v192
    v_exp_f32 v193, v193
    v_smfmac_f32_32x32x32_bf16 v[16:31], v[124:127], v[184:191], v250
    v_exp_f32 v194, v194
    v_exp_f32 v195, v195
    v_exp_f32 v196, v196
    v_exp_f32 v197, v197
    v_mfma_f32_32x32x16_bf16 v[176:191], v[128:131], a[224:227], 0
    v_exp_f32 v198, v198
    v_exp_f32 v199, v199
    v_exp_f32 v200, v200
    v_exp_f32 v201, v201
    v_smfmac_f32_32x32x32_bf16 v[32:47], v[120:123], v[192:199], v250
    v_accvgpr_read_b32 v13, a196
    v_cvt_pk_bf16_f32 v15, v13, 0
    v_lshlrev_b32 v14, 16, v15
    v_sub_f32 v13, v13, v14
    v_cvt_pk_bf16_f32 v14, v14, v13
    s_mov_b32 exec_hi, 0
    buffer_store_dwordx2 v[14:15], v1, s[4:7], s82 offen sc1
    s_mov_b64 exec, -1
    v_exp_f32 v202, v202
    v_exp_f32 v203, v203
    v_exp_f32 v204, v204
    v_exp_f32 v205, v205
    v_exp_f32 v206, v206
    v_exp_f32 v207, v207
    v_exp_f32 v208, v208
    v_exp_f32 v209, v209
    v_smfmac_f32_32x32x32_bf16 v[32:47], v[124:127], v[200:207], v250
    v_exp_f32 v210, v210
    v_exp_f32 v211, v211
    v_exp_f32 v212, v212
    v_exp_f32 v213, v213
    v_mfma_f32_32x32x16_bf16 v[192:207], v[128:131], a[228:231], 0
    v_exp_f32 v214, v214
    v_exp_f32 v215, v215
    v_exp_f32 v216, v216
    v_exp_f32 v217, v217
    v_smfmac_f32_32x32x32_bf16 v[48:63], v[120:123], v[208:215], v250
    v_exp_f32 v218, v218
    v_exp_f32 v219, v219
    v_exp_f32 v220, v220
    v_exp_f32 v221, v221
    v_exp_f32 v222, v222
    v_exp_f32 v223, v223
    v_exp_f32 v224, v224
    v_exp_f32 v225, v225
    v_smfmac_f32_32x32x32_bf16 v[48:63], v[124:127], v[216:223], v250
    v_exp_f32 v226, v226
    v_exp_f32 v227, v227
    v_exp_f32 v228, v228
    v_exp_f32 v229, v229
    v_mfma_f32_32x32x16_bf16 v[208:223], v[128:131], a[232:235], 0
    v_exp_f32 v230, v230
    v_exp_f32 v231, v231
    v_exp_f32 v232, v232
    v_exp_f32 v233, v233
    v_smfmac_f32_32x32x32_bf16 v[64:79], v[120:123], v[224:231], v250
    v_exp_f32 v234, v234
    v_exp_f32 v235, v235
    v_exp_f32 v236, v236
    v_exp_f32 v237, v237
    v_exp_f32 v238, v238
    v_exp_f32 v239, v239
    v_exp_f32 v176, v176
    v_exp_f32 v177, v177
    v_smfmac_f32_32x32x32_bf16 v[64:79], v[124:127], v[232:239], v250
    v_exp_f32 v178, v178
    v_exp_f32 v179, v179
    v_exp_f32 v180, v180
    v_exp_f32 v181, v181
    v_mfma_f32_32x32x16_bf16 v[224:239], v[128:131], a[236:239], 0
    v_exp_f32 v182, v182
    v_exp_f32 v183, v183
    v_exp_f32 v184, v184
    v_exp_f32 v185, v185
    v_smfmac_f32_32x32x32_bf16 v[16:31], v[132:135], v[176:183], v250
    s_xor_b32 s24, s69, 40960
    buffer_load_dwordx4 v[104:107], v248, s[4:7], s24 offen offset:0 sc1
    buffer_load_dwordx4 v[116:119], v248, s[4:7], s24 offen offset:2048 sc1
    s_mov_b64 exec, s[30:31]
    buffer_load_dwordx4 v[108:111], v249, s[4:7], s24 offen offset:1024 sc1
    buffer_load_dwordx4 v[112:115], v249, s[4:7], s24 offen offset:1536 sc1
    buffer_load_dwordx4 v[120:123], v249, s[4:7], s24 offen offset:3072 sc1
    buffer_load_dwordx4 v[124:127], v249, s[4:7], s24 offen offset:3584 sc1
    s_mov_b64 exec, -1
    v_exp_f32 v186, v186
    v_exp_f32 v187, v187
    v_exp_f32 v188, v188
    v_exp_f32 v189, v189
    v_exp_f32 v190, v190
    v_exp_f32 v191, v191
    v_exp_f32 v192, v192
    v_exp_f32 v193, v193
    v_smfmac_f32_32x32x32_bf16 v[16:31], v[136:139], v[184:191], v250
    v_exp_f32 v194, v194
    v_exp_f32 v195, v195
    v_exp_f32 v196, v196
    v_exp_f32 v197, v197
    v_mfma_f32_32x32x16_bf16 v[176:191], v[140:143], a[224:227], 0
    v_exp_f32 v198, v198
    v_exp_f32 v199, v199
    v_exp_f32 v200, v200
    v_exp_f32 v201, v201
    v_smfmac_f32_32x32x32_bf16 v[32:47], v[132:135], v[192:199], v250
    v_exp_f32 v202, v202
    v_exp_f32 v203, v203
    v_exp_f32 v204, v204
    v_exp_f32 v205, v205
    v_exp_f32 v206, v206
    v_exp_f32 v207, v207
    v_exp_f32 v208, v208
    v_exp_f32 v209, v209
    v_smfmac_f32_32x32x32_bf16 v[32:47], v[136:139], v[200:207], v250
    v_exp_f32 v210, v210
    v_exp_f32 v211, v211
    v_exp_f32 v212, v212
    v_exp_f32 v213, v213
    v_mfma_f32_32x32x16_bf16 v[192:207], v[140:143], a[228:231], 0
    v_exp_f32 v214, v214
    v_exp_f32 v215, v215
    v_exp_f32 v216, v216
    v_exp_f32 v217, v217
    v_smfmac_f32_32x32x32_bf16 v[48:63], v[132:135], v[208:215], v250
    v_exp_f32 v218, v218
    v_exp_f32 v219, v219
    v_exp_f32 v220, v220
    v_exp_f32 v221, v221
    v_exp_f32 v222, v222
    v_exp_f32 v223, v223
    v_exp_f32 v224, v224
    v_exp_f32 v225, v225
    v_smfmac_f32_32x32x32_bf16 v[48:63], v[136:139], v[216:223], v250
    v_exp_f32 v226, v226
    v_exp_f32 v227, v227
    v_exp_f32 v228, v228
    v_exp_f32 v229, v229
    v_mfma_f32_32x32x16_bf16 v[208:223], v[140:143], a[232:235], 0
    v_exp_f32 v230, v230
    v_exp_f32 v231, v231
    v_exp_f32 v232, v232
    v_exp_f32 v233, v233
    v_smfmac_f32_32x32x32_bf16 v[64:79], v[132:135], v[224:231], v250
    v_exp_f32 v234, v234
    v_exp_f32 v235, v235
    v_exp_f32 v236, v236
    v_exp_f32 v237, v237
    v_exp_f32 v238, v238
    v_exp_f32 v239, v239
    v_exp_f32 v176, v176
    v_exp_f32 v177, v177
    v_smfmac_f32_32x32x32_bf16 v[64:79], v[136:139], v[232:239], v250
    v_exp_f32 v178, v178
    v_exp_f32 v179, v179
    v_exp_f32 v180, v180
    v_exp_f32 v181, v181
    v_mfma_f32_32x32x16_bf16 v[224:239], v[140:143], a[236:239], 0
    v_exp_f32 v182, v182
    v_exp_f32 v183, v183
    v_exp_f32 v184, v184
    v_exp_f32 v185, v185
    v_smfmac_f32_32x32x32_bf16 v[16:31], v[144:147], v[176:183], v250
    v_exp_f32 v186, v186
    v_exp_f32 v187, v187
    v_exp_f32 v188, v188
    v_exp_f32 v189, v189
    v_exp_f32 v190, v190
    v_exp_f32 v191, v191
    v_exp_f32 v192, v192
    v_exp_f32 v193, v193
    v_smfmac_f32_32x32x32_bf16 v[16:31], v[148:151], v[184:191], v250
    v_exp_f32 v194, v194
    v_exp_f32 v195, v195
    v_exp_f32 v196, v196
    v_exp_f32 v197, v197
    v_mfma_f32_32x32x16_bf16 v[176:191], v[152:155], a[224:227], 0
    v_exp_f32 v198, v198
    v_exp_f32 v199, v199
    v_exp_f32 v200, v200
    v_exp_f32 v201, v201
    v_smfmac_f32_32x32x32_bf16 v[32:47], v[144:147], v[192:199], v250
    v_exp_f32 v202, v202
    v_exp_f32 v203, v203
    v_exp_f32 v204, v204
    v_exp_f32 v205, v205
    v_exp_f32 v206, v206
    v_exp_f32 v207, v207
    v_exp_f32 v208, v208
    v_exp_f32 v209, v209
    v_smfmac_f32_32x32x32_bf16 v[32:47], v[148:151], v[200:207], v250
    v_exp_f32 v210, v210
    v_exp_f32 v211, v211
    v_exp_f32 v212, v212
    v_exp_f32 v213, v213
    v_mfma_f32_32x32x16_bf16 v[192:207], v[152:155], a[228:231], 0
    v_exp_f32 v214, v214
    v_exp_f32 v215, v215
    v_exp_f32 v216, v216
    v_exp_f32 v217, v217
    v_smfmac_f32_32x32x32_bf16 v[48:63], v[144:147], v[208:215], v250
    s_lshl_b32 s41, s96, 7
    s_add_u32 s41, s41, 8278016
    v_mov_b32 v13, 0
    v_mov_b32 v14, s32
    v_mov_b32 v15, s33
    s_waitcnt vmcnt(6)
    s_barrier
    s_cmp_lg_u32 s12, 0
    s_cbranch_scc1 pw_7
    s_mov_b64 exec, 1
    v_xor_b32 v12, s35, v14
    v_mov_b32 v13, v15
    buffer_store_dwordx4 v[12:15], v1, s[4:7], s41 offen sc1
    s_mov_b64 exec, -1
pw_7:
    v_exp_f32 v218, v218
    v_exp_f32 v219, v219
    v_exp_f32 v220, v220
    v_exp_f32 v221, v221
    v_exp_f32 v222, v222
    v_exp_f32 v223, v223
    v_exp_f32 v224, v224
    v_exp_f32 v225, v225
    v_smfmac_f32_32x32x32_bf16 v[48:63], v[148:151], v[216:223], v250
    v_exp_f32 v226, v226
    v_exp_f32 v227, v227
    v_exp_f32 v228, v228
    v_exp_f32 v229, v229
    v_mfma_f32_32x32x16_bf16 v[208:223], v[152:155], a[232:235], 0
    v_exp_f32 v230, v230
    v_exp_f32 v231, v231
    v_exp_f32 v232, v232
    v_exp_f32 v233, v233
    v_smfmac_f32_32x32x32_bf16 v[64:79], v[144:147], v[224:231], v250
    v_exp_f32 v234, v234
    v_exp_f32 v235, v235
    v_exp_f32 v236, v236
    v_exp_f32 v237, v237
    v_exp_f32 v238, v238
    v_exp_f32 v239, v239
    v_exp_f32 v176, v176
    v_exp_f32 v177, v177
    v_smfmac_f32_32x32x32_bf16 v[64:79], v[148:151], v[232:239], v250
    v_exp_f32 v178, v178
    v_exp_f32 v179, v179
    v_exp_f32 v180, v180
    v_exp_f32 v181, v181
    v_mfma_f32_32x32x16_bf16 v[224:239], v[152:155], a[236:239], 0
    v_exp_f32 v182, v182
    v_exp_f32 v183, v183
    v_exp_f32 v184, v184
    v_exp_f32 v185, v185
    v_smfmac_f32_32x32x32_bf16 v[16:31], v[156:159], v[176:183], v250
    s_xor_b32 s24, s69, 49152
    buffer_load_dwordx4 v[128:131], v248, s[4:7], s24 offen offset:0 sc1
    buffer_load_dwordx4 v[140:143], v248, s[4:7], s24 offen offset:2048 sc1
    s_mov_b64 exec, s[30:31]
    buffer_load_dwordx4 v[132:135], v249, s[4:7], s24 offen offset:1024 sc1
    buffer_load_dwordx4 v[136:139], v249, s[4:7], s24 offen offset:1536 sc1
    buffer_load_dwordx4 v[144:147], v249, s[4:7], s24 offen offset:3072 sc1
    buffer_load_dwordx4 v[148:151], v249, s[4:7], s24 offen offset:3584 sc1
    s_mov_b64 exec, -1
    v_exp_f32 v186, v186
    v_exp_f32 v187, v187
    v_exp_f32 v188, v188
    v_exp_f32 v189, v189
    v_exp_f32 v190, v190
    v_exp_f32 v191, v191
    v_exp_f32 v192, v192
    v_exp_f32 v193, v193
    v_smfmac_f32_32x32x32_bf16 v[16:31], v[160:163], v[184:191], v250
    v_exp_f32 v194, v194
    v_exp_f32 v195, v195
    v_exp_f32 v196, v196
    v_exp_f32 v197, v197
    v_mfma_f32_32x32x16_bf16 v[176:191], v[164:167], a[224:227], 0
    v_exp_f32 v198, v198
    v_exp_f32 v199, v199
    v_exp_f32 v200, v200
    v_exp_f32 v201, v201
    v_smfmac_f32_32x32x32_bf16 v[32:47], v[156:159], v[192:199], v250
    v_exp_f32 v202, v202
    v_exp_f32 v203, v203
    v_exp_f32 v204, v204
    v_exp_f32 v205, v205
    v_exp_f32 v206, v206
    v_exp_f32 v207, v207
    v_exp_f32 v208, v208
    v_exp_f32 v209, v209
    v_smfmac_f32_32x32x32_bf16 v[32:47], v[160:163], v[200:207], v250
    v_exp_f32 v210, v210
    v_exp_f32 v211, v211
    v_exp_f32 v212, v212
    v_exp_f32 v213, v213
    v_mfma_f32_32x32x16_bf16 v[192:207], v[164:167], a[228:231], 0
    v_exp_f32 v214, v214
    v_exp_f32 v215, v215
    v_exp_f32 v216, v216
    v_exp_f32 v217, v217
    v_smfmac_f32_32x32x32_bf16 v[48:63], v[156:159], v[208:215], v250
    v_exp_f32 v218, v218
    v_exp_f32 v219, v219
    v_exp_f32 v220, v220
    v_exp_f32 v221, v221
    v_exp_f32 v222, v222
    v_exp_f32 v223, v223
    v_exp_f32 v224, v224
    v_exp_f32 v225, v225
    v_smfmac_f32_32x32x32_bf16 v[48:63], v[160:163], v[216:223], v250
    v_exp_f32 v226, v226
    v_exp_f32 v227, v227
    v_exp_f32 v228, v228
    v_exp_f32 v229, v229
    v_mfma_f32_32x32x16_bf16 v[208:223], v[164:167], a[232:235], 0
    v_exp_f32 v230, v230
    v_exp_f32 v231, v231
    v_exp_f32 v232, v232
    v_exp_f32 v233, v233
    v_smfmac_f32_32x32x32_bf16 v[64:79], v[156:159], v[224:231], v250
    v_exp_f32 v234, v234
    v_exp_f32 v235, v235
    v_exp_f32 v236, v236
    v_exp_f32 v237, v237
    v_exp_f32 v238, v238
    v_exp_f32 v239, v239
    v_exp_f32 v176, v176
    v_exp_f32 v177, v177
    v_smfmac_f32_32x32x32_bf16 v[64:79], v[160:163], v[232:239], v250
    v_exp_f32 v178, v178
    v_exp_f32 v179, v179
    v_exp_f32 v180, v180
    v_exp_f32 v181, v181
    v_mfma_f32_32x32x16_bf16 v[224:239], v[164:167], a[236:239], 0
    v_exp_f32 v182, v182
    v_exp_f32 v183, v183
    v_exp_f32 v184, v184
    v_exp_f32 v185, v185
    v_smfmac_f32_32x32x32_bf16 v[16:31], v[168:171], v[176:183], v250
    v_exp_f32 v186, v186
    v_exp_f32 v187, v187
    v_exp_f32 v188, v188
    v_exp_f32 v189, v189
    v_exp_f32 v190, v190
    v_exp_f32 v191, v191
    v_exp_f32 v192, v192
    v_exp_f32 v193, v193
    v_smfmac_f32_32x32x32_bf16 v[16:31], v[172:175], v[184:191], v250
    v_exp_f32 v194, v194
    v_exp_f32 v195, v195
    v_exp_f32 v196, v196
    v_exp_f32 v197, v197
    v_mfma_f32_32x32x16_bf16 v[176:191], v[80:83], a[224:227], 0
    v_exp_f32 v198, v198
    v_exp_f32 v199, v199
    v_exp_f32 v200, v200
    v_exp_f32 v201, v201
    v_smfmac_f32_32x32x32_bf16 v[32:47], v[168:171], v[192:199], v250
    v_exp_f32 v202, v202
    v_exp_f32 v203, v203
    v_exp_f32 v204, v204
    v_exp_f32 v205, v205
    v_exp_f32 v206, v206
    v_exp_f32 v207, v207
    v_exp_f32 v208, v208
    v_exp_f32 v209, v209
    v_smfmac_f32_32x32x32_bf16 v[32:47], v[172:175], v[200:207], v250
    v_exp_f32 v210, v210
    v_exp_f32 v211, v211
    v_exp_f32 v212, v212
    v_exp_f32 v213, v213
    v_mfma_f32_32x32x16_bf16 v[192:207], v[80:83], a[228:231], 0
    v_exp_f32 v214, v214
    v_exp_f32 v215, v215
    v_exp_f32 v216, v216
    v_exp_f32 v217, v217
    v_smfmac_f32_32x32x32_bf16 v[48:63], v[168:171], v[208:215], v250
    v_accvgpr_read_b32 v12, a213
    s_mov_b32 s20, 8278016
    buffer_load_dwordx2 v[10:11], v12, s[4:7], s20 offen offset:8 sc1
    v_exp_f32 v218, v218
    v_exp_f32 v219, v219
    v_exp_f32 v220, v220
    v_exp_f32 v221, v221
    v_exp_f32 v222, v222
    v_exp_f32 v223, v223
    v_exp_f32 v224, v224
    v_exp_f32 v225, v225
    v_smfmac_f32_32x32x32_bf16 v[48:63], v[172:175], v[216:223], v250
    v_exp_f32 v226, v226
    v_exp_f32 v227, v227
    v_exp_f32 v228, v228
    v_exp_f32 v229, v229
    v_mfma_f32_32x32x16_bf16 v[208:223], v[80:83], a[232:235], 0
    v_exp_f32 v230, v230
    v_exp_f32 v231, v231
    v_exp_f32 v232, v232
    v_exp_f32 v233, v233
    v_smfmac_f32_32x32x32_bf16 v[64:79], v[168:171], v[224:231], v250
    v_exp_f32 v234, v234
    v_exp_f32 v235, v235
    v_exp_f32 v236, v236
    v_exp_f32 v237, v237
    v_exp_f32 v238, v238
    v_exp_f32 v239, v239
    v_exp_f32 v176, v176
    v_exp_f32 v177, v177
    v_smfmac_f32_32x32x32_bf16 v[64:79], v[172:175], v[232:239], v250
    v_exp_f32 v178, v178
    v_exp_f32 v179, v179
    v_exp_f32 v180, v180
    v_exp_f32 v181, v181
    v_mfma_f32_32x32x16_bf16 v[224:239], v[80:83], a[236:239], 0
    v_exp_f32 v182, v182
    v_exp_f32 v183, v183
    v_exp_f32 v184, v184
    v_exp_f32 v185, v185
    v_smfmac_f32_32x32x32_bf16 v[16:31], v[84:87], v[176:183], v250
    s_xor_b32 s24, s69, 57344
    buffer_load_dwordx4 v[152:155], v248, s[4:7], s24 offen offset:0 sc1
    buffer_load_dwordx4 v[164:167], v248, s[4:7], s24 offen offset:2048 sc1
    s_mov_b64 exec, s[30:31]
    buffer_load_dwordx4 v[156:159], v249, s[4:7], s24 offen offset:1024 sc1
    buffer_load_dwordx4 v[160:163], v249, s[4:7], s24 offen offset:1536 sc1
    buffer_load_dwordx4 v[168:171], v249, s[4:7], s24 offen offset:3072 sc1
    buffer_load_dwordx4 v[172:175], v249, s[4:7], s24 offen offset:3584 sc1
    s_mov_b64 exec, -1
    v_exp_f32 v186, v186
    v_exp_f32 v187, v187
    v_exp_f32 v188, v188
    v_exp_f32 v189, v189
    v_exp_f32 v190, v190
    v_exp_f32 v191, v191
    v_exp_f32 v192, v192
    v_exp_f32 v193, v193
    v_smfmac_f32_32x32x32_bf16 v[16:31], v[88:91], v[184:191], v250
    v_exp_f32 v194, v194
    v_exp_f32 v195, v195
    v_exp_f32 v196, v196
    v_exp_f32 v197, v197
    v_mfma_f32_32x32x16_bf16 v[176:191], v[92:95], a[224:227], 0
    v_exp_f32 v198, v198
    v_exp_f32 v199, v199
    v_exp_f32 v200, v200
    v_exp_f32 v201, v201
    v_smfmac_f32_32x32x32_bf16 v[32:47], v[84:87], v[192:199], v250
    v_exp_f32 v202, v202
    v_exp_f32 v203, v203
    v_exp_f32 v204, v204
    v_exp_f32 v205, v205
    v_exp_f32 v206, v206
    v_exp_f32 v207, v207
    v_exp_f32 v208, v208
    v_exp_f32 v209, v209
    v_smfmac_f32_32x32x32_bf16 v[32:47], v[88:91], v[200:207], v250
    v_exp_f32 v210, v210
    v_exp_f32 v211, v211
    v_exp_f32 v212, v212
    v_exp_f32 v213, v213
    v_mfma_f32_32x32x16_bf16 v[192:207], v[92:95], a[228:231], 0
    v_exp_f32 v214, v214
    v_exp_f32 v215, v215
    v_exp_f32 v216, v216
    v_exp_f32 v217, v217
    v_smfmac_f32_32x32x32_bf16 v[48:63], v[84:87], v[208:215], v250
    v_exp_f32 v218, v218
    v_exp_f32 v219, v219
    v_exp_f32 v220, v220
    v_exp_f32 v221, v221
    v_exp_f32 v222, v222
    v_exp_f32 v223, v223
    v_exp_f32 v224, v224
    v_exp_f32 v225, v225
    v_smfmac_f32_32x32x32_bf16 v[48:63], v[88:91], v[216:223], v250
    v_exp_f32 v226, v226
    v_exp_f32 v227, v227
    v_exp_f32 v228, v228
    v_exp_f32 v229, v229
    v_mfma_f32_32x32x16_bf16 v[208:223], v[92:95], a[232:235], 0
    v_exp_f32 v230, v230
    v_exp_f32 v231, v231
    v_exp_f32 v232, v232
    v_exp_f32 v233, v233
    v_smfmac_f32_32x32x32_bf16 v[64:79], v[84:87], v[224:231], v250
    buffer_load_dwordx2 v[8:9], v253, s[4:7], s68 offen sc1
    v_exp_f32 v234, v234
    v_exp_f32 v235, v235
    v_exp_f32 v236, v236
    v_exp_f32 v237, v237
    v_exp_f32 v238, v238
    v_exp_f32 v239, v239
    v_exp_f32 v176, v176
    v_exp_f32 v177, v177
    v_smfmac_f32_32x32x32_bf16 v[64:79], v[88:91], v[232:239], v250
    v_exp_f32 v178, v178
    v_exp_f32 v179, v179
    v_exp_f32 v180, v180
    v_exp_f32 v181, v181
    v_mfma_f32_32x32x16_bf16 v[224:239], v[92:95], a[236:239], 0
    v_exp_f32 v182, v182
    v_exp_f32 v183, v183
    v_exp_f32 v184, v184
    v_exp_f32 v185, v185
    v_smfmac_f32_32x32x32_bf16 v[16:31], v[96:99], v[176:183], v250
    s_waitcnt vmcnt(7)
    v_cmp_ne_u64 vcc, s[32:33], v[10:11]
    s_nop 0
    s_cbranch_vccnz ap_8
apok_9:
    s_and_b32 s18, s14, 7
    s_lshl_b32 s18, s18, 1
    s_lshr_b32 s19, s12, 1
    s_add_u32 s18, s18, s19
    s_mul_i32 s19, s12, 28672
    s_add_u32 s19, s19, 5963776
    s_mul_i32 s20, s18, 114688
    s_add_u32 s20, s20, s19
    s_xor_b32 s18, s18, 1
    s_mul_i32 s39, s18, 114688
    s_add_u32 s39, s39, s19
    v_exp_f32 v186, v186
    v_exp_f32 v187, v187
    v_exp_f32 v188, v188
    v_exp_f32 v189, v189
    v_exp_f32 v190, v190
    v_exp_f32 v191, v191
    v_exp_f32 v192, v192
    v_exp_f32 v193, v193
    v_smfmac_f32_32x32x32_bf16 v[16:31], v[100:103], v[184:191], v250
    v_exp_f32 v194, v194
    v_exp_f32 v195, v195
    v_exp_f32 v196, v196
    v_exp_f32 v197, v197
    v_mfma_f32_32x32x16_bf16 v[176:191], v[104:107], a[224:227], 0
    v_exp_f32 v198, v198
    v_exp_f32 v199, v199
    v_exp_f32 v200, v200
    v_exp_f32 v201, v201
    v_smfmac_f32_32x32x32_bf16 v[32:47], v[96:99], v[192:199], v250
    v_exp_f32 v202, v202
    v_exp_f32 v203, v203
    v_exp_f32 v204, v204
    v_exp_f32 v205, v205
    v_exp_f32 v206, v206
    v_exp_f32 v207, v207
    v_exp_f32 v208, v208
    v_exp_f32 v209, v209
    v_smfmac_f32_32x32x32_bf16 v[32:47], v[100:103], v[200:207], v250
    v_exp_f32 v210, v210
    v_exp_f32 v211, v211
    v_exp_f32 v212, v212
    v_exp_f32 v213, v213
    v_mfma_f32_32x32x16_bf16 v[192:207], v[104:107], a[228:231], 0
    v_exp_f32 v214, v214
    v_exp_f32 v215, v215
    v_exp_f32 v216, v216
    v_exp_f32 v217, v217
    v_smfmac_f32_32x32x32_bf16 v[48:63], v[96:99], v[208:215], v250
    buffer_load_dwordx4 a[0:3], v1, s[4:7], s20 offen offset:0 sc1
    buffer_load_dwordx4 a[8:11], v1, s[4:7], s20 offen offset:1024 sc1
    buffer_load_dwordx4 a[16:19], v1, s[4:7], s20 offen offset:2048 sc1
    buffer_load_dwordx4 a[24:27], v1, s[4:7], s20 offen offset:3072 sc1
    v_exp_f32 v218, v218
    v_exp_f32 v219, v219
    v_exp_f32 v220, v220
    v_exp_f32 v221, v221
    v_exp_f32 v222, v222
    v_exp_f32 v223, v223
    v_exp_f32 v224, v224
    v_exp_f32 v225, v225
    v_smfmac_f32_32x32x32_bf16 v[48:63], v[100:103], v[216:223], v250
    v_exp_f32 v226, v226
    v_exp_f32 v227, v227
    v_exp_f32 v228, v228
    v_exp_f32 v229, v229
    v_mfma_f32_32x32x16_bf16 v[208:223], v[104:107], a[232:235], 0
    v_exp_f32 v230, v230
    v_exp_f32 v231, v231
    v_exp_f32 v232, v232
    v_exp_f32 v233, v233
    v_smfmac_f32_32x32x32_bf16 v[64:79], v[96:99], v[224:231], v250
    v_exp_f32 v234, v234
    v_exp_f32 v235, v235
    v_exp_f32 v236, v236
    v_exp_f32 v237, v237
    v_exp_f32 v238, v238
    v_exp_f32 v239, v239
    v_exp_f32 v176, v176
    v_exp_f32 v177, v177
    v_smfmac_f32_32x32x32_bf16 v[64:79], v[100:103], v[232:239], v250
    v_exp_f32 v178, v178
    v_exp_f32 v179, v179
    v_exp_f32 v180, v180
    v_exp_f32 v181, v181
    v_mfma_f32_32x32x16_bf16 v[224:239], v[104:107], a[236:239], 0
    v_exp_f32 v182, v182
    v_exp_f32 v183, v183
    v_exp_f32 v184, v184
    v_exp_f32 v185, v185
    v_smfmac_f32_32x32x32_bf16 v[16:31], v[108:111], v[176:183], v250
    s_waitcnt vmcnt(4)
    v_cmp_ne_u64 vcc, s[32:33], v[8:9]
    s_nop 0
    s_cbranch_vccnz ap_10
apok_11:
    s_xor_b32 s24, s69, 65536
    buffer_load_dwordx4 v[80:83], v248, s[4:7], s24 offen offset:0 sc1
    buffer_load_dwordx4 v[92:95], v248, s[4:7], s24 offen offset:2048 sc1
    s_mov_b64 exec, s[30:31]
    buffer_load_dwordx4 v[84:87], v249, s[4:7], s24 offen offset:1024 sc1
    buffer_load_dwordx4 v[88:91], v249, s[4:7], s24 offen offset:1536 sc1
    buffer_load_dwordx4 v[96:99], v249, s[4:7], s24 offen offset:3072 sc1
    buffer_load_dwordx4 v[100:103], v249, s[4:7], s24 offen offset:3584 sc1
    s_mov_b64 exec, -1
    v_exp_f32 v186, v186
    v_exp_f32 v187, v187
    v_exp_f32 v188, v188
    v_exp_f32 v189, v189
    v_exp_f32 v190, v190
    v_exp_f32 v191, v191
    v_exp_f32 v192, v192
    v_exp_f32 v193, v193
    v_smfmac_f32_32x32x32_bf16 v[16:31], v[112:115], v[184:191], v250
    v_exp_f32 v194, v194
    v_exp_f32 v195, v195
    v_exp_f32 v196, v196
    v_exp_f32 v197, v197
    v_mfma_f32_32x32x16_bf16 v[176:191], v[116:119], a[224:227], 0
    v_exp_f32 v198, v198
    v_exp_f32 v199, v199
    v_exp_f32 v200, v200
    v_exp_f32 v201, v201
    v_smfmac_f32_32x32x32_bf16 v[32:47], v[108:111], v[192:199], v250
    v_exp_f32 v202, v202
    v_exp_f32 v203, v203
    v_exp_f32 v204, v204
    v_exp_f32 v205, v205
    v_exp_f32 v206, v206
    v_exp_f32 v207, v207
    v_exp_f32 v208, v208
    v_exp_f32 v209, v209
    v_smfmac_f32_32x32x32_bf16 v[32:47], v[112:115], v[200:207], v250
    v_exp_f32 v210, v210
    v_exp_f32 v211, v211
    v_exp_f32 v212, v212
    v_exp_f32 v213, v213
    v_mfma_f32_32x32x16_bf16 v[192:207], v[116:119], a[228:231], 0
    v_exp_f32 v214, v214
    v_exp_f32 v215, v215
    v_exp_f32 v216, v216
    v_exp_f32 v217, v217
    v_smfmac_f32_32x32x32_bf16 v[48:63], v[108:111], v[208:215], v250
    s_add_u32 s20, s20, 4096
    buffer_load_dwordx4 a[32:35], v1, s[4:7], s20 offen offset:0 sc1
    buffer_load_dwordx4 a[40:43], v1, s[4:7], s20 offen offset:1024 sc1
    buffer_load_dwordx4 a[48:51], v1, s[4:7], s20 offen offset:2048 sc1
    buffer_load_dwordx4 a[56:59], v1, s[4:7], s20 offen offset:3072 sc1
    v_exp_f32 v218, v218
    v_exp_f32 v219, v219
    v_exp_f32 v220, v220
    v_exp_f32 v221, v221
    v_exp_f32 v222, v222
    v_exp_f32 v223, v223
    v_exp_f32 v224, v224
    v_exp_f32 v225, v225
    v_smfmac_f32_32x32x32_bf16 v[48:63], v[112:115], v[216:223], v250
    v_exp_f32 v226, v226
    v_exp_f32 v227, v227
    v_exp_f32 v228, v228
    v_exp_f32 v229, v229
    v_mfma_f32_32x32x16_bf16 v[208:223], v[116:119], a[232:235], 0
    v_exp_f32 v230, v230
    v_exp_f32 v231, v231
    v_exp_f32 v232, v232
    v_exp_f32 v233, v233
    v_smfmac_f32_32x32x32_bf16 v[64:79], v[108:111], v[224:231], v250
    v_exp_f32 v234, v234
    v_exp_f32 v235, v235
    v_exp_f32 v236, v236
    v_exp_f32 v237, v237
    v_exp_f32 v238, v238
    v_exp_f32 v239, v239
    v_exp_f32 v176, v176
    v_exp_f32 v177, v177
    v_smfmac_f32_32x32x32_bf16 v[64:79], v[112:115], v[232:239], v250
    v_exp_f32 v178, v178
    v_exp_f32 v179, v179
    v_exp_f32 v180, v180
    v_exp_f32 v181, v181
    v_mfma_f32_32x32x16_bf16 v[224:239], v[116:119], a[236:239], 0
    v_exp_f32 v182, v182
    v_exp_f32 v183, v183
    v_exp_f32 v184, v184
    v_exp_f32 v185, v185
    v_smfmac_f32_32x32x32_bf16 v[16:31], v[120:123], v[176:183], v250
    s_add_u32 m0, s97, 0
    s_add_u32 s21, s36, s97
    buffer_load_dwordx4 v1, s[4:7], s21 offen offset:0 sc1 lds
    buffer_load_dwordx4 v1, s[4:7], s21 offen offset:1024 sc1 lds
    buffer_load_dwordx4 v1, s[4:7], s21 offen offset:2048 sc1 lds
    buffer_load_dwordx4 v1, s[4:7], s21 offen offset:3072 sc1 lds
    v_exp_f32 v186, v186
    v_exp_f32 v187, v187
    v_exp_f32 v188, v188
    v_exp_f32 v189, v189
    v_exp_f32 v190, v190
    v_exp_f32 v191, v191
    v_exp_f32 v192, v192
    v_exp_f32 v193, v193
    v_smfmac_f32_32x32x32_bf16 v[16:31], v[124:127], v[184:191], v250
    v_exp_f32 v194, v194
    v_exp_f32 v195, v195
    v_exp_f32 v196, v196
    v_exp_f32 v197, v197
    v_mfma_f32_32x32x16_bf16 v[176:191], v[128:131], a[224:227], 0
    v_exp_f32 v198, v198
    v_exp_f32 v199, v199
    v_exp_f32 v200, v200
    v_exp_f32 v201, v201
    v_smfmac_f32_32x32x32_bf16 v[32:47], v[120:123], v[192:199], v250
    v_exp_f32 v202, v202
    v_exp_f32 v203, v203
    v_exp_f32 v204, v204
    v_exp_f32 v205, v205
    v_exp_f32 v206, v206
    v_exp_f32 v207, v207
    v_exp_f32 v208, v208
    v_exp_f32 v209, v209
    v_smfmac_f32_32x32x32_bf16 v[32:47], v[124:127], v[200:207], v250
    v_exp_f32 v210, v210
    v_exp_f32 v211, v211
    v_exp_f32 v212, v212
    v_exp_f32 v213, v213
    v_mfma_f32_32x32x16_bf16 v[192:207], v[128:131], a[228:231], 0
    v_exp_f32 v214, v214
    v_exp_f32 v215, v215
    v_exp_f32 v216, v216
    v_exp_f32 v217, v217
    v_smfmac_f32_32x32x32_bf16 v[48:63], v[120:123], v[208:215], v250
    s_add_u32 s20, s20, 4096
    buffer_load_dwordx4 a[64:67], v1, s[4:7], s20 offen offset:0 sc1
    buffer_load_dwordx4 a[72:75], v1, s[4:7], s20 offen offset:1024 sc1
    buffer_load_dwordx4 a[80:83], v1, s[4:7], s20 offen offset:2048 sc1
    buffer_load_dwordx4 a[88:91], v1, s[4:7], s20 offen offset:3072 sc1
    v_exp_f32 v218, v218
    v_exp_f32 v219, v219
    v_exp_f32 v220, v220
    v_exp_f32 v221, v221
    v_exp_f32 v222, v222
    v_exp_f32 v223, v223
    v_exp_f32 v224, v224
    v_exp_f32 v225, v225
    v_smfmac_f32_32x32x32_bf16 v[48:63], v[124:127], v[216:223], v250
    v_exp_f32 v226, v226
    v_exp_f32 v227, v227
    v_exp_f32 v228, v228
    v_exp_f32 v229, v229
    v_mfma_f32_32x32x16_bf16 v[208:223], v[128:131], a[232:235], 0
    v_exp_f32 v230, v230
    v_exp_f32 v231, v231
    v_exp_f32 v232, v232
    v_exp_f32 v233, v233
    v_smfmac_f32_32x32x32_bf16 v[64:79], v[120:123], v[224:231], v250
    v_exp_f32 v234, v234
    v_exp_f32 v235, v235
    v_exp_f32 v236, v236
    v_exp_f32 v237, v237
    v_exp_f32 v238, v238
    v_exp_f32 v239, v239
    v_exp_f32 v176, v176
    v_exp_f32 v177, v177
    v_smfmac_f32_32x32x32_bf16 v[64:79], v[124:127], v[232:239], v250
    v_exp_f32 v178, v178
    v_exp_f32 v179, v179
    v_exp_f32 v180, v180
    v_exp_f32 v181, v181
    v_mfma_f32_32x32x16_bf16 v[224:239], v[128:131], a[236:239], 0
    v_exp_f32 v182, v182
    v_exp_f32 v183, v183
    v_exp_f32 v184, v184
    v_exp_f32 v185, v185
    v_smfmac_f32_32x32x32_bf16 v[16:31], v[132:135], v[176:183], v250
    s_xor_b32 s24, s69, 73728
    buffer_load_dwordx4 v[104:107], v248, s[4:7], s24 offen offset:0 sc1
    buffer_load_dwordx4 v[116:119], v248, s[4:7], s24 offen offset:2048 sc1
    s_mov_b64 exec, s[30:31]
    buffer_load_dwordx4 v[108:111], v249, s[4:7], s24 offen offset:1024 sc1
    buffer_load_dwordx4 v[112:115], v249, s[4:7], s24 offen offset:1536 sc1
    buffer_load_dwordx4 v[120:123], v249, s[4:7], s24 offen offset:3072 sc1
    buffer_load_dwordx4 v[124:127], v249, s[4:7], s24 offen offset:3584 sc1
    s_mov_b64 exec, -1
    v_exp_f32 v186, v186
    v_exp_f32 v187, v187
    v_exp_f32 v188, v188
    v_exp_f32 v189, v189
    v_exp_f32 v190, v190
    v_exp_f32 v191, v191
    v_exp_f32 v192, v192
    v_exp_f32 v193, v193
    v_smfmac_f32_32x32x32_bf16 v[16:31], v[136:139], v[184:191], v250
    v_exp_f32 v194, v194
    v_exp_f32 v195, v195
    v_exp_f32 v196, v196
    v_exp_f32 v197, v197
    v_mfma_f32_32x32x16_bf16 v[176:191], v[140:143], a[224:227], 0
    v_exp_f32 v198, v198
    v_exp_f32 v199, v199
    v_exp_f32 v200, v200
    v_exp_f32 v201, v201
    v_smfmac_f32_32x32x32_bf16 v[32:47], v[132:135], v[192:199], v250
    v_exp_f32 v202, v202
    v_exp_f32 v203, v203
    v_exp_f32 v204, v204
    v_exp_f32 v205, v205
    v_exp_f32 v206, v206
    v_exp_f32 v207, v207
    v_exp_f32 v208, v208
    v_exp_f32 v209, v209
    v_smfmac_f32_32x32x32_bf16 v[32:47], v[136:139], v[200:207], v250
    v_exp_f32 v210, v210
    v_exp_f32 v211, v211
    v_exp_f32 v212, v212
    v_exp_f32 v213, v213
    v_mfma_f32_32x32x16_bf16 v[192:207], v[140:143], a[228:231], 0
    v_exp_f32 v214, v214
    v_exp_f32 v215, v215
    v_exp_f32 v216, v216
    v_exp_f32 v217, v217
    v_smfmac_f32_32x32x32_bf16 v[48:63], v[132:135], v[208:215], v250
    s_add_u32 s20, s20, 4096
    buffer_load_dwordx4 a[96:99], v1, s[4:7], s20 offen offset:0 sc1
    buffer_load_dwordx4 a[104:107], v1, s[4:7], s20 offen offset:1024 sc1
    buffer_load_dwordx4 a[112:115], v1, s[4:7], s20 offen offset:2048 sc1
    buffer_load_dwordx4 a[120:123], v1, s[4:7], s20 offen offset:3072 sc1
    v_exp_f32 v218, v218
    v_exp_f32 v219, v219
    v_exp_f32 v220, v220
    v_exp_f32 v221, v221
    v_exp_f32 v222, v222
    v_exp_f32 v223, v223
    v_exp_f32 v224, v224
    v_exp_f32 v225, v225
    v_smfmac_f32_32x32x32_bf16 v[48:63], v[136:139], v[216:223], v250
    v_exp_f32 v226, v226
    v_exp_f32 v227, v227
    v_exp_f32 v228, v228
    v_exp_f32 v229, v229
    v_mfma_f32_32x32x16_bf16 v[208:223], v[140:143], a[232:235], 0
    v_exp_f32 v230, v230
    v_exp_f32 v231, v231
    v_exp_f32 v232, v232
    v_exp_f32 v233, v233
    v_smfmac_f32_32x32x32_bf16 v[64:79], v[132:135], v[224:231], v250
    v_exp_f32 v234, v234
    v_exp_f32 v235, v235
    v_exp_f32 v236, v236
    v_exp_f32 v237, v237
    v_exp_f32 v238, v238
    v_exp_f32 v239, v239
    v_exp_f32 v176, v176
    v_exp_f32 v177, v177
    v_smfmac_f32_32x32x32_bf16 v[64:79], v[136:139], v[232:239], v250
    v_exp_f32 v178, v178
    v_exp_f32 v179, v179
    v_exp_f32 v180, v180
    v_exp_f32 v181, v181
    v_mfma_f32_32x32x16_bf16 v[224:239], v[140:143], a[236:239], 0
    v_exp_f32 v182, v182
    v_exp_f32 v183, v183
    v_exp_f32 v184, v184
    v_exp_f32 v185, v185
    v_smfmac_f32_32x32x32_bf16 v[16:31], v[144:147], v[176:183], v250
    s_add_u32 m0, s97, 16384
    s_add_u32 s21, s21, 16384
    buffer_load_dwordx4 v1, s[4:7], s21 offen offset:0 sc1 lds
    buffer_load_dwordx4 v1, s[4:7], s21 offen offset:1024 sc1 lds
    buffer_load_dwordx4 v1, s[4:7], s21 offen offset:2048 sc1 lds
    buffer_load_dwordx4 v1, s[4:7], s21 offen offset:3072 sc1 lds
    v_exp_f32 v186, v186
    v_exp_f32 v187, v187
    v_exp_f32 v188, v188
    v_exp_f32 v189, v189
    v_exp_f32 v190, v190
    v_exp_f32 v191, v191
    v_exp_f32 v192, v192
    v_exp_f32 v193, v193
    v_smfmac_f32_32x32x32_bf16 v[16:31], v[148:151], v[184:191], v250
    v_exp_f32 v194, v194
    v_exp_f32 v195, v195
    v_exp_f32 v196, v196
    v_exp_f32 v197, v197
    v_mfma_f32_32x32x16_bf16 v[176:191], v[152:155], a[224:227], 0
    v_exp_f32 v198, v198
    v_exp_f32 v199, v199
    v_exp_f32 v200, v200
    v_exp_f32 v201, v201
    v_smfmac_f32_32x32x32_bf16 v[32:47], v[144:147], v[192:199], v250
    v_exp_f32 v202, v202
    v_exp_f32 v203, v203
    v_exp_f32 v204, v204
    v_exp_f32 v205, v205
    v_exp_f32 v206, v206
    v_exp_f32 v207, v207
    v_exp_f32 v208, v208
    v_exp_f32 v209, v209
    v_smfmac_f32_32x32x32_bf16 v[32:47], v[148:151], v[200:207], v250
    v_exp_f32 v210, v210
    v_exp_f32 v211, v211
    v_exp_f32 v212, v212
    v_exp_f32 v213, v213
    v_mfma_f32_32x32x16_bf16 v[192:207], v[152:155], a[228:231], 0
    v_exp_f32 v214, v214
    v_exp_f32 v215, v215
    v_exp_f32 v216, v216
    v_exp_f32 v217, v217
    v_smfmac_f32_32x32x32_bf16 v[48:63], v[144:147], v[208:215], v250
    s_add_u32 s20, s20, 4096
    buffer_load_dwordx4 a[128:131], v1, s[4:7], s20 offen offset:0 sc1
    buffer_load_dwordx4 a[136:139], v1, s[4:7], s20 offen offset:1024 sc1
    buffer_load_dwordx4 a[144:147], v1, s[4:7], s20 offen offset:2048 sc1
    buffer_load_dwordx4 a[152:155], v1, s[4:7], s20 offen offset:3072 sc1
    v_exp_f32 v218, v218
    v_exp_f32 v219, v219
    v_exp_f32 v220, v220
    v_exp_f32 v221, v221
    v_exp_f32 v222, v222
    v_exp_f32 v223, v223
    v_exp_f32 v224, v224
    v_exp_f32 v225, v225
    v_smfmac_f32_32x32x32_bf16 v[48:63], v[148:151], v[216:223], v250
    v_exp_f32 v226, v226
    v_exp_f32 v227, v227
    v_exp_f32 v228, v228
    v_exp_f32 v229, v229
    v_mfma_f32_32x32x16_bf16 v[208:223], v[152:155], a[232:235], 0
    v_exp_f32 v230, v230
    v_exp_f32 v231, v231
    v_exp_f32 v232, v232
    v_exp_f32 v233, v233
    v_smfmac_f32_32x32x32_bf16 v[64:79], v[144:147], v[224:231], v250
    v_exp_f32 v234, v234
    v_exp_f32 v235, v235
    v_exp_f32 v236, v236
    v_exp_f32 v237, v237
    v_exp_f32 v238, v238
    v_exp_f32 v239, v239
    v_exp_f32 v176, v176
    v_exp_f32 v177, v177
    v_smfmac_f32_32x32x32_bf16 v[64:79], v[148:151], v[232:239], v250
    v_exp_f32 v178, v178
    v_exp_f32 v179, v179
    v_exp_f32 v180, v180
    v_exp_f32 v181, v181
    v_mfma_f32_32x32x16_bf16 v[224:239], v[152:155], a[236:239], 0
    v_exp_f32 v182, v182
    v_exp_f32 v183, v183
    v_exp_f32 v184, v184
    v_exp_f32 v185, v185
    v_smfmac_f32_32x32x32_bf16 v[16:31], v[156:159], v[176:183], v250
    s_xor_b32 s24, s69, 81920
    buffer_load_dwordx4 v[128:131], v248, s[4:7], s24 offen offset:0 sc1
    buffer_load_dwordx4 v[140:143], v248, s[4:7], s24 offen offset:2048 sc1
    s_mov_b64 exec, s[30:31]
    buffer_load_dwordx4 v[132:135], v249, s[4:7], s24 offen offset:1024 sc1
    buffer_load_dwordx4 v[136:139], v249, s[4:7], s24 offen offset:1536 sc1
    buffer_load_dwordx4 v[144:147], v249, s[4:7], s24 offen offset:3072 sc1
    buffer_load_dwordx4 v[148:151], v249, s[4:7], s24 offen offset:3584 sc1
    s_mov_b64 exec, -1
    v_exp_f32 v186, v186
    v_exp_f32 v187, v187
    v_exp_f32 v188, v188
    v_exp_f32 v189, v189
    v_exp_f32 v190, v190
    v_exp_f32 v191, v191
    v_exp_f32 v192, v192
    v_exp_f32 v193, v193
    v_smfmac_f32_32x32x32_bf16 v[16:31], v[160:163], v[184:191], v250
    v_exp_f32 v194, v194
    v_exp_f32 v195, v195
    v_exp_f32 v196, v196
    v_exp_f32 v197, v197
    v_mfma_f32_32x32x16_bf16 v[176:191], v[164:167], a[224:227], 0
    v_exp_f32 v198, v198
    v_exp_f32 v199, v199
    v_exp_f32 v200, v200
    v_exp_f32 v201, v201
    v_smfmac_f32_32x32x32_bf16 v[32:47], v[156:159], v[192:199], v250
    v_exp_f32 v202, v202
    v_exp_f32 v203, v203
    v_exp_f32 v204, v204
    v_exp_f32 v205, v205
    v_exp_f32 v206, v206
    v_exp_f32 v207, v207
    v_exp_f32 v208, v208
    v_exp_f32 v209, v209
    v_smfmac_f32_32x32x32_bf16 v[32:47], v[160:163], v[200:207], v250
    v_exp_f32 v210, v210
    v_exp_f32 v211, v211
    v_exp_f32 v212, v212
    v_exp_f32 v213, v213
    v_mfma_f32_32x32x16_bf16 v[192:207], v[164:167], a[228:231], 0
    v_exp_f32 v214, v214
    v_exp_f32 v215, v215
    v_exp_f32 v216, v216
    v_exp_f32 v217, v217
    v_smfmac_f32_32x32x32_bf16 v[48:63], v[156:159], v[208:215], v250
    s_add_u32 s20, s20, 4096
    buffer_load_dwordx4 a[160:163], v1, s[4:7], s20 offen offset:0 sc1
    buffer_load_dwordx4 a[168:171], v1, s[4:7], s20 offen offset:1024 sc1
    buffer_load_dwordx4 a[176:179], v1, s[4:7], s20 offen offset:2048 sc1
    buffer_load_dwordx4 a[184:187], v1, s[4:7], s20 offen offset:3072 sc1
    v_exp_f32 v218, v218
    v_exp_f32 v219, v219
    v_exp_f32 v220, v220
    v_exp_f32 v221, v221
    v_exp_f32 v222, v222
    v_exp_f32 v223, v223
    v_exp_f32 v224, v224
    v_exp_f32 v225, v225
    v_smfmac_f32_32x32x32_bf16 v[48:63], v[160:163], v[216:223], v250
    v_exp_f32 v226, v226
    v_exp_f32 v227, v227
    v_exp_f32 v228, v228
    v_exp_f32 v229, v229
    v_mfma_f32_32x32x16_bf16 v[208:223], v[164:167], a[232:235], 0
    v_exp_f32 v230, v230
    v_exp_f32 v231, v231
    v_exp_f32 v232, v232
    v_exp_f32 v233, v233
    v_smfmac_f32_32x32x32_bf16 v[64:79], v[156:159], v[224:231], v250
    v_exp_f32 v234, v234
    v_exp_f32 v235, v235
    v_exp_f32 v236, v236
    v_exp_f32 v237, v237
    v_exp_f32 v238, v238
    v_exp_f32 v239, v239
    v_exp_f32 v176, v176
    v_exp_f32 v177, v177
    v_smfmac_f32_32x32x32_bf16 v[64:79], v[160:163], v[232:239], v250
    v_exp_f32 v178, v178
    v_exp_f32 v179, v179
    v_exp_f32 v180, v180
    v_exp_f32 v181, v181
    v_mfma_f32_32x32x16_bf16 v[224:239], v[164:167], a[236:239], 0
    v_exp_f32 v182, v182
    v_exp_f32 v183, v183
    v_exp_f32 v184, v184
    v_exp_f32 v185, v185
    v_smfmac_f32_32x32x32_bf16 v[16:31], v[168:171], v[176:183], v250
    s_add_u32 m0, s97, 32768
    s_add_u32 s21, s21, 16384
    buffer_load_dwordx4 v1, s[4:7], s21 offen offset:0 sc1 lds
    buffer_load_dwordx4 v1, s[4:7], s21 offen offset:1024 sc1 lds
    buffer_load_dwordx4 v1, s[4:7], s21 offen offset:2048 sc1 lds
    buffer_load_dwordx4 v1, s[4:7], s21 offen offset:3072 sc1 lds
    v_exp_f32 v186, v186
    v_exp_f32 v187, v187
    v_exp_f32 v188, v188
    v_exp_f32 v189, v189
    v_exp_f32 v190, v190
    v_exp_f32 v191, v191
    v_exp_f32 v192, v192
    v_exp_f32 v193, v193
    v_smfmac_f32_32x32x32_bf16 v[16:31], v[172:175], v[184:191], v250
    v_exp_f32 v194, v194
    v_exp_f32 v195, v195
    v_exp_f32 v196, v196
    v_exp_f32 v197, v197
    s_waitcnt vmcnt(44)
    v_mfma_f32_32x32x16_bf16 v[176:191], v[80:83], a[224:227], 0
    v_exp_f32 v198, v198
    v_exp_f32 v199, v199
    v_exp_f32 v200, v200
    v_exp_f32 v201, v201
    v_smfmac_f32_32x32x32_bf16 v[32:47], v[168:171], v[192:199], v250
    v_exp_f32 v202, v202
    v_exp_f32 v203, v203
    v_exp_f32 v204, v204
    v_exp_f32 v205, v205
    v_exp_f32 v206, v206
    v_exp_f32 v207, v207
    v_exp_f32 v208, v208
    v_exp_f32 v209, v209
    v_smfmac_f32_32x32x32_bf16 v[32:47], v[172:175], v[200:207], v250
    v_exp_f32 v210, v210
    v_exp_f32 v211, v211
    v_exp_f32 v212, v212
    v_exp_f32 v213, v213
    v_mfma_f32_32x32x16_bf16 v[192:207], v[80:83], a[228:231], 0
    v_exp_f32 v214, v214
    v_exp_f32 v215, v215
    v_exp_f32 v216, v216
    v_exp_f32 v217, v217
    v_smfmac_f32_32x32x32_bf16 v[48:63], v[168:171], v[208:215], v250
    s_add_u32 s20, s20, 4096
    buffer_load_dwordx4 a[192:195], v1, s[4:7], s20 offen offset:0 sc1
    buffer_load_dwordx4 a[200:203], v1, s[4:7], s20 offen offset:1024 sc1
    buffer_load_dwordx4 a[208:211], v1, s[4:7], s20 offen offset:2048 sc1
    buffer_load_dwordx4 a[216:219], v1, s[4:7], s20 offen offset:3072 sc1
    v_exp_f32 v218, v218
    v_exp_f32 v219, v219
    v_exp_f32 v220, v220
    v_exp_f32 v221, v221
    v_exp_f32 v222, v222
    v_exp_f32 v223, v223
    v_exp_f32 v224, v224
    v_exp_f32 v225, v225
    v_smfmac_f32_32x32x32_bf16 v[48:63], v[172:175], v[216:223], v250
    v_exp_f32 v226, v226
    v_exp_f32 v227, v227
    v_exp_f32 v228, v228
    v_exp_f32 v229, v229
    v_mfma_f32_32x32x16_bf16 v[208:223], v[80:83], a[232:235], 0
    v_exp_f32 v230, v230
    v_exp_f32 v231, v231
    v_exp_f32 v232, v232
    v_exp_f32 v233, v233
    v_smfmac_f32_32x32x32_bf16 v[64:79], v[168:171], v[224:231], v250
    v_exp_f32 v234, v234
    v_exp_f32 v235, v235
    v_exp_f32 v236, v236
    v_exp_f32 v237, v237
    v_exp_f32 v238, v238
    v_exp_f32 v239, v239
    v_exp_f32 v176, v176
    v_exp_f32 v177, v177
    v_smfmac_f32_32x32x32_bf16 v[64:79], v[172:175], v[232:239], v250
    v_exp_f32 v178, v178
    v_exp_f32 v179, v179
    v_exp_f32 v180, v180
    v_exp_f32 v181, v181
    v_mfma_f32_32x32x16_bf16 v[224:239], v[80:83], a[236:239], 0
    v_exp_f32 v182, v182
    v_exp_f32 v183, v183
    v_exp_f32 v184, v184
    v_exp_f32 v185, v185
    v_smfmac_f32_32x32x32_bf16 v[16:31], v[84:87], v[176:183], v250
    s_xor_b32 s24, s69, 90112
    buffer_load_dwordx4 v[152:155], v248, s[4:7], s24 offen offset:0 sc1
    buffer_load_dwordx4 v[164:167], v248, s[4:7], s24 offen offset:2048 sc1
    s_mov_b64 exec, s[30:31]
    buffer_load_dwordx4 v[156:159], v249, s[4:7], s24 offen offset:1024 sc1
    buffer_load_dwordx4 v[160:163], v249, s[4:7], s24 offen offset:1536 sc1
    buffer_load_dwordx4 v[168:171], v249, s[4:7], s24 offen offset:3072 sc1
    buffer_load_dwordx4 v[172:175], v249, s[4:7], s24 offen offset:3584 sc1
    s_mov_b64 exec, -1
    v_exp_f32 v186, v186
    v_exp_f32 v187, v187
    v_exp_f32 v188, v188
    v_exp_f32 v189, v189
    v_exp_f32 v190, v190
    v_exp_f32 v191, v191
    v_exp_f32 v192, v192
    v_exp_f32 v193, v193
    v_smfmac_f32_32x32x32_bf16 v[16:31], v[88:91], v[184:191], v250
    v_exp_f32 v194, v194
    v_exp_f32 v195, v195
    v_exp_f32 v196, v196
    v_exp_f32 v197, v197
    v_mfma_f32_32x32x16_bf16 v[176:191], v[92:95], a[224:227], 0
    v_exp_f32 v198, v198
    v_exp_f32 v199, v199
    v_exp_f32 v200, v200
    v_exp_f32 v201, v201
    v_smfmac_f32_32x32x32_bf16 v[32:47], v[84:87], v[192:199], v250
    v_exp_f32 v202, v202
    v_exp_f32 v203, v203
    v_exp_f32 v204, v204
    v_exp_f32 v205, v205
    v_exp_f32 v206, v206
    v_exp_f32 v207, v207
    v_exp_f32 v208, v208
    v_exp_f32 v209, v209
    v_smfmac_f32_32x32x32_bf16 v[32:47], v[88:91], v[200:207], v250
    v_exp_f32 v210, v210
    v_exp_f32 v211, v211
    v_exp_f32 v212, v212
    v_exp_f32 v213, v213
    v_mfma_f32_32x32x16_bf16 v[192:207], v[92:95], a[228:231], 0
    v_exp_f32 v214, v214
    v_exp_f32 v215, v215
    v_exp_f32 v216, v216
    v_exp_f32 v217, v217
    v_smfmac_f32_32x32x32_bf16 v[48:63], v[84:87], v[208:215], v250
    buffer_load_dwordx4 a[4:7], v1, s[4:7], s39 offen offset:0 sc1
    buffer_load_dwordx4 a[12:15], v1, s[4:7], s39 offen offset:1024 sc1
    buffer_load_dwordx4 a[20:23], v1, s[4:7], s39 offen offset:2048 sc1
    buffer_load_dwordx4 a[28:31], v1, s[4:7], s39 offen offset:3072 sc1
    v_exp_f32 v218, v218
    v_exp_f32 v219, v219
    v_exp_f32 v220, v220
    v_exp_f32 v221, v221
    v_exp_f32 v222, v222
    v_exp_f32 v223, v223
    v_exp_f32 v224, v224
    v_exp_f32 v225, v225
    v_smfmac_f32_32x32x32_bf16 v[48:63], v[88:91], v[216:223], v250
    v_exp_f32 v226, v226
    v_exp_f32 v227, v227
    v_exp_f32 v228, v228
    v_exp_f32 v229, v229
    v_mfma_f32_32x32x16_bf16 v[208:223], v[92:95], a[232:235], 0
    v_exp_f32 v230, v230
    v_exp_f32 v231, v231
    v_exp_f32 v232, v232
    v_exp_f32 v233, v233
    v_smfmac_f32_32x32x32_bf16 v[64:79], v[84:87], v[224:231], v250
    v_exp_f32 v234, v234
    v_exp_f32 v235, v235
    v_exp_f32 v236, v236
    v_exp_f32 v237, v237
    v_exp_f32 v238, v238
    v_exp_f32 v239, v239
    v_exp_f32 v176, v176
    v_exp_f32 v177, v177
    v_smfmac_f32_32x32x32_bf16 v[64:79], v[88:91], v[232:239], v250
    v_exp_f32 v178, v178
    v_exp_f32 v179, v179
    v_exp_f32 v180, v180
    v_exp_f32 v181, v181
    v_mfma_f32_32x32x16_bf16 v[224:239], v[92:95], a[236:239], 0
    v_exp_f32 v182, v182
    v_exp_f32 v183, v183
    v_exp_f32 v184, v184
    v_exp_f32 v185, v185
    v_smfmac_f32_32x32x32_bf16 v[16:31], v[96:99], v[176:183], v250
    s_add_u32 m0, s97, 49152
    s_add_u32 s21, s21, 16384
    buffer_load_dwordx4 v1, s[4:7], s21 offen offset:0 sc1 lds
    buffer_load_dwordx4 v1, s[4:7], s21 offen offset:1024 sc1 lds
    buffer_load_dwordx4 v1, s[4:7], s21 offen offset:2048 sc1 lds
    buffer_load_dwordx4 v1, s[4:7], s21 offen offset:3072 sc1 lds
    v_exp_f32 v186, v186
    v_exp_f32 v187, v187
    v_exp_f32 v188, v188
    v_exp_f32 v189, v189
    v_exp_f32 v190, v190
    v_exp_f32 v191, v191
    v_exp_f32 v192, v192
    v_exp_f32 v193, v193
    v_smfmac_f32_32x32x32_bf16 v[16:31], v[100:103], v[184:191], v250
    v_exp_f32 v194, v194
    v_exp_f32 v195, v195
    v_exp_f32 v196, v196
    v_exp_f32 v197, v197
    s_waitcnt vmcnt(44)
    v_mfma_f32_32x32x16_bf16 v[176:191], v[104:107], a[224:227], 0
    v_exp_f32 v198, v198
    v_exp_f32 v199, v199
    v_exp_f32 v200, v200
    v_exp_f32 v201, v201
    v_smfmac_f32_32x32x32_bf16 v[32:47], v[96:99], v[192:199], v250
    v_exp_f32 v202, v202
    v_exp_f32 v203, v203
    v_exp_f32 v204, v204
    v_exp_f32 v205, v205
    v_exp_f32 v206, v206
    v_exp_f32 v207, v207
    v_exp_f32 v208, v208
    v_exp_f32 v209, v209
    v_smfmac_f32_32x32x32_bf16 v[32:47], v[100:103], v[200:207], v250
    v_exp_f32 v210, v210
    v_exp_f32 v211, v211
    v_exp_f32 v212, v212
    v_exp_f32 v213, v213
    v_mfma_f32_32x32x16_bf16 v[192:207], v[104:107], a[228:231], 0
    v_exp_f32 v214, v214
    v_exp_f32 v215, v215
    v_exp_f32 v216, v216
    v_exp_f32 v217, v217
    v_smfmac_f32_32x32x32_bf16 v[48:63], v[96:99], v[208:215], v250
    s_add_u32 s39, s39, 4096
    buffer_load_dwordx4 a[36:39], v1, s[4:7], s39 offen offset:0 sc1
    buffer_load_dwordx4 a[44:47], v1, s[4:7], s39 offen offset:1024 sc1
    buffer_load_dwordx4 a[52:55], v1, s[4:7], s39 offen offset:2048 sc1
    buffer_load_dwordx4 a[60:63], v1, s[4:7], s39 offen offset:3072 sc1
    v_exp_f32 v218, v218
    v_exp_f32 v219, v219
    v_exp_f32 v220, v220
    v_exp_f32 v221, v221
    v_exp_f32 v222, v222
    v_exp_f32 v223, v223
    v_exp_f32 v224, v224
    v_exp_f32 v225, v225
    v_smfmac_f32_32x32x32_bf16 v[48:63], v[100:103], v[216:223], v250
    v_exp_f32 v226, v226
    v_exp_f32 v227, v227
    v_exp_f32 v228, v228
    v_exp_f32 v229, v229
    v_mfma_f32_32x32x16_bf16 v[208:223], v[104:107], a[232:235], 0
    v_exp_f32 v230, v230
    v_exp_f32 v231, v231
    v_exp_f32 v232, v232
    v_exp_f32 v233, v233
    v_smfmac_f32_32x32x32_bf16 v[64:79], v[96:99], v[224:231], v250
    v_exp_f32 v234, v234
    v_exp_f32 v235, v235
    v_exp_f32 v236, v236
    v_exp_f32 v237, v237
    v_exp_f32 v238, v238
    v_exp_f32 v239, v239
    v_exp_f32 v176, v176
    v_exp_f32 v177, v177
    v_smfmac_f32_32x32x32_bf16 v[64:79], v[100:103], v[232:239], v250
    v_exp_f32 v178, v178
    v_exp_f32 v179, v179
    v_exp_f32 v180, v180
    v_exp_f32 v181, v181
    v_mfma_f32_32x32x16_bf16 v[224:239], v[104:107], a[236:239], 0
    v_exp_f32 v182, v182
    v_exp_f32 v183, v183
    v_exp_f32 v184, v184
    v_exp_f32 v185, v185
    v_smfmac_f32_32x32x32_bf16 v[16:31], v[108:111], v[176:183], v250
    s_xor_b32 s24, s69, 98304
    buffer_load_dwordx4 v[80:83], v248, s[4:7], s24 offen offset:0 sc1
    buffer_load_dwordx4 v[92:95], v248, s[4:7], s24 offen offset:2048 sc1
    s_mov_b64 exec, s[30:31]
    buffer_load_dwordx4 v[84:87], v249, s[4:7], s24 offen offset:1024 sc1
    buffer_load_dwordx4 v[88:91], v249, s[4:7], s24 offen offset:1536 sc1
    buffer_load_dwordx4 v[96:99], v249, s[4:7], s24 offen offset:3072 sc1
    buffer_load_dwordx4 v[100:103], v249, s[4:7], s24 offen offset:3584 sc1
    s_mov_b64 exec, -1
    v_exp_f32 v186, v186
    v_exp_f32 v187, v187
    v_exp_f32 v188, v188
    v_exp_f32 v189, v189
    v_exp_f32 v190, v190
    v_exp_f32 v191, v191
    v_exp_f32 v192, v192
    v_exp_f32 v193, v193
    v_smfmac_f32_32x32x32_bf16 v[16:31], v[112:115], v[184:191], v250
    v_exp_f32 v194, v194
    v_exp_f32 v195, v195
    v_exp_f32 v196, v196
    v_exp_f32 v197, v197
    v_mfma_f32_32x32x16_bf16 v[176:191], v[116:119], a[224:227], 0
    v_exp_f32 v198, v198
    v_exp_f32 v199, v199
    v_exp_f32 v200, v200
    v_exp_f32 v201, v201
    v_smfmac_f32_32x32x32_bf16 v[32:47], v[108:111], v[192:199], v250
    v_exp_f32 v202, v202
    v_exp_f32 v203, v203
    v_exp_f32 v204, v204
    v_exp_f32 v205, v205
    v_exp_f32 v206, v206
    v_exp_f32 v207, v207
    v_exp_f32 v208, v208
    v_exp_f32 v209, v209
    v_smfmac_f32_32x32x32_bf16 v[32:47], v[112:115], v[200:207], v250
    v_exp_f32 v210, v210
    v_exp_f32 v211, v211
    v_exp_f32 v212, v212
    v_exp_f32 v213, v213
    v_mfma_f32_32x32x16_bf16 v[192:207], v[116:119], a[228:231], 0
    v_exp_f32 v214, v214
    v_exp_f32 v215, v215
    v_exp_f32 v216, v216
    v_exp_f32 v217, v217
    v_smfmac_f32_32x32x32_bf16 v[48:63], v[108:111], v[208:215], v250
    s_add_u32 s39, s39, 4096
    buffer_load_dwordx4 a[68:71], v1, s[4:7], s39 offen offset:0 sc1
    buffer_load_dwordx4 a[76:79], v1, s[4:7], s39 offen offset:1024 sc1
    buffer_load_dwordx4 a[84:87], v1, s[4:7], s39 offen offset:2048 sc1
    buffer_load_dwordx4 a[92:95], v1, s[4:7], s39 offen offset:3072 sc1
    v_exp_f32 v218, v218
    v_exp_f32 v219, v219
    v_exp_f32 v220, v220
    v_exp_f32 v221, v221
    v_exp_f32 v222, v222
    v_exp_f32 v223, v223
    v_exp_f32 v224, v224
    v_exp_f32 v225, v225
    v_smfmac_f32_32x32x32_bf16 v[48:63], v[112:115], v[216:223], v250
    v_exp_f32 v226, v226
    v_exp_f32 v227, v227
    v_exp_f32 v228, v228
    v_exp_f32 v229, v229
    v_mfma_f32_32x32x16_bf16 v[208:223], v[116:119], a[232:235], 0
    v_exp_f32 v230, v230
    v_exp_f32 v231, v231
    v_exp_f32 v232, v232
    v_exp_f32 v233, v233
    v_smfmac_f32_32x32x32_bf16 v[64:79], v[108:111], v[224:231], v250
    v_exp_f32 v234, v234
    v_exp_f32 v235, v235
    v_exp_f32 v236, v236
    v_exp_f32 v237, v237
    v_exp_f32 v238, v238
    v_exp_f32 v239, v239
    v_exp_f32 v176, v176
    v_exp_f32 v177, v177
    v_smfmac_f32_32x32x32_bf16 v[64:79], v[112:115], v[232:239], v250
    v_exp_f32 v178, v178
    v_exp_f32 v179, v179
    v_exp_f32 v180, v180
    v_exp_f32 v181, v181
    v_mfma_f32_32x32x16_bf16 v[224:239], v[116:119], a[236:239], 0
    v_exp_f32 v182, v182
    v_exp_f32 v183, v183
    v_exp_f32 v184, v184
    v_exp_f32 v185, v185
    v_smfmac_f32_32x32x32_bf16 v[16:31], v[120:123], v[176:183], v250
    s_add_u32 m0, s97, 65536
    s_add_u32 s21, s37, s97
    buffer_load_dwordx4 v1, s[4:7], s21 offen offset:0 sc1 lds
    buffer_load_dwordx4 v1, s[4:7], s21 offen offset:1024 sc1 lds
    buffer_load_dwordx4 v1, s[4:7], s21 offen offset:2048 sc1 lds
    buffer_load_dwordx4 v1, s[4:7], s21 offen offset:3072 sc1 lds
    v_exp_f32 v186, v186
    v_exp_f32 v187, v187
    v_exp_f32 v188, v188
    v_exp_f32 v189, v189
    v_exp_f32 v190, v190
    v_exp_f32 v191, v191
    v_exp_f32 v192, v192
    v_exp_f32 v193, v193
    v_smfmac_f32_32x32x32_bf16 v[16:31], v[124:127], v[184:191], v250
    v_exp_f32 v194, v194
    v_exp_f32 v195, v195
    v_exp_f32 v196, v196
    v_exp_f32 v197, v197
    s_waitcnt vmcnt(44)
    v_mfma_f32_32x32x16_bf16 v[176:191], v[128:131], a[224:227], 0
    v_exp_f32 v198, v198
    v_exp_f32 v199, v199
    v_exp_f32 v200, v200
    v_exp_f32 v201, v201
    v_smfmac_f32_32x32x32_bf16 v[32:47], v[120:123], v[192:199], v250
    v_exp_f32 v202, v202
    v_exp_f32 v203, v203
    v_exp_f32 v204, v204
    v_exp_f32 v205, v205
    v_exp_f32 v206, v206
    v_exp_f32 v207, v207
    v_exp_f32 v208, v208
    v_exp_f32 v209, v209
    v_smfmac_f32_32x32x32_bf16 v[32:47], v[124:127], v[200:207], v250
    v_exp_f32 v210, v210
    v_exp_f32 v211, v211
    v_exp_f32 v212, v212
    v_exp_f32 v213, v213
    v_mfma_f32_32x32x16_bf16 v[192:207], v[128:131], a[228:231], 0
    v_exp_f32 v214, v214
    v_exp_f32 v215, v215
    v_exp_f32 v216, v216
    v_exp_f32 v217, v217
    v_smfmac_f32_32x32x32_bf16 v[48:63], v[120:123], v[208:215], v250
    s_add_u32 s39, s39, 4096
    buffer_load_dwordx4 a[100:103], v1, s[4:7], s39 offen offset:0 sc1
    buffer_load_dwordx4 a[108:111], v1, s[4:7], s39 offen offset:1024 sc1
    buffer_load_dwordx4 a[116:119], v1, s[4:7], s39 offen offset:2048 sc1
    buffer_load_dwordx4 a[124:127], v1, s[4:7], s39 offen offset:3072 sc1
    v_exp_f32 v218, v218
    v_exp_f32 v219, v219
    v_exp_f32 v220, v220
    v_exp_f32 v221, v221
    v_exp_f32 v222, v222
    v_exp_f32 v223, v223
    v_exp_f32 v224, v224
    v_exp_f32 v225, v225
    v_smfmac_f32_32x32x32_bf16 v[48:63], v[124:127], v[216:223], v250
    v_exp_f32 v226, v226
    v_exp_f32 v227, v227
    v_exp_f32 v228, v228
    v_exp_f32 v229, v229
    v_mfma_f32_32x32x16_bf16 v[208:223], v[128:131], a[232:235], 0
    v_exp_f32 v230, v230
    v_exp_f32 v231, v231
    v_exp_f32 v232, v232
    v_exp_f32 v233, v233
    v_smfmac_f32_32x32x32_bf16 v[64:79], v[120:123], v[224:231], v250
    v_exp_f32 v234, v234
    v_exp_f32 v235, v235
    v_exp_f32 v236, v236
    v_exp_f32 v237, v237
    v_exp_f32 v238, v238
    v_exp_f32 v239, v239
    v_exp_f32 v176, v176
    v_exp_f32 v177, v177
    v_smfmac_f32_32x32x32_bf16 v[64:79], v[124:127], v[232:239], v250
    v_exp_f32 v178, v178
    v_exp_f32 v179, v179
    v_exp_f32 v180, v180
    v_exp_f32 v181, v181
    v_mfma_f32_32x32x16_bf16 v[224:239], v[128:131], a[236:239], 0
    v_exp_f32 v182, v182
    v_exp_f32 v183, v183
    v_exp_f32 v184, v184
    v_exp_f32 v185, v185
    v_smfmac_f32_32x32x32_bf16 v[16:31], v[132:135], v[176:183], v250
    s_xor_b32 s24, s69, 106496
    buffer_load_dwordx4 v[104:107], v248, s[4:7], s24 offen offset:0 sc1
    buffer_load_dwordx4 v[116:119], v248, s[4:7], s24 offen offset:2048 sc1
    s_mov_b64 exec, s[30:31]
    buffer_load_dwordx4 v[108:111], v249, s[4:7], s24 offen offset:1024 sc1
    buffer_load_dwordx4 v[112:115], v249, s[4:7], s24 offen offset:1536 sc1
    buffer_load_dwordx4 v[120:123], v249, s[4:7], s24 offen offset:3072 sc1
    buffer_load_dwordx4 v[124:127], v249, s[4:7], s24 offen offset:3584 sc1
    s_mov_b64 exec, -1
    v_exp_f32 v186, v186
    v_exp_f32 v187, v187
    v_exp_f32 v188, v188
    v_exp_f32 v189, v189
    v_exp_f32 v190, v190
    v_exp_f32 v191, v191
    v_exp_f32 v192, v192
    v_exp_f32 v193, v193
    v_smfmac_f32_32x32x32_bf16 v[16:31], v[136:139], v[184:191], v250
    v_exp_f32 v194, v194
    v_exp_f32 v195, v195
    v_exp_f32 v196, v196
    v_exp_f32 v197, v197
    v_mfma_f32_32x32x16_bf16 v[176:191], v[140:143], a[224:227], 0
    v_exp_f32 v198, v198
    v_exp_f32 v199, v199
    v_exp_f32 v200, v200
    v_exp_f32 v201, v201
    v_smfmac_f32_32x32x32_bf16 v[32:47], v[132:135], v[192:199], v250
    v_and_b32 v11, 0xf80, v251
    s_lshl_b32 s25, s13, 12
    s_add_u32 s25, s25, 8278016
    buffer_load_dwordx4 v[12:15], v11, s[4:7], s25 offen sc1
    v_exp_f32 v202, v202
    v_exp_f32 v203, v203
    v_exp_f32 v204, v204
    v_exp_f32 v205, v205
    v_exp_f32 v206, v206
    v_exp_f32 v207, v207
    v_exp_f32 v208, v208
    v_exp_f32 v209, v209
    v_smfmac_f32_32x32x32_bf16 v[32:47], v[136:139], v[200:207], v250
    v_exp_f32 v210, v210
    v_exp_f32 v211, v211
    v_exp_f32 v212, v212
    v_exp_f32 v213, v213
    v_mfma_f32_32x32x16_bf16 v[192:207], v[140:143], a[228:231], 0
    v_exp_f32 v214, v214
    v_exp_f32 v215, v215
    v_exp_f32 v216, v216
    v_exp_f32 v217, v217
    v_smfmac_f32_32x32x32_bf16 v[48:63], v[132:135], v[208:215], v250
    s_add_u32 s39, s39, 4096
    buffer_load_dwordx4 a[132:135], v1, s[4:7], s39 offen offset:0 sc1
    buffer_load_dwordx4 a[140:143], v1, s[4:7], s39 offen offset:1024 sc1
    buffer_load_dwordx4 a[148:151], v1, s[4:7], s39 offen offset:2048 sc1
    buffer_load_dwordx4 a[156:159], v1, s[4:7], s39 offen offset:3072 sc1
    v_exp_f32 v218, v218
    v_exp_f32 v219, v219
    v_exp_f32 v220, v220
    v_exp_f32 v221, v221
    v_exp_f32 v222, v222
    v_exp_f32 v223, v223
    v_exp_f32 v224, v224
    v_exp_f32 v225, v225
    v_smfmac_f32_32x32x32_bf16 v[48:63], v[136:139], v[216:223], v250
    v_exp_f32 v226, v226
    v_exp_f32 v227, v227
    v_exp_f32 v228, v228
    v_exp_f32 v229, v229
    v_mfma_f32_32x32x16_bf16 v[208:223], v[140:143], a[232:235], 0
    v_exp_f32 v230, v230
    v_exp_f32 v231, v231
    v_exp_f32 v232, v232
    v_exp_f32 v233, v233
    v_smfmac_f32_32x32x32_bf16 v[64:79], v[132:135], v[224:231], v250
    v_exp_f32 v234, v234
    v_exp_f32 v235, v235
    v_exp_f32 v236, v236
    v_exp_f32 v237, v237
    v_exp_f32 v238, v238
    v_exp_f32 v239, v239
    v_exp_f32 v176, v176
    v_exp_f32 v177, v177
    v_smfmac_f32_32x32x32_bf16 v[64:79], v[136:139], v[232:239], v250
    v_exp_f32 v178, v178
    v_exp_f32 v179, v179
    v_exp_f32 v180, v180
    v_exp_f32 v181, v181
    v_mfma_f32_32x32x16_bf16 v[224:239], v[140:143], a[236:239], 0
    v_exp_f32 v182, v182
    v_exp_f32 v183, v183
    v_exp_f32 v184, v184
    v_exp_f32 v185, v185
    v_smfmac_f32_32x32x32_bf16 v[16:31], v[144:147], v[176:183], v250
    s_add_u32 m0, s97, 81920
    s_add_u32 s21, s21, 16384
    buffer_load_dwordx4 v1, s[4:7], s21 offen offset:0 sc1 lds
    buffer_load_dwordx4 v1, s[4:7], s21 offen offset:1024 sc1 lds
    buffer_load_dwordx4 v1, s[4:7], s21 offen offset:2048 sc1 lds
    buffer_load_dwordx4 v1, s[4:7], s21 offen offset:3072 sc1 lds
    v_exp_f32 v186, v186
    v_exp_f32 v187, v187
    v_exp_f32 v188, v188
    v_exp_f32 v189, v189
    v_exp_f32 v190, v190
    v_exp_f32 v191, v191
    v_exp_f32 v192, v192
    v_exp_f32 v193, v193
    v_smfmac_f32_32x32x32_bf16 v[16:31], v[148:151], v[184:191], v250
    v_exp_f32 v194, v194
    v_exp_f32 v195, v195
    v_exp_f32 v196, v196
    v_exp_f32 v197, v197
    s_waitcnt vmcnt(45)
    v_mfma_f32_32x32x16_bf16 v[176:191], v[152:155], a[224:227], 0
    v_exp_f32 v198, v198
    v_exp_f32 v199, v199
    v_exp_f32 v200, v200
    v_exp_f32 v201, v201
    v_smfmac_f32_32x32x32_bf16 v[32:47], v[144:147], v[192:199], v250
    v_exp_f32 v202, v202
    v_exp_f32 v203, v203
    v_exp_f32 v204, v204
    v_exp_f32 v205, v205
    v_exp_f32 v206, v206
    v_exp_f32 v207, v207
    v_exp_f32 v208, v208
    v_exp_f32 v209, v209
    v_smfmac_f32_32x32x32_bf16 v[32:47], v[148:151], v[200:207], v250
    v_exp_f32 v210, v210
    v_exp_f32 v211, v211
    v_exp_f32 v212, v212
    v_exp_f32 v213, v213
    v_mfma_f32_32x32x16_bf16 v[192:207], v[152:155], a[228:231], 0
    v_exp_f32 v214, v214
    v_exp_f32 v215, v215
    v_exp_f32 v216, v216
    v_exp_f32 v217, v217
    v_smfmac_f32_32x32x32_bf16 v[48:63], v[144:147], v[208:215], v250
    s_add_u32 s39, s39, 4096
    buffer_load_dwordx4 a[164:167], v1, s[4:7], s39 offen offset:0 sc1
    buffer_load_dwordx4 a[172:175], v1, s[4:7], s39 offen offset:1024 sc1
    buffer_load_dwordx4 a[180:183], v1, s[4:7], s39 offen offset:2048 sc1
    buffer_load_dwordx4 a[188:191], v1, s[4:7], s39 offen offset:3072 sc1
    v_exp_f32 v218, v218
    v_exp_f32 v219, v219
    v_exp_f32 v220, v220
    v_exp_f32 v221, v221
    v_exp_f32 v222, v222
    v_exp_f32 v223, v223
    v_exp_f32 v224, v224
    v_exp_f32 v225, v225
    v_smfmac_f32_32x32x32_bf16 v[48:63], v[148:151], v[216:223], v250
    v_exp_f32 v226, v226
    v_exp_f32 v227, v227
    v_exp_f32 v228, v228
    v_exp_f32 v229, v229
    v_mfma_f32_32x32x16_bf16 v[208:223], v[152:155], a[232:235], 0
    v_exp_f32 v230, v230
    v_exp_f32 v231, v231
    v_exp_f32 v232, v232
    v_exp_f32 v233, v233
    v_smfmac_f32_32x32x32_bf16 v[64:79], v[144:147], v[224:231], v250
    v_exp_f32 v234, v234
    v_exp_f32 v235, v235
    v_exp_f32 v236, v236
    v_exp_f32 v237, v237
    v_exp_f32 v238, v238
    v_exp_f32 v239, v239
    v_exp_f32 v176, v176
    v_exp_f32 v177, v177
    v_smfmac_f32_32x32x32_bf16 v[64:79], v[148:151], v[232:239], v250
    v_exp_f32 v178, v178
    v_exp_f32 v179, v179
    v_exp_f32 v180, v180
    v_exp_f32 v181, v181
    v_mfma_f32_32x32x16_bf16 v[224:239], v[152:155], a[236:239], 0
    v_exp_f32 v182, v182
    v_exp_f32 v183, v183
    v_exp_f32 v184, v184
    v_exp_f32 v185, v185
    v_smfmac_f32_32x32x32_bf16 v[16:31], v[156:159], v[176:183], v250
    s_xor_b32 s24, s69, 114688
    buffer_load_dwordx4 v[128:131], v248, s[4:7], s24 offen offset:0 sc1
    buffer_load_dwordx4 v[140:143], v248, s[4:7], s24 offen offset:2048 sc1
    s_mov_b64 exec, s[30:31]
    buffer_load_dwordx4 v[132:135], v249, s[4:7], s24 offen offset:1024 sc1
    buffer_load_dwordx4 v[136:139], v249, s[4:7], s24 offen offset:1536 sc1
    buffer_load_dwordx4 v[144:147], v249, s[4:7], s24 offen offset:3072 sc1
    buffer_load_dwordx4 v[148:151], v249, s[4:7], s24 offen offset:3584 sc1
    s_mov_b64 exec, -1
    v_exp_f32 v186, v186
    v_exp_f32 v187, v187
    v_exp_f32 v188, v188
    v_exp_f32 v189, v189
    v_exp_f32 v190, v190
    v_exp_f32 v191, v191
    v_exp_f32 v192, v192
    v_exp_f32 v193, v193
    v_smfmac_f32_32x32x32_bf16 v[16:31], v[160:163], v[184:191], v250
    v_exp_f32 v194, v194
    v_exp_f32 v195, v195
    v_exp_f32 v196, v196
    v_exp_f32 v197, v197
    v_mfma_f32_32x32x16_bf16 v[176:191], v[164:167], a[224:227], 0
    v_exp_f32 v198, v198
    v_exp_f32 v199, v199
    v_exp_f32 v200, v200
    v_exp_f32 v201, v201
    v_smfmac_f32_32x32x32_bf16 v[32:47], v[156:159], v[192:199], v250
    v_exp_f32 v202, v202
    v_exp_f32 v203, v203
    v_exp_f32 v204, v204
    v_exp_f32 v205, v205
    v_exp_f32 v206, v206
    v_exp_f32 v207, v207
    v_exp_f32 v208, v208
    v_exp_f32 v209, v209
    v_smfmac_f32_32x32x32_bf16 v[32:47], v[160:163], v[200:207], v250
    v_exp_f32 v210, v210
    v_exp_f32 v211, v211
    v_exp_f32 v212, v212
    v_exp_f32 v213, v213
    v_mfma_f32_32x32x16_bf16 v[192:207], v[164:167], a[228:231], 0
    v_exp_f32 v214, v214
    v_exp_f32 v215, v215
    v_exp_f32 v216, v216
    v_exp_f32 v217, v217
    v_smfmac_f32_32x32x32_bf16 v[48:63], v[156:159], v[208:215], v250
    s_add_u32 s39, s39, 4096
    buffer_load_dwordx4 a[196:199], v1, s[4:7], s39 offen offset:0 sc1
    buffer_load_dwordx4 a[204:207], v1, s[4:7], s39 offen offset:1024 sc1
    buffer_load_dwordx4 a[212:215], v1, s[4:7], s39 offen offset:2048 sc1
    buffer_load_dwordx4 a[220:223], v1, s[4:7], s39 offen offset:3072 sc1
    v_exp_f32 v218, v218
    v_exp_f32 v219, v219
    v_exp_f32 v220, v220
    v_exp_f32 v221, v221
    v_exp_f32 v222, v222
    v_exp_f32 v223, v223
    v_exp_f32 v224, v224
    v_exp_f32 v225, v225
    v_smfmac_f32_32x32x32_bf16 v[48:63], v[160:163], v[216:223], v250
    v_exp_f32 v226, v226
    v_exp_f32 v227, v227
    v_exp_f32 v228, v228
    v_exp_f32 v229, v229
    v_mfma_f32_32x32x16_bf16 v[208:223], v[164:167], a[232:235], 0
    v_exp_f32 v230, v230
    v_exp_f32 v231, v231
    v_exp_f32 v232, v232
    v_exp_f32 v233, v233
    v_smfmac_f32_32x32x32_bf16 v[64:79], v[156:159], v[224:231], v250
    v_exp_f32 v234, v234
    v_exp_f32 v235, v235
    v_exp_f32 v236, v236
    v_exp_f32 v237, v237
    v_exp_f32 v238, v238
    v_exp_f32 v239, v239
    v_exp_f32 v176, v176
    v_exp_f32 v177, v177
    v_smfmac_f32_32x32x32_bf16 v[64:79], v[160:163], v[232:239], v250
    v_exp_f32 v178, v178
    v_exp_f32 v179, v179
    v_exp_f32 v180, v180
    v_exp_f32 v181, v181
    v_mfma_f32_32x32x16_bf16 v[224:239], v[164:167], a[236:239], 0
    v_exp_f32 v182, v182
    v_exp_f32 v183, v183
    v_exp_f32 v184, v184
    v_exp_f32 v185, v185
    v_smfmac_f32_32x32x32_bf16 v[16:31], v[168:171], v[176:183], v250
    s_add_u32 m0, s97, 98304
    s_add_u32 s21, s21, 16384
    buffer_load_dwordx4 v1, s[4:7], s21 offen offset:0 sc1 lds
    buffer_load_dwordx4 v1, s[4:7], s21 offen offset:1024 sc1 lds
    buffer_load_dwordx4 v1, s[4:7], s21 offen offset:2048 sc1 lds
    buffer_load_dwordx4 v1, s[4:7], s21 offen offset:3072 sc1 lds
    s_getpc_b64 s[90:91]
pc_12:
    s_min_u32 s40, s85, L_end-pc_12-1024
    s_add_u32 s90, s90, s40
    s_addc_u32 s91, s91, 0
    global_load_dword v5, v1, s[90:91] offset:0
    v_exp_f32 v186, v186
    v_exp_f32 v187, v187
    v_exp_f32 v188, v188
    v_exp_f32 v189, v189
    v_exp_f32 v190, v190
    v_exp_f32 v191, v191
    v_exp_f32 v192, v192
    v_exp_f32 v193, v193
    v_smfmac_f32_32x32x32_bf16 v[16:31], v[172:175], v[184:191], v250
    v_exp_f32 v194, v194
    v_exp_f32 v195, v195
    v_exp_f32 v196, v196
    v_exp_f32 v197, v197
    s_waitcnt vmcnt(46)
    v_mfma_f32_32x32x16_bf16 v[176:191], v[80:83], a[224:227], 0
    v_exp_f32 v198, v198
    v_exp_f32 v199, v199
    v_exp_f32 v200, v200
    v_exp_f32 v201, v201
    v_smfmac_f32_32x32x32_bf16 v[32:47], v[168:171], v[192:199], v250
    v_exp_f32 v202, v202
    v_exp_f32 v203, v203
    v_exp_f32 v204, v204
    v_exp_f32 v205, v205
    v_exp_f32 v206, v206
    v_exp_f32 v207, v207
    v_exp_f32 v208, v208
    v_exp_f32 v209, v209
    v_smfmac_f32_32x32x32_bf16 v[32:47], v[172:175], v[200:207], v250
    v_exp_f32 v210, v210
    v_exp_f32 v211, v211
    v_exp_f32 v212, v212
    v_exp_f32 v213, v213
    v_mfma_f32_32x32x16_bf16 v[192:207], v[80:83], a[228:231], 0
    v_exp_f32 v214, v214
    v_exp_f32 v215, v215
    v_exp_f32 v216, v216
    v_exp_f32 v217, v217
    v_smfmac_f32_32x32x32_bf16 v[48:63], v[168:171], v[208:215], v250
    s_add_u32 m0, s97, 114688
    s_add_u32 s21, s21, 16384
    buffer_load_dwordx4 v1, s[4:7], s21 offen offset:0 sc1 lds
    buffer_load_dwordx4 v1, s[4:7], s21 offen offset:1024 sc1 lds
    buffer_load_dwordx4 v1, s[4:7], s21 offen offset:2048 sc1 lds
    buffer_load_dwordx4 v1, s[4:7], s21 offen offset:3072 sc1 lds
    v_exp_f32 v218, v218
    v_exp_f32 v219, v219
    v_exp_f32 v220, v220
    v_exp_f32 v221, v221
    v_exp_f32 v222, v222
    v_exp_f32 v223, v223
    v_exp_f32 v224, v224
    v_exp_f32 v225, v225
    v_smfmac_f32_32x32x32_bf16 v[48:63], v[172:175], v[216:223], v250
    v_exp_f32 v226, v226
    v_exp_f32 v227, v227
    v_exp_f32 v228, v228
    v_exp_f32 v229, v229
    v_mfma_f32_32x32x16_bf16 v[208:223], v[80:83], a[232:235], 0
    v_exp_f32 v230, v230
    v_exp_f32 v231, v231
    v_exp_f32 v232, v232
    v_exp_f32 v233, v233
    v_smfmac_f32_32x32x32_bf16 v[64:79], v[168:171], v[224:231], v250
    s_waitcnt vmcnt(31)
    v_cmp_ne_u64 vcc, s[32:33], v[14:15]
    s_nop 0
    s_cbranch_vccnz ap_13
apok_14:
    s_xor_b32 s18, s32, s35
    v_cmp_ne_u32 vcc, s18, v12
    s_nop 0
    s_cmp_eq_u64 vcc, 0
    s_cselect_b32 s34, 1, 0
    v_exp_f32 v234, v234
    v_exp_f32 v235, v235
    v_exp_f32 v236, v236
    v_exp_f32 v237, v237
    v_exp_f32 v238, v238
    v_exp_f32 v239, v239
    v_exp_f32 v176, v176
    v_exp_f32 v177, v177
    v_smfmac_f32_32x32x32_bf16 v[64:79], v[172:175], v[232:239], v250
    v_exp_f32 v178, v178
    v_exp_f32 v179, v179
    v_exp_f32 v180, v180
    v_exp_f32 v181, v181
    v_mfma_f32_32x32x16_bf16 v[224:239], v[80:83], a[236:239], 0
    v_exp_f32 v182, v182
    v_exp_f32 v183, v183
    v_exp_f32 v184, v184
    v_exp_f32 v185, v185
    v_smfmac_f32_32x32x32_bf16 v[16:31], v[84:87], v[176:183], v250
    s_xor_b32 s24, s69, 122880
    buffer_load_dwordx4 v[152:155], v248, s[4:7], s24 offen offset:0 sc1
    buffer_load_dwordx4 v[164:167], v248, s[4:7], s24 offen offset:2048 sc1
    s_mov_b64 exec, s[30:31]
    buffer_load_dwordx4 v[156:159], v249, s[4:7], s24 offen offset:1024 sc1
    buffer_load_dwordx4 v[160:163], v249, s[4:7], s24 offen offset:1536 sc1
    buffer_load_dwordx4 v[168:171], v249, s[4:7], s24 offen offset:3072 sc1
    buffer_load_dwordx4 v[172:175], v249, s[4:7], s24 offen offset:3584 sc1
    s_mov_b64 exec, -1
    v_exp_f32 v186, v186
    v_exp_f32 v187, v187
    v_exp_f32 v188, v188
    v_exp_f32 v189, v189
    v_exp_f32 v190, v190
    v_exp_f32 v191, v191
    v_exp_f32 v192, v192
    v_exp_f32 v193, v193
    v_smfmac_f32_32x32x32_bf16 v[16:31], v[88:91], v[184:191], v250
    v_exp_f32 v194, v194
    v_exp_f32 v195, v195
    v_exp_f32 v196, v196
    v_exp_f32 v197, v197
    v_mfma_f32_32x32x16_bf16 v[176:191], v[92:95], a[224:227], 0
    v_exp_f32 v198, v198
    v_exp_f32 v199, v199
    v_exp_f32 v200, v200
    v_exp_f32 v201, v201
    v_smfmac_f32_32x32x32_bf16 v[32:47], v[84:87], v[192:199], v250
    v_and_b32 v14, 31, v0
    v_lshlrev_b32 v14, 10, v14
    v_bfe_u32 v15, v0, 5, 1
    v_lshlrev_b32 v15, 4, v15
    v_add_u32 v14, v14, v15
    s_and_b32 s16, s100, 0xffff8000
    s_bfe_u32 s19, s100, 0x5000a
    s_lshl_b32 s19, s19, 5
    s_add_u32 s16, s16, s19
    buffer_load_dwordx4 v[240:243], v14, s[60:63], s16 offen
    buffer_load_dwordx4 v[244:247], v14, s[60:63], s16 offen offset:32
    v_exp_f32 v202, v202
    v_exp_f32 v203, v203
    v_exp_f32 v204, v204
    v_exp_f32 v205, v205
    v_exp_f32 v206, v206
    v_exp_f32 v207, v207
    v_exp_f32 v208, v208
    v_exp_f32 v209, v209
    v_smfmac_f32_32x32x32_bf16 v[32:47], v[88:91], v[200:207], v250
    v_exp_f32 v210, v210
    v_exp_f32 v211, v211
    v_exp_f32 v212, v212
    v_exp_f32 v213, v213
    v_mfma_f32_32x32x16_bf16 v[192:207], v[92:95], a[228:231], 0
    v_exp_f32 v214, v214
    v_exp_f32 v215, v215
    v_exp_f32 v216, v216
    v_exp_f32 v217, v217
    v_smfmac_f32_32x32x32_bf16 v[48:63], v[84:87], v[208:215], v250
    v_exp_f32 v218, v218
    v_exp_f32 v219, v219
    v_exp_f32 v220, v220
    v_exp_f32 v221, v221
    v_exp_f32 v222, v222
    v_exp_f32 v223, v223
    v_exp_f32 v224, v224
    v_exp_f32 v225, v225
    v_smfmac_f32_32x32x32_bf16 v[48:63], v[88:91], v[216:223], v250
    v_exp_f32 v226, v226
    v_exp_f32 v227, v227
    v_exp_f32 v228, v228
    v_exp_f32 v229, v229
    v_mfma_f32_32x32x16_bf16 v[208:223], v[92:95], a[232:235], 0
    v_exp_f32 v230, v230
    v_exp_f32 v231, v231
    v_exp_f32 v232, v232
    v_exp_f32 v233, v233
    v_smfmac_f32_32x32x32_bf16 v[64:79], v[84:87], v[224:231], v250
    v_and_b32 v4, 3968, v251
    buffer_load_dword v5, v4, s[4:7], s73 offen sc1
    v_exp_f32 v234, v234
    v_exp_f32 v235, v235
    v_exp_f32 v236, v236
    v_exp_f32 v237, v237
    v_exp_f32 v238, v238
    v_exp_f32 v239, v239
    v_exp_f32 v176, v176
    v_exp_f32 v177, v177
    v_smfmac_f32_32x32x32_bf16 v[64:79], v[88:91], v[232:239], v250
    v_exp_f32 v178, v178
    v_exp_f32 v179, v179
    v_exp_f32 v180, v180
    v_exp_f32 v181, v181
    v_mfma_f32_32x32x16_bf16 v[224:239], v[92:95], a[236:239], 0
    v_exp_f32 v182, v182
    v_exp_f32 v183, v183
    v_exp_f32 v184, v184
    v_exp_f32 v185, v185
    v_smfmac_f32_32x32x32_bf16 v[16:31], v[96:99], v[176:183], v250
    v_exp_f32 v186, v186
    v_exp_f32 v187, v187
    v_exp_f32 v188, v188
    v_exp_f32 v189, v189
    v_exp_f32 v190, v190
    v_exp_f32 v191, v191
    v_exp_f32 v192, v192
    v_exp_f32 v193, v193
    v_smfmac_f32_32x32x32_bf16 v[16:31], v[100:103], v[184:191], v250
    v_exp_f32 v194, v194
    v_exp_f32 v195, v195
    v_exp_f32 v196, v196
    v_exp_f32 v197, v197
    v_mfma_f32_32x32x16_bf16 v[176:191], v[104:107], a[224:227], 0
    v_exp_f32 v198, v198
    v_exp_f32 v199, v199
    v_exp_f32 v200, v200
    v_exp_f32 v201, v201
    v_smfmac_f32_32x32x32_bf16 v[32:47], v[96:99], v[192:199], v250
    s_add_u32 s73, s73, 4096
    buffer_load_dword v5, v4, s[4:7], s73 offen sc1
    v_exp_f32 v202, v202
    v_exp_f32 v203, v203
    v_exp_f32 v204, v204
    v_exp_f32 v205, v205
    v_exp_f32 v206, v206
    v_exp_f32 v207, v207
    v_exp_f32 v208, v208
    v_exp_f32 v209, v209
    v_smfmac_f32_32x32x32_bf16 v[32:47], v[100:103], v[200:207], v250
    v_exp_f32 v210, v210
    v_exp_f32 v211, v211
    v_exp_f32 v212, v212
    v_exp_f32 v213, v213
    v_mfma_f32_32x32x16_bf16 v[192:207], v[104:107], a[228:231], 0
    v_exp_f32 v214, v214
    v_exp_f32 v215, v215
    v_exp_f32 v216, v216
    v_exp_f32 v217, v217
    v_smfmac_f32_32x32x32_bf16 v[48:63], v[96:99], v[208:215], v250
    v_exp_f32 v218, v218
    v_exp_f32 v219, v219
    v_exp_f32 v220, v220
    v_exp_f32 v221, v221
    v_exp_f32 v222, v222
    v_exp_f32 v223, v223
    v_exp_f32 v224, v224
    v_exp_f32 v225, v225
    v_smfmac_f32_32x32x32_bf16 v[48:63], v[100:103], v[216:223], v250
    v_exp_f32 v226, v226
    v_exp_f32 v227, v227
    v_exp_f32 v228, v228
    v_exp_f32 v229, v229
    v_mfma_f32_32x32x16_bf16 v[208:223], v[104:107], a[232:235], 0
    v_exp_f32 v230, v230
    v_exp_f32 v231, v231
    v_exp_f32 v232, v232
    v_exp_f32 v233, v233
    v_smfmac_f32_32x32x32_bf16 v[64:79], v[96:99], v[224:231], v250
    v_and_b32 v4, 3968, v251
    buffer_load_dword v5, v4, s[4:7], s72 offen sc1
    v_exp_f32 v234, v234
    v_exp_f32 v235, v235
    v_exp_f32 v236, v236
    v_exp_f32 v237, v237
    v_exp_f32 v238, v238
    v_exp_f32 v239, v239
    v_exp_f32 v176, v176
    v_exp_f32 v177, v177
    v_smfmac_f32_32x32x32_bf16 v[64:79], v[100:103], v[232:239], v250
    v_exp_f32 v178, v178
    v_exp_f32 v179, v179
    v_exp_f32 v180, v180
    v_exp_f32 v181, v181
    v_mfma_f32_32x32x16_bf16 v[224:239], v[104:107], a[236:239], 0
    v_exp_f32 v182, v182
    v_exp_f32 v183, v183
    v_exp_f32 v184, v184
    v_exp_f32 v185, v185
    v_smfmac_f32_32x32x32_bf16 v[16:31], v[108:111], v[176:183], v250
    v_exp_f32 v186, v186
    v_exp_f32 v187, v187
    v_exp_f32 v188, v188
    v_exp_f32 v189, v189
    v_exp_f32 v190, v190
    v_exp_f32 v191, v191
    v_exp_f32 v192, v192
    v_exp_f32 v193, v193
    v_smfmac_f32_32x32x32_bf16 v[16:31], v[112:115], v[184:191], v250
    v_exp_f32 v194, v194
    v_exp_f32 v195, v195
    v_exp_f32 v196, v196
    v_exp_f32 v197, v197
    v_mfma_f32_32x32x16_bf16 v[176:191], v[116:119], a[224:227], 0
    v_exp_f32 v198, v198
    v_exp_f32 v199, v199
    v_exp_f32 v200, v200
    v_exp_f32 v201, v201
    v_smfmac_f32_32x32x32_bf16 v[32:47], v[108:111], v[192:199], v250
    v_exp_f32 v202, v202
    v_exp_f32 v203, v203
    v_exp_f32 v204, v204
    v_exp_f32 v205, v205
    v_exp_f32 v206, v206
    v_exp_f32 v207, v207
    v_exp_f32 v208, v208
    v_exp_f32 v209, v209
    v_smfmac_f32_32x32x32_bf16 v[32:47], v[112:115], v[200:207], v250
    v_exp_f32 v210, v210
    v_exp_f32 v211, v211
    v_exp_f32 v212, v212
    v_exp_f32 v213, v213
    v_mfma_f32_32x32x16_bf16 v[192:207], v[116:119], a[228:231], 0
    v_exp_f32 v214, v214
    v_exp_f32 v215, v215
    v_exp_f32 v216, v216
    v_exp_f32 v217, v217
    v_smfmac_f32_32x32x32_bf16 v[48:63], v[108:111], v[208:215], v250
    s_add_u32 s72, s72, 4096
    buffer_load_dword v5, v4, s[4:7], s72 offen sc1
    v_exp_f32 v218, v218
    v_exp_f32 v219, v219
    v_exp_f32 v220, v220
    v_exp_f32 v221, v221
    v_exp_f32 v222, v222
    v_exp_f32 v223, v223
    v_exp_f32 v224, v224
    v_exp_f32 v225, v225
    v_smfmac_f32_32x32x32_bf16 v[48:63], v[112:115], v[216:223], v250
    v_exp_f32 v226, v226
    v_exp_f32 v227, v227
    v_exp_f32 v228, v228
    v_exp_f32 v229, v229
    v_mfma_f32_32x32x16_bf16 v[208:223], v[116:119], a[232:235], 0
    v_exp_f32 v230, v230
    v_exp_f32 v231, v231
    v_exp_f32 v232, v232
    v_exp_f32 v233, v233
    v_smfmac_f32_32x32x32_bf16 v[64:79], v[108:111], v[224:231], v250
    buffer_load_dword v5, v252, s[4:7], 0 offen sc1
    v_exp_f32 v234, v234
    v_exp_f32 v235, v235
    v_exp_f32 v236, v236
    v_exp_f32 v237, v237
    v_exp_f32 v238, v238
    v_exp_f32 v239, v239
    v_exp_f32 v176, v176
    v_exp_f32 v177, v177
    v_smfmac_f32_32x32x32_bf16 v[64:79], v[112:115], v[232:239], v250
    v_exp_f32 v178, v178
    v_exp_f32 v179, v179
    v_exp_f32 v180, v180
    v_exp_f32 v181, v181
    v_mfma_f32_32x32x16_bf16 v[224:239], v[116:119], a[236:239], 0
    v_exp_f32 v182, v182
    v_exp_f32 v183, v183
    v_exp_f32 v184, v184
    v_exp_f32 v185, v185
    v_smfmac_f32_32x32x32_bf16 v[16:31], v[120:123], v[176:183], v250
    v_exp_f32 v186, v186
    v_exp_f32 v187, v187
    v_exp_f32 v188, v188
    v_exp_f32 v189, v189
    v_exp_f32 v190, v190
    v_exp_f32 v191, v191
    v_exp_f32 v192, v192
    v_exp_f32 v193, v193
    v_smfmac_f32_32x32x32_bf16 v[16:31], v[124:127], v[184:191], v250
    v_exp_f32 v194, v194
    v_exp_f32 v195, v195
    v_exp_f32 v196, v196
    v_exp_f32 v197, v197
    s_waitcnt vmcnt(26)
    v_mfma_f32_32x32x16_bf16 v[176:191], v[128:131], a[224:227], 0
    v_exp_f32 v198, v198
    v_exp_f32 v199, v199
    v_exp_f32 v200, v200
    v_exp_f32 v201, v201
    v_smfmac_f32_32x32x32_bf16 v[32:47], v[120:123], v[192:199], v250
    v_exp_f32 v202, v202
    v_exp_f32 v203, v203
    v_exp_f32 v204, v204
    v_exp_f32 v205, v205
    v_exp_f32 v206, v206
    v_exp_f32 v207, v207
    v_exp_f32 v208, v208
    v_exp_f32 v209, v209
    v_smfmac_f32_32x32x32_bf16 v[32:47], v[124:127], v[200:207], v250
    v_exp_f32 v210, v210
    v_exp_f32 v211, v211
    v_exp_f32 v212, v212
    v_exp_f32 v213, v213
    v_mfma_f32_32x32x16_bf16 v[192:207], v[128:131], a[228:231], 0
    v_exp_f32 v214, v214
    v_exp_f32 v215, v215
    v_exp_f32 v216, v216
    v_exp_f32 v217, v217
    v_smfmac_f32_32x32x32_bf16 v[48:63], v[120:123], v[208:215], v250
    v_exp_f32 v218, v218
    v_exp_f32 v219, v219
    v_exp_f32 v220, v220
    v_exp_f32 v221, v221
    v_exp_f32 v222, v222
    v_exp_f32 v223, v223
    v_exp_f32 v224, v224
    v_exp_f32 v225, v225
    v_smfmac_f32_32x32x32_bf16 v[48:63], v[124:127], v[216:223], v250
    v_exp_f32 v226, v226
    v_exp_f32 v227, v227
    v_exp_f32 v228, v228
    v_exp_f32 v229, v229
    v_mfma_f32_32x32x16_bf16 v[208:223], v[128:131], a[232:235], 0
    v_exp_f32 v230, v230
    v_exp_f32 v231, v231
    v_exp_f32 v232, v232
    v_exp_f32 v233, v233
    v_smfmac_f32_32x32x32_bf16 v[64:79], v[120:123], v[224:231], v250
    v_exp_f32 v234, v234
    v_exp_f32 v235, v235
    v_exp_f32 v236, v236
    v_exp_f32 v237, v237
    v_exp_f32 v238, v238
    v_exp_f32 v239, v239
    v_exp_f32 v176, v176
    v_exp_f32 v177, v177
    v_smfmac_f32_32x32x32_bf16 v[64:79], v[124:127], v[232:239], v250
    v_exp_f32 v178, v178
    v_exp_f32 v179, v179
    v_exp_f32 v180, v180
    v_exp_f32 v181, v181
    v_mfma_f32_32x32x16_bf16 v[224:239], v[128:131], a[236:239], 0
    v_exp_f32 v182, v182
    v_exp_f32 v183, v183
    v_exp_f32 v184, v184
    v_exp_f32 v185, v185
    v_smfmac_f32_32x32x32_bf16 v[16:31], v[132:135], v[176:183], v250
    s_mul_i32 s16, s12, 6144
    s_add_u32 s16, s16, 139264
    v_add_u32 v13, s16, v1
    s_xor_b32 s16, s12, 2
    s_mul_i32 s16, s16, 6144
    s_add_u32 s16, s16, 139264
    v_add_u32 v10, s16, v1
    v_exp_f32 v186, v186
    v_exp_f32 v187, v187
    v_exp_f32 v188, v188
    v_exp_f32 v189, v189
    v_exp_f32 v190, v190
    v_exp_f32 v191, v191
    v_exp_f32 v192, v192
    v_exp_f32 v193, v193
    v_smfmac_f32_32x32x32_bf16 v[16:31], v[136:139], v[184:191], v250
    v_exp_f32 v194, v194
    v_exp_f32 v195, v195
    v_exp_f32 v196, v196
    v_exp_f32 v197, v197
    v_mfma_f32_32x32x16_bf16 v[176:191], v[140:143], a[232:235], 0
    v_exp_f32 v198, v198
    v_exp_f32 v199, v199
    v_exp_f32 v200, v200
    v_exp_f32 v201, v201
    v_smfmac_f32_32x32x32_bf16 v[32:47], v[132:135], v[192:199], v250
    v_exp_f32 v202, v202
    v_exp_f32 v203, v203
    v_exp_f32 v204, v204
    v_exp_f32 v205, v205
    v_exp_f32 v206, v206
    v_exp_f32 v207, v207
    v_exp_f32 v208, v208
    v_exp_f32 v209, v209
    v_smfmac_f32_32x32x32_bf16 v[32:47], v[136:139], v[200:207], v250
    v_exp_f32 v210, v210
    v_exp_f32 v211, v211
    v_exp_f32 v212, v212
    v_exp_f32 v213, v213
    s_waitcnt vmcnt(7)
    v_mfma_f32_32x32x16_bf16 v[192:207], v[152:155], a[232:235], 0
    v_exp_f32 v214, v214
    v_exp_f32 v215, v215
    v_exp_f32 v216, v216
    v_exp_f32 v217, v217
    v_smfmac_f32_32x32x32_bf16 v[48:63], v[132:135], v[208:215], v250
    v_exp_f32 v218, v218
    v_exp_f32 v219, v219
    v_exp_f32 v220, v220
    v_exp_f32 v221, v221
    v_exp_f32 v222, v222
    v_exp_f32 v223, v223
    v_exp_f32 v224, v224
    v_exp_f32 v225, v225
    v_smfmac_f32_32x32x32_bf16 v[48:63], v[136:139], v[216:223], v250
    v_exp_f32 v226, v226
    v_exp_f32 v227, v227
    v_exp_f32 v228, v228
    v_exp_f32 v229, v229
    v_mfma_f32_32x32x16_bf16 v[208:223], v[164:167], a[232:235], 0
    v_exp_f32 v230, v230
    v_exp_f32 v231, v231
    v_exp_f32 v232, v232
    v_exp_f32 v233, v233
    v_smfmac_f32_32x32x32_bf16 v[64:79], v[132:135], v[224:231], v250
    v_exp_f32 v234, v234
    v_exp_f32 v235, v235
    v_exp_f32 v236, v236
    v_exp_f32 v237, v237
    v_exp_f32 v238, v238
    v_exp_f32 v239, v239
    v_exp_f32 v176, v176
    v_exp_f32 v177, v177
    v_smfmac_f32_32x32x32_bf16 v[64:79], v[136:139], v[232:239], v250
    v_exp_f32 v178, v178
    v_exp_f32 v179, v179
    v_exp_f32 v180, v180
    v_exp_f32 v181, v181
    v_mfma_f32_32x32x16_bf16 v[224:239], v[140:143], a[236:239], 0
    v_exp_f32 v182, v182
    v_exp_f32 v183, v183
    v_exp_f32 v184, v184
    v_exp_f32 v185, v185
    v_smfmac_f32_32x32x32_bf16 v[48:63], v[144:147], v[176:183], v250
    v_exp_f32 v186, v186
    v_exp_f32 v187, v187
    v_exp_f32 v188, v188
    v_exp_f32 v189, v189
    v_exp_f32 v190, v190
    v_exp_f32 v191, v191
    v_exp_f32 v192, v192
    v_exp_f32 v193, v193
    v_smfmac_f32_32x32x32_bf16 v[48:63], v[148:151], v[184:191], v250
    v_exp_f32 v194, v194
    v_exp_f32 v195, v195
    v_exp_f32 v196, v196
    v_exp_f32 v197, v197
    v_mfma_f32_32x32x16_bf16 v[176:191], v[152:155], a[236:239], 0
    v_exp_f32 v198, v198
    v_exp_f32 v199, v199
    v_exp_f32 v200, v200
    v_exp_f32 v201, v201
    v_smfmac_f32_32x32x32_bf16 v[48:63], v[156:159], v[192:199], v250
    v_exp_f32 v202, v202
    v_exp_f32 v203, v203
    v_exp_f32 v204, v204
    v_exp_f32 v205, v205
    v_exp_f32 v206, v206
    v_exp_f32 v207, v207
    v_exp_f32 v208, v208
    v_exp_f32 v209, v209
    v_smfmac_f32_32x32x32_bf16 v[48:63], v[160:163], v[200:207], v250
    v_exp_f32 v210, v210
    v_exp_f32 v211, v211
    v_exp_f32 v212, v212
    v_exp_f32 v213, v213
    v_mfma_f32_32x32x16_bf16 v[192:207], v[164:167], a[236:239], 0
    v_exp_f32 v214, v214
    v_exp_f32 v215, v215
    v_exp_f32 v216, v216
    v_exp_f32 v217, v217
    v_smfmac_f32_32x32x32_bf16 v[48:63], v[168:171], v[208:215], v250
    v_exp_f32 v218, v218
    v_exp_f32 v219, v219
    v_exp_f32 v220, v220
    v_exp_f32 v221, v221
    v_exp_f32 v222, v222
    v_exp_f32 v223, v223
    v_exp_f32 v224, v224
    v_exp_f32 v225, v225
    v_smfmac_f32_32x32x32_bf16 v[48:63], v[172:175], v[216:223], v250
    v_exp_f32 v226, v226
    v_exp_f32 v227, v227
    v_exp_f32 v228, v228
    v_exp_f32 v229, v229
    v_mfma_f32_32x32x16_bf16 v[208:223], v[140:143], a[224:227], 0
    v_exp_f32 v230, v230
    v_exp_f32 v231, v231
    v_exp_f32 v232, v232
    v_exp_f32 v233, v233
    v_smfmac_f32_32x32x32_bf16 v[64:79], v[144:147], v[224:231], v250
    v_exp_f32 v234, v234
    v_exp_f32 v235, v235
    v_exp_f32 v236, v236
    v_exp_f32 v237, v237
    v_exp_f32 v238, v238
    v_exp_f32 v239, v239
    v_exp_f32 v176, v176
    v_exp_f32 v177, v177
    v_smfmac_f32_32x32x32_bf16 v[64:79], v[148:151], v[232:239], v250
    ds_write_b128 v10, v[48:51] offset:0
    ds_write_b128 v10, v[52:55] offset:1024
    ds_write_b32 v10, v56 offset:2048
    v_exp_f32 v178, v178
    v_exp_f32 v179, v179
    v_exp_f32 v180, v180
    v_exp_f32 v181, v181
    v_mfma_f32_32x32x16_bf16 v[224:239], v[152:155], a[224:227], 0
    v_exp_f32 v182, v182
    v_exp_f32 v183, v183
    v_exp_f32 v184, v184
    v_exp_f32 v185, v185
    v_smfmac_f32_32x32x32_bf16 v[64:79], v[156:159], v[176:183], v250
    v_exp_f32 v186, v186
    v_exp_f32 v187, v187
    v_exp_f32 v188, v188
    v_exp_f32 v189, v189
    v_exp_f32 v190, v190
    v_exp_f32 v191, v191
    v_exp_f32 v192, v192
    v_exp_f32 v193, v193
    v_smfmac_f32_32x32x32_bf16 v[64:79], v[160:163], v[184:191], v250
    v_exp_f32 v194, v194
    v_exp_f32 v195, v195
    v_exp_f32 v196, v196
    v_exp_f32 v197, v197
    v_mfma_f32_32x32x16_bf16 v[176:191], v[164:167], a[224:227], 0
    v_exp_f32 v198, v198
    v_exp_f32 v199, v199
    v_exp_f32 v200, v200
    v_exp_f32 v201, v201
    v_smfmac_f32_32x32x32_bf16 v[64:79], v[168:171], v[192:199], v250
    v_exp_f32 v202, v202
    v_exp_f32 v203, v203
    v_exp_f32 v204, v204
    v_exp_f32 v205, v205
    v_exp_f32 v206, v206
    v_exp_f32 v207, v207
    v_exp_f32 v208, v208
    v_exp_f32 v209, v209
    v_smfmac_f32_32x32x32_bf16 v[64:79], v[172:175], v[200:207], v250
    v_exp_f32 v210, v210
    v_exp_f32 v211, v211
    v_exp_f32 v212, v212
    v_exp_f32 v213, v213
    v_mfma_f32_32x32x16_bf16 v[192:207], v[140:143], a[228:231], 0
    v_exp_f32 v214, v214
    v_exp_f32 v215, v215
    v_exp_f32 v216, v216
    v_exp_f32 v217, v217
    v_smfmac_f32_32x32x32_bf16 v[16:31], v[144:147], v[208:215], v250
    v_exp_f32 v218, v218
    v_exp_f32 v219, v219
    v_exp_f32 v220, v220
    v_exp_f32 v221, v221
    v_exp_f32 v222, v222
    v_exp_f32 v223, v223
    v_exp_f32 v224, v224
    v_exp_f32 v225, v225
    v_smfmac_f32_32x32x32_bf16 v[16:31], v[148:151], v[216:223], v250
    ds_write_b128 v10, v[64:67] offset:3072
    ds_write_b128 v10, v[68:71] offset:4096
    ds_write_b32 v10, v72 offset:5120
    v_exp_f32 v226, v226
    v_exp_f32 v227, v227
    v_exp_f32 v228, v228
    v_exp_f32 v229, v229
    v_mfma_f32_32x32x16_bf16 v[208:223], v[152:155], a[228:231], 0
    v_exp_f32 v230, v230
    v_exp_f32 v231, v231
    v_exp_f32 v232, v232
    v_exp_f32 v233, v233
    v_smfmac_f32_32x32x32_bf16 v[16:31], v[156:159], v[224:231], v250
    v_exp_f32 v234, v234
    v_exp_f32 v235, v235
    v_exp_f32 v236, v236
    v_exp_f32 v237, v237
    v_exp_f32 v238, v238
    v_exp_f32 v239, v239
    v_exp_f32 v176, v176
    v_exp_f32 v177, v177
    v_smfmac_f32_32x32x32_bf16 v[16:31], v[160:163], v[232:239], v250
    v_exp_f32 v178, v178
    v_exp_f32 v179, v179
    v_exp_f32 v180, v180
    v_exp_f32 v181, v181
    v_mfma_f32_32x32x16_bf16 v[224:239], v[164:167], a[228:231], 0
    v_exp_f32 v182, v182
    v_exp_f32 v183, v183
    v_exp_f32 v184, v184
    v_exp_f32 v185, v185
    v_smfmac_f32_32x32x32_bf16 v[16:31], v[168:171], v[176:183], v250
    v_exp_f32 v186, v186
    v_exp_f32 v187, v187
    v_exp_f32 v188, v188
    v_exp_f32 v189, v189
    v_exp_f32 v190, v190
    v_exp_f32 v191, v191
    v_exp_f32 v192, v192
    v_exp_f32 v193, v193
    v_smfmac_f32_32x32x32_bf16 v[16:31], v[172:175], v[184:191], v250
    v_exp_f32 v194, v194
    v_exp_f32 v195, v195
    v_exp_f32 v196, v196
    v_exp_f32 v197, v197
    v_exp_f32 v198, v198
    v_exp_f32 v199, v199
    v_exp_f32 v200, v200
    v_exp_f32 v201, v201
    v_smfmac_f32_32x32x32_bf16 v[32:47], v[144:147], v[192:199], v250
    v_exp_f32 v202, v202
    v_exp_f32 v203, v203
    v_exp_f32 v204, v204
    v_exp_f32 v205, v205
    v_exp_f32 v206, v206
    v_exp_f32 v207, v207
    v_exp_f32 v208, v208
    v_exp_f32 v209, v209
    v_smfmac_f32_32x32x32_bf16 v[32:47], v[148:151], v[200:207], v250
    v_exp_f32 v210, v210
    v_exp_f32 v211, v211
    v_exp_f32 v212, v212
    v_exp_f32 v213, v213
    v_exp_f32 v214, v214
    v_exp_f32 v215, v215
    v_exp_f32 v216, v216
    v_exp_f32 v217, v217
    v_smfmac_f32_32x32x32_bf16 v[32:47], v[156:159], v[208:215], v250
    s_waitcnt lgkmcnt(0)
    s_barrier
    ds_read_b32 v56, v13 offset:2048
    ds_read_b128 v[48:51], v13 offset:0
    ds_read_b128 v[52:55], v13 offset:1024
    ds_read_b32 v72, v13 offset:5120
    ds_read_b128 v[64:67], v13 offset:3072
    ds_read_b128 v[68:71], v13 offset:4096
    v_exp_f32 v218, v218
    v_exp_f32 v219, v219
    v_exp_f32 v220, v220
    v_exp_f32 v221, v221
    v_exp_f32 v222, v222
    v_exp_f32 v223, v223
    v_exp_f32 v224, v224
    v_exp_f32 v225, v225
    v_smfmac_f32_32x32x32_bf16 v[32:47], v[160:163], v[216:223], v250
    v_exp_f32 v226, v226
    v_exp_f32 v227, v227
    v_exp_f32 v228, v228
    v_exp_f32 v229, v229
    v_exp_f32 v230, v230
    v_exp_f32 v231, v231
    v_exp_f32 v232, v232
    v_exp_f32 v233, v233
    v_smfmac_f32_32x32x32_bf16 v[32:47], v[168:171], v[224:231], v250
    v_exp_f32 v234, v234
    v_exp_f32 v235, v235
    v_exp_f32 v236, v236
    v_exp_f32 v237, v237
    v_exp_f32 v238, v238
    v_exp_f32 v239, v239
    s_nop 1
    v_smfmac_f32_32x32x32_bf16 v[32:47], v[172:175], v[232:239], v250
    s_waitcnt lgkmcnt(3)
    v_add_f32 v24, v24, v56
    v_rcp_f32 v25, v24
    v_add_f32 v16, v16, v48
    v_add_f32 v17, v17, v49
    v_add_f32 v18, v18, v50
    v_add_f32 v19, v19, v51
    v_add_f32 v20, v20, v52
    v_add_f32 v21, v21, v53
    v_add_f32 v22, v22, v54
    v_add_f32 v23, v23, v55
    v_mul_f32 v16, v16, v25
    v_mul_f32 v17, v17, v25
    v_cvt_pk_bf16_f32 v28, v16, v17
    v_mul_f32 v18, v18, v25
    v_mul_f32 v19, v19, v25
    v_cvt_pk_bf16_f32 v29, v18, v19
    v_mul_f32 v20, v20, v25
    v_mul_f32 v21, v21, v25
    v_cvt_pk_bf16_f32 v30, v20, v21
    v_mul_f32 v22, v22, v25
    v_mul_f32 v23, v23, v25
    v_cvt_pk_bf16_f32 v31, v22, v23
    buffer_store_dwordx4 v[28:31], v1, s[4:7], s64 offen
    s_waitcnt lgkmcnt(0)
    v_add_f32 v40, v40, v72
    v_rcp_f32 v41, v40
    v_add_f32 v32, v32, v64
    v_add_f32 v33, v33, v65
    v_add_f32 v34, v34, v66
    v_add_f32 v35, v35, v67
    v_add_f32 v36, v36, v68
    v_add_f32 v37, v37, v69
    v_add_f32 v38, v38, v70
    v_add_f32 v39, v39, v71
    v_mul_f32 v32, v32, v41
    v_mul_f32 v33, v33, v41
    v_cvt_pk_bf16_f32 v44, v32, v33
    v_mul_f32 v34, v34, v41
    v_mul_f32 v35, v35, v41
    v_cvt_pk_bf16_f32 v45, v34, v35
    v_mul_f32 v36, v36, v41
    v_mul_f32 v37, v37, v41
    v_cvt_pk_bf16_f32 v46, v36, v37
    v_mul_f32 v38, v38, v41
    v_mul_f32 v39, v39, v41
    v_cvt_pk_bf16_f32 v47, v38, v39
    buffer_store_dwordx4 v[44:47], v1, s[4:7], s65 offen
    v_add_f32 v16, v16, v17
    v_add_f32 v18, v18, v19
    v_add_f32 v20, v20, v21
    v_add_f32 v22, v22, v23
    v_add_f32 v16, v16, v18
    v_add_f32 v20, v20, v22
    v_add_f32 v16, v16, v20
    v_fma_f32 v24, v16, 0, v24
    v_subrev_u32 v24, 0x21800000, v24
    v_add_f32 v32, v32, v33
    v_add_f32 v34, v34, v35
    v_add_f32 v36, v36, v37
    v_add_f32 v38, v38, v39
    v_add_f32 v32, v32, v34
    v_add_f32 v36, v36, v38
    v_add_f32 v32, v32, v36
    v_fma_f32 v40, v32, 0, v40
    v_subrev_u32 v40, 0x21800000, v40
    v_max_u32 v24, v24, v40
    v_cmp_lt_u32 vcc, 0x3c000000, v24
    s_nop 0
    s_cbranch_vccnz fb_15
fbret_16:
    s_waitcnt vmcnt(2)
    s_mov_b32 s41, s79
    s_sub_u32 s21, s21, s97
    s_add_u32 s21, s21, 12288
L_wo0:
    s_lshr_b32 s22, s100, 15
    s_lshr_b32 s26, s12, 1
    s_mul_i32 s20, s22, 114688
    s_lshl_b32 s16, s26, 14
    s_add_u32 s20, s20, s16
    s_add_u32 s20, s20, 10485760
    s_lshl_b32 s16, s26, 11
    v_add_u32 v3, s16, v1
    v_add_u32 v4, 0x10000, v3
    v_add_u32 v5, 0x20000, v3
    s_barrier
    ds_read_b128 a[224:227], v3 offset:1024
    ds_read_b128 a[228:231], v3 offset:0
    ds_read_b128 a[232:235], v3 offset:5120
    ds_read_b128 a[236:239], v3 offset:4096
    v_mov_b32 v14, s32
    v_mov_b32 v15, s33
    s_cmp_eq_u32 s34, 0
    s_cbranch_scc1 slow_17
    s_waitcnt vmcnt(0)
    buffer_store_dwordx2 v[14:15], off, s[4:7], s41
join_18:
    s_and_b32 s41, s22, 0xfe
    s_add_u32 s41, s41, s26
    s_lshl_b32 s41, s41, 7
    s_add_u32 s41, s41, 7999488
    s_xor_b32 s16, s12, 2
    s_lshl_b32 s16, s16, 12
    s_add_u32 s16, s16, 147456
    v_add_u32 v6, s16, v1
    s_lshl_b32 s16, s12, 12
    s_add_u32 s16, s16, 147456
    v_add_u32 v7, s16, v1
    v_lshlrev_b32 v120, 16, v240
    v_and_b32 v121, 0xffff0000, v240
    v_lshlrev_b32 v122, 16, v241
    v_and_b32 v123, 0xffff0000, v241
    v_lshlrev_b32 v124, 16, v242
    v_and_b32 v125, 0xffff0000, v242
    v_lshlrev_b32 v126, 16, v243
    v_and_b32 v127, 0xffff0000, v243
    v_lshlrev_b32 v128, 16, v244
    v_and_b32 v129, 0xffff0000, v244
    v_lshlrev_b32 v130, 16, v245
    v_and_b32 v131, 0xffff0000, v245
    v_lshlrev_b32 v132, 16, v246
    v_and_b32 v133, 0xffff0000, v246
    v_lshlrev_b32 v134, 16, v247
    v_and_b32 v135, 0xffff0000, v247
    s_branch nr_19
ap_2:
    s_mov_b32 s40, 0x40000
ap_2_l:
    buffer_load_dwordx2 v[10:11], v253, s[4:7], s68 offen sc1
    s_sub_u32 s40, s40, 1
    s_cbranch_scc1 L_abort
    s_waitcnt vmcnt(0)
    v_cmp_ne_u64 vcc, s[32:33], v[10:11]
    s_nop 0
    s_and_b32 s19, vcc_lo, 0xe
    s_cbranch_scc1 ap_2_l
    s_branch apok_3
ap_5:
    s_mov_b32 s40, 0x40000
ap_5_l:
    buffer_load_dwordx2 v[8:9], v253, s[4:7], s68 offen sc1
    s_sub_u32 s40, s40, 1
    s_cbranch_scc1 L_abort
    s_waitcnt vmcnt(0)
    v_cmp_ne_u64 vcc, s[32:33], v[8:9]
    s_nop 0
    s_and_b32 s19, vcc_lo, 0xf0
    s_cbranch_scc1 ap_5_l
    s_branch apok_6
ap_8:
    s_mov_b32 s40, 0x40000
ap_8_l:
    buffer_load_dwordx2 v[10:11], v12, s[4:7], s20 offen offset:8 sc1
    s_sub_u32 s40, s40, 1
    s_cbranch_scc1 L_abort
    s_waitcnt vmcnt(0)
    v_cmp_ne_u64 vcc, s[32:33], v[10:11]
    s_nop 0
    s_cbranch_vccnz ap_8_l
    s_branch apok_9
ap_10:
    s_mov_b32 s40, 0x40000
ap_10_l:
    buffer_load_dwordx2 v[8:9], v253, s[4:7], s68 offen sc1
    s_sub_u32 s40, s40, 1
    s_cbranch_scc1 L_abort
    s_waitcnt vmcnt(0)
    v_cmp_ne_u64 vcc, s[32:33], v[8:9]
    s_nop 0
    s_cbranch_vccnz ap_10_l
    s_branch apok_11
ap_13:
    s_mov_b32 s40, 0x40000
ap_13_l:
    buffer_load_dwordx4 v[12:15], v11, s[4:7], s25 offen sc1
    s_sub_u32 s40, s40, 1
    s_cbranch_scc1 L_abort
    s_waitcnt vmcnt(0)
    v_cmp_ne_u64 vcc, s[32:33], v[14:15]
    s_nop 0
    s_cbranch_vccnz ap_13_l
    s_branch apok_14
nr_19:
    v_and_b32 v13, 15, v0
    v_lshlrev_b32 v13, 3, v13
    s_mov_b32 s40, 0x40000
poll_20:
    buffer_load_dwordx2 v[14:15], v13, s[4:7], s41 offen sc1
    s_sub_u32 s40, s40, 1
    s_cbranch_scc1 L_abort
    s_waitcnt vmcnt(0)
    v_cmp_ne_u64 vcc, s[32:33], v[14:15]
    s_nop 0
    s_cbranch_vccnz poll_20
    buffer_load_dwordx4 v[16:19], v1, s[4:7], s20 offen offset:0 sc1
    buffer_load_dwordx4 v[20:23], v1, s[4:7], s20 offen offset:1024 sc1
    buffer_load_dwordx4 v[24:27], v1, s[4:7], s20 offen offset:2048 sc1
    buffer_load_dwordx4 v[28:31], v1, s[4:7], s20 offen offset:3072 sc1
    s_add_u32 s20, s20, 4096
    buffer_load_dwordx4 v[32:35], v1, s[4:7], s20 offen offset:0 sc1
    buffer_load_dwordx4 v[36:39], v1, s[4:7], s20 offen offset:1024 sc1
    buffer_load_dwordx4 v[40:43], v1, s[4:7], s20 offen offset:2048 sc1
    buffer_load_dwordx4 v[44:47], v1, s[4:7], s20 offen offset:3072 sc1
    s_add_u32 s20, s20, 4096
    buffer_load_dwordx4 v[48:51], v1, s[4:7], s20 offen offset:0 sc1
    buffer_load_dwordx4 v[52:55], v1, s[4:7], s20 offen offset:1024 sc1
    s_waitcnt vmcnt(9) lgkmcnt(2)
    v_mfma_f32_32x32x16_bf16 v[96:111], a[224:227], v[16:19], 0
    ds_read_b128 a[240:243], v3 offset:9216
    ds_read_b128 a[244:247], v3 offset:8192
    v_mfma_f32_32x32x16_bf16 v[80:95], a[228:231], v[16:19], 0
    buffer_load_dwordx4 v[56:59], v1, s[4:7], s20 offen offset:2048 sc1
    s_waitcnt vmcnt(9) lgkmcnt(2)
    v_mfma_f32_32x32x16_bf16 v[96:111], a[232:235], v[20:23], v[96:111]
    ds_read_b128 a[248:251], v3 offset:13312
    ds_read_b128 a[252:255], v3 offset:12288
    v_mfma_f32_32x32x16_bf16 v[80:95], a[236:239], v[20:23], v[80:95]
    buffer_load_dwordx4 v[60:63], v1, s[4:7], s20 offen offset:3072 sc1
    s_waitcnt vmcnt(9) lgkmcnt(2)
    v_mfma_f32_32x32x16_bf16 v[96:111], a[240:243], v[24:27], v[96:111]
    ds_read_b128 a[224:227], v3 offset:17408
    ds_read_b128 a[228:231], v3 offset:16384
    v_mfma_f32_32x32x16_bf16 v[80:95], a[244:247], v[24:27], v[80:95]
    s_add_u32 s20, s20, 4096
    buffer_load_dwordx4 v[64:67], v1, s[4:7], s20 offen offset:0 sc1
    s_waitcnt vmcnt(9) lgkmcnt(2)
    v_mfma_f32_32x32x16_bf16 v[96:111], a[248:251], v[28:31], v[96:111]
    ds_read_b128 a[232:235], v3 offset:21504
    ds_read_b128 a[236:239], v3 offset:20480
    v_mfma_f32_32x32x16_bf16 v[80:95], a[252:255], v[28:31], v[80:95]
    buffer_load_dwordx4 v[68:71], v1, s[4:7], s20 offen offset:1024 sc1
    s_waitcnt vmcnt(9) lgkmcnt(2)
    v_mfma_f32_32x32x16_bf16 v[96:111], a[224:227], v[32:35], v[96:111]
    ds_read_b128 a[240:243], v3 offset:25600
    ds_read_b128 a[244:247], v3 offset:24576
    v_mfma_f32_32x32x16_bf16 v[80:95], a[228:231], v[32:35], v[80:95]
    buffer_load_dwordx4 v[72:75], v1, s[4:7], s20 offen offset:2048 sc1
    s_waitcnt vmcnt(9) lgkmcnt(2)
    v_mfma_f32_32x32x16_bf16 v[96:111], a[232:235], v[36:39], v[96:111]
    ds_read_b128 a[248:251], v3 offset:29696
    ds_read_b128 a[252:255], v3 offset:28672
    v_mfma_f32_32x32x16_bf16 v[80:95], a[236:239], v[36:39], v[80:95]
    buffer_load_dwordx4 v[76:79], v1, s[4:7], s20 offen offset:3072 sc1
    s_waitcnt vmcnt(9) lgkmcnt(2)
    v_mfma_f32_32x32x16_bf16 v[96:111], a[240:243], v[40:43], v[96:111]
    ds_read_b128 a[224:227], v3 offset:33792
    ds_read_b128 a[228:231], v3 offset:37888
    v_mfma_f32_32x32x16_bf16 v[80:95], a[244:247], v[40:43], v[80:95]
    s_add_u32 m0, s15, 131072
    s_add_u32 s21, s21, 4096
    buffer_load_dwordx4 v2, s[4:7], s21 offen sc1 lds
    s_waitcnt vmcnt(9) lgkmcnt(2)
    v_mfma_f32_32x32x16_bf16 v[96:111], a[248:251], v[44:47], v[96:111]
    ds_read_b128 a[232:235], v3 offset:41984
    ds_read_b128 a[236:239], v3 offset:46080
    v_mfma_f32_32x32x16_bf16 v[80:95], a[252:255], v[44:47], v[80:95]
    s_add_u32 m0, s15, 135168
    s_add_u32 s21, s21, 4096
    buffer_load_dwordx4 v2, s[4:7], s21 offen sc1 lds
    s_waitcnt vmcnt(8) lgkmcnt(2)
    v_mfma_f32_32x32x16_bf16 v[96:111], a[224:227], v[48:51], v[96:111]
    ds_read_b128 a[240:243], v3 offset:50176
    ds_read_b128 a[244:247], v3 offset:54272
    v_mfma_f32_32x32x16_bf16 v[96:111], a[228:231], v[52:55], v[96:111]
    s_add_u32 m0, s15, 139264
    s_add_u32 s21, s21, 4096
    buffer_load_dwordx4 v2, s[4:7], s21 offen sc1 lds
    s_waitcnt vmcnt(7) lgkmcnt(2)
    v_mfma_f32_32x32x16_bf16 v[96:111], a[232:235], v[56:59], v[96:111]
    ds_read_b128 a[248:251], v3 offset:58368
    ds_read_b128 a[252:255], v3 offset:62464
    v_mfma_f32_32x32x16_bf16 v[96:111], a[236:239], v[60:63], v[96:111]
    s_add_u32 m0, s15, 143360
    s_add_u32 s21, s21, 4096
    buffer_load_dwordx4 v2, s[4:7], s21 offen sc1 lds
    s_waitcnt vmcnt(6) lgkmcnt(2)
    v_mfma_f32_32x32x16_bf16 v[96:111], a[240:243], v[64:67], v[96:111]
    ds_read_b128 a[224:227], v3 offset:32768
    ds_read_b128 a[228:231], v3 offset:36864
    v_mfma_f32_32x32x16_bf16 v[96:111], a[244:247], v[68:71], v[96:111]
    s_waitcnt vmcnt(4) lgkmcnt(2)
    v_mfma_f32_32x32x16_bf16 v[96:111], a[248:251], v[72:75], v[96:111]
    ds_read_b128 a[232:235], v3 offset:40960
    ds_read_b128 a[236:239], v3 offset:45056
    v_mfma_f32_32x32x16_bf16 v[96:111], a[252:255], v[76:79], v[96:111]
    s_waitcnt lgkmcnt(2)
    v_mfma_f32_32x32x16_bf16 v[80:95], a[224:227], v[48:51], v[80:95]
    ds_read_b128 a[240:243], v3 offset:49152
    ds_read_b128 a[244:247], v3 offset:53248
    v_mfma_f32_32x32x16_bf16 v[80:95], a[228:231], v[52:55], v[80:95]
    ds_read_b128 a[248:251], v3 offset:57344
    ds_read_b128 a[252:255], v3 offset:61440
    s_nop 4
    ds_write_b128 v6, v[96:99] offset:0
    ds_write_b128 v6, v[100:103] offset:1024
    ds_write_b128 v6, v[104:107] offset:2048
    ds_write_b128 v6, v[108:111] offset:3072
    s_waitcnt lgkmcnt(8)
    v_mfma_f32_32x32x16_bf16 v[80:95], a[232:235], v[56:59], v[80:95]
    v_mfma_f32_32x32x16_bf16 v[80:95], a[236:239], v[60:63], v[80:95]
    s_waitcnt lgkmcnt(6)
    v_mfma_f32_32x32x16_bf16 v[80:95], a[240:243], v[64:67], v[80:95]
    s_waitcnt lgkmcnt(0)
    s_barrier
    ds_read_b128 v[96:99], v7 offset:0
    ds_read_b128 v[100:103], v7 offset:1024
    ds_read_b128 v[104:107], v7 offset:2048
    ds_read_b128 v[108:111], v7 offset:3072
    v_mfma_f32_32x32x16_bf16 v[80:95], a[244:247], v[68:71], v[80:95]
    s_add_u32 m0, s15, 0
    s_add_u32 s21, s21, 4096
    buffer_load_dwordx4 v2, s[4:7], s21 offen sc1 lds
    v_mfma_f32_32x32x16_bf16 v[80:95], a[248:251], v[72:75], v[80:95]
    v_mfma_f32_32x32x16_bf16 v[80:95], a[252:255], v[76:79], v[80:95]
    s_add_u32 m0, s15, 4096
    s_add_u32 s21, s21, 4096
    buffer_load_dwordx4 v2, s[4:7], s21 offen sc1 lds
    s_waitcnt lgkmcnt(0)
    v_add_f32 v120, v120, v96
    v_add_f32 v121, v121, v97
    v_add_f32 v122, v122, v98
    v_add_f32 v123, v123, v99
    v_add_f32 v124, v124, v100
    v_add_f32 v125, v125, v101
    v_add_f32 v126, v126, v102
    v_add_f32 v127, v127, v103
    v_add_f32 v128, v128, v104
    v_add_f32 v129, v129, v105
    v_add_f32 v130, v130, v106
    v_add_f32 v131, v131, v107
    v_add_f32 v132, v132, v108
    v_add_f32 v133, v133, v109
    v_add_f32 v134, v134, v110
    v_add_f32 v135, v135, v111
    v_add_f32 v80, v80, v120
    v_add_f32 v81, v81, v121
    v_cvt_pk_bf16_f32 v136, v80, v81
    v_add_f32 v82, v82, v122
    v_add_f32 v83, v83, v123
    v_cvt_pk_bf16_f32 v137, v82, v83
    v_add_f32 v84, v84, v124
    v_add_f32 v85, v85, v125
    v_cvt_pk_bf16_f32 v138, v84, v85
    v_add_f32 v86, v86, v126
    v_add_f32 v87, v87, v127
    v_cvt_pk_bf16_f32 v139, v86, v87
    v_add_f32 v88, v88, v128
    v_add_f32 v89, v89, v129
    v_cvt_pk_bf16_f32 v140, v88, v89
    v_add_f32 v90, v90, v130
    v_add_f32 v91, v91, v131
    v_cvt_pk_bf16_f32 v141, v90, v91
    v_add_f32 v92, v92, v132
    v_add_f32 v93, v93, v133
    v_cvt_pk_bf16_f32 v142, v92, v93
    v_add_f32 v94, v94, v134
    v_add_f32 v95, v95, v135
    v_cvt_pk_bf16_f32 v143, v94, v95
    s_add_u32 s17, s100, 8388608
    buffer_store_dwordx4 v[136:139], v1, s[4:7], s17 offen
    buffer_store_dwordx4 v[140:143], v1, s[4:7], s17 offen offset:1024
    v_add_f32 v10, v80, v82
    v_mul_f32 v11, v80, v80
    v_add_f32 v8, v81, v83
    v_mul_f32 v9, v81, v81
    v_fmac_f32 v11, v82, v82
    v_fmac_f32 v9, v83, v83
    v_add_f32 v10, v10, v84
    v_fmac_f32 v11, v84, v84
    v_add_f32 v8, v8, v85
    v_fmac_f32 v9, v85, v85
    s_add_u32 m0, s15, 8192
    s_add_u32 s21, s21, 4096
    buffer_load_dwordx4 v2, s[4:7], s21 offen sc1 lds
    s_add_u32 m0, s15, 12288
    s_add_u32 s21, s21, 4096
    buffer_load_dwordx4 v2, s[4:7], s21 offen sc1 lds
    s_add_u32 m0, s15, 16384
    s_add_u32 s21, s21, 4096
    buffer_load_dwordx4 v2, s[4:7], s21 offen sc1 lds
    s_add_u32 m0, s15, 20480
    s_add_u32 s21, s21, 4096
    buffer_load_dwordx4 v2, s[4:7], s21 offen sc1 lds
    s_add_u32 m0, s15, 24576
    s_add_u32 s21, s21, 4096
    buffer_load_dwordx4 v2, s[4:7], s21 offen sc1 lds
    v_add_f32 v10, v10, v86
    v_fmac_f32 v11, v86, v86
    v_add_f32 v8, v8, v87
    v_fmac_f32 v9, v87, v87
    v_add_f32 v10, v10, v88
    v_fmac_f32 v11, v88, v88
    v_add_f32 v8, v8, v89
    v_fmac_f32 v9, v89, v89
    v_add_f32 v10, v10, v90
    v_fmac_f32 v11, v90, v90
    v_add_f32 v8, v8, v91
    v_fmac_f32 v9, v91, v91
    s_add_u32 m0, s15, 28672
    s_add_u32 s21, s21, 4096
    buffer_load_dwordx4 v2, s[4:7], s21 offen sc1 lds
    s_add_u32 m0, s15, 32768
    s_add_u32 s21, s21, 4096
    buffer_load_dwordx4 v2, s[4:7], s21 offen sc1 lds
    s_add_u32 m0, s15, 36864
    s_add_u32 s21, s21, 4096
    buffer_load_dwordx4 v2, s[4:7], s21 offen sc1 lds
    s_add_u32 m0, s15, 40960
    s_add_u32 s21, s21, 4096
    buffer_load_dwordx4 v2, s[4:7], s21 offen sc1 lds
    s_add_u32 m0, s15, 45056
    s_add_u32 s21, s21, 4096
    buffer_load_dwordx4 v2, s[4:7], s21 offen sc1 lds
    v_add_f32 v10, v10, v92
    v_fmac_f32 v11, v92, v92
    v_add_f32 v8, v8, v93
    v_fmac_f32 v9, v93, v93
    v_add_f32 v10, v10, v94
    v_fmac_f32 v11, v94, v94
    v_add_f32 v8, v8, v95
    v_fmac_f32 v9, v95, v95
    v_add_f32 v10, v10, v8
    v_add_f32 v11, v11, v9
    v_mov_b32 v8, v10
    v_mov_b32 v9, v11
    s_nop 0
    v_permlane32_swap_b32 v10, v8
    v_permlane32_swap_b32 v11, v9
    v_add_f32 v10, v10, v8
    v_add_f32 v11, v11, v9
    s_mov_b32 exec_hi, 0
    buffer_store_dwordx2 v[10:11], v1, s[4:7], s29 offen
    s_mov_b64 exec, -1
    s_lshr_b32 s41, s100, 8
    s_add_u32 s41, s41, 8007680
    v_mov_b32 v14, s32
    v_mov_b32 v15, s33
    s_cmp_eq_u32 s34, 0
    s_cbranch_scc1 slow_21
    s_waitcnt vmcnt(11)
    buffer_store_dwordx2 v[14:15], off, s[4:7], s41
join_22:
    s_add_u32 s41, s41, 40960
    s_lshl_b32 s16, s2, 2
    s_lshl_b32 s22, s13, 3
    s_add_u32 s22, s22, s16
    s_add_u32 s22, s22, s12
    s_and_b32 s23, s14, 15
    s_lshl_b32 s20, s22, 15
    s_add_u32 s20, s20, 8388608
    v_mov_b32 v3, v1
    v_add_u32 v4, 0x10000, v3
    v_add_u32 v5, 0x20000, v3
    v_bfe_u32 v8, v0, 4, 2
    v_lshlrev_b32 v8, 9, v8
    v_and_b32 v9, 15, v0
    v_lshl_add_u32 v12, v9, 4, v8
    v_and_b32 v9, 3, v0
    v_bfe_u32 v10, v0, 2, 1
    v_lshl_or_b32 v9, v10, 3, v9
    v_bfe_u32 v10, v0, 3, 1
    v_lshl_or_b32 v9, v10, 2, v9
    v_lshl_add_u32 v3, v9, 4, v8
    v_add_u32 v4, 0x10000, v3
    v_add_u32 v5, 0x20000, v3
    s_barrier
    ds_read_b128 a[224:227], v4 offset:0
    ds_read_b128 a[228:231], v4 offset:256
    ds_read_b128 a[232:235], v4 offset:2048
    ds_read_b128 a[236:239], v4 offset:2304
    ds_read_b128 a[240:243], v4 offset:4096
    s_add_u32 m0, s15, 49152
    s_add_u32 s21, s21, 4096
    buffer_load_dwordx4 v2, s[4:7], s21 offen sc1 lds
    s_add_u32 m0, s15, 53248
    s_add_u32 s21, s21, 4096
    buffer_load_dwordx4 v2, s[4:7], s21 offen sc1 lds
    v_mov_b32 v14, s32
    v_mov_b32 v15, s33
    s_cmp_eq_u32 s34, 0
    s_cbranch_scc1 slow_23
    s_waitcnt vmcnt(3)
    buffer_store_dwordx2 v[14:15], off, s[4:7], s41
join_24:
    s_lshl_b32 s28, s22, 12
    s_add_u32 s28, s28, 17825792
    s_mul_i32 s26, s22, 112
    s_mul_i32 s18, s23, 7
    s_add_u32 s26, s26, s18
    s_lshl_b32 s26, s26, 10
    s_add_u32 s26, s26, 10485760
    s_add_u32 s27, s26, 4096
    s_lshl_b32 s41, s22, 7
    s_add_u32 s41, s41, 8007680
    v_and_b32 v13, 15, v0
    v_lshlrev_b32 v13, 3, v13
    s_mov_b32 s40, 0x40000
poll_25:
    buffer_load_dwordx2 v[14:15], v13, s[4:7], s41 offen sc1
    s_sub_u32 s40, s40, 1
    s_cbranch_scc1 L_abort
    s_waitcnt vmcnt(0)
    v_cmp_ne_u64 vcc, s[32:33], v[14:15]
    s_nop 0
    s_cbranch_vccnz poll_25
    s_add_u32 s41, s41, 40960
    buffer_load_dwordx4 v[16:19], v12, s[4:7], s20 offen offset:0 sc1
    buffer_load_dwordx4 v[20:23], v12, s[4:7], s20 offen offset:256 sc1
    buffer_load_dwordx4 v[24:27], v12, s[4:7], s20 offen offset:2048 sc1
    buffer_load_dwordx4 v[28:31], v12, s[4:7], s20 offen offset:2304 sc1
    s_add_u32 s20, s20, 4096
    buffer_load_dwordx4 v[32:35], v12, s[4:7], s20 offen offset:0 sc1
    buffer_load_dwordx4 v[36:39], v12, s[4:7], s20 offen offset:256 sc1
    s_waitcnt vmcnt(4) lgkmcnt(3)
    v_mfma_f32_16x16x32_bf16 v[144:147], a[224:227], v[16:19], 0
    ds_read_b128 a[244:247], v4 offset:4352
    v_mfma_f32_16x16x32_bf16 v[148:151], a[224:227], v[20:23], 0
    buffer_load_dwordx4 v[40:43], v12, s[4:7], s20 offen offset:2048 sc1
    v_mfma_f32_16x16x32_bf16 v[152:155], a[228:231], v[16:19], 0
    ds_read_b128 a[248:251], v4 offset:6144
    s_waitcnt lgkmcnt(3)
    v_mfma_f32_16x16x32_bf16 v[156:159], a[228:231], v[20:23], 0
    v_mfma_f32_16x16x32_bf16 v[160:163], a[232:235], v[16:19], 0
    ds_read_b128 a[252:255], v4 offset:6400
    v_mfma_f32_16x16x32_bf16 v[164:167], a[232:235], v[20:23], 0
    buffer_load_dwordx4 v[44:47], v12, s[4:7], s20 offen offset:2304 sc1
    v_mfma_f32_16x16x32_bf16 v[168:171], a[236:239], v[16:19], 0
    ds_read_b128 a[224:227], v4 offset:8192
    s_waitcnt lgkmcnt(3)
    v_mfma_f32_16x16x32_bf16 v[172:175], a[236:239], v[20:23], 0
    v_mfma_f32_16x16x32_bf16 v[176:179], a[240:243], v[16:19], 0
    ds_read_b128 a[228:231], v4 offset:8448
    v_mfma_f32_16x16x32_bf16 v[180:183], a[240:243], v[20:23], 0
    s_add_u32 s20, s20, 4096
    buffer_load_dwordx4 v[48:51], v12, s[4:7], s20 offen offset:0 sc1
    v_mfma_f32_16x16x32_bf16 v[184:187], a[244:247], v[16:19], 0
    ds_read_b128 a[232:235], v4 offset:10240
    s_waitcnt vmcnt(5) lgkmcnt(3)
    v_mfma_f32_16x16x32_bf16 v[188:191], a[244:247], v[20:23], 0
    v_mfma_f32_16x16x32_bf16 v[144:147], a[248:251], v[24:27], v[144:147]
    ds_read_b128 a[236:239], v4 offset:10496
    v_mfma_f32_16x16x32_bf16 v[148:151], a[248:251], v[28:31], v[148:151]
    buffer_load_dwordx4 v[52:55], v12, s[4:7], s20 offen offset:256 sc1
    v_mfma_f32_16x16x32_bf16 v[152:155], a[252:255], v[24:27], v[152:155]
    ds_read_b128 a[240:243], v4 offset:12288
    s_waitcnt lgkmcnt(3)
    v_mfma_f32_16x16x32_bf16 v[156:159], a[252:255], v[28:31], v[156:159]
    v_mfma_f32_16x16x32_bf16 v[160:163], a[224:227], v[24:27], v[160:163]
    ds_read_b128 a[244:247], v4 offset:12544
    v_mfma_f32_16x16x32_bf16 v[164:167], a[224:227], v[28:31], v[164:167]
    buffer_load_dwordx4 v[56:59], v12, s[4:7], s20 offen offset:2048 sc1
    v_mfma_f32_16x16x32_bf16 v[168:171], a[228:231], v[24:27], v[168:171]
    ds_read_b128 a[248:251], v4 offset:14336
    s_waitcnt lgkmcnt(3)
    v_mfma_f32_16x16x32_bf16 v[172:175], a[228:231], v[28:31], v[172:175]
    v_mfma_f32_16x16x32_bf16 v[176:179], a[232:235], v[24:27], v[176:179]
    ds_read_b128 a[252:255], v4 offset:14592
    v_mfma_f32_16x16x32_bf16 v[180:183], a[232:235], v[28:31], v[180:183]
    s_add_u32 m0, s99, 57344
    s_add_u32 s21, s21, 4096
    s_add_u32 s21, s21, s15
    v_mfma_f32_16x16x32_bf16 v[184:187], a[236:239], v[24:27], v[184:187]
    ds_read_b128 a[224:227], v4 offset:16384
    s_waitcnt vmcnt(5) lgkmcnt(3)
    v_mfma_f32_16x16x32_bf16 v[188:191], a[236:239], v[28:31], v[188:191]
    buffer_load_dwordx4 v2, s[4:7], s21 offen sc1 lds
    v_mfma_f32_16x16x32_bf16 v[144:147], a[240:243], v[32:35], v[144:147]
    ds_read_b128 a[228:231], v4 offset:16640
    v_mfma_f32_16x16x32_bf16 v[148:151], a[240:243], v[36:39], v[148:151]
    buffer_load_dwordx2 v[14:15], v13, s[4:7], s41 offen sc1
    buffer_load_dwordx4 v[60:63], v12, s[4:7], s20 offen offset:2304 sc1
    v_mfma_f32_16x16x32_bf16 v[152:155], a[244:247], v[32:35], v[152:155]
    ds_read_b128 a[232:235], v4 offset:18432
    s_waitcnt lgkmcnt(3)
    v_mfma_f32_16x16x32_bf16 v[156:159], a[244:247], v[36:39], v[156:159]
    v_mfma_f32_16x16x32_bf16 v[160:163], a[248:251], v[32:35], v[160:163]
    ds_read_b128 a[236:239], v4 offset:18688
    v_mfma_f32_16x16x32_bf16 v[164:167], a[248:251], v[36:39], v[164:167]
    s_add_u32 s20, s20, 4096
    buffer_load_dwordx4 v[64:67], v12, s[4:7], s20 offen offset:0 sc1
    v_mfma_f32_16x16x32_bf16 v[168:171], a[252:255], v[32:35], v[168:171]
    ds_read_b128 a[240:243], v4 offset:20480
    s_waitcnt lgkmcnt(3)
    v_mfma_f32_16x16x32_bf16 v[172:175], a[252:255], v[36:39], v[172:175]
    v_mfma_f32_16x16x32_bf16 v[176:179], a[224:227], v[32:35], v[176:179]
    ds_read_b128 a[244:247], v4 offset:20736
    v_mfma_f32_16x16x32_bf16 v[180:183], a[224:227], v[36:39], v[180:183]
    buffer_load_dwordx4 v2, s[4:7], s21 offen offset:1024 sc1 lds
    v_mfma_f32_16x16x32_bf16 v[184:187], a[228:231], v[32:35], v[184:187]
    ds_read_b128 a[248:251], v4 offset:22528
    s_waitcnt vmcnt(8) lgkmcnt(3)
    v_mfma_f32_16x16x32_bf16 v[188:191], a[228:231], v[36:39], v[188:191]
    v_mfma_f32_16x16x32_bf16 v[144:147], a[232:235], v[40:43], v[144:147]
    ds_read_b128 a[252:255], v4 offset:22784
    v_mfma_f32_16x16x32_bf16 v[148:151], a[232:235], v[44:47], v[148:151]
    buffer_load_dwordx4 v[68:71], v12, s[4:7], s20 offen offset:256 sc1
    v_mfma_f32_16x16x32_bf16 v[152:155], a[236:239], v[40:43], v[152:155]
    ds_read_b128 a[224:227], v4 offset:24576
    s_waitcnt lgkmcnt(3)
    v_mfma_f32_16x16x32_bf16 v[156:159], a[236:239], v[44:47], v[156:159]
    v_mfma_f32_16x16x32_bf16 v[160:163], a[240:243], v[40:43], v[160:163]
    ds_read_b128 a[228:231], v4 offset:24832
    v_mfma_f32_16x16x32_bf16 v[164:167], a[240:243], v[44:47], v[164:167]
    buffer_load_dwordx4 v[72:75], v12, s[4:7], s20 offen offset:2048 sc1
    v_mfma_f32_16x16x32_bf16 v[168:171], a[244:247], v[40:43], v[168:171]
    ds_read_b128 a[232:235], v4 offset:26624
    s_waitcnt lgkmcnt(3)
    v_mfma_f32_16x16x32_bf16 v[172:175], a[244:247], v[44:47], v[172:175]
    v_mfma_f32_16x16x32_bf16 v[176:179], a[248:251], v[40:43], v[176:179]
    ds_read_b128 a[236:239], v4 offset:26880
    v_mfma_f32_16x16x32_bf16 v[180:183], a[248:251], v[44:47], v[180:183]
    buffer_load_dwordx4 v[76:79], v12, s[4:7], s20 offen offset:2304 sc1
    v_mfma_f32_16x16x32_bf16 v[184:187], a[252:255], v[40:43], v[184:187]
    ds_read_b128 a[240:243], v4 offset:28672
    s_waitcnt vmcnt(9) lgkmcnt(3)
    v_mfma_f32_16x16x32_bf16 v[188:191], a[252:255], v[44:47], v[188:191]
    v_mfma_f32_16x16x32_bf16 v[144:147], a[224:227], v[48:51], v[144:147]
    ds_read_b128 a[244:247], v4 offset:28928
    v_mfma_f32_16x16x32_bf16 v[148:151], a[224:227], v[52:55], v[148:151]
    s_add_u32 s20, s20, 4096
    buffer_load_dwordx4 v[80:83], v12, s[4:7], s20 offen offset:0 sc1
    v_mfma_f32_16x16x32_bf16 v[152:155], a[228:231], v[48:51], v[152:155]
    ds_read_b128 a[248:251], v4 offset:30720
    s_waitcnt lgkmcnt(3)
    v_mfma_f32_16x16x32_bf16 v[156:159], a[228:231], v[52:55], v[156:159]
    v_mfma_f32_16x16x32_bf16 v[160:163], a[232:235], v[48:51], v[160:163]
    ds_read_b128 a[252:255], v4 offset:30976
    v_mfma_f32_16x16x32_bf16 v[164:167], a[232:235], v[52:55], v[164:167]
    buffer_load_dwordx4 v[84:87], v12, s[4:7], s20 offen offset:256 sc1
    v_mfma_f32_16x16x32_bf16 v[168:171], a[236:239], v[48:51], v[168:171]
    ds_read_b128 a[224:227], v4 offset:32768
    s_waitcnt lgkmcnt(3)
    v_mfma_f32_16x16x32_bf16 v[172:175], a[236:239], v[52:55], v[172:175]
    v_mfma_f32_16x16x32_bf16 v[176:179], a[240:243], v[48:51], v[176:179]
    ds_read_b128 a[228:231], v4 offset:33024
    v_mfma_f32_16x16x32_bf16 v[180:183], a[240:243], v[52:55], v[180:183]
    buffer_load_dwordx4 v[88:91], v12, s[4:7], s20 offen offset:2048 sc1
    v_mfma_f32_16x16x32_bf16 v[184:187], a[244:247], v[48:51], v[184:187]
    ds_read_b128 a[232:235], v4 offset:34816
    s_waitcnt vmcnt(8) lgkmcnt(3)
    v_mfma_f32_16x16x32_bf16 v[188:191], a[244:247], v[52:55], v[188:191]
    v_mfma_f32_16x16x32_bf16 v[144:147], a[248:251], v[56:59], v[144:147]
    ds_read_b128 a[236:239], v4 offset:35072
    v_mfma_f32_16x16x32_bf16 v[148:151], a[248:251], v[60:63], v[148:151]
    v_cmp_ne_u64 vcc, s[32:33], v[14:15]
    s_nop 0
    s_cbranch_vccnz ap_26
apok_27:
    buffer_load_dwordx4 v[92:95], v12, s[4:7], s20 offen offset:2304 sc1
    v_mfma_f32_16x16x32_bf16 v[152:155], a[252:255], v[56:59], v[152:155]
    ds_read_b128 a[240:243], v4 offset:36864
    s_waitcnt lgkmcnt(3)
    v_mfma_f32_16x16x32_bf16 v[156:159], a[252:255], v[60:63], v[156:159]
    v_mfma_f32_16x16x32_bf16 v[160:163], a[224:227], v[56:59], v[160:163]
    ds_read_b128 a[244:247], v4 offset:37120
    v_mfma_f32_16x16x32_bf16 v[164:167], a[224:227], v[60:63], v[164:167]
    buffer_load_dwordx4 v[224:227], v1, s[4:7], s28 offen offset:0 sc1
    v_mfma_f32_16x16x32_bf16 v[168:171], a[228:231], v[56:59], v[168:171]
    ds_read_b128 a[248:251], v4 offset:38912
    s_waitcnt lgkmcnt(3)
    v_mfma_f32_16x16x32_bf16 v[172:175], a[228:231], v[60:63], v[172:175]
    v_mfma_f32_16x16x32_bf16 v[176:179], a[232:235], v[56:59], v[176:179]
    ds_read_b128 a[252:255], v4 offset:39168
    v_mfma_f32_16x16x32_bf16 v[180:183], a[232:235], v[60:63], v[180:183]
    buffer_load_dwordx4 v[228:231], v1, s[4:7], s28 offen offset:1024 sc1
    v_and_b32 v13, 0xf0, v3
    v_mfma_f32_16x16x32_bf16 v[184:187], a[236:239], v[56:59], v[184:187]
    ds_read_b128 a[224:227], v4 offset:40960
    s_waitcnt vmcnt(8) lgkmcnt(3)
    v_mfma_f32_16x16x32_bf16 v[188:191], a[236:239], v[60:63], v[188:191]
    v_bfe_u32 v7, v0, 5, 1
    v_lshl_add_u32 v13, v7, 9, v13
    v_mfma_f32_16x16x32_bf16 v[144:147], a[240:243], v[64:67], v[144:147]
    ds_read_b128 a[228:231], v4 offset:41216
    v_bfe_u32 v7, v0, 4, 1
    v_mfma_f32_16x16x32_bf16 v[148:151], a[240:243], v[68:71], v[148:151]
    s_add_u32 s20, s20, 4096
    buffer_load_dwordx4 v[96:99], v12, s[4:7], s20 offen offset:0 sc1
    v_lshl_add_u32 v13, v7, 3, v13
    v_mfma_f32_16x16x32_bf16 v[152:155], a[244:247], v[64:67], v[152:155]
    ds_read_b128 a[232:235], v4 offset:43008
    s_waitcnt lgkmcnt(3)
    v_mfma_f32_16x16x32_bf16 v[156:159], a[244:247], v[68:71], v[156:159]
    v_add_u32 v13, 16384, v13
    s_lshl_b32 s41, s22, 4
    v_mfma_f32_16x16x32_bf16 v[160:163], a[248:251], v[64:67], v[160:163]
    ds_read_b128 a[236:239], v4 offset:43264
    s_add_u32 s41, s41, s23
    v_mfma_f32_16x16x32_bf16 v[164:167], a[248:251], v[68:71], v[164:167]
    buffer_load_dwordx4 v[232:235], v1, s[4:7], s28 offen offset:2048 sc1
    s_lshl_b32 s41, s41, 3
    v_mfma_f32_16x16x32_bf16 v[168:171], a[252:255], v[64:67], v[168:171]
    ds_read_b128 a[240:243], v4 offset:45056
    s_waitcnt lgkmcnt(3)
    v_mfma_f32_16x16x32_bf16 v[172:175], a[252:255], v[68:71], v[172:175]
    s_add_u32 s41, s41, 8073216
    v_mov_b32 v14, s32
    v_mfma_f32_16x16x32_bf16 v[176:179], a[224:227], v[64:67], v[176:179]
    ds_read_b128 a[244:247], v4 offset:45312
    v_mov_b32 v15, s33
    v_mfma_f32_16x16x32_bf16 v[180:183], a[224:227], v[68:71], v[180:183]
    buffer_load_dwordx4 v[236:239], v1, s[4:7], s28 offen offset:3072 sc1
    s_lshr_b32 s16, s100, 15
    v_mfma_f32_16x16x32_bf16 v[184:187], a[228:231], v[64:67], v[184:187]
    ds_read_b128 a[248:251], v4 offset:47104
    s_waitcnt vmcnt(9) lgkmcnt(3)
    v_mfma_f32_16x16x32_bf16 v[188:191], a[228:231], v[68:71], v[188:191]
    s_mul_i32 s17, s12, 28672
    s_add_u32 s17, s17, 10485760
    v_mfma_f32_16x16x32_bf16 v[144:147], a[232:235], v[72:75], v[144:147]
    ds_read_b128 a[252:255], v4 offset:47360
    s_mul_i32 s24, s16, 114688
    v_mfma_f32_16x16x32_bf16 v[148:151], a[232:235], v[76:79], v[148:151]
    buffer_load_dwordx4 v[100:103], v12, s[4:7], s20 offen offset:256 sc1
    s_add_u32 s24, s24, s17
    v_mfma_f32_16x16x32_bf16 v[152:155], a[236:239], v[72:75], v[152:155]
    ds_read_b128 a[224:227], v4 offset:49152
    s_waitcnt lgkmcnt(3)
    v_mfma_f32_16x16x32_bf16 v[156:159], a[236:239], v[76:79], v[156:159]
    s_xor_b32 s18, s16, 1
    s_mul_i32 s39, s18, 114688
    v_mfma_f32_16x16x32_bf16 v[160:163], a[240:243], v[72:75], v[160:163]
    ds_read_b128 a[228:231], v4 offset:49408
    s_add_u32 s39, s39, s17
    v_mfma_f32_16x16x32_bf16 v[164:167], a[240:243], v[76:79], v[164:167]
    buffer_load_dwordx4 v[104:107], v12, s[4:7], s20 offen offset:2048 sc1
    s_and_b32 s25, s16, 0xfe
    v_mfma_f32_16x16x32_bf16 v[168:171], a[244:247], v[72:75], v[168:171]
    ds_read_b128 a[232:235], v4 offset:51200
    s_waitcnt lgkmcnt(3)
    v_mfma_f32_16x16x32_bf16 v[172:175], a[244:247], v[76:79], v[172:175]
    s_lshl_b32 s25, s25, 7
    s_lshl_b32 s17, s12, 5
    v_mfma_f32_16x16x32_bf16 v[176:179], a[248:251], v[72:75], v[176:179]
    ds_read_b128 a[236:239], v4 offset:51456
    s_add_u32 s25, s25, s17
    v_mfma_f32_16x16x32_bf16 v[180:183], a[248:251], v[76:79], v[180:183]
    buffer_load_dwordx4 v[108:111], v12, s[4:7], s20 offen offset:2304 sc1
    s_add_u32 s25, s25, 8073216
    v_mfma_f32_16x16x32_bf16 v[184:187], a[252:255], v[72:75], v[184:187]
    ds_read_b128 a[240:243], v4 offset:53248
    s_waitcnt vmcnt(10) lgkmcnt(3)
    v_mfma_f32_16x16x32_bf16 v[188:191], a[252:255], v[76:79], v[188:191]
    s_getpc_b64 s[90:91]
pc_28:
    s_min_u32 s19, s85, L_end-pc_28-1024
    s_barrier
    v_mfma_f32_16x16x32_bf16 v[144:147], a[224:227], v[80:83], v[144:147]
    ds_read_b128 a[244:247], v4 offset:53504
    s_add_u32 s90, s90, s19
    s_addc_u32 s91, s91, 0
    v_mfma_f32_16x16x32_bf16 v[148:151], a[224:227], v[84:87], v[148:151]
    s_add_u32 s20, s20, 4096
    buffer_load_dwordx4 v[112:115], v12, s[4:7], s20 offen offset:0 sc1
    v_mfma_f32_16x16x32_bf16 v[152:155], a[228:231], v[80:83], v[152:155]
    ds_read_b128 a[248:251], v4 offset:55296
    s_waitcnt lgkmcnt(3)
    v_mfma_f32_16x16x32_bf16 v[156:159], a[228:231], v[84:87], v[156:159]
    v_mfma_f32_16x16x32_bf16 v[160:163], a[232:235], v[80:83], v[160:163]
    ds_read_b128 a[252:255], v4 offset:55552
    v_mfma_f32_16x16x32_bf16 v[164:167], a[232:235], v[84:87], v[164:167]
    s_add_u32 m0, s99, 65536
    s_add_u32 s21, s21, 8192
    v_mfma_f32_16x16x32_bf16 v[168:171], a[236:239], v[80:83], v[168:171]
    ds_read_b128 a[224:227], v4 offset:57344
    s_waitcnt lgkmcnt(3)
    v_mfma_f32_16x16x32_bf16 v[172:175], a[236:239], v[84:87], v[172:175]
    buffer_load_dwordx4 v2, s[4:7], s21 offen sc1 lds
    v_mfma_f32_16x16x32_bf16 v[176:179], a[240:243], v[80:83], v[176:179]
    ds_read_b128 a[228:231], v4 offset:57600
    v_mfma_f32_16x16x32_bf16 v[180:183], a[240:243], v[84:87], v[180:183]
    buffer_load_dwordx4 v2, s[4:7], s21 offen offset:1024 sc1 lds
    v_mfma_f32_16x16x32_bf16 v[184:187], a[244:247], v[80:83], v[184:187]
    ds_read_b128 a[232:235], v4 offset:59392
    s_waitcnt vmcnt(11) lgkmcnt(3)
    v_mfma_f32_16x16x32_bf16 v[188:191], a[244:247], v[84:87], v[188:191]
    v_mfma_f32_16x16x32_bf16 v[144:147], a[248:251], v[88:91], v[144:147]
    ds_read_b128 a[236:239], v4 offset:59648
    v_mfma_f32_16x16x32_bf16 v[148:151], a[248:251], v[92:95], v[148:151]
    buffer_load_dwordx4 v[116:119], v12, s[4:7], s20 offen offset:256 sc1
    v_mfma_f32_16x16x32_bf16 v[152:155], a[252:255], v[88:91], v[152:155]
    ds_read_b128 a[240:243], v4 offset:61440
    s_waitcnt lgkmcnt(3)
    v_mfma_f32_16x16x32_bf16 v[156:159], a[252:255], v[92:95], v[156:159]
    v_mfma_f32_16x16x32_bf16 v[160:163], a[224:227], v[88:91], v[160:163]
    ds_read_b128 a[244:247], v4 offset:61696
    v_mfma_f32_16x16x32_bf16 v[164:167], a[224:227], v[92:95], v[164:167]
    buffer_load_dwordx4 v[120:123], v12, s[4:7], s20 offen offset:2048 sc1
    v_mfma_f32_16x16x32_bf16 v[168:171], a[228:231], v[88:91], v[168:171]
    ds_read_b128 a[248:251], v4 offset:63488
    s_waitcnt lgkmcnt(3)
    v_mfma_f32_16x16x32_bf16 v[172:175], a[228:231], v[92:95], v[172:175]
    v_mfma_f32_16x16x32_bf16 v[176:179], a[232:235], v[88:91], v[176:179]
    ds_read_b128 a[252:255], v4 offset:63744
    v_mfma_f32_16x16x32_bf16 v[180:183], a[232:235], v[92:95], v[180:183]
    s_add_u32 m0, s99, 73728
    s_add_u32 s21, s21, 8192
    v_mfma_f32_16x16x32_bf16 v[184:187], a[236:239], v[88:91], v[184:187]
    ds_read_b128 a[224:227], v5 offset:0
    s_waitcnt vmcnt(7) lgkmcnt(3)
    v_mfma_f32_16x16x32_bf16 v[188:191], a[236:239], v[92:95], v[188:191]
    buffer_load_dwordx4 v2, s[4:7], s21 offen sc1 lds
    v_mfma_f32_16x16x32_bf16 v[144:147], a[240:243], v[96:99], v[144:147]
    ds_read_b128 a[228:231], v5 offset:256
    v_mfma_f32_16x16x32_bf16 v[148:151], a[240:243], v[100:103], v[148:151]
    buffer_load_dwordx4 v[124:127], v12, s[4:7], s20 offen offset:2304 sc1
    v_mfma_f32_16x16x32_bf16 v[152:155], a[244:247], v[96:99], v[152:155]
    ds_read_b128 a[232:235], v5 offset:2048
    s_waitcnt lgkmcnt(3)
    v_mfma_f32_16x16x32_bf16 v[156:159], a[244:247], v[100:103], v[156:159]
    v_mfma_f32_16x16x32_bf16 v[160:163], a[248:251], v[96:99], v[160:163]
    ds_read_b128 a[236:239], v5 offset:2304
    v_mfma_f32_16x16x32_bf16 v[164:167], a[248:251], v[100:103], v[164:167]
    s_add_u32 s20, s20, 4096
    buffer_load_dwordx4 v[128:131], v12, s[4:7], s20 offen offset:0 sc1
    v_mfma_f32_16x16x32_bf16 v[168:171], a[252:255], v[96:99], v[168:171]
    ds_read_b128 a[240:243], v5 offset:4096
    s_waitcnt lgkmcnt(3)
    v_mfma_f32_16x16x32_bf16 v[172:175], a[252:255], v[100:103], v[172:175]
    v_mfma_f32_16x16x32_bf16 v[176:179], a[224:227], v[96:99], v[176:179]
    ds_read_b128 a[244:247], v5 offset:4352
    v_mfma_f32_16x16x32_bf16 v[180:183], a[224:227], v[100:103], v[180:183]
    buffer_load_dwordx4 v2, s[4:7], s21 offen offset:1024 sc1 lds
    v_add_f32 v224, v224, v232
    v_mfma_f32_16x16x32_bf16 v[184:187], a[228:231], v[96:99], v[184:187]
    ds_read_b128 a[248:251], v5 offset:6144
    s_waitcnt vmcnt(9) lgkmcnt(3)
    v_mfma_f32_16x16x32_bf16 v[188:191], a[228:231], v[100:103], v[188:191]
    v_add_f32 v225, v225, v233
    v_add_f32 v226, v226, v234
    v_mfma_f32_16x16x32_bf16 v[144:147], a[232:235], v[104:107], v[144:147]
    ds_read_b128 a[252:255], v5 offset:6400
    v_add_f32 v227, v227, v235
    v_mfma_f32_16x16x32_bf16 v[148:151], a[232:235], v[108:111], v[148:151]
    buffer_load_dwordx4 v[132:135], v12, s[4:7], s20 offen offset:256 sc1
    v_add_f32 v228, v228, v236
    v_mfma_f32_16x16x32_bf16 v[152:155], a[236:239], v[104:107], v[152:155]
    ds_read_b128 a[224:227], v5 offset:8192
    s_waitcnt lgkmcnt(3)
    v_mfma_f32_16x16x32_bf16 v[156:159], a[236:239], v[108:111], v[156:159]
    v_add_f32 v229, v229, v237
    v_add_f32 v230, v230, v238
    v_mfma_f32_16x16x32_bf16 v[160:163], a[240:243], v[104:107], v[160:163]
    ds_read_b128 a[228:231], v5 offset:8448
    v_add_f32 v231, v231, v239
    v_mfma_f32_16x16x32_bf16 v[164:167], a[240:243], v[108:111], v[164:167]
    buffer_load_dwordx4 v[136:139], v12, s[4:7], s20 offen offset:2048 sc1
    v_add_f32 v224, v224, v228
    v_mfma_f32_16x16x32_bf16 v[168:171], a[244:247], v[104:107], v[168:171]
    ds_read_b128 a[232:235], v5 offset:10240
    s_waitcnt lgkmcnt(3)
    v_mfma_f32_16x16x32_bf16 v[172:175], a[244:247], v[108:111], v[172:175]
    v_add_f32 v225, v225, v229
    v_add_f32 v226, v226, v230
    v_mfma_f32_16x16x32_bf16 v[176:179], a[248:251], v[104:107], v[176:179]
    ds_read_b128 a[236:239], v5 offset:10496
    v_add_f32 v227, v227, v231
    v_mfma_f32_16x16x32_bf16 v[180:183], a[248:251], v[108:111], v[180:183]
    s_add_u32 m0, s99, 81920
    s_add_u32 s21, s21, 8192
    v_mfma_f32_16x16x32_bf16 v[184:187], a[252:255], v[104:107], v[184:187]
    ds_read_b128 a[240:243], v5 offset:12288
    s_waitcnt vmcnt(7) lgkmcnt(3)
    v_mfma_f32_16x16x32_bf16 v[188:191], a[252:255], v[108:111], v[188:191]
    buffer_load_dwordx4 v2, s[4:7], s21 offen sc1 lds
    v_add_f32 v224, v224, v226
    v_mfma_f32_16x16x32_bf16 v[144:147], a[224:227], v[112:115], v[144:147]
    ds_read_b128 a[244:247], v5 offset:12544
    v_add_f32 v225, v225, v227
    v_mfma_f32_16x16x32_bf16 v[148:151], a[224:227], v[116:119], v[148:151]
    buffer_load_dwordx4 v[140:143], v12, s[4:7], s20 offen offset:2304 sc1
    v_mov_b32 v226, v224
    v_mfma_f32_16x16x32_bf16 v[152:155], a[228:231], v[112:115], v[152:155]
    ds_read_b128 a[248:251], v5 offset:14336
    s_waitcnt lgkmcnt(3)
    v_mfma_f32_16x16x32_bf16 v[156:159], a[228:231], v[116:119], v[156:159]
    v_mov_b32 v227, v225
    v_permlane32_swap_b32 v224, v226
    v_mfma_f32_16x16x32_bf16 v[160:163], a[232:235], v[112:115], v[160:163]
    ds_read_b128 a[252:255], v5 offset:14592
    v_permlane32_swap_b32 v225, v227
    v_mfma_f32_16x16x32_bf16 v[164:167], a[232:235], v[116:119], v[164:167]
    buffer_load_dwordx4 v2, s[4:7], s21 offen offset:1024 sc1 lds
    v_add_f32 v224, v224, v226
    v_mfma_f32_16x16x32_bf16 v[168:171], a[236:239], v[112:115], v[168:171]
    ds_read_b128 a[224:227], v3 offset:0
    s_waitcnt lgkmcnt(3)
    v_mfma_f32_16x16x32_bf16 v[172:175], a[236:239], v[116:119], v[172:175]
    v_add_f32 v225, v225, v227
    v_mul_f32 v224, 0xbb000000, v224
    v_mfma_f32_16x16x32_bf16 v[176:179], a[240:243], v[112:115], v[176:179]
    ds_read_b128 a[228:231], v3 offset:256
    v_mul_f32 v225, 0x3b000000, v225
    v_mfma_f32_16x16x32_bf16 v[180:183], a[240:243], v[116:119], v[180:183]
    s_add_u32 m0, s99, 90112
    s_add_u32 s21, s21, 8192
    v_mfma_f32_16x16x32_bf16 v[184:187], a[244:247], v[112:115], v[184:187]
    ds_read_b128 a[232:235], v3 offset:2048
    s_waitcnt vmcnt(7) lgkmcnt(3)
    v_mfma_f32_16x16x32_bf16 v[188:191], a[244:247], v[116:119], v[188:191]
    buffer_load_dwordx4 v2, s[4:7], s21 offen sc1 lds
    v_fma_f32 v225, -v224, v224, v225
    v_mfma_f32_16x16x32_bf16 v[144:147], a[248:251], v[120:123], v[144:147]
    ds_read_b128 a[236:239], v3 offset:2304
    v_max_f32 v225, 0, v225
    v_mfma_f32_16x16x32_bf16 v[148:151], a[248:251], v[124:127], v[148:151]
    buffer_load_dwordx4 v2, s[4:7], s21 offen offset:1024 sc1 lds
    v_cvt_pk_bf16_f32 v225, v225, 0
    v_mfma_f32_16x16x32_bf16 v[152:155], a[252:255], v[120:123], v[152:155]
    ds_read_b128 a[240:243], v3 offset:4096
    s_waitcnt lgkmcnt(3)
    v_mfma_f32_16x16x32_bf16 v[156:159], a[252:255], v[124:127], v[156:159]
    v_lshlrev_b32 v225, 16, v225
    v_add_f32 v225, 0x3727c5ac, v225
    s_barrier
    v_mfma_f32_16x16x32_bf16 v[160:163], a[224:227], v[120:123], v[160:163]
    ds_read_b128 a[244:247], v3 offset:4352
    v_cvt_pk_bf16_f32 v225, v225, 0
    v_mfma_f32_16x16x32_bf16 v[164:167], a[224:227], v[124:127], v[164:167]
    s_add_u32 m0, s99, 98304
    s_add_u32 s21, s21, 8192
    v_mfma_f32_16x16x32_bf16 v[168:171], a[228:231], v[120:123], v[168:171]
    ds_read_b128 a[248:251], v3 offset:6144
    s_waitcnt lgkmcnt(3)
    v_mfma_f32_16x16x32_bf16 v[172:175], a[228:231], v[124:127], v[172:175]
    buffer_load_dwordx4 v2, s[4:7], s21 offen sc1 lds
    v_lshlrev_b32 v225, 16, v225
    v_mfma_f32_16x16x32_bf16 v[176:179], a[232:235], v[120:123], v[176:179]
    ds_read_b128 a[252:255], v3 offset:6400
    v_sqrt_f32 v225, v225
    v_mfma_f32_16x16x32_bf16 v[180:183], a[232:235], v[124:127], v[180:183]
    buffer_load_dwordx4 v2, s[4:7], s21 offen offset:1024 sc1 lds
    v_cvt_pk_bf16_f32 v8, v224, v224
    v_mfma_f32_16x16x32_bf16 v[184:187], a[236:239], v[120:123], v[184:187]
    ds_read_b128 a[224:227], v3 offset:8192
    s_waitcnt vmcnt(8) lgkmcnt(3)
    v_mfma_f32_16x16x32_bf16 v[188:191], a[236:239], v[124:127], v[188:191]
    v_cvt_pk_bf16_f32 v225, v225, 0
    v_lshlrev_b32 v225, 16, v225
    v_mfma_f32_16x16x32_bf16 v[144:147], a[240:243], v[128:131], v[144:147]
    ds_read_b128 a[228:231], v3 offset:8448
    v_rcp_f32 v6, v225
    v_mfma_f32_16x16x32_bf16 v[148:151], a[240:243], v[132:135], v[148:151]
    s_add_u32 m0, s99, 106496
    s_add_u32 s21, s21, 8192
    v_mfma_f32_16x16x32_bf16 v[152:155], a[244:247], v[128:131], v[152:155]
    ds_read_b128 a[232:235], v3 offset:10240
    s_waitcnt lgkmcnt(3)
    v_mfma_f32_16x16x32_bf16 v[156:159], a[244:247], v[132:135], v[156:159]
    buffer_load_dwordx4 v2, s[4:7], s21 offen sc1 lds
    v_mov_b32 v9, 0
    v_mfma_f32_16x16x32_bf16 v[160:163], a[248:251], v[128:131], v[160:163]
    ds_read_b128 a[236:239], v3 offset:10496
    v_mov_b32 v10, v8
    v_mfma_f32_16x16x32_bf16 v[164:167], a[248:251], v[132:135], v[164:167]
    buffer_load_dwordx4 v2, s[4:7], s21 offen offset:1024 sc1 lds
    v_mov_b32 v11, 0
    v_mfma_f32_16x16x32_bf16 v[168:171], a[252:255], v[128:131], v[168:171]
    ds_read_b128 a[240:243], v3 offset:12288
    s_waitcnt lgkmcnt(3)
    v_mfma_f32_16x16x32_bf16 v[172:175], a[252:255], v[132:135], v[172:175]
    v_mul_f32 v6, v6, v6
    v_permlane16_swap_b32 v8, v10
    v_mfma_f32_16x16x32_bf16 v[176:179], a[224:227], v[128:131], v[176:179]
    ds_read_b128 a[244:247], v3 offset:12544
    v_mov_b32 v7, v6
    v_mfma_f32_16x16x32_bf16 v[180:183], a[224:227], v[132:135], v[180:183]
    s_add_u32 m0, s99, 114688
    s_add_u32 s21, s21, 8192
    v_mfma_f32_16x16x32_bf16 v[184:187], a[228:231], v[128:131], v[184:187]
    ds_read_b128 a[248:251], v3 offset:14336
    s_waitcnt vmcnt(7) lgkmcnt(3)
    v_mfma_f32_16x16x32_bf16 v[188:191], a[228:231], v[132:135], v[188:191]
    buffer_load_dwordx4 v2, s[4:7], s21 offen sc1 lds
    v_permlane16_swap_b32 v6, v7
    v_mfma_f32_16x16x32_bf16 v[144:147], a[232:235], v[136:139], v[144:147]
    ds_read_b128 a[252:255], v3 offset:14592
    v_mfma_f32_16x16x32_bf16 v[148:151], a[232:235], v[140:143], v[148:151]
    buffer_load_dwordx4 v2, s[4:7], s21 offen offset:1024 sc1 lds
    v_mfma_f32_16x16x32_bf16 v[152:155], a[236:239], v[136:139], v[152:155]
    ds_read_b64 a[224:225], v13 offset:0
    ds_read_b64 a[226:227], v13 offset:256
    s_waitcnt lgkmcnt(4)
    v_mfma_f32_16x16x32_bf16 v[156:159], a[236:239], v[140:143], v[156:159]
    v_mfma_f32_16x16x32_bf16 v[160:163], a[240:243], v[136:139], v[160:163]
    ds_read_b64 a[228:229], v13 offset:1024
    ds_read_b64 a[230:231], v13 offset:1280
    v_mfma_f32_16x16x32_bf16 v[164:167], a[240:243], v[140:143], v[164:167]
    s_add_u32 m0, s99, 122880
    s_add_u32 s21, s21, 8192
    v_mfma_f32_16x16x32_bf16 v[168:171], a[244:247], v[136:139], v[168:171]
    ds_read_b64 a[232:233], v13 offset:2048
    ds_read_b64 a[234:235], v13 offset:2304
    s_waitcnt lgkmcnt(6)
    v_mfma_f32_16x16x32_bf16 v[172:175], a[244:247], v[140:143], v[172:175]
    buffer_load_dwordx4 v2, s[4:7], s21 offen sc1 lds
    v_mfma_f32_16x16x32_bf16 v[176:179], a[248:251], v[136:139], v[176:179]
    ds_read_b128 a[236:239], v3 offset:20480
    v_mfma_f32_16x16x32_bf16 v[180:183], a[248:251], v[140:143], v[180:183]
    buffer_load_dwordx4 v2, s[4:7], s21 offen offset:1024 sc1 lds
    v_mfma_f32_16x16x32_bf16 v[184:187], a[252:255], v[136:139], v[184:187]
    ds_read_b128 a[240:243], v3 offset:20736
    s_waitcnt lgkmcnt(4)
    v_mfma_f32_16x16x32_bf16 v[188:191], a[252:255], v[140:143], v[188:191]
    v_mfma_f32_16x16x16_bf16 v[144:147], a[224:225], v[8:9], v[144:147]
    ds_read_b128 a[244:247], v3 offset:22528
    v_mfma_f32_16x16x16_bf16 v[148:151], a[224:225], v[10:11], v[148:151]
    v_mfma_f32_16x16x16_bf16 v[152:155], a[226:227], v[8:9], v[152:155]
    v_mfma_f32_16x16x16_bf16 v[156:159], a[226:227], v[10:11], v[156:159]
    s_add_u32 m0, s99, 131072
    s_add_u32 s21, s21, 8192
    v_mfma_f32_16x16x16_bf16 v[160:163], a[228:229], v[8:9], v[160:163]
    ds_read_b128 a[248:251], v3 offset:22784
    s_waitcnt lgkmcnt(3)
    v_mfma_f32_16x16x16_bf16 v[164:167], a[228:229], v[10:11], v[164:167]
    buffer_load_dwordx4 v2, s[4:7], s21 offen sc1 lds
    v_mfma_f32_16x16x16_bf16 v[168:171], a[230:231], v[8:9], v[168:171]
    v_mfma_f32_16x16x16_bf16 v[172:175], a[230:231], v[10:11], v[172:175]
    v_mfma_f32_16x16x16_bf16 v[176:179], a[232:233], v[8:9], v[176:179]
    ds_read_b128 a[252:255], v3 offset:24576
    v_mfma_f32_16x16x16_bf16 v[180:183], a[232:233], v[10:11], v[180:183]
    v_mfma_f32_16x16x16_bf16 v[184:187], a[234:235], v[8:9], v[184:187]
    v_mfma_f32_16x16x16_bf16 v[188:191], a[234:235], v[10:11], v[188:191]
    buffer_load_dwordx4 v2, s[4:7], s21 offen offset:1024 sc1 lds
    v_mfma_f32_16x16x32_bf16 v[192:195], a[236:239], v[16:19], 0
    ds_read_b128 a[224:227], v3 offset:24832
    s_waitcnt lgkmcnt(3)
    v_mfma_f32_16x16x32_bf16 v[196:199], a[236:239], v[20:23], 0
    v_mfma_f32_16x16x32_bf16 v[200:203], a[240:243], v[16:19], 0
    ds_read_b128 a[228:231], v3 offset:26624
    v_mfma_f32_16x16x32_bf16 v[204:207], a[240:243], v[20:23], 0
    global_load_dword v255, v1, s[90:91]
    v_mul_f32 v144, v144, v6
    v_mul_f32 v145, v145, v6
    v_mfma_f32_16x16x32_bf16 v[208:211], a[244:247], v[16:19], 0
    ds_read_b128 a[232:235], v3 offset:26880
    s_waitcnt lgkmcnt(3)
    v_mfma_f32_16x16x32_bf16 v[212:215], a[244:247], v[20:23], 0
    v_mul_f32 v146, v146, v6
    v_mul_f32 v147, v147, v6
    v_mfma_f32_16x16x32_bf16 v[216:219], a[248:251], v[16:19], 0
    ds_read_b128 a[236:239], v3 offset:28672
    v_mul_f32 v144, v144, v152
    v_mfma_f32_16x16x32_bf16 v[220:223], a[248:251], v[20:23], 0
    v_mul_f32 v145, v145, v153
    v_mul_f32 v146, v146, v154
    v_mfma_f32_16x16x32_bf16 v[192:195], a[252:255], v[24:27], v[192:195]
    ds_read_b128 a[240:243], v3 offset:28928
    s_waitcnt lgkmcnt(3)
    v_mfma_f32_16x16x32_bf16 v[196:199], a[252:255], v[28:31], v[196:199]
    v_mul_f32 v147, v147, v155
    v_cvt_pk_bf16_f32 v152, v144, v145
    v_mfma_f32_16x16x32_bf16 v[200:203], a[224:227], v[24:27], v[200:203]
    ds_read_b128 a[244:247], v3 offset:30720
    v_cvt_pk_bf16_f32 v153, v146, v147
    v_mfma_f32_16x16x32_bf16 v[204:207], a[224:227], v[28:31], v[204:207]
    v_mul_f32 v148, v148, v7
    v_mul_f32 v149, v149, v7
    v_mfma_f32_16x16x32_bf16 v[208:211], a[228:231], v[24:27], v[208:211]
    ds_read_b128 a[248:251], v3 offset:30976
    s_waitcnt lgkmcnt(3)
    v_mfma_f32_16x16x32_bf16 v[212:215], a[228:231], v[28:31], v[212:215]
    v_mul_f32 v150, v150, v7
    v_mul_f32 v151, v151, v7
    v_mfma_f32_16x16x32_bf16 v[216:219], a[232:235], v[24:27], v[216:219]
    ds_read_b128 a[252:255], v3 offset:32768
    v_mul_f32 v148, v148, v156
    v_mfma_f32_16x16x32_bf16 v[220:223], a[232:235], v[28:31], v[220:223]
    v_mul_f32 v149, v149, v157
    v_mul_f32 v150, v150, v158
    v_mfma_f32_16x16x32_bf16 v[192:195], a[236:239], v[32:35], v[192:195]
    ds_read_b128 a[224:227], v3 offset:33024
    s_waitcnt lgkmcnt(3)
    v_mfma_f32_16x16x32_bf16 v[196:199], a[236:239], v[36:39], v[196:199]
    v_mul_f32 v151, v151, v159
    v_cvt_pk_bf16_f32 v154, v148, v149
    v_mfma_f32_16x16x32_bf16 v[200:203], a[240:243], v[32:35], v[200:203]
    ds_read_b128 a[228:231], v3 offset:34816
    v_cvt_pk_bf16_f32 v155, v150, v151
    v_mfma_f32_16x16x32_bf16 v[204:207], a[240:243], v[36:39], v[204:207]
    v_permlane16_swap_b32 v152, v154
    v_permlane16_swap_b32 v153, v155
    v_mfma_f32_16x16x32_bf16 v[208:211], a[244:247], v[32:35], v[208:211]
    ds_read_b128 a[232:235], v3 offset:35072
    s_waitcnt lgkmcnt(3)
    v_mfma_f32_16x16x32_bf16 v[212:215], a[244:247], v[36:39], v[212:215]
    buffer_store_dwordx4 v[152:155], v1, s[4:7], s26 offen offset:0
    v_mul_f32 v160, v160, v6
    v_mfma_f32_16x16x32_bf16 v[216:219], a[248:251], v[32:35], v[216:219]
    ds_read_b128 a[236:239], v3 offset:36864
    v_mul_f32 v161, v161, v6
    v_mfma_f32_16x16x32_bf16 v[220:223], a[248:251], v[36:39], v[220:223]
    v_mul_f32 v162, v162, v6
    v_mul_f32 v163, v163, v6
    v_mfma_f32_16x16x32_bf16 v[192:195], a[252:255], v[40:43], v[192:195]
    ds_read_b128 a[240:243], v3 offset:37120
    s_waitcnt lgkmcnt(3)
    v_mfma_f32_16x16x32_bf16 v[196:199], a[252:255], v[44:47], v[196:199]
    v_mul_f32 v160, v160, v168
    v_mul_f32 v161, v161, v169
    s_barrier
    v_mfma_f32_16x16x32_bf16 v[200:203], a[224:227], v[40:43], v[200:203]
    ds_read_b128 a[244:247], v3 offset:38912
    v_mul_f32 v162, v162, v170
    v_mfma_f32_16x16x32_bf16 v[204:207], a[224:227], v[44:47], v[204:207]
    s_add_u32 m0, s99, 139264
    s_add_u32 s21, s21, 8192
    v_mfma_f32_16x16x32_bf16 v[208:211], a[228:231], v[40:43], v[208:211]
    ds_read_b128 a[248:251], v3 offset:39168
    s_waitcnt lgkmcnt(3)
    v_mfma_f32_16x16x32_bf16 v[212:215], a[228:231], v[44:47], v[212:215]
    buffer_load_dwordx4 v2, s[4:7], s21 offen sc1 lds
    v_mul_f32 v163, v163, v171
    v_mfma_f32_16x16x32_bf16 v[216:219], a[232:235], v[40:43], v[216:219]
    ds_read_b128 a[252:255], v3 offset:40960
    v_cvt_pk_bf16_f32 v168, v160, v161
    v_mfma_f32_16x16x32_bf16 v[220:223], a[232:235], v[44:47], v[220:223]
    buffer_load_dwordx4 v2, s[4:7], s21 offen offset:1024 sc1 lds
    v_cvt_pk_bf16_f32 v169, v162, v163
    v_mfma_f32_16x16x32_bf16 v[192:195], a[236:239], v[48:51], v[192:195]
    ds_read_b128 a[224:227], v3 offset:41216
    s_waitcnt lgkmcnt(3)
    v_mfma_f32_16x16x32_bf16 v[196:199], a[236:239], v[52:55], v[196:199]
    v_mul_f32 v164, v164, v7
    v_mul_f32 v165, v165, v7
    v_mfma_f32_16x16x32_bf16 v[200:203], a[240:243], v[48:51], v[200:203]
    ds_read_b128 a[228:231], v3 offset:43008
    v_mul_f32 v166, v166, v7
    v_mfma_f32_16x16x32_bf16 v[204:207], a[240:243], v[52:55], v[204:207]
    s_add_u32 m0, s99, 0
    s_add_u32 s21, s21, 8192
    v_mfma_f32_16x16x32_bf16 v[208:211], a[244:247], v[48:51], v[208:211]
    ds_read_b128 a[232:235], v3 offset:43264
    s_waitcnt lgkmcnt(3)
    v_mfma_f32_16x16x32_bf16 v[212:215], a[244:247], v[52:55], v[212:215]
    buffer_load_dwordx4 v2, s[4:7], s21 offen sc1 lds
    v_mul_f32 v167, v167, v7
    v_mfma_f32_16x16x32_bf16 v[216:219], a[248:251], v[48:51], v[216:219]
    ds_read_b128 a[236:239], v3 offset:45056
    v_mul_f32 v164, v164, v172
    v_mfma_f32_16x16x32_bf16 v[220:223], a[248:251], v[52:55], v[220:223]
    buffer_load_dwordx4 v2, s[4:7], s21 offen offset:1024 sc1 lds
    v_mul_f32 v165, v165, v173
    v_mfma_f32_16x16x32_bf16 v[192:195], a[252:255], v[56:59], v[192:195]
    ds_read_b128 a[240:243], v3 offset:45312
    s_waitcnt lgkmcnt(3)
    v_mfma_f32_16x16x32_bf16 v[196:199], a[252:255], v[60:63], v[196:199]
    v_mul_f32 v166, v166, v174
    v_mul_f32 v167, v167, v175
    v_mfma_f32_16x16x32_bf16 v[200:203], a[224:227], v[56:59], v[200:203]
    ds_read_b128 a[244:247], v3 offset:47104
    v_cvt_pk_bf16_f32 v170, v164, v165
    v_mfma_f32_16x16x32_bf16 v[204:207], a[224:227], v[60:63], v[204:207]
    s_add_u32 m0, s99, 8192
    s_add_u32 s21, s38, s15
    v_mfma_f32_16x16x32_bf16 v[208:211], a[228:231], v[56:59], v[208:211]
    ds_read_b128 a[248:251], v3 offset:47360
    s_waitcnt lgkmcnt(3)
    v_mfma_f32_16x16x32_bf16 v[212:215], a[228:231], v[60:63], v[212:215]
    buffer_load_dwordx4 v2, s[4:7], s21 offen sc1 lds
    v_cvt_pk_bf16_f32 v171, v166, v167
    v_mfma_f32_16x16x32_bf16 v[216:219], a[232:235], v[56:59], v[216:219]
    ds_read_b128 a[252:255], v3 offset:49152
    v_permlane16_swap_b32 v168, v170
    v_mfma_f32_16x16x32_bf16 v[220:223], a[232:235], v[60:63], v[220:223]
    buffer_load_dwordx4 v2, s[4:7], s21 offen offset:1024 sc1 lds
    v_permlane16_swap_b32 v169, v171
    v_mfma_f32_16x16x32_bf16 v[192:195], a[236:239], v[64:67], v[192:195]
    ds_read_b128 a[224:227], v3 offset:49408
    s_waitcnt lgkmcnt(3)
    v_mfma_f32_16x16x32_bf16 v[196:199], a[236:239], v[68:71], v[196:199]
    buffer_store_dwordx4 v[168:171], v1, s[4:7], s26 offen offset:1024
    v_mul_f32 v176, v176, v6
    v_mfma_f32_16x16x32_bf16 v[200:203], a[240:243], v[64:67], v[200:203]
    ds_read_b128 a[228:231], v3 offset:51200
    v_mul_f32 v177, v177, v6
    v_mfma_f32_16x16x32_bf16 v[204:207], a[240:243], v[68:71], v[204:207]
    s_add_u32 m0, s99, 16384
    s_add_u32 s21, s21, 8192
    v_mfma_f32_16x16x32_bf16 v[208:211], a[244:247], v[64:67], v[208:211]
    ds_read_b128 a[232:235], v3 offset:51456
    s_waitcnt lgkmcnt(3)
    v_mfma_f32_16x16x32_bf16 v[212:215], a[244:247], v[68:71], v[212:215]
    buffer_load_dwordx4 v2, s[4:7], s21 offen sc1 lds
    v_mul_f32 v178, v178, v6
    v_mfma_f32_16x16x32_bf16 v[216:219], a[248:251], v[64:67], v[216:219]
    ds_read_b128 a[236:239], v3 offset:53248
    v_mul_f32 v179, v179, v6
    v_mfma_f32_16x16x32_bf16 v[220:223], a[248:251], v[68:71], v[220:223]
    buffer_load_dwordx4 v2, s[4:7], s21 offen offset:1024 sc1 lds
    v_mul_f32 v176, v176, v184
    v_mfma_f32_16x16x32_bf16 v[192:195], a[252:255], v[72:75], v[192:195]
    ds_read_b128 a[240:243], v3 offset:53504
    s_waitcnt lgkmcnt(3)
    v_mfma_f32_16x16x32_bf16 v[196:199], a[252:255], v[76:79], v[196:199]
    v_mul_f32 v177, v177, v185
    v_mul_f32 v178, v178, v186
    v_mfma_f32_16x16x32_bf16 v[200:203], a[224:227], v[72:75], v[200:203]
    ds_read_b128 a[244:247], v3 offset:55296
    v_mul_f32 v179, v179, v187
    v_mfma_f32_16x16x32_bf16 v[204:207], a[224:227], v[76:79], v[204:207]
    v_cvt_pk_bf16_f32 v184, v176, v177
    v_cvt_pk_bf16_f32 v185, v178, v179
    v_mfma_f32_16x16x32_bf16 v[208:211], a[228:231], v[72:75], v[208:211]
    ds_read_b128 a[248:251], v3 offset:55552
    s_waitcnt lgkmcnt(3)
    v_mfma_f32_16x16x32_bf16 v[212:215], a[228:231], v[76:79], v[212:215]
    v_mul_f32 v180, v180, v7
    v_mul_f32 v181, v181, v7
    v_mfma_f32_16x16x32_bf16 v[216:219], a[232:235], v[72:75], v[216:219]
    ds_read_b128 a[252:255], v3 offset:57344
    v_mul_f32 v182, v182, v7
    v_mfma_f32_16x16x32_bf16 v[220:223], a[232:235], v[76:79], v[220:223]
    v_mul_f32 v183, v183, v7
    v_mul_f32 v180, v180, v188
    v_mfma_f32_16x16x32_bf16 v[192:195], a[236:239], v[80:83], v[192:195]
    ds_read_b128 a[224:227], v3 offset:57600
    s_waitcnt lgkmcnt(3)
    v_mfma_f32_16x16x32_bf16 v[196:199], a[236:239], v[84:87], v[196:199]
    v_mul_f32 v181, v181, v189
    v_mul_f32 v182, v182, v190
    v_mfma_f32_16x16x32_bf16 v[200:203], a[240:243], v[80:83], v[200:203]
    ds_read_b128 a[228:231], v3 offset:59392
    v_mul_f32 v183, v183, v191
    v_mfma_f32_16x16x32_bf16 v[204:207], a[240:243], v[84:87], v[204:207]
    v_cvt_pk_bf16_f32 v186, v180, v181
    v_cvt_pk_bf16_f32 v187, v182, v183
    v_mfma_f32_16x16x32_bf16 v[208:211], a[244:247], v[80:83], v[208:211]
    ds_read_b128 a[232:235], v3 offset:59648
    s_waitcnt lgkmcnt(3)
    v_mfma_f32_16x16x32_bf16 v[212:215], a[244:247], v[84:87], v[212:215]
    v_permlane16_swap_b32 v184, v186
    v_permlane16_swap_b32 v185, v187
    v_mfma_f32_16x16x32_bf16 v[216:219], a[248:251], v[80:83], v[216:219]
    ds_read_b128 a[236:239], v3 offset:61440
    v_mfma_f32_16x16x32_bf16 v[220:223], a[248:251], v[84:87], v[220:223]
    buffer_store_dwordx4 v[184:187], v1, s[4:7], s26 offen offset:2048
    v_lshlrev_b32 v12, 3, v0
    v_mfma_f32_16x16x32_bf16 v[192:195], a[252:255], v[88:91], v[192:195]
    ds_read_b128 a[240:243], v3 offset:61696
    s_waitcnt lgkmcnt(3)
    v_mfma_f32_16x16x32_bf16 v[196:199], a[252:255], v[92:95], v[196:199]
    v_and_b32 v12, 0x98, v12
    v_mfma_f32_16x16x32_bf16 v[200:203], a[224:227], v[88:91], v[200:203]
    ds_read_b128 a[244:247], v3 offset:63488
    v_mfma_f32_16x16x32_bf16 v[204:207], a[224:227], v[92:95], v[204:207]
    v_mfma_f32_16x16x32_bf16 v[208:211], a[228:231], v[88:91], v[208:211]
    ds_read_b128 a[248:251], v3 offset:63744
    s_waitcnt lgkmcnt(3)
    v_mfma_f32_16x16x32_bf16 v[212:215], a[228:231], v[92:95], v[212:215]
    v_mfma_f32_16x16x32_bf16 v[216:219], a[232:235], v[88:91], v[216:219]
    ds_read_b128 a[252:255], v4 offset:0
    v_mfma_f32_16x16x32_bf16 v[220:223], a[232:235], v[92:95], v[220:223]
    v_mfma_f32_16x16x32_bf16 v[192:195], a[236:239], v[96:99], v[192:195]
    ds_read_b128 a[224:227], v4 offset:256
    s_waitcnt lgkmcnt(3)
    v_mfma_f32_16x16x32_bf16 v[196:199], a[236:239], v[100:103], v[196:199]
    v_mfma_f32_16x16x32_bf16 v[200:203], a[240:243], v[96:99], v[200:203]
    ds_read_b128 a[228:231], v4 offset:2048
    v_mfma_f32_16x16x32_bf16 v[204:207], a[240:243], v[100:103], v[204:207]
    v_mfma_f32_16x16x32_bf16 v[208:211], a[244:247], v[96:99], v[208:211]
    ds_read_b128 a[232:235], v4 offset:2304
    s_waitcnt lgkmcnt(3)
    v_mfma_f32_16x16x32_bf16 v[212:215], a[244:247], v[100:103], v[212:215]
    v_mfma_f32_16x16x32_bf16 v[216:219], a[248:251], v[96:99], v[216:219]
    ds_read_b128 a[236:239], v4 offset:4096
    v_mfma_f32_16x16x32_bf16 v[220:223], a[248:251], v[100:103], v[220:223]
    v_mfma_f32_16x16x32_bf16 v[192:195], a[252:255], v[104:107], v[192:195]
    ds_read_b128 a[240:243], v4 offset:4352
    s_waitcnt lgkmcnt(3)
    v_mfma_f32_16x16x32_bf16 v[196:199], a[252:255], v[108:111], v[196:199]
    s_waitcnt vmcnt(20)
    s_barrier
    v_mfma_f32_16x16x32_bf16 v[200:203], a[224:227], v[104:107], v[200:203]
    ds_read_b128 a[244:247], v4 offset:6144
    v_mfma_f32_16x16x32_bf16 v[204:207], a[224:227], v[108:111], v[204:207]
    v_mfma_f32_16x16x32_bf16 v[208:211], a[228:231], v[104:107], v[208:211]
    ds_read_b128 a[248:251], v4 offset:6400
    s_waitcnt lgkmcnt(3)
    v_mfma_f32_16x16x32_bf16 v[212:215], a[228:231], v[108:111], v[212:215]
    v_mfma_f32_16x16x32_bf16 v[216:219], a[232:235], v[104:107], v[216:219]
    ds_read_b128 a[252:255], v4 offset:8192
    v_mfma_f32_16x16x32_bf16 v[220:223], a[232:235], v[108:111], v[220:223]
    v_mfma_f32_16x16x32_bf16 v[192:195], a[236:239], v[112:115], v[192:195]
    ds_read_b128 a[224:227], v4 offset:8448
    s_waitcnt lgkmcnt(3)
    v_mfma_f32_16x16x32_bf16 v[196:199], a[236:239], v[116:119], v[196:199]
    v_mfma_f32_16x16x32_bf16 v[200:203], a[240:243], v[112:115], v[200:203]
    ds_read_b128 a[228:231], v4 offset:10240
    v_mfma_f32_16x16x32_bf16 v[204:207], a[240:243], v[116:119], v[204:207]
    v_mfma_f32_16x16x32_bf16 v[208:211], a[244:247], v[112:115], v[208:211]
    ds_read_b128 a[232:235], v4 offset:10496
    s_waitcnt lgkmcnt(3)
    v_mfma_f32_16x16x32_bf16 v[212:215], a[244:247], v[116:119], v[212:215]
    v_mfma_f32_16x16x32_bf16 v[216:219], a[248:251], v[112:115], v[216:219]
    ds_read_b128 a[236:239], v4 offset:12288
    v_mfma_f32_16x16x32_bf16 v[220:223], a[248:251], v[116:119], v[220:223]
    v_mfma_f32_16x16x32_bf16 v[192:195], a[252:255], v[120:123], v[192:195]
    ds_read_b128 a[240:243], v4 offset:12544
    s_waitcnt lgkmcnt(3)
    v_mfma_f32_16x16x32_bf16 v[196:199], a[252:255], v[124:127], v[196:199]
    v_mfma_f32_16x16x32_bf16 v[200:203], a[224:227], v[120:123], v[200:203]
    ds_read_b128 a[244:247], v4 offset:14336
    v_mfma_f32_16x16x32_bf16 v[204:207], a[224:227], v[124:127], v[204:207]
    v_mfma_f32_16x16x32_bf16 v[208:211], a[228:231], v[120:123], v[208:211]
    ds_read_b128 a[248:251], v4 offset:14592
    s_waitcnt lgkmcnt(3)
    v_mfma_f32_16x16x32_bf16 v[212:215], a[228:231], v[124:127], v[212:215]
    v_mfma_f32_16x16x32_bf16 v[216:219], a[232:235], v[120:123], v[216:219]
    ds_read_b128 a[252:255], v4 offset:16384
    v_mfma_f32_16x16x32_bf16 v[220:223], a[232:235], v[124:127], v[220:223]
    v_mfma_f32_16x16x32_bf16 v[192:195], a[236:239], v[128:131], v[192:195]
    ds_read_b128 a[224:227], v4 offset:16640
    s_waitcnt lgkmcnt(3)
    v_mfma_f32_16x16x32_bf16 v[196:199], a[236:239], v[132:135], v[196:199]
    v_mfma_f32_16x16x32_bf16 v[200:203], a[240:243], v[128:131], v[200:203]
    ds_read_b128 a[228:231], v4 offset:18432
    v_mfma_f32_16x16x32_bf16 v[204:207], a[240:243], v[132:135], v[204:207]
    s_cmp_eq_u32 s34, 0
    s_cbranch_scc1 slow_29
    s_waitcnt vmcnt(0)
    buffer_store_dwordx2 v[14:15], off, s[4:7], s41
join_30:
    s_add_u32 s41, s41, 8192
    v_mfma_f32_16x16x32_bf16 v[208:211], a[244:247], v[128:131], v[208:211]
    ds_read_b128 a[232:235], v4 offset:18688
    s_waitcnt lgkmcnt(3)
    v_mfma_f32_16x16x32_bf16 v[212:215], a[244:247], v[132:135], v[212:215]
    v_mfma_f32_16x16x32_bf16 v[216:219], a[248:251], v[128:131], v[216:219]
    v_add_u32 v13, 69632, v13
    ds_read_b64 a[236:237], v13 offset:0
    ds_read_b64 a[238:239], v13 offset:256
    v_mfma_f32_16x16x32_bf16 v[220:223], a[248:251], v[132:135], v[220:223]
    v_mfma_f32_16x16x32_bf16 v[192:195], a[252:255], v[136:139], v[192:195]
    ds_read_b64 a[240:241], v13 offset:1024
    ds_read_b64 a[242:243], v13 offset:1280
    s_waitcnt lgkmcnt(5)
    v_mfma_f32_16x16x32_bf16 v[196:199], a[252:255], v[140:143], v[196:199]
    v_mfma_f32_16x16x32_bf16 v[200:203], a[224:227], v[136:139], v[200:203]
    ds_read_b128 a[244:247], v4 offset:22528
    v_mfma_f32_16x16x32_bf16 v[204:207], a[224:227], v[140:143], v[204:207]
    v_mfma_f32_16x16x32_bf16 v[208:211], a[228:231], v[136:139], v[208:211]
    ds_read_b128 a[248:251], v4 offset:22784
    s_waitcnt lgkmcnt(4)
    v_mfma_f32_16x16x32_bf16 v[212:215], a[228:231], v[140:143], v[212:215]
    v_mfma_f32_16x16x32_bf16 v[216:219], a[232:235], v[136:139], v[216:219]
    ds_read_b128 a[252:255], v4 offset:24576
    v_mfma_f32_16x16x32_bf16 v[220:223], a[232:235], v[140:143], v[220:223]
    v_mfma_f32_16x16x16_bf16 v[192:195], a[236:237], v[8:9], v[192:195]
    ds_read_b128 a[224:227], v4 offset:24832
    s_waitcnt lgkmcnt(3)
    v_mfma_f32_16x16x16_bf16 v[196:199], a[236:237], v[10:11], v[196:199]
    v_mfma_f32_16x16x16_bf16 v[200:203], a[238:239], v[8:9], v[200:203]
    v_mfma_f32_16x16x16_bf16 v[204:207], a[238:239], v[10:11], v[204:207]
    v_mfma_f32_16x16x16_bf16 v[208:211], a[240:241], v[8:9], v[208:211]
    ds_read_b128 a[228:231], v4 offset:26624
    v_mfma_f32_16x16x16_bf16 v[212:215], a[240:241], v[10:11], v[212:215]
    v_mfma_f32_16x16x16_bf16 v[216:219], a[242:243], v[8:9], v[216:219]
    v_mfma_f32_16x16x16_bf16 v[220:223], a[242:243], v[10:11], v[220:223]
    v_mfma_f32_16x16x32_bf16 v[224:227], a[244:247], v[16:19], 0
    ds_read_b128 a[232:235], v4 offset:26880
    s_waitcnt lgkmcnt(3)
    v_mfma_f32_16x16x32_bf16 v[228:231], a[244:247], v[20:23], 0
    v_mfma_f32_16x16x32_bf16 v[232:235], a[248:251], v[16:19], 0
    ds_read_b128 a[236:239], v4 offset:28672
    v_mfma_f32_16x16x32_bf16 v[236:239], a[248:251], v[20:23], 0
    v_mfma_f32_16x16x32_bf16 v[240:243], a[252:255], v[16:19], 0
    ds_read_b128 a[240:243], v4 offset:28928
    s_waitcnt lgkmcnt(3)
    v_mfma_f32_16x16x32_bf16 v[244:247], a[252:255], v[20:23], 0
    v_mul_f32 v192, v192, v6
    v_mul_f32 v193, v193, v6
    v_mfma_f32_16x16x32_bf16 v[248:251], a[224:227], v[16:19], 0
    ds_read_b128 a[244:247], v4 offset:30720
    v_mul_f32 v194, v194, v6
    v_mfma_f32_16x16x32_bf16 v[252:255], a[224:227], v[20:23], 0
    v_mul_f32 v195, v195, v6
    v_mul_f32 v192, v192, v200
    v_mfma_f32_16x16x32_bf16 v[224:227], a[228:231], v[24:27], v[224:227]
    ds_read_b128 a[248:251], v4 offset:30976
    s_waitcnt lgkmcnt(3)
    v_mfma_f32_16x16x32_bf16 v[228:231], a[228:231], v[28:31], v[228:231]
    v_mul_f32 v193, v193, v201
    v_mul_f32 v194, v194, v202
    v_mfma_f32_16x16x32_bf16 v[232:235], a[232:235], v[24:27], v[232:235]
    ds_read_b128 a[252:255], v4 offset:32768
    v_mul_f32 v195, v195, v203
    v_mfma_f32_16x16x32_bf16 v[236:239], a[232:235], v[28:31], v[236:239]
    v_cvt_pk_bf16_f32 v200, v192, v193
    v_cvt_pk_bf16_f32 v201, v194, v195
    v_mfma_f32_16x16x32_bf16 v[240:243], a[236:239], v[24:27], v[240:243]
    ds_read_b128 a[224:227], v4 offset:33024
    s_waitcnt lgkmcnt(3)
    v_mfma_f32_16x16x32_bf16 v[244:247], a[236:239], v[28:31], v[244:247]
    v_mul_f32 v196, v196, v7
    v_mul_f32 v197, v197, v7
    v_mfma_f32_16x16x32_bf16 v[248:251], a[240:243], v[24:27], v[248:251]
    ds_read_b128 a[228:231], v4 offset:34816
    v_mul_f32 v198, v198, v7
    v_mfma_f32_16x16x32_bf16 v[252:255], a[240:243], v[28:31], v[252:255]
    v_mul_f32 v199, v199, v7
    v_mul_f32 v196, v196, v204
    v_mfma_f32_16x16x32_bf16 v[224:227], a[244:247], v[32:35], v[224:227]
    ds_read_b128 a[232:235], v4 offset:35072
    s_waitcnt lgkmcnt(3)
    v_mfma_f32_16x16x32_bf16 v[228:231], a[244:247], v[36:39], v[228:231]
    v_mul_f32 v197, v197, v205
    v_mul_f32 v198, v198, v206
    v_mfma_f32_16x16x32_bf16 v[232:235], a[248:251], v[32:35], v[232:235]
    ds_read_b128 a[236:239], v4 offset:36864
    v_mul_f32 v199, v199, v207
    v_mfma_f32_16x16x32_bf16 v[236:239], a[248:251], v[36:39], v[236:239]
    buffer_load_dwordx2 v[14:15], v12, s[4:7], s25 offen sc1
    v_cvt_pk_bf16_f32 v202, v196, v197
    v_cvt_pk_bf16_f32 v203, v198, v199
    v_mfma_f32_16x16x32_bf16 v[240:243], a[252:255], v[32:35], v[240:243]
    ds_read_b128 a[240:243], v4 offset:37120
    s_waitcnt lgkmcnt(3)
    v_mfma_f32_16x16x32_bf16 v[244:247], a[252:255], v[36:39], v[244:247]
    v_permlane16_swap_b32 v200, v202
    v_permlane16_swap_b32 v201, v203
    s_barrier
    v_mfma_f32_16x16x32_bf16 v[248:251], a[224:227], v[32:35], v[248:251]
    ds_read_b128 a[244:247], v4 offset:38912
    v_mfma_f32_16x16x32_bf16 v[252:255], a[224:227], v[36:39], v[252:255]
    buffer_store_dwordx4 v[200:203], v1, s[4:7], s26 offen offset:3072
    v_mul_f32 v208, v208, v6
    v_mfma_f32_16x16x32_bf16 v[224:227], a[228:231], v[40:43], v[224:227]
    ds_read_b128 a[248:251], v4 offset:39168
    s_waitcnt lgkmcnt(3)
    v_mfma_f32_16x16x32_bf16 v[228:231], a[228:231], v[44:47], v[228:231]
    v_mul_f32 v209, v209, v6
    v_mul_f32 v210, v210, v6
    v_mfma_f32_16x16x32_bf16 v[232:235], a[232:235], v[40:43], v[232:235]
    ds_read_b128 a[252:255], v4 offset:40960
    v_mul_f32 v211, v211, v6
    v_mfma_f32_16x16x32_bf16 v[236:239], a[232:235], v[44:47], v[236:239]
    v_mul_f32 v208, v208, v216
    v_mul_f32 v209, v209, v217
    v_mfma_f32_16x16x32_bf16 v[240:243], a[236:239], v[40:43], v[240:243]
    ds_read_b128 a[224:227], v4 offset:41216
    s_waitcnt lgkmcnt(3)
    v_mfma_f32_16x16x32_bf16 v[244:247], a[236:239], v[44:47], v[244:247]
    v_mul_f32 v210, v210, v218
    v_mul_f32 v211, v211, v219
    v_mfma_f32_16x16x32_bf16 v[248:251], a[240:243], v[40:43], v[248:251]
    ds_read_b128 a[228:231], v4 offset:43008
    v_cvt_pk_bf16_f32 v216, v208, v209
    v_mfma_f32_16x16x32_bf16 v[252:255], a[240:243], v[44:47], v[252:255]
    v_cvt_pk_bf16_f32 v217, v210, v211
    v_mul_f32 v212, v212, v7
    v_mfma_f32_16x16x32_bf16 v[224:227], a[244:247], v[48:51], v[224:227]
    ds_read_b128 a[232:235], v4 offset:43264
    s_waitcnt lgkmcnt(3)
    v_mfma_f32_16x16x32_bf16 v[228:231], a[244:247], v[52:55], v[228:231]
    v_mul_f32 v213, v213, v7
    v_mul_f32 v214, v214, v7
    v_mfma_f32_16x16x32_bf16 v[232:235], a[248:251], v[48:51], v[232:235]
    ds_read_b128 a[236:239], v4 offset:45056
    v_mul_f32 v215, v215, v7
    v_mfma_f32_16x16x32_bf16 v[236:239], a[248:251], v[52:55], v[236:239]
    v_mul_f32 v212, v212, v220
    v_mul_f32 v213, v213, v221
    v_mfma_f32_16x16x32_bf16 v[240:243], a[252:255], v[48:51], v[240:243]
    ds_read_b128 a[240:243], v4 offset:45312
    s_waitcnt lgkmcnt(3)
    v_mfma_f32_16x16x32_bf16 v[244:247], a[252:255], v[52:55], v[244:247]
    v_mul_f32 v214, v214, v222
    v_mul_f32 v215, v215, v223
    v_mfma_f32_16x16x32_bf16 v[248:251], a[224:227], v[48:51], v[248:251]
    ds_read_b128 a[244:247], v4 offset:47104
    v_cvt_pk_bf16_f32 v218, v212, v213
    v_mfma_f32_16x16x32_bf16 v[252:255], a[224:227], v[52:55], v[252:255]
    v_cvt_pk_bf16_f32 v219, v214, v215
    v_permlane16_swap_b32 v216, v218
    v_mfma_f32_16x16x32_bf16 v[224:227], a[228:231], v[56:59], v[224:227]
    ds_read_b128 a[248:251], v4 offset:47360
    s_waitcnt lgkmcnt(3)
    v_mfma_f32_16x16x32_bf16 v[228:231], a[228:231], v[60:63], v[228:231]
    v_permlane16_swap_b32 v217, v219
    v_mfma_f32_16x16x32_bf16 v[232:235], a[232:235], v[56:59], v[232:235]
    ds_read_b128 a[252:255], v4 offset:49152
    v_mfma_f32_16x16x32_bf16 v[236:239], a[232:235], v[60:63], v[236:239]
    buffer_store_dwordx4 v[216:219], v1, s[4:7], s27 offen offset:0
    v_mfma_f32_16x16x32_bf16 v[240:243], a[236:239], v[56:59], v[240:243]
    ds_read_b128 a[224:227], v4 offset:49408
    s_waitcnt lgkmcnt(3)
    v_mfma_f32_16x16x32_bf16 v[244:247], a[236:239], v[60:63], v[244:247]
    v_mfma_f32_16x16x32_bf16 v[248:251], a[240:243], v[56:59], v[248:251]
    ds_read_b128 a[228:231], v4 offset:51200
    v_mfma_f32_16x16x32_bf16 v[252:255], a[240:243], v[60:63], v[252:255]
    s_waitcnt vmcnt(2)
    v_cmp_ne_u64 vcc, s[32:33], v[14:15]
    s_nop 0
    s_cbranch_vccnz ap_31
apok_32:
    s_add_u32 s25, s25, 8192
    v_mov_b32 v14, s32
    v_mfma_f32_16x16x32_bf16 v[224:227], a[244:247], v[64:67], v[224:227]
    ds_read_b128 a[232:235], v4 offset:51456
    s_waitcnt lgkmcnt(3)
    v_mfma_f32_16x16x32_bf16 v[228:231], a[244:247], v[68:71], v[228:231]
    v_mov_b32 v15, s33
    v_mfma_f32_16x16x32_bf16 v[232:235], a[248:251], v[64:67], v[232:235]
    ds_read_b128 a[236:239], v4 offset:53248
    v_mfma_f32_16x16x32_bf16 v[236:239], a[248:251], v[68:71], v[236:239]
    buffer_load_dwordx4 v[144:147], v1, s[4:7], s24 offen offset:0 sc1
    v_mfma_f32_16x16x32_bf16 v[240:243], a[252:255], v[64:67], v[240:243]
    ds_read_b128 a[240:243], v4 offset:53504
    s_waitcnt lgkmcnt(3)
    v_mfma_f32_16x16x32_bf16 v[244:247], a[252:255], v[68:71], v[244:247]
    v_mfma_f32_16x16x32_bf16 v[248:251], a[224:227], v[64:67], v[248:251]
    ds_read_b128 a[244:247], v4 offset:55296
    v_mfma_f32_16x16x32_bf16 v[252:255], a[224:227], v[68:71], v[252:255]
    buffer_load_dwordx4 v[148:151], v1, s[4:7], s39 offen offset:0 sc1
    v_mfma_f32_16x16x32_bf16 v[224:227], a[228:231], v[72:75], v[224:227]
    ds_read_b128 a[248:251], v4 offset:55552
    s_waitcnt lgkmcnt(3)
    v_mfma_f32_16x16x32_bf16 v[228:231], a[228:231], v[76:79], v[228:231]
    v_mfma_f32_16x16x32_bf16 v[232:235], a[232:235], v[72:75], v[232:235]
    ds_read_b128 a[252:255], v4 offset:57344
    v_mfma_f32_16x16x32_bf16 v[236:239], a[232:235], v[76:79], v[236:239]
    buffer_load_dwordx4 v[152:155], v1, s[4:7], s24 offen offset:1024 sc1
    v_mfma_f32_16x16x32_bf16 v[240:243], a[236:239], v[72:75], v[240:243]
    ds_read_b128 a[224:227], v4 offset:57600
    s_waitcnt lgkmcnt(3)
    v_mfma_f32_16x16x32_bf16 v[244:247], a[236:239], v[76:79], v[244:247]
    v_mfma_f32_16x16x32_bf16 v[248:251], a[240:243], v[72:75], v[248:251]
    ds_read_b128 a[228:231], v4 offset:59392
    v_mfma_f32_16x16x32_bf16 v[252:255], a[240:243], v[76:79], v[252:255]
    buffer_load_dwordx4 v[156:159], v1, s[4:7], s39 offen offset:1024 sc1
    v_mfma_f32_16x16x32_bf16 v[224:227], a[244:247], v[80:83], v[224:227]
    ds_read_b128 a[232:235], v4 offset:59648
    s_waitcnt lgkmcnt(3)
    v_mfma_f32_16x16x32_bf16 v[228:231], a[244:247], v[84:87], v[228:231]
    v_mfma_f32_16x16x32_bf16 v[232:235], a[248:251], v[80:83], v[232:235]
    ds_read_b128 a[236:239], v4 offset:61440
    v_mfma_f32_16x16x32_bf16 v[236:239], a[248:251], v[84:87], v[236:239]
    buffer_load_dwordx4 v[160:163], v1, s[4:7], s24 offen offset:2048 sc1
    v_mfma_f32_16x16x32_bf16 v[240:243], a[252:255], v[80:83], v[240:243]
    ds_read_b128 a[240:243], v4 offset:61696
    s_waitcnt lgkmcnt(3)
    v_mfma_f32_16x16x32_bf16 v[244:247], a[252:255], v[84:87], v[244:247]
    s_barrier
    v_mfma_f32_16x16x32_bf16 v[248:251], a[224:227], v[80:83], v[248:251]
    ds_read_b128 a[244:247], v4 offset:63488
    v_mfma_f32_16x16x32_bf16 v[252:255], a[224:227], v[84:87], v[252:255]
    buffer_load_dwordx4 v[164:167], v1, s[4:7], s39 offen offset:2048 sc1
    v_mfma_f32_16x16x32_bf16 v[224:227], a[228:231], v[88:91], v[224:227]
    ds_read_b128 a[248:251], v4 offset:63744
    s_waitcnt lgkmcnt(3)
    v_mfma_f32_16x16x32_bf16 v[228:231], a[228:231], v[92:95], v[228:231]
    v_mfma_f32_16x16x32_bf16 v[232:235], a[232:235], v[88:91], v[232:235]
    ds_read_b128 a[252:255], v5 offset:0
    v_mfma_f32_16x16x32_bf16 v[236:239], a[232:235], v[92:95], v[236:239]
    s_add_u32 s24, s24, 7168
    buffer_load_dwordx4 v[168:171], v1, s[4:7], s24 offen offset:0 sc1
    v_mfma_f32_16x16x32_bf16 v[240:243], a[236:239], v[88:91], v[240:243]
    ds_read_b128 a[224:227], v5 offset:256
    s_waitcnt lgkmcnt(3)
    v_mfma_f32_16x16x32_bf16 v[244:247], a[236:239], v[92:95], v[244:247]
    v_mfma_f32_16x16x32_bf16 v[248:251], a[240:243], v[88:91], v[248:251]
    ds_read_b128 a[228:231], v5 offset:2048
    v_mfma_f32_16x16x32_bf16 v[252:255], a[240:243], v[92:95], v[252:255]
    s_add_u32 s39, s39, 7168
    buffer_load_dwordx4 v[172:175], v1, s[4:7], s39 offen offset:0 sc1
    v_mfma_f32_16x16x32_bf16 v[224:227], a[244:247], v[96:99], v[224:227]
    ds_read_b128 a[232:235], v5 offset:2304
    s_waitcnt lgkmcnt(3)
    v_mfma_f32_16x16x32_bf16 v[228:231], a[244:247], v[100:103], v[228:231]
    v_mfma_f32_16x16x32_bf16 v[232:235], a[248:251], v[96:99], v[232:235]
    ds_read_b128 a[236:239], v5 offset:4096
    v_mfma_f32_16x16x32_bf16 v[236:239], a[248:251], v[100:103], v[236:239]
    s_cmp_eq_u32 s34, 0
    s_cbranch_scc1 slow_33
    s_waitcnt vmcnt(8)
    buffer_store_dwordx2 v[14:15], off, s[4:7], s41
join_34:
    buffer_load_dwordx4 v[176:179], v1, s[4:7], s24 offen offset:1024 sc1
    s_add_u32 s41, s41, 8192
    v_mfma_f32_16x16x32_bf16 v[240:243], a[252:255], v[96:99], v[240:243]
    ds_read_b128 a[240:243], v5 offset:4352
    s_waitcnt lgkmcnt(3)
    v_mfma_f32_16x16x32_bf16 v[244:247], a[252:255], v[100:103], v[244:247]
    v_mfma_f32_16x16x32_bf16 v[248:251], a[224:227], v[96:99], v[248:251]
    ds_read_b128 a[244:247], v5 offset:6144
    v_mfma_f32_16x16x32_bf16 v[252:255], a[224:227], v[100:103], v[252:255]
    buffer_load_dwordx4 v[180:183], v1, s[4:7], s39 offen offset:1024 sc1
    v_mfma_f32_16x16x32_bf16 v[224:227], a[228:231], v[104:107], v[224:227]
    ds_read_b128 a[248:251], v5 offset:6400
    s_waitcnt lgkmcnt(3)
    v_mfma_f32_16x16x32_bf16 v[228:231], a[228:231], v[108:111], v[228:231]
    v_mfma_f32_16x16x32_bf16 v[232:235], a[232:235], v[104:107], v[232:235]
    ds_read_b128 a[252:255], v5 offset:8192
    v_mfma_f32_16x16x32_bf16 v[236:239], a[232:235], v[108:111], v[236:239]
    buffer_load_dwordx4 v[184:187], v1, s[4:7], s24 offen offset:2048 sc1
    v_mfma_f32_16x16x32_bf16 v[240:243], a[236:239], v[104:107], v[240:243]
    ds_read_b128 a[224:227], v5 offset:8448
    s_waitcnt lgkmcnt(3)
    v_mfma_f32_16x16x32_bf16 v[244:247], a[236:239], v[108:111], v[244:247]
    v_mfma_f32_16x16x32_bf16 v[248:251], a[240:243], v[104:107], v[248:251]
    ds_read_b128 a[228:231], v5 offset:10240
    v_mfma_f32_16x16x32_bf16 v[252:255], a[240:243], v[108:111], v[252:255]
    buffer_load_dwordx4 v[188:191], v1, s[4:7], s39 offen offset:2048 sc1
    v_mfma_f32_16x16x32_bf16 v[224:227], a[244:247], v[112:115], v[224:227]
    ds_read_b128 a[232:235], v5 offset:10496
    s_waitcnt lgkmcnt(3)
    v_mfma_f32_16x16x32_bf16 v[228:231], a[244:247], v[116:119], v[228:231]
    v_mfma_f32_16x16x32_bf16 v[232:235], a[248:251], v[112:115], v[232:235]
    ds_read_b128 a[236:239], v5 offset:12288
    v_mfma_f32_16x16x32_bf16 v[236:239], a[248:251], v[116:119], v[236:239]
    s_add_u32 s24, s24, 7168
    buffer_load_dwordx4 v[192:195], v1, s[4:7], s24 offen offset:0 sc1
    v_mfma_f32_16x16x32_bf16 v[240:243], a[252:255], v[112:115], v[240:243]
    ds_read_b128 a[240:243], v5 offset:12544
    s_waitcnt lgkmcnt(3)
    v_mfma_f32_16x16x32_bf16 v[244:247], a[252:255], v[116:119], v[244:247]
    v_mfma_f32_16x16x32_bf16 v[248:251], a[224:227], v[112:115], v[248:251]
    ds_read_b128 a[244:247], v5 offset:14336
    v_mfma_f32_16x16x32_bf16 v[252:255], a[224:227], v[116:119], v[252:255]
    s_add_u32 s39, s39, 7168
    buffer_load_dwordx4 v[196:199], v1, s[4:7], s39 offen offset:0 sc1
    v_mfma_f32_16x16x32_bf16 v[224:227], a[228:231], v[120:123], v[224:227]
    ds_read_b128 a[248:251], v5 offset:14592
    s_waitcnt lgkmcnt(3)
    v_mfma_f32_16x16x32_bf16 v[228:231], a[228:231], v[124:127], v[228:231]
    v_mfma_f32_16x16x32_bf16 v[232:235], a[232:235], v[120:123], v[232:235]
    ds_read_b128 a[252:255], v3 offset:0
    v_mfma_f32_16x16x32_bf16 v[236:239], a[232:235], v[124:127], v[236:239]
    buffer_load_dwordx4 v[200:203], v1, s[4:7], s24 offen offset:1024 sc1
    v_mfma_f32_16x16x32_bf16 v[240:243], a[236:239], v[120:123], v[240:243]
    ds_read_b128 a[224:227], v3 offset:256
    s_waitcnt lgkmcnt(3)
    v_mfma_f32_16x16x32_bf16 v[244:247], a[236:239], v[124:127], v[244:247]
    v_mfma_f32_16x16x32_bf16 v[248:251], a[240:243], v[120:123], v[248:251]
    ds_read_b128 a[228:231], v3 offset:2048
    v_mfma_f32_16x16x32_bf16 v[252:255], a[240:243], v[124:127], v[252:255]
    buffer_load_dwordx4 v[204:207], v1, s[4:7], s39 offen offset:1024 sc1
    v_mfma_f32_16x16x32_bf16 v[224:227], a[244:247], v[128:131], v[224:227]
    ds_read_b128 a[232:235], v3 offset:2304
    s_waitcnt lgkmcnt(3)
    v_mfma_f32_16x16x32_bf16 v[228:231], a[244:247], v[132:135], v[228:231]
    v_mfma_f32_16x16x32_bf16 v[232:235], a[248:251], v[128:131], v[232:235]
    ds_read_b128 a[236:239], v3 offset:4096
    v_mfma_f32_16x16x32_bf16 v[236:239], a[248:251], v[132:135], v[236:239]
    buffer_load_dwordx4 v[208:211], v1, s[4:7], s24 offen offset:2048 sc1
    v_mfma_f32_16x16x32_bf16 v[240:243], a[252:255], v[128:131], v[240:243]
    ds_read_b128 a[240:243], v3 offset:4352
    s_waitcnt lgkmcnt(3)
    v_mfma_f32_16x16x32_bf16 v[244:247], a[252:255], v[132:135], v[244:247]
    v_mfma_f32_16x16x32_bf16 v[248:251], a[224:227], v[128:131], v[248:251]
    v_add_u32 v13, -79872, v13
    ds_read_b64 a[244:245], v13 offset:0
    ds_read_b64 a[246:247], v13 offset:256
    v_mfma_f32_16x16x32_bf16 v[252:255], a[224:227], v[132:135], v[252:255]
    buffer_load_dwordx4 v[212:215], v1, s[4:7], s39 offen offset:2048 sc1
    v_mfma_f32_16x16x32_bf16 v[224:227], a[228:231], v[136:139], v[224:227]
    ds_read_b64 a[248:249], v13 offset:1024
    ds_read_b64 a[250:251], v13 offset:1280
    s_waitcnt lgkmcnt(5)
    v_mfma_f32_16x16x32_bf16 v[228:231], a[228:231], v[140:143], v[228:231]
    v_mfma_f32_16x16x32_bf16 v[232:235], a[232:235], v[136:139], v[232:235]
    v_mfma_f32_16x16x32_bf16 v[236:239], a[232:235], v[140:143], v[236:239]
    buffer_load_dwordx2 v[14:15], v12, s[4:7], s25 offen sc1
    s_add_u32 s24, s24, 7168
    buffer_load_dwordx4 v[216:219], v1, s[4:7], s24 offen offset:0 sc1
    v_mfma_f32_16x16x32_bf16 v[240:243], a[236:239], v[136:139], v[240:243]
    s_waitcnt lgkmcnt(2)
    v_mfma_f32_16x16x32_bf16 v[244:247], a[236:239], v[140:143], v[244:247]
    v_mfma_f32_16x16x32_bf16 v[248:251], a[240:243], v[136:139], v[248:251]
    v_mfma_f32_16x16x32_bf16 v[252:255], a[240:243], v[140:143], v[252:255]
    s_add_u32 s39, s39, 7168
    buffer_load_dwordx4 v[220:223], v1, s[4:7], s39 offen offset:0 sc1
    v_mfma_f32_16x16x16_bf16 v[224:227], a[244:245], v[8:9], v[224:227]
    s_waitcnt lgkmcnt(0)
    v_mfma_f32_16x16x16_bf16 v[228:231], a[244:245], v[10:11], v[228:231]
    v_mfma_f32_16x16x16_bf16 v[232:235], a[246:247], v[8:9], v[232:235]
    v_mfma_f32_16x16x16_bf16 v[236:239], a[246:247], v[10:11], v[236:239]
    v_mfma_f32_16x16x16_bf16 v[240:243], a[248:249], v[8:9], v[240:243]
    v_mfma_f32_16x16x16_bf16 v[244:247], a[248:249], v[10:11], v[244:247]
    v_mfma_f32_16x16x16_bf16 v[248:251], a[250:251], v[8:9], v[248:251]
    v_mfma_f32_16x16x16_bf16 v[252:255], a[250:251], v[10:11], v[252:255]
    s_add_u32 s21, s21, 4096
    s_sub_u32 s21, s21, s15
    v_mul_f32 v224, v224, v6
    v_mul_f32 v225, v225, v6
    v_mul_f32 v226, v226, v6
    v_mul_f32 v227, v227, v6
    v_mul_f32 v224, v224, v232
    buffer_load_dwordx4 v[80:83], v1, s[4:7], s24 offen offset:1024 sc1
    v_mul_f32 v225, v225, v233
    v_mul_f32 v226, v226, v234
    v_mul_f32 v227, v227, v235
    v_cvt_pk_bf16_f32 v232, v224, v225
    v_cvt_pk_bf16_f32 v233, v226, v227
    v_mul_f32 v228, v228, v7
    v_mul_f32 v229, v229, v7
    v_mul_f32 v230, v230, v7
    v_mul_f32 v231, v231, v7
    v_mul_f32 v228, v228, v236
    buffer_load_dwordx4 v[84:87], v1, s[4:7], s39 offen offset:1024 sc1
    v_mul_f32 v229, v229, v237
    v_mul_f32 v230, v230, v238
    v_mul_f32 v231, v231, v239
    v_cvt_pk_bf16_f32 v234, v228, v229
    v_cvt_pk_bf16_f32 v235, v230, v231
    s_nop 0
    v_permlane16_swap_b32 v232, v234
    v_permlane16_swap_b32 v233, v235
    buffer_store_dwordx4 v[232:235], v1, s[4:7], s27 offen offset:1024
    v_mul_f32 v240, v240, v6
    v_mul_f32 v241, v241, v6
    v_mul_f32 v242, v242, v6
    v_mul_f32 v243, v243, v6
    v_mul_f32 v240, v240, v248
    buffer_load_dwordx4 v[88:91], v1, s[4:7], s24 offen offset:2048 sc1
    v_mul_f32 v241, v241, v249
    v_mul_f32 v242, v242, v250
    v_mul_f32 v243, v243, v251
    v_cvt_pk_bf16_f32 v248, v240, v241
    v_cvt_pk_bf16_f32 v249, v242, v243
    v_mul_f32 v244, v244, v7
    v_mul_f32 v245, v245, v7
    v_mul_f32 v246, v246, v7
    v_mul_f32 v247, v247, v7
    v_mul_f32 v244, v244, v252
    buffer_load_dwordx4 v[92:95], v1, s[4:7], s39 offen offset:2048 sc1
    v_mul_f32 v245, v245, v253
    v_mul_f32 v246, v246, v254
    v_mul_f32 v247, v247, v255
    v_cvt_pk_bf16_f32 v250, v244, v245
    v_cvt_pk_bf16_f32 v251, v246, v247
    s_nop 0
    v_permlane16_swap_b32 v248, v250
    v_permlane16_swap_b32 v249, v251
    buffer_store_dwordx4 v[248:251], v1, s[4:7], s27 offen offset:2048
    s_waitcnt vmcnt(26)
    v_mfma_f32_32x32x16_bf16 v[64:79], a[4:7], v[148:151], 0
    v_mfma_f32_32x32x16_bf16 v[48:63], a[4:7], v[144:147], 0
    v_mfma_f32_32x32x16_bf16 v[32:47], a[0:3], v[148:151], 0
    v_mfma_f32_32x32x16_bf16 v[16:31], a[0:3], v[144:147], 0
    s_waitcnt vmcnt(8)
    v_cmp_ne_u64 vcc, s[32:33], v[14:15]
    s_nop 0
    s_cbranch_vccnz ap_35
apok_36:
    s_add_u32 s25, s25, 8192
    v_mfma_f32_32x32x16_bf16 v[64:79], a[12:15], v[156:159], v[64:79]
    s_sub_u32 s24, s24, 18432
    buffer_load_dwordx4 v[96:99], v1, s[4:7], s24 offen offset:0 sc1
    v_mfma_f32_32x32x16_bf16 v[48:63], a[12:15], v[152:155], v[48:63]
    v_mfma_f32_32x32x16_bf16 v[32:47], a[8:11], v[156:159], v[32:47]
    s_sub_u32 s39, s39, 18432
    buffer_load_dwordx4 v[100:103], v1, s[4:7], s39 offen offset:0 sc1
    v_mfma_f32_32x32x16_bf16 v[16:31], a[8:11], v[152:155], v[16:31]
    v_mfma_f32_32x32x16_bf16 v[64:79], a[20:23], v[164:167], v[64:79]
    buffer_load_dwordx4 v[104:107], v1, s[4:7], s24 offen offset:1024 sc1
    v_mfma_f32_32x32x16_bf16 v[48:63], a[20:23], v[160:163], v[48:63]
    v_mfma_f32_32x32x16_bf16 v[32:47], a[16:19], v[164:167], v[32:47]
    buffer_load_dwordx4 v[108:111], v1, s[4:7], s39 offen offset:1024 sc1
    v_mfma_f32_32x32x16_bf16 v[16:31], a[16:19], v[160:163], v[16:31]
    v_mfma_f32_32x32x16_bf16 v[64:79], a[60:63], v[172:175], v[64:79]
    s_add_u32 s24, s24, 7168
    buffer_load_dwordx4 v[112:115], v1, s[4:7], s24 offen offset:0 sc1
    v_mfma_f32_32x32x16_bf16 v[48:63], a[60:63], v[168:171], v[48:63]
    v_mfma_f32_32x32x16_bf16 v[32:47], a[56:59], v[172:175], v[32:47]
    s_add_u32 s39, s39, 7168
    buffer_load_dwordx4 v[116:119], v1, s[4:7], s39 offen offset:0 sc1
    v_mfma_f32_32x32x16_bf16 v[16:31], a[56:59], v[168:171], v[16:31]
    v_mov_b32 v14, s32
    v_mov_b32 v15, s33
    s_cmp_eq_u32 s34, 0
    s_cbranch_scc1 slow_37
    s_waitcnt vmcnt(6)
    buffer_store_dwordx2 v[14:15], off, s[4:7], s41
join_38:
    v_mfma_f32_32x32x16_bf16 v[64:79], a[68:71], v[180:183], v[64:79]
    buffer_load_dwordx4 v[120:123], v1, s[4:7], s24 offen offset:1024 sc1
    v_mfma_f32_32x32x16_bf16 v[48:63], a[68:71], v[176:179], v[48:63]
    v_mfma_f32_32x32x16_bf16 v[32:47], a[64:67], v[180:183], v[32:47]
    buffer_load_dwordx4 v[124:127], v1, s[4:7], s39 offen offset:1024 sc1
    v_mfma_f32_32x32x16_bf16 v[16:31], a[64:67], v[176:179], v[16:31]
    v_mfma_f32_32x32x16_bf16 v[64:79], a[76:79], v[188:191], v[64:79]
    s_add_u32 s24, s24, 7168
    buffer_load_dwordx4 v[128:131], v1, s[4:7], s24 offen offset:0 sc1
    v_mfma_f32_32x32x16_bf16 v[48:63], a[76:79], v[184:187], v[48:63]
    v_mfma_f32_32x32x16_bf16 v[32:47], a[72:75], v[188:191], v[32:47]
    s_add_u32 s39, s39, 7168
    buffer_load_dwordx4 v[132:135], v1, s[4:7], s39 offen offset:0 sc1
    v_mfma_f32_32x32x16_bf16 v[16:31], a[72:75], v[184:187], v[16:31]
    v_mfma_f32_32x32x16_bf16 v[64:79], a[116:119], v[196:199], v[64:79]
    buffer_load_dwordx4 v[136:139], v1, s[4:7], s24 offen offset:1024 sc1
    v_mfma_f32_32x32x16_bf16 v[48:63], a[116:119], v[192:195], v[48:63]
    v_mfma_f32_32x32x16_bf16 v[32:47], a[112:115], v[196:199], v[32:47]
    buffer_load_dwordx4 v[140:143], v1, s[4:7], s39 offen offset:1024 sc1
    v_mfma_f32_32x32x16_bf16 v[16:31], a[112:115], v[192:195], v[16:31]
    buffer_load_dwordx2 v[14:15], v12, s[4:7], s25 offen sc1
    s_add_u32 s17, s100, 8388608
    buffer_load_dwordx4 v[240:243], v1, s[4:7], s17 offen sc1
    buffer_load_dwordx4 v[244:247], v1, s[4:7], s17 offen offset:1024 sc1
    v_mfma_f32_32x32x16_bf16 v[64:79], a[124:127], v[204:207], v[64:79]
    s_add_u32 s24, s24, 7168
    buffer_load_dwordx4 v[144:147], v1, s[4:7], s24 offen offset:0 sc1
    v_mfma_f32_32x32x16_bf16 v[48:63], a[124:127], v[200:203], v[48:63]
    v_mfma_f32_32x32x16_bf16 v[32:47], a[120:123], v[204:207], v[32:47]
    s_add_u32 s39, s39, 7168
    buffer_load_dwordx4 v[148:151], v1, s[4:7], s39 offen offset:0 sc1
    v_mfma_f32_32x32x16_bf16 v[16:31], a[120:123], v[200:203], v[16:31]
    v_mfma_f32_32x32x16_bf16 v[64:79], a[132:135], v[212:215], v[64:79]
    buffer_load_dwordx4 v[152:155], v1, s[4:7], s24 offen offset:1024 sc1
    v_mfma_f32_32x32x16_bf16 v[48:63], a[132:135], v[208:211], v[48:63]
    v_mfma_f32_32x32x16_bf16 v[32:47], a[128:131], v[212:215], v[32:47]
    buffer_load_dwordx4 v[156:159], v1, s[4:7], s39 offen offset:1024 sc1
    v_mfma_f32_32x32x16_bf16 v[16:31], a[128:131], v[208:211], v[16:31]
    v_mfma_f32_32x32x16_bf16 v[64:79], a[172:175], v[220:223], v[64:79]
    v_mfma_f32_32x32x16_bf16 v[48:63], a[172:175], v[216:219], v[48:63]
    v_mfma_f32_32x32x16_bf16 v[32:47], a[168:171], v[220:223], v[32:47]
    v_mfma_f32_32x32x16_bf16 v[16:31], a[168:171], v[216:219], v[16:31]
    v_mfma_f32_32x32x16_bf16 v[64:79], a[180:183], v[84:87], v[64:79]
    v_mfma_f32_32x32x16_bf16 v[48:63], a[180:183], v[80:83], v[48:63]
    v_mfma_f32_32x32x16_bf16 v[32:47], a[176:179], v[84:87], v[32:47]
    v_mfma_f32_32x32x16_bf16 v[16:31], a[176:179], v[80:83], v[16:31]
    v_mfma_f32_32x32x16_bf16 v[64:79], a[188:191], v[92:95], v[64:79]
    v_mfma_f32_32x32x16_bf16 v[48:63], a[188:191], v[88:91], v[48:63]
    v_mfma_f32_32x32x16_bf16 v[32:47], a[184:187], v[92:95], v[32:47]
    v_mfma_f32_32x32x16_bf16 v[16:31], a[184:187], v[88:91], v[16:31]
    s_waitcnt vmcnt(6)
    v_cmp_ne_u64 vcc, s[32:33], v[14:15]
    s_nop 0
    s_cbranch_vccnz ap_39
apok_40:
    s_sub_u32 s24, s24, 19456
    buffer_load_dwordx4 v[160:163], v1, s[4:7], s24 offen offset:0 sc1
    s_sub_u32 s39, s39, 19456
    buffer_load_dwordx4 v[164:167], v1, s[4:7], s39 offen offset:0 sc1
    buffer_load_dwordx4 v[168:171], v1, s[4:7], s24 offen offset:1024 sc1
    v_mfma_f32_32x32x16_bf16 v[64:79], a[28:31], v[100:103], v[64:79]
    buffer_load_dwordx4 v[172:175], v1, s[4:7], s39 offen offset:1024 sc1
    v_mfma_f32_32x32x16_bf16 v[48:63], a[28:31], v[96:99], v[48:63]
    v_mfma_f32_32x32x16_bf16 v[32:47], a[24:27], v[100:103], v[32:47]
    s_add_u32 s24, s24, 7168
    buffer_load_dwordx4 v[176:179], v1, s[4:7], s24 offen offset:0 sc1
    v_mfma_f32_32x32x16_bf16 v[16:31], a[24:27], v[96:99], v[16:31]
    v_mfma_f32_32x32x16_bf16 v[64:79], a[36:39], v[108:111], v[64:79]
    s_add_u32 s39, s39, 7168
    buffer_load_dwordx4 v[180:183], v1, s[4:7], s39 offen offset:0 sc1
    v_mfma_f32_32x32x16_bf16 v[48:63], a[36:39], v[104:107], v[48:63]
    v_mfma_f32_32x32x16_bf16 v[32:47], a[32:35], v[108:111], v[32:47]
    buffer_load_dwordx4 v[184:187], v1, s[4:7], s24 offen offset:1024 sc1
    v_mfma_f32_32x32x16_bf16 v[16:31], a[32:35], v[104:107], v[16:31]
    s_barrier
    v_mfma_f32_32x32x16_bf16 v[64:79], a[84:87], v[116:119], v[64:79]
    buffer_load_dwordx4 v[188:191], v1, s[4:7], s39 offen offset:1024 sc1
    v_mfma_f32_32x32x16_bf16 v[48:63], a[84:87], v[112:115], v[48:63]
    s_waitcnt vmcnt(12)
    s_xor_b32 s16, s12, 1
    s_mul_i32 s16, s16, 12288
    s_add_u32 s16, s16, 110592
    v_add_u32 v6, s16, v1
    v_mfma_f32_32x32x16_bf16 v[32:47], a[80:83], v[116:119], v[32:47]
    s_add_u32 s24, s24, 7168
    buffer_load_dwordx4 v[192:195], v1, s[4:7], s24 offen offset:0 sc1
    v_mfma_f32_32x32x16_bf16 v[16:31], a[80:83], v[112:115], v[16:31]
    s_xor_b32 s16, s12, 2
    s_mul_i32 s16, s16, 12288
    s_add_u32 s16, s16, 114688
    v_add_u32 v7, s16, v1
    v_mfma_f32_32x32x16_bf16 v[64:79], a[92:95], v[124:127], v[64:79]
    s_add_u32 s39, s39, 7168
    buffer_load_dwordx4 v[196:199], v1, s[4:7], s39 offen offset:0 sc1
    v_mfma_f32_32x32x16_bf16 v[48:63], a[92:95], v[120:123], v[48:63]
    s_xor_b32 s16, s12, 3
    s_mul_i32 s16, s16, 12288
    s_add_u32 s16, s16, 118784
    v_add_u32 v8, s16, v1
    v_mfma_f32_32x32x16_bf16 v[32:47], a[88:91], v[124:127], v[32:47]
    buffer_load_dwordx4 v[200:203], v1, s[4:7], s24 offen offset:1024 sc1
    v_mfma_f32_32x32x16_bf16 v[16:31], a[88:91], v[120:123], v[16:31]
    s_mul_i32 s16, s12, 12288
    s_add_u32 s16, s16, 110592
    v_add_u32 v9, s16, v1
    v_lshlrev_b32 v224, 16, v240
    v_mfma_f32_32x32x16_bf16 v[64:79], a[140:143], v[132:135], v[64:79]
    buffer_load_dwordx4 v[204:207], v1, s[4:7], s39 offen offset:1024 sc1
    v_mfma_f32_32x32x16_bf16 v[48:63], a[140:143], v[128:131], v[48:63]
    v_and_b32 v225, 0xffff0000, v240
    v_lshlrev_b32 v226, 16, v241
    v_and_b32 v227, 0xffff0000, v241
    v_lshlrev_b32 v228, 16, v242
    v_mfma_f32_32x32x16_bf16 v[32:47], a[136:139], v[132:135], v[32:47]
    s_add_u32 s24, s24, 7168
    buffer_load_dwordx4 v[208:211], v1, s[4:7], s24 offen offset:0 sc1
    v_mfma_f32_32x32x16_bf16 v[64:79], a[148:151], v[140:143], v[64:79]
    v_and_b32 v229, 0xffff0000, v242
    v_lshlrev_b32 v230, 16, v243
    v_and_b32 v231, 0xffff0000, v243
    v_lshlrev_b32 v232, 16, v244
    v_mfma_f32_32x32x16_bf16 v[48:63], a[148:151], v[136:139], v[48:63]
    s_add_u32 s39, s39, 7168
    buffer_load_dwordx4 v[212:215], v1, s[4:7], s39 offen offset:0 sc1
    v_mfma_f32_32x32x16_bf16 v[32:47], a[144:147], v[140:143], v[32:47]
    v_and_b32 v233, 0xffff0000, v244
    v_lshlrev_b32 v234, 16, v245
    v_and_b32 v235, 0xffff0000, v245
    v_lshlrev_b32 v236, 16, v246
    s_waitcnt vmcnt(16)
    v_mfma_f32_32x32x16_bf16 v[64:79], a[196:199], v[148:151], v[64:79]
    buffer_load_dwordx4 v[216:219], v1, s[4:7], s24 offen offset:1024 sc1
    v_mfma_f32_32x32x16_bf16 v[48:63], a[196:199], v[144:147], v[48:63]
    v_and_b32 v237, 0xffff0000, v246
    v_lshlrev_b32 v238, 16, v247
    v_and_b32 v239, 0xffff0000, v247
    v_mfma_f32_32x32x16_bf16 v[32:47], a[192:195], v[148:151], v[32:47]
    buffer_load_dwordx4 v[220:223], v1, s[4:7], s39 offen offset:1024 sc1
    s_waitcnt vmcnt(16)
    v_mfma_f32_32x32x16_bf16 v[64:79], a[204:207], v[156:159], v[64:79]
    v_mfma_f32_32x32x16_bf16 v[48:63], a[204:207], v[152:155], v[48:63]
    s_add_u32 m0, s15, 24576
    s_add_u32 s21, s21, 4096
    buffer_load_dwordx4 v2, s[4:7], s21 offen sc1 lds
    v_mfma_f32_32x32x16_bf16 v[32:47], a[200:203], v[156:159], v[32:47]
    s_waitcnt vmcnt(15)
    v_mfma_f32_32x32x16_bf16 v[64:79], a[44:47], v[164:167], v[64:79]
    s_add_u32 m0, s15, 28672
    s_add_u32 s21, s21, 4096
    buffer_load_dwordx4 v2, s[4:7], s21 offen sc1 lds
    s_waitcnt vmcnt(14)
    v_mfma_f32_32x32x16_bf16 v[64:79], a[52:55], v[172:175], v[64:79]
    s_waitcnt vmcnt(12)
    v_mfma_f32_32x32x16_bf16 v[64:79], a[100:103], v[180:183], v[64:79]
    s_add_u32 m0, s15, 32768
    s_add_u32 s21, s21, 4096
    buffer_load_dwordx4 v2, s[4:7], s21 offen sc1 lds
    s_waitcnt vmcnt(11)
    v_mfma_f32_32x32x16_bf16 v[64:79], a[108:111], v[188:191], v[64:79]
    s_waitcnt vmcnt(9)
    v_mfma_f32_32x32x16_bf16 v[64:79], a[156:159], v[196:199], v[64:79]
    s_add_u32 m0, s15, 36864
    s_add_u32 s21, s21, 4096
    buffer_load_dwordx4 v2, s[4:7], s21 offen sc1 lds
    s_waitcnt vmcnt(8)
    v_mfma_f32_32x32x16_bf16 v[64:79], a[164:167], v[204:207], v[64:79]
    s_waitcnt vmcnt(6)
    v_mfma_f32_32x32x16_bf16 v[64:79], a[212:215], v[212:215], v[64:79]
    s_add_u32 m0, s15, 40960
    s_add_u32 s21, s21, 4096
    buffer_load_dwordx4 v2, s[4:7], s21 offen sc1 lds
    s_waitcnt vmcnt(5)
    v_mfma_f32_32x32x16_bf16 v[64:79], a[220:223], v[220:223], v[64:79]
    v_mfma_f32_32x32x16_bf16 v[48:63], a[44:47], v[160:163], v[48:63]
    s_add_u32 m0, s15, 45056
    s_add_u32 s21, s21, 4096
    buffer_load_dwordx4 v2, s[4:7], s21 offen sc1 lds
    v_mfma_f32_32x32x16_bf16 v[48:63], a[52:55], v[168:171], v[48:63]
    s_nop 6
    ds_write_b128 v8, v[64:67] offset:0
    v_mfma_f32_32x32x16_bf16 v[48:63], a[100:103], v[176:179], v[48:63]
    s_add_u32 m0, s15, 49152
    s_add_u32 s21, s21, 4096
    buffer_load_dwordx4 v2, s[4:7], s21 offen sc1 lds
    v_mfma_f32_32x32x16_bf16 v[48:63], a[108:111], v[184:187], v[48:63]
    ds_write_b128 v8, v[68:71] offset:1024
    v_mfma_f32_32x32x16_bf16 v[48:63], a[156:159], v[192:195], v[48:63]
    s_add_u32 m0, s15, 53248
    s_add_u32 s21, s21, 4096
    buffer_load_dwordx4 v2, s[4:7], s21 offen sc1 lds
    v_mfma_f32_32x32x16_bf16 v[48:63], a[164:167], v[200:203], v[48:63]
    ds_write_b128 v8, v[72:75] offset:2048
    v_mfma_f32_32x32x16_bf16 v[48:63], a[212:215], v[208:211], v[48:63]
    s_add_u32 m0, s15, 57344
    s_add_u32 s21, s21, 4096
    buffer_load_dwordx4 v2, s[4:7], s21 offen sc1 lds
    v_mfma_f32_32x32x16_bf16 v[48:63], a[220:223], v[216:219], v[48:63]
    ds_write_b128 v8, v[76:79] offset:3072
    v_mfma_f32_32x32x16_bf16 v[32:47], a[40:43], v[164:167], v[32:47]
    s_add_u32 m0, s15, 61440
    s_add_u32 s21, s21, 4096
    buffer_load_dwordx4 v2, s[4:7], s21 offen sc1 lds
    v_mfma_f32_32x32x16_bf16 v[32:47], a[48:51], v[172:175], v[32:47]
    s_nop 5
    ds_write_b128 v7, v[48:51] offset:0
    v_mfma_f32_32x32x16_bf16 v[32:47], a[96:99], v[180:183], v[32:47]
    s_add_u32 m0, s15, 65536
    s_add_u32 s21, s21, 4096
    buffer_load_dwordx4 v2, s[4:7], s21 offen sc1 lds
    v_mfma_f32_32x32x16_bf16 v[32:47], a[104:107], v[188:191], v[32:47]
    ds_write_b128 v7, v[52:55] offset:1024
    v_mfma_f32_32x32x16_bf16 v[32:47], a[152:155], v[196:199], v[32:47]
    s_add_u32 m0, s15, 69632
    s_add_u32 s21, s21, 4096
    buffer_load_dwordx4 v2, s[4:7], s21 offen sc1 lds
    v_mfma_f32_32x32x16_bf16 v[32:47], a[160:163], v[204:207], v[32:47]
    ds_write_b128 v7, v[56:59] offset:2048
    v_mfma_f32_32x32x16_bf16 v[32:47], a[208:211], v[212:215], v[32:47]
    s_add_u32 m0, s15, 73728
    s_add_u32 s21, s21, 4096
    buffer_load_dwordx4 v2, s[4:7], s21 offen sc1 lds
    v_mfma_f32_32x32x16_bf16 v[32:47], a[216:219], v[220:223], v[32:47]
    ds_write_b128 v7, v[60:63] offset:3072
    v_mfma_f32_32x32x16_bf16 v[16:31], a[136:139], v[128:131], v[16:31]
    s_add_u32 m0, s15, 77824
    s_add_u32 s21, s21, 4096
    buffer_load_dwordx4 v2, s[4:7], s21 offen sc1 lds
    s_waitcnt lgkmcnt(0)
    s_barrier
    ds_read_b128 v[64:67], v9 offset:8192
    ds_read_b128 v[68:71], v9 offset:9216
    ds_read_b128 v[72:75], v9 offset:10240
    ds_read_b128 v[76:79], v9 offset:11264
    ds_read_b128 v[48:51], v9 offset:4096
    ds_read_b128 v[52:55], v9 offset:5120
    ds_read_b128 v[56:59], v9 offset:6144
    ds_read_b128 v[60:63], v9 offset:7168
    v_mfma_f32_32x32x16_bf16 v[16:31], a[144:147], v[136:139], v[16:31]
    ds_write_b128 v6, v[32:35] offset:0
    v_mfma_f32_32x32x16_bf16 v[16:31], a[192:195], v[144:147], v[16:31]
    s_add_u32 m0, s15, 81920
    s_add_u32 s21, s21, 4096
    buffer_load_dwordx4 v2, s[4:7], s21 offen sc1 lds
    s_waitcnt lgkmcnt(5)
    v_add_f32 v224, v224, v64
    v_add_f32 v225, v225, v65
    v_add_f32 v226, v226, v66
    v_add_f32 v227, v227, v67
    v_add_f32 v228, v228, v68
    v_mfma_f32_32x32x16_bf16 v[16:31], a[200:203], v[152:155], v[16:31]
    ds_write_b128 v6, v[36:39] offset:1024
    v_add_f32 v229, v229, v69
    v_add_f32 v230, v230, v70
    v_add_f32 v231, v231, v71
    v_add_f32 v232, v232, v72
    v_add_f32 v233, v233, v73
    v_mfma_f32_32x32x16_bf16 v[16:31], a[40:43], v[160:163], v[16:31]
    s_add_u32 m0, s15, 86016
    s_add_u32 s21, s21, 4096
    buffer_load_dwordx4 v2, s[4:7], s21 offen sc1 lds
    v_add_f32 v234, v234, v74
    v_add_f32 v235, v235, v75
    v_add_f32 v236, v236, v76
    v_add_f32 v237, v237, v77
    v_add_f32 v238, v238, v78
    v_mfma_f32_32x32x16_bf16 v[16:31], a[48:51], v[168:171], v[16:31]
    ds_write_b128 v6, v[40:43] offset:2048
    v_add_f32 v239, v239, v79
    s_waitcnt lgkmcnt(3)
    v_add_f32 v224, v224, v48
    v_add_f32 v225, v225, v49
    v_add_f32 v226, v226, v50
    v_add_f32 v227, v227, v51
    v_mfma_f32_32x32x16_bf16 v[16:31], a[96:99], v[176:179], v[16:31]
    s_add_u32 m0, s15, 90112
    s_add_u32 s21, s21, 4096
    buffer_load_dwordx4 v2, s[4:7], s21 offen sc1 lds
    v_add_f32 v228, v228, v52
    v_add_f32 v229, v229, v53
    v_add_f32 v230, v230, v54
    v_add_f32 v231, v231, v55
    v_add_f32 v232, v232, v56
    v_mfma_f32_32x32x16_bf16 v[16:31], a[104:107], v[184:187], v[16:31]
    ds_write_b128 v6, v[44:47] offset:3072
    v_add_f32 v233, v233, v57
    v_add_f32 v234, v234, v58
    v_add_f32 v235, v235, v59
    v_add_f32 v236, v236, v60
    v_add_f32 v237, v237, v61
    v_mfma_f32_32x32x16_bf16 v[16:31], a[152:155], v[192:195], v[16:31]
    s_add_u32 m0, s15, 94208
    s_add_u32 s21, s21, 4096
    buffer_load_dwordx4 v2, s[4:7], s21 offen sc1 lds
    v_add_f32 v238, v238, v62
    v_add_f32 v239, v239, v63
    v_mfma_f32_32x32x16_bf16 v[16:31], a[160:163], v[200:203], v[16:31]
    s_waitcnt lgkmcnt(0)
    s_barrier
    ds_read_b128 v[32:35], v9 offset:0
    ds_read_b128 v[36:39], v9 offset:1024
    ds_read_b128 v[40:43], v9 offset:2048
    ds_read_b128 v[44:47], v9 offset:3072
    v_mfma_f32_32x32x16_bf16 v[16:31], a[208:211], v[208:211], v[16:31]
    s_add_u32 m0, s15, 98304
    s_add_u32 s21, s21, 4096
    buffer_load_dwordx4 v2, s[4:7], s21 offen sc1 lds
    v_mfma_f32_32x32x16_bf16 v[16:31], a[216:219], v[216:219], v[16:31]
    s_waitcnt lgkmcnt(0)
    v_add_f32 v224, v224, v32
    v_add_f32 v225, v225, v33
    v_add_f32 v226, v226, v34
    v_add_f32 v227, v227, v35
    v_add_f32 v228, v228, v36
    v_add_f32 v229, v229, v37
    v_add_f32 v230, v230, v38
    v_add_f32 v231, v231, v39
    v_add_f32 v232, v232, v40
    v_add_f32 v233, v233, v41
    v_add_f32 v234, v234, v42
    v_add_f32 v235, v235, v43
    v_add_f32 v236, v236, v44
    v_add_f32 v237, v237, v45
    v_add_f32 v238, v238, v46
    v_add_f32 v239, v239, v47
    v_add_f32 v16, v16, v224
    v_add_f32 v17, v17, v225
    v_cvt_pk_bf16_f32 v240, v16, v17
    v_add_f32 v18, v18, v226
    v_add_f32 v19, v19, v227
    v_cvt_pk_bf16_f32 v241, v18, v19
    v_add_f32 v20, v20, v228
    v_add_f32 v21, v21, v229
    v_cvt_pk_bf16_f32 v242, v20, v21
    v_add_f32 v22, v22, v230
    v_add_f32 v23, v23, v231
    v_cvt_pk_bf16_f32 v243, v22, v23
    v_add_f32 v24, v24, v232
    v_add_f32 v25, v25, v233
    v_cvt_pk_bf16_f32 v244, v24, v25
    v_add_f32 v26, v26, v234
    v_add_f32 v27, v27, v235
    v_cvt_pk_bf16_f32 v245, v26, v27
    v_add_f32 v28, v28, v236
    v_add_f32 v29, v29, v237
    v_cvt_pk_bf16_f32 v246, v28, v29
    v_add_f32 v30, v30, v238
    v_add_f32 v31, v31, v239
    v_cvt_pk_bf16_f32 v247, v30, v31
    s_add_u32 s17, s100, 8388608
    buffer_store_dwordx4 v[240:243], v1, s[4:7], s17 offen
    buffer_store_dwordx4 v[244:247], v1, s[4:7], s17 offen offset:1024
    v_add_f32 v10, v16, v18
    v_mul_f32 v11, v16, v16
    v_add_f32 v8, v17, v19
    v_mul_f32 v9, v17, v17
    v_fmac_f32 v11, v18, v18
    v_fmac_f32 v9, v19, v19
    v_add_f32 v10, v10, v20
    v_fmac_f32 v11, v20, v20
    v_add_f32 v8, v8, v21
    v_fmac_f32 v9, v21, v21
    s_add_u32 m0, s15, 102400
    s_add_u32 s21, s21, 4096
    buffer_load_dwordx4 v2, s[4:7], s21 offen sc1 lds
    s_add_u32 m0, s15, 106496
    s_add_u32 s21, s21, 4096
    buffer_load_dwordx4 v2, s[4:7], s21 offen sc1 lds
    v_add_f32 v10, v10, v22
    v_fmac_f32 v11, v22, v22
    v_add_f32 v8, v8, v23
    v_fmac_f32 v9, v23, v23
    v_add_f32 v10, v10, v24
    v_fmac_f32 v11, v24, v24
    v_add_f32 v8, v8, v25
    v_fmac_f32 v9, v25, v25
    v_add_f32 v10, v10, v26
    v_fmac_f32 v11, v26, v26
    v_add_f32 v8, v8, v27
    v_fmac_f32 v9, v27, v27
    v_add_f32 v10, v10, v28
    v_fmac_f32 v11, v28, v28
    v_add_f32 v8, v8, v29
    v_fmac_f32 v9, v29, v29
    v_add_f32 v10, v10, v30
    v_fmac_f32 v11, v30, v30
    v_add_f32 v8, v8, v31
    v_fmac_f32 v9, v31, v31
    v_add_f32 v10, v10, v8
    v_add_f32 v11, v11, v9
    v_mov_b32 v8, v10
    v_mov_b32 v9, v11
    s_nop 0
    v_permlane32_swap_b32 v10, v8
    v_permlane32_swap_b32 v11, v9
    v_add_f32 v10, v10, v8
    v_add_f32 v11, v11, v9
    s_mov_b32 exec_hi, 0
    buffer_store_dwordx2 v[10:11], v1, s[4:7], s29 offen
    s_mov_b64 exec, -1
    s_lshr_b32 s41, s100, 8
    s_add_u32 s41, s41, 8065024
    v_mov_b32 v14, s32
    v_mov_b32 v15, s33
    s_cmp_eq_u32 s34, 0
    s_cbranch_scc1 slow_41
    s_waitcnt vmcnt(3)
    buffer_store_dwordx2 v[14:15], off, s[4:7], s41
join_42:
    s_add_u32 s41, s41, -8192
    s_lshl_b32 s16, s2, 2
    s_lshl_b32 s22, s13, 3
    s_add_u32 s22, s22, s16
    s_add_u32 s22, s22, s12
    s_and_b32 s23, s14, 15
    s_lshl_b32 s20, s22, 15
    s_add_u32 s20, s20, 8388608
    v_mov_b32 v3, v1
    v_add_u32 v4, 0x10000, v3
    v_add_u32 v5, 0x20000, v3
    s_lshl_b32 s28, s22, 12
    s_add_u32 s28, s28, 17825792
    s_lshl_b32 s25, s23, 18
    s_lshl_b32 s17, s22, 11
    s_add_u32 s25, s25, s17
    s_mul_i32 s24, s22, 114688
    s_lshl_b32 s17, s23, 11
    s_add_u32 s24, s24, s17
    s_waitcnt vmcnt(2)
    s_barrier
    ds_read_b128 a[224:227], v3 offset:8192
    ds_read_b128 a[228:231], v3 offset:9216
    ds_read_b128 a[232:235], v4 offset:10240
    ds_read_b128 a[236:239], v3 offset:10240
    v_mov_b32 v14, s32
    v_mov_b32 v15, s33
    s_cmp_eq_u32 s34, 0
    s_cbranch_scc1 slow_43
    s_waitcnt vmcnt(1)
    buffer_store_dwordx2 v[14:15], off, s[4:7], s41
join_44:
    s_lshl_b32 s41, s22, 7
    s_add_u32 s41, s41, 8065024
    s_branch nr_45
ap_26:
    s_mov_b32 s40, 0x40000
ap_26_l:
    buffer_load_dwordx2 v[14:15], v13, s[4:7], s41 offen sc1
    s_sub_u32 s40, s40, 1
    s_cbranch_scc1 L_abort
    s_waitcnt vmcnt(0)
    v_cmp_ne_u64 vcc, s[32:33], v[14:15]
    s_nop 0
    s_cbranch_vccnz ap_26_l
    s_branch apok_27
ap_31:
    s_mov_b32 s40, 0x40000
ap_31_l:
    buffer_load_dwordx2 v[14:15], v12, s[4:7], s25 offen sc1
    s_sub_u32 s40, s40, 1
    s_cbranch_scc1 L_abort
    s_waitcnt vmcnt(0)
    v_cmp_ne_u64 vcc, s[32:33], v[14:15]
    s_nop 0
    s_cbranch_vccnz ap_31_l
    s_branch apok_32
ap_35:
    s_mov_b32 s40, 0x40000
ap_35_l:
    buffer_load_dwordx2 v[14:15], v12, s[4:7], s25 offen sc1
    s_sub_u32 s40, s40, 1
    s_cbranch_scc1 L_abort
    s_waitcnt vmcnt(0)
    v_cmp_ne_u64 vcc, s[32:33], v[14:15]
    s_nop 0
    s_cbranch_vccnz ap_35_l
    s_branch apok_36
ap_39:
    s_mov_b32 s40, 0x40000
ap_39_l:
    buffer_load_dwordx2 v[14:15], v12, s[4:7], s25 offen sc1
    s_sub_u32 s40, s40, 1
    s_cbranch_scc1 L_abort
    s_waitcnt vmcnt(0)
    v_cmp_ne_u64 vcc, s[32:33], v[14:15]
    s_nop 0
    s_cbranch_vccnz ap_39_l
    s_branch apok_40
nr_45:
    v_and_b32 v13, 15, v0
    v_lshlrev_b32 v13, 3, v13
    s_mov_b32 s40, 0x40000
poll_46:
    buffer_load_dwordx2 v[14:15], v13, s[4:7], s41 offen sc1
    s_sub_u32 s40, s40, 1
    s_cbranch_scc1 L_abort
    s_waitcnt vmcnt(0)
    v_cmp_ne_u64 vcc, s[32:33], v[14:15]
    s_nop 0
    s_cbranch_vccnz poll_46
    s_add_u32 s41, s41, -8192
    buffer_load_dwordx4 v[16:19], v1, s[4:7], s20 offen offset:0 sc1
    buffer_load_dwordx4 v[20:23], v1, s[4:7], s20 offen offset:1024 sc1
    buffer_load_dwordx4 v[24:27], v1, s[4:7], s20 offen offset:2048 sc1
    buffer_load_dwordx4 v[28:31], v1, s[4:7], s20 offen offset:3072 sc1
    s_add_u32 s20, s20, 4096
    buffer_load_dwordx4 v[32:35], v1, s[4:7], s20 offen offset:0 sc1
    buffer_load_dwordx4 v[36:39], v1, s[4:7], s20 offen offset:1024 sc1
    buffer_load_dwordx4 v[40:43], v1, s[4:7], s20 offen offset:2048 sc1
    buffer_load_dwordx4 v[44:47], v1, s[4:7], s20 offen offset:3072 sc1
    s_waitcnt vmcnt(7) lgkmcnt(2)
    v_mfma_f32_32x32x16_bf16 v[144:159], a[224:227], v[16:19], 0
    ds_read_b128 a[240:243], v3 offset:11264
    ds_read_b128 a[244:247], v4 offset:11264
    s_and_b32 s16, s14, 15
    s_lshl_b32 s68, s16, 11
    s_add_u32 s68, s68, 8245248
    v_mfma_f32_32x32x16_bf16 v[160:175], v[16:19], a[228:231], 0
    s_add_u32 s20, s20, 4096
    buffer_load_dwordx4 v[48:51], v1, s[4:7], s20 offen offset:0 sc1
    s_lshl_b32 s16, s16, 1
    s_and_b32 s17, s12, 1
    s_add_u32 s16, s16, s17
    s_waitcnt vmcnt(7) lgkmcnt(2)
    v_mfma_f32_32x32x16_bf16 v[176:191], a[232:235], v[16:19], 0
    ds_read_b128 a[248:251], v3 offset:12288
    ds_read_b128 a[252:255], v3 offset:13312
    s_lshr_b32 s17, s12, 1
    s_lshl_b32 s69, s13, 1
    s_add_u32 s69, s69, s2
    v_mfma_f32_32x32x16_bf16 v[144:159], a[236:239], v[20:23], v[144:159]
    buffer_load_dwordx4 v[52:55], v1, s[4:7], s20 offen offset:1024 sc1
    s_lshl_b32 s18, s69, 1
    s_add_u32 s18, s18, s17
    s_lshl_b32 s79, s18, 5
    s_waitcnt lgkmcnt(2)
    v_mfma_f32_32x32x16_bf16 v[160:175], v[20:23], a[240:243], v[160:175]
    ds_read_b128 a[224:227], v4 offset:12288
    ds_read_b128 a[228:231], v3 offset:14336
    buffer_load_dwordx2 v[14:15], v13, s[4:7], s41 offen sc1
    s_add_u32 s79, s79, s16
    s_lshl_b32 s79, s79, 3
    s_add_u32 s79, s79, 8105984
    v_mfma_f32_32x32x16_bf16 v[176:191], a[244:247], v[20:23], v[176:191]
    buffer_load_dwordx4 v[56:59], v1, s[4:7], s20 offen offset:2048 sc1
    s_mul_i32 s64, s18, 229376
    s_lshl_b32 s19, s16, 10
    s_add_u32 s64, s64, s19
    s_waitcnt vmcnt(9) lgkmcnt(2)
    v_mfma_f32_32x32x16_bf16 v[144:159], a[248:251], v[24:27], v[144:159]
    ds_read_b128 a[232:235], v3 offset:15360
    ds_read_b128 a[236:239], v4 offset:13312
    s_add_u32 s64, s64, 10485760
    s_add_u32 s65, s64, 114688
    s_xor_b32 s18, s18, 2
    v_mfma_f32_32x32x16_bf16 v[160:175], v[24:27], a[252:255], v[160:175]
    buffer_load_dwordx4 v[60:63], v1, s[4:7], s20 offen offset:3072 sc1
    s_mul_i32 s66, s18, 229376
    s_lshl_b32 s19, s16, 11
    s_add_u32 s66, s66, s19
    s_waitcnt vmcnt(9) lgkmcnt(2)
    v_mfma_f32_32x32x16_bf16 v[176:191], a[224:227], v[24:27], v[176:191]
    ds_read_b128 a[240:243], v3 offset:16384
    ds_read_b128 a[244:247], v3 offset:17408
    s_add_u32 s66, s66, 10518528
    s_add_u32 s67, s66, 114688
    s_lshl_b32 s69, s69, 13
    v_mfma_f32_32x32x16_bf16 v[144:159], a[228:231], v[28:31], v[144:159]
    s_add_u32 s20, s20, 4096
    buffer_load_dwordx4 v[64:67], v1, s[4:7], s20 offen offset:0 sc1
    s_lshl_b32 s16, s16, 17
    s_lshl_b32 s17, s17, 12
    s_add_u32 s16, s16, s17
    s_waitcnt lgkmcnt(2)
    v_mfma_f32_32x32x16_bf16 v[160:175], v[28:31], a[232:235], v[160:175]
    ds_read_b128 a[248:251], v4 offset:14336
    ds_read_b128 a[252:255], v3 offset:18432
    v_mfma_f32_32x32x16_bf16 v[176:191], a[236:239], v[28:31], v[176:191]
    buffer_load_dwordx4 v[68:71], v1, s[4:7], s20 offen offset:1024 sc1
    s_waitcnt vmcnt(10) lgkmcnt(2)
    v_mfma_f32_32x32x16_bf16 v[144:159], a[240:243], v[32:35], v[144:159]
    ds_read_b128 a[224:227], v3 offset:19456
    ds_read_b128 a[228:231], v4 offset:15360
    v_mfma_f32_32x32x16_bf16 v[160:175], v[32:35], a[244:247], v[160:175]
    buffer_load_dwordx4 v[72:75], v1, s[4:7], s20 offen offset:2048 sc1
    s_waitcnt vmcnt(10) lgkmcnt(2)
    v_mfma_f32_32x32x16_bf16 v[176:191], a[248:251], v[32:35], v[176:191]
    ds_read_b128 a[232:235], v3 offset:20480
    ds_read_b128 a[236:239], v3 offset:21504
    v_mfma_f32_32x32x16_bf16 v[144:159], a[252:255], v[36:39], v[144:159]
    buffer_load_dwordx4 v[76:79], v1, s[4:7], s20 offen offset:3072 sc1
    s_waitcnt lgkmcnt(2)
    v_mfma_f32_32x32x16_bf16 v[160:175], v[36:39], a[224:227], v[160:175]
    ds_read_b128 a[240:243], v3 offset:22528
    ds_read_b128 a[244:247], v3 offset:23552
    v_mfma_f32_32x32x16_bf16 v[176:191], a[228:231], v[36:39], v[176:191]
    s_add_u32 s20, s20, 4096
    buffer_load_dwordx4 v[80:83], v1, s[4:7], s20 offen offset:0 sc1
    s_waitcnt vmcnt(11) lgkmcnt(2)
    v_mfma_f32_32x32x16_bf16 v[144:159], a[232:235], v[40:43], v[144:159]
    ds_read_b128 a[248:251], v3 offset:24576
    ds_read_b128 a[252:255], v3 offset:25600
    v_mfma_f32_32x32x16_bf16 v[160:175], v[40:43], a[236:239], v[160:175]
    buffer_load_dwordx4 v[84:87], v1, s[4:7], s20 offen offset:1024 sc1
    s_waitcnt vmcnt(11) lgkmcnt(2)
    v_mfma_f32_32x32x16_bf16 v[144:159], a[240:243], v[44:47], v[144:159]
    ds_read_b128 a[224:227], v3 offset:26624
    ds_read_b128 a[228:231], v3 offset:27648
    v_mfma_f32_32x32x16_bf16 v[160:175], v[44:47], a[244:247], v[160:175]
    buffer_load_dwordx4 v[88:91], v1, s[4:7], s20 offen offset:2048 sc1
    s_waitcnt vmcnt(11) lgkmcnt(2)
    v_mfma_f32_32x32x16_bf16 v[144:159], a[248:251], v[48:51], v[144:159]
    ds_read_b128 a[232:235], v3 offset:28672
    ds_read_b128 a[236:239], v3 offset:29696
    s_waitcnt vmcnt(9)
    v_cmp_ne_u64 vcc, s[32:33], v[14:15]
    s_nop 0
    s_cbranch_vccnz ap_47
apok_48:
    buffer_load_dwordx4 v[192:195], v1, s[4:7], s28 offen offset:0 sc1
    buffer_load_dwordx4 v[196:199], v1, s[4:7], s28 offen offset:1024 sc1
    buffer_load_dwordx4 v[200:203], v1, s[4:7], s28 offen offset:2048 sc1
    buffer_load_dwordx4 v[204:207], v1, s[4:7], s28 offen offset:3072 sc1
    v_mfma_f32_32x32x16_bf16 v[160:175], v[48:51], a[252:255], v[160:175]
    buffer_load_dwordx4 v[92:95], v1, s[4:7], s20 offen offset:3072 sc1
    s_add_u32 s69, s69, s16
    s_add_u32 s69, s69, 23068672
    v_and_b32 v246, 0x33, v0
    v_bfe_u32 v247, v0, 2, 1
    s_waitcnt lgkmcnt(2)
    v_mfma_f32_32x32x16_bf16 v[144:159], a[224:227], v[52:55], v[144:159]
    ds_read_b128 a[240:243], v3 offset:30720
    ds_read_b128 a[244:247], v3 offset:31744
    v_lshl_or_b32 v246, v247, 3, v246
    v_bfe_u32 v247, v0, 3, 1
    v_lshl_or_b32 v246, v247, 2, v246
    v_lshlrev_b32 v248, 4, v246
    v_mfma_f32_32x32x16_bf16 v[160:175], v[52:55], a[228:231], v[160:175]
    s_add_u32 s20, s20, 4096
    buffer_load_dwordx4 v[96:99], v1, s[4:7], s20 offen offset:0 sc1
    v_and_b32 v246, 15, v0
    s_bfe_u32 s16, s69, 0x4000d
    v_xor_b32 v253, s16, v246
    v_lshlrev_b32 v253, 7, v253
    s_waitcnt vmcnt(14) lgkmcnt(2)
    v_mfma_f32_32x32x16_bf16 v[144:159], a[232:235], v[56:59], v[144:159]
    ds_read_b128 a[248:251], v3 offset:32768
    ds_read_b128 a[252:255], v3 offset:33792
    v_bfe_u32 v247, v0, 5, 1
    v_lshl_add_u32 v246, v247, 4, v246
    v_lshlrev_b32 v249, 4, v246
    v_mov_b32 v250, 0xdddddddd
    v_mfma_f32_32x32x16_bf16 v[160:175], v[56:59], a[236:239], v[160:175]
    buffer_load_dwordx4 v[100:103], v1, s[4:7], s20 offen offset:1024 sc1
    v_lshlrev_b32 v251, 3, v1
    v_and_b32 v246, 27, v0
    v_cmp_eq_u32 vcc, 16, v246
    v_mov_b32 v247, 0x3afe3f80
    s_waitcnt vmcnt(14) lgkmcnt(2)
    v_mfma_f32_32x32x16_bf16 v[144:159], a[240:243], v[60:63], v[144:159]
    ds_read_b128 a[224:227], v3 offset:34816
    ds_read_b128 a[228:231], v3 offset:35840
    v_cndmask_b32 v254, 0, v247, vcc
    s_lshl_b32 s19, s96, 2
    s_add_u32 s19, s19, s12
    s_mul_i32 s72, s19, 7168
    v_mfma_f32_32x32x16_bf16 v[160:175], v[60:63], a[244:247], v[160:175]
    buffer_load_dwordx4 v[104:107], v1, s[4:7], s20 offen offset:2048 sc1
    s_add_u32 s72, s72, 10485760
    s_lshl_b32 s16, s19, 11
    s_add_u32 s16, s16, 8388608
    s_lshl_b32 s17, s19, 8
    s_waitcnt vmcnt(14) lgkmcnt(2)
    v_mfma_f32_32x32x16_bf16 v[144:159], a[248:251], v[64:67], v[144:159]
    ds_read_b128 a[232:235], v3 offset:36864
    ds_read_b128 a[236:239], v3 offset:37888
    s_add_u32 s17, s17, 17825792
    v_and_b32 v246, 0x780, v251
    v_add_u32 v246, s16, v246
    v_and_b32 v247, 0x80, v251
    v_mfma_f32_32x32x16_bf16 v[160:175], v[64:67], a[252:255], v[160:175]
    buffer_load_dwordx4 v[108:111], v1, s[4:7], s20 offen offset:3072 sc1
    v_add_u32 v247, s17, v247
    v_cmp_gt_u32 vcc, 512, v1
    s_nop 1
    v_cndmask_b32 v252, v247, v246, vcc
    s_lshl_b32 s73, s2, 2
    s_waitcnt vmcnt(14) lgkmcnt(2)
    v_mfma_f32_32x32x16_bf16 v[144:159], a[224:227], v[68:71], v[144:159]
    ds_read_b128 a[240:243], v3 offset:38912
    ds_read_b128 a[244:247], v3 offset:39936
    s_add_u32 s73, s73, s12
    s_mul_i32 s73, s73, 12288
    s_add_u32 s73, s73, s37
    s_add_u32 s73, s73, 65536
    v_mfma_f32_32x32x16_bf16 v[160:175], v[68:71], a[228:231], v[160:175]
    s_add_u32 s20, s20, 4096
    buffer_load_dwordx4 v[112:115], v1, s[4:7], s20 offen offset:0 sc1
    s_and_b32 s85, s19, 31
    s_lshl_b32 s85, s85, 10
    v_bfe_u32 v222, v0, 4, 1
    v_lshl_add_u32 v222, v222, 11, v249
    s_waitcnt vmcnt(14) lgkmcnt(2)
    v_mfma_f32_32x32x16_bf16 v[144:159], a[232:235], v[72:75], v[144:159]
    ds_read_b128 a[248:251], v3 offset:40960
    ds_read_b128 a[252:255], v3 offset:41984
    s_mul_i32 s19, s12, 6144
    s_add_u32 s19, s19, 114688
    v_add_u32 v216, s19, v1
    v_add_u32 v217, s19, v222
    v_mfma_f32_32x32x16_bf16 v[160:175], v[72:75], a[236:239], v[160:175]
    buffer_load_dwordx4 v[116:119], v1, s[4:7], s20 offen offset:1024 sc1
    s_lshr_b32 s19, s12, 1
    s_mul_i32 s19, s19, 12288
    s_and_b32 s16, s12, 1
    s_lshl_b32 s16, s16, 10
    s_waitcnt vmcnt(14) lgkmcnt(2)
    v_mfma_f32_32x32x16_bf16 v[144:159], a[240:243], v[76:79], v[144:159]
    ds_read_b128 a[224:227], v3 offset:43008
    ds_read_b128 a[228:231], v3 offset:44032
    s_add_u32 s18, s16, 114688
    s_add_u32 s17, s18, s19
    v_add_u32 v218, s17, v1
    s_sub_u32 s18, s18, s19
    v_mfma_f32_32x32x16_bf16 v[160:175], v[76:79], a[244:247], v[160:175]
    buffer_load_dwordx4 v[120:123], v1, s[4:7], s20 offen offset:2048 sc1
    v_add_u32 v219, s18, v1
    s_add_u32 s17, s17, s16
    v_add_u32 v220, s17, v248
    v_add_u32 v221, s17, v249
    s_waitcnt vmcnt(14) lgkmcnt(2)
    v_mfma_f32_32x32x16_bf16 v[144:159], a[248:251], v[80:83], v[144:159]
    ds_read_b128 a[232:235], v3 offset:45056
    ds_read_b128 a[236:239], v3 offset:46080
    s_lshl_b32 s27, s23, 11
    s_add_u32 s27, s27, s24
    s_add_u32 s27, s27, 10518528
    v_mfma_f32_32x32x16_bf16 v[160:175], v[80:83], a[252:255], v[160:175]
    buffer_load_dwordx4 v[124:127], v1, s[4:7], s20 offen offset:3072 sc1
    s_waitcnt vmcnt(14) lgkmcnt(2)
    v_mfma_f32_32x32x16_bf16 v[144:159], a[224:227], v[84:87], v[144:159]
    ds_read_b128 a[240:243], v3 offset:47104
    ds_read_b128 a[244:247], v3 offset:48128
    v_mfma_f32_32x32x16_bf16 v[160:175], v[84:87], a[228:231], v[160:175]
    s_add_u32 s20, s20, 4096
    buffer_load_dwordx4 v[128:131], v1, s[4:7], s20 offen offset:0 sc1
    s_waitcnt vmcnt(14) lgkmcnt(2)
    v_mfma_f32_32x32x16_bf16 v[144:159], a[232:235], v[88:91], v[144:159]
    ds_read_b128 a[248:251], v3 offset:49152
    ds_read_b128 a[252:255], v3 offset:50176
    v_mfma_f32_32x32x16_bf16 v[160:175], v[88:91], a[236:239], v[160:175]
    buffer_load_dwordx4 v[132:135], v1, s[4:7], s20 offen offset:1024 sc1
    s_waitcnt vmcnt(10) lgkmcnt(2)
    v_mfma_f32_32x32x16_bf16 v[144:159], a[240:243], v[92:95], v[144:159]
    ds_read_b128 a[224:227], v3 offset:51200
    ds_read_b128 a[228:231], v3 offset:52224
    v_add_f32 v192, v192, v200
    v_add_f32 v193, v193, v201
    v_add_f32 v194, v194, v202
    v_mfma_f32_32x32x16_bf16 v[160:175], v[92:95], a[244:247], v[160:175]
    buffer_load_dwordx4 v[136:139], v1, s[4:7], s20 offen offset:2048 sc1
    v_add_f32 v195, v195, v203
    v_add_f32 v196, v196, v204
    v_add_f32 v197, v197, v205
    s_waitcnt vmcnt(10) lgkmcnt(2)
    v_mfma_f32_32x32x16_bf16 v[144:159], a[248:251], v[96:99], v[144:159]
    ds_read_b128 a[232:235], v3 offset:53248
    ds_read_b128 a[236:239], v3 offset:54272
    v_add_f32 v198, v198, v206
    v_add_f32 v199, v199, v207
    v_add_f32 v192, v192, v196
    v_mfma_f32_32x32x16_bf16 v[160:175], v[96:99], a[252:255], v[160:175]
    buffer_load_dwordx4 v[140:143], v1, s[4:7], s20 offen offset:3072 sc1
    v_add_f32 v193, v193, v197
    v_add_f32 v194, v194, v198
    v_add_f32 v195, v195, v199
    s_waitcnt vmcnt(10) lgkmcnt(2)
    v_mfma_f32_32x32x16_bf16 v[144:159], a[224:227], v[100:103], v[144:159]
    ds_read_b128 a[240:243], v3 offset:55296
    ds_read_b128 a[244:247], v3 offset:56320
    v_add_f32 v192, v192, v194
    v_add_f32 v193, v193, v195
    v_mov_b32 v194, v192
    v_mfma_f32_32x32x16_bf16 v[160:175], v[100:103], a[228:231], v[160:175]
    v_mov_b32 v195, v193
    v_permlane32_swap_b32 v192, v194
    s_nop 0
    v_permlane32_swap_b32 v193, v195
    s_waitcnt vmcnt(9) lgkmcnt(2)
    v_mfma_f32_32x32x16_bf16 v[144:159], a[232:235], v[104:107], v[144:159]
    ds_read_b128 a[248:251], v3 offset:57344
    ds_read_b128 a[252:255], v3 offset:58368
    v_add_f32 v192, v192, v194
    v_add_f32 v193, v193, v195
    v_mul_f32 v192, 0xbb000000, v192
    v_mfma_f32_32x32x16_bf16 v[160:175], v[104:107], a[236:239], v[160:175]
    v_mul_f32 v193, 0x3b000000, v193
    v_fma_f32 v193, -v192, v192, v193
    v_max_f32 v193, 0, v193
    s_waitcnt vmcnt(8) lgkmcnt(2)
    v_mfma_f32_32x32x16_bf16 v[144:159], a[240:243], v[108:111], v[144:159]
    ds_read_b128 a[224:227], v3 offset:59392
    ds_read_b128 a[228:231], v3 offset:60416
    v_cvt_pk_bf16_f32 v193, v193, 0
    v_lshlrev_b32 v193, 16, v193
    v_add_f32 v193, 0x3727c5ac, v193
    v_mfma_f32_32x32x16_bf16 v[160:175], v[108:111], a[244:247], v[160:175]
    v_cvt_pk_bf16_f32 v193, v193, 0
    v_lshlrev_b32 v193, 16, v193
    v_sqrt_f32 v193, v193
    s_waitcnt vmcnt(7) lgkmcnt(2)
    v_mfma_f32_32x32x16_bf16 v[144:159], a[248:251], v[112:115], v[144:159]
    ds_read_b128 a[232:235], v3 offset:61440
    ds_read_b128 a[236:239], v3 offset:62464
    v_cvt_pk_bf16_f32 v8, v192, v192
    v_cvt_pk_bf16_f32 v193, v193, 0
    v_lshlrev_b32 v193, 16, v193
    v_mfma_f32_32x32x16_bf16 v[160:175], v[112:115], a[252:255], v[160:175]
    v_rcp_f32 v6, v193
    v_mov_b32 v9, 0
    v_mov_b32 v10, v8
    s_waitcnt vmcnt(6) lgkmcnt(2)
    v_mfma_f32_32x32x16_bf16 v[144:159], a[224:227], v[116:119], v[144:159]
    ds_read_b128 a[240:243], v3 offset:63488
    ds_read_b128 a[244:247], v3 offset:64512
    v_mov_b32 v11, 0
    v_cvt_pk_bf16_f32 v224, v6, 0
    v_lshlrev_b32 v225, 16, v224
    v_mfma_f32_32x32x16_bf16 v[160:175], v[116:119], a[228:231], v[160:175]
    v_sub_f32 v226, v6, v225
    v_cvt_pk_bf16_f32 v224, v225, v226
    v_mov_b32 v225, 0
    s_waitcnt vmcnt(5) lgkmcnt(2)
    v_mfma_f32_32x32x16_bf16 v[144:159], a[232:235], v[120:123], v[144:159]
    ds_read_b128 a[248:251], v4 offset:0
    ds_read_b128 a[252:255], v4 offset:1024
    v_mov_b32 v226, 0
    v_mov_b32 v227, 0
    v_cmp_gt_u32 vcc, 512, v1
    v_mfma_f32_32x32x16_bf16 v[160:175], v[120:123], a[236:239], v[160:175]
    v_mov_b32 v228, 0x3f803f80
    v_cndmask_b32 v228, 0, v228, vcc
    v_mov_b32 v229, 0
    s_waitcnt vmcnt(4) lgkmcnt(2)
    v_mfma_f32_32x32x16_bf16 v[144:159], a[240:243], v[124:127], v[144:159]
    ds_read_b128 a[224:227], v4 offset:2048
    ds_read_b128 a[228:231], v4 offset:3072
    v_mov_b32 v230, 0
    v_mov_b32 v231, 0
    v_mul_f32 v7, 0x3eb8aa3b, v6
    v_mfma_f32_32x32x16_bf16 v[160:175], v[124:127], a[244:247], v[160:175]
    v_bfe_u32 v12, v0, 4, 1
    v_lshlrev_b32 v12, 17, v12
    v_and_b32 v13, 15, v0
    s_waitcnt vmcnt(3) lgkmcnt(2)
    v_mfma_f32_32x32x16_bf16 v[144:159], a[248:251], v[128:131], v[144:159]
    ds_read_b128 a[232:235], v4 offset:4096
    ds_read_b128 a[236:239], v4 offset:5120
    v_lshlrev_b32 v13, 4, v13
    v_add_u32 v12, v12, v13
    v_bfe_u32 v13, v0, 5, 1
    v_mfma_f32_32x32x16_bf16 v[160:175], v[128:131], a[252:255], v[160:175]
    v_lshlrev_b32 v13, 8, v13
    v_add_u32 v12, v12, v13
    v_mfma_f32_32x32x16_bf16 v[232:247], v[224:227], v[228:231], 0
    s_waitcnt vmcnt(2) lgkmcnt(2)
    v_mfma_f32_32x32x16_bf16 v[144:159], a[224:227], v[132:135], v[144:159]
    ds_read_b128 a[240:243], v4 offset:6144
    ds_read_b128 a[244:247], v4 offset:7168
    v_mfma_f32_32x32x16_bf16 v[160:175], v[132:135], a[228:231], v[160:175]
    s_waitcnt vmcnt(1) lgkmcnt(2)
    v_mfma_f32_32x32x16_bf16 v[144:159], a[232:235], v[136:139], v[144:159]
    ds_read_b128 a[248:251], v4 offset:8192
    ds_read_b128 a[252:255], v4 offset:9216
    v_mfma_f32_32x32x16_bf16 v[160:175], v[136:139], a[236:239], v[160:175]
    s_waitcnt vmcnt(0) lgkmcnt(2)
    v_mfma_f32_32x32x16_bf16 v[144:159], a[240:243], v[140:143], v[144:159]
    ds_read_b128 a[224:227], v4 offset:16384
    ds_read_b128 a[228:231], v4 offset:17408
    v_mfma_f32_32x32x16_bf16 v[160:175], v[140:143], a[244:247], v[160:175]
    s_waitcnt lgkmcnt(2)
    v_mfma_f32_32x32x16_bf16 v[144:159], a[248:251], v[8:11], v[144:159]
    ds_read_b128 a[232:235], v4 offset:18432
    ds_read_b128 a[236:239], v4 offset:19456
    v_mfma_f32_32x32x16_bf16 v[160:175], v[8:11], a[252:255], v[160:175]
    s_waitcnt lgkmcnt(2)
    v_mfma_f32_32x32x16_bf16 v[176:191], a[224:227], v[40:43], v[176:191]
    ds_read_b128 a[240:243], v4 offset:20480
    ds_read_b128 a[244:247], v4 offset:21504
    v_mfma_f32_32x32x16_bf16 v[176:191], a[228:231], v[44:47], v[176:191]
    s_waitcnt lgkmcnt(2)
    v_mfma_f32_32x32x16_bf16 v[176:191], a[232:235], v[48:51], v[176:191]
    ds_read_b128 a[248:251], v4 offset:22528
    ds_read_b128 a[252:255], v4 offset:23552
    v_mul_f32 v144, v144, v6
    v_mul_f32 v145, v145, v6
    v_cvt_pk_bf16_f32 v192, v144, v145
    v_mul_f32 v146, v146, v6
    v_mul_f32 v147, v147, v6
    v_mfma_f32_32x32x16_bf16 v[176:191], a[236:239], v[52:55], v[176:191]
    v_cvt_pk_bf16_f32 v193, v146, v147
    v_mul_f32 v148, v148, v6
    v_mul_f32 v149, v149, v6
    v_cvt_pk_bf16_f32 v194, v148, v149
    v_mul_f32 v150, v150, v6
    s_waitcnt lgkmcnt(2)
    v_mfma_f32_32x32x16_bf16 v[176:191], a[240:243], v[56:59], v[176:191]
    ds_read_b128 a[224:227], v4 offset:24576
    ds_read_b128 a[228:231], v4 offset:25600
    v_mul_f32 v151, v151, v6
    v_cvt_pk_bf16_f32 v195, v150, v151
    buffer_store_dwordx4 v[192:195], v1, s[4:7], s27 offen
    v_mul_f32 v152, v152, v6
    v_mul_f32 v153, v153, v6
    v_mfma_f32_32x32x16_bf16 v[176:191], a[244:247], v[60:63], v[176:191]
    v_cvt_pk_bf16_f32 v196, v152, v153
    v_mul_f32 v154, v154, v6
    v_mul_f32 v155, v155, v6
    v_cvt_pk_bf16_f32 v197, v154, v155
    v_mul_f32 v156, v156, v6
    s_waitcnt lgkmcnt(2)
    v_mfma_f32_32x32x16_bf16 v[176:191], a[248:251], v[64:67], v[176:191]
    ds_read_b128 a[232:235], v4 offset:26624
    ds_read_b128 a[236:239], v4 offset:27648
    v_mul_f32 v157, v157, v6
    v_cvt_pk_bf16_f32 v198, v156, v157
    v_mul_f32 v158, v158, v6
    v_mul_f32 v159, v159, v6
    v_cvt_pk_bf16_f32 v199, v158, v159
    v_mfma_f32_32x32x16_bf16 v[176:191], a[252:255], v[68:71], v[176:191]
    buffer_store_dwordx4 v[196:199], v1, s[4:7], s27 offen offset:2048
    v_mul_f32 v160, v160, v232
    v_mul_f32 v161, v161, v233
    v_cvt_pk_bf16_f32 v208, v160, v161
    v_mul_f32 v162, v162, v234
    s_waitcnt lgkmcnt(2)
    v_mfma_f32_32x32x16_bf16 v[176:191], a[224:227], v[72:75], v[176:191]
    ds_read_b128 a[240:243], v4 offset:28672
    ds_read_b128 a[244:247], v4 offset:29696
    v_mul_f32 v163, v163, v235
    v_cvt_pk_bf16_f32 v209, v162, v163
    v_mul_f32 v164, v164, v236
    v_mul_f32 v165, v165, v237
    v_cvt_pk_bf16_f32 v210, v164, v165
    v_mfma_f32_32x32x16_bf16 v[176:191], a[228:231], v[76:79], v[176:191]
    v_mul_f32 v166, v166, v238
    v_mul_f32 v167, v167, v239
    v_cvt_pk_bf16_f32 v211, v166, v167
    buffer_store_dwordx4 v[208:211], v222, s[4:7], s27 offen offset:1024
    v_mul_f32 v168, v168, v240
    s_waitcnt lgkmcnt(2)
    v_mfma_f32_32x32x16_bf16 v[176:191], a[232:235], v[80:83], v[176:191]
    ds_read_b128 a[248:251], v4 offset:30720
    ds_read_b128 a[252:255], v4 offset:31744
    v_mul_f32 v169, v169, v241
    v_cvt_pk_bf16_f32 v212, v168, v169
    v_mul_f32 v170, v170, v242
    v_mul_f32 v171, v171, v243
    v_cvt_pk_bf16_f32 v213, v170, v171
    v_mfma_f32_32x32x16_bf16 v[176:191], a[236:239], v[84:87], v[176:191]
    v_mul_f32 v172, v172, v244
    v_mul_f32 v173, v173, v245
    v_cvt_pk_bf16_f32 v214, v172, v173
    v_mul_f32 v174, v174, v246
    v_mul_f32 v175, v175, v247
    s_waitcnt lgkmcnt(2)
    v_mfma_f32_32x32x16_bf16 v[176:191], a[240:243], v[88:91], v[176:191]
    ds_read_b128 a[224:227], v4 offset:32768
    ds_read_b128 a[228:231], v4 offset:33792
    v_cvt_pk_bf16_f32 v215, v174, v175
    buffer_store_dwordx4 v[212:215], v222, s[4:7], s27 offen offset:1536
    s_add_u32 s18, s25, 23068672
    buffer_store_dwordx4 v[192:195], v1, s[4:7], s18 offen sc1
    v_mfma_f32_32x32x16_bf16 v[176:191], a[244:247], v[92:95], v[176:191]
    s_add_u32 s18, s25, 23199744
    buffer_store_dwordx4 v[196:199], v1, s[4:7], s18 offen sc1
    s_add_u32 s18, s25, 23069696
    buffer_store_dwordx4 v[208:211], v12, s[4:7], s18 offen offset:0 sc1
    buffer_store_dwordx4 v[212:215], v12, s[4:7], s18 offen offset:512 sc1
    s_waitcnt lgkmcnt(2)
    v_mfma_f32_32x32x16_bf16 v[176:191], a[248:251], v[96:99], v[176:191]
    ds_read_b128 a[232:235], v4 offset:34816
    ds_read_b128 a[236:239], v4 offset:35840
    ds_write_b128 v216, v[192:195]
    ds_write_b128 v216, v[196:199] offset:2048
    ds_write_b128 v217, v[208:211] offset:1024
    ds_write_b128 v217, v[212:215] offset:1536
    v_mfma_f32_32x32x16_bf16 v[176:191], a[252:255], v[100:103], v[176:191]
    s_waitcnt lgkmcnt(6)
    v_mfma_f32_32x32x16_bf16 v[176:191], a[224:227], v[104:107], v[176:191]
    ds_read_b128 a[240:243], v4 offset:36864
    ds_read_b128 a[244:247], v4 offset:37888
    v_mfma_f32_32x32x16_bf16 v[176:191], a[228:231], v[108:111], v[176:191]
    s_waitcnt lgkmcnt(6)
    v_mfma_f32_32x32x16_bf16 v[176:191], a[232:235], v[112:115], v[176:191]
    ds_read_b128 a[248:251], v4 offset:38912
    ds_read_b128 a[252:255], v4 offset:39936
    v_mfma_f32_32x32x16_bf16 v[176:191], a[236:239], v[116:119], v[176:191]
    s_waitcnt lgkmcnt(2)
    v_mfma_f32_32x32x16_bf16 v[176:191], a[240:243], v[120:123], v[176:191]
    ds_read_b128 a[224:227], v4 offset:40960
    ds_read_b128 a[228:231], v4 offset:41984
    v_mfma_f32_32x32x16_bf16 v[176:191], a[244:247], v[124:127], v[176:191]
    s_waitcnt lgkmcnt(2)
    v_mfma_f32_32x32x16_bf16 v[176:191], a[248:251], v[128:131], v[176:191]
    ds_read_b128 a[232:235], v4 offset:43008
    v_mfma_f32_32x32x16_bf16 v[176:191], a[252:255], v[132:135], v[176:191]
    s_waitcnt lgkmcnt(1)
    v_mfma_f32_32x32x16_bf16 v[176:191], a[224:227], v[136:139], v[176:191]
    v_mfma_f32_32x32x16_bf16 v[176:191], a[228:231], v[140:143], v[176:191]
    s_waitcnt lgkmcnt(0)
    v_mfma_f32_32x32x16_bf16 v[176:191], a[232:235], v[8:11], v[176:191]
    v_mov_b32 v224, 0
    s_nop 1
    v_mfma_f32_32x32x16_bf16 v[16:31], v[228:231], v[224:227], 0
    v_mfma_f32_32x32x16_bf16 v[32:47], v[228:231], v[224:227], 0
    v_mfma_f32_32x32x16_bf16 v[48:63], v[228:231], v[224:227], 0
    v_mfma_f32_32x32x16_bf16 v[64:79], v[228:231], v[224:227], 0
    v_mov_b32 v224, v254
    s_nop 3
    v_mul_f32 v176, v176, v7
    v_mul_f32 v177, v177, v7
    v_cvt_pk_bf16_f32 v200, v176, v177
    v_mfma_f32_32x32x16_bf16 v[80:95], v[228:231], v[224:227], 0
    v_mul_f32 v178, v178, v7
    v_mul_f32 v179, v179, v7
    v_cvt_pk_bf16_f32 v201, v178, v179
    v_mfma_f32_32x32x16_bf16 v[96:111], v[228:231], v[224:227], 0
    v_mul_f32 v180, v180, v7
    v_mul_f32 v181, v181, v7
    v_cvt_pk_bf16_f32 v202, v180, v181
    v_mfma_f32_32x32x16_bf16 v[112:127], v[228:231], v[224:227], 0
    v_mul_f32 v182, v182, v7
    v_mul_f32 v183, v183, v7
    v_cvt_pk_bf16_f32 v203, v182, v183
    v_mfma_f32_32x32x16_bf16 v[128:143], v[228:231], v[224:227], 0
    ds_write_b128 v216, v[200:203] offset:4096
    v_mul_f32 v184, v184, v7
    v_mul_f32 v185, v185, v7
    v_cvt_pk_bf16_f32 v204, v184, v185
    v_mfma_f32_32x32x16_bf16 v[144:159], v[228:231], v[224:227], 0
    v_mul_f32 v186, v186, v7
    v_mul_f32 v187, v187, v7
    v_cvt_pk_bf16_f32 v205, v186, v187
    v_mfma_f32_32x32x16_bf16 v[160:175], v[228:231], v[224:227], 0
    v_mul_f32 v188, v188, v7
    v_mul_f32 v189, v189, v7
    v_cvt_pk_bf16_f32 v206, v188, v189
    v_mul_f32 v190, v190, v7
    v_mul_f32 v191, v191, v7
    v_cvt_pk_bf16_f32 v207, v190, v191
    ds_write_b128 v216, v[204:207] offset:5120
    s_lshr_b32 s41, s22, 3
    s_lshl_b32 s41, s41, 4
    s_add_u32 s41, s41, s23
    s_lshl_b32 s41, s41, 3
    s_and_b32 s17, s22, 7
    s_add_u32 s41, s41, s17
    s_lshl_b32 s41, s41, 3
    s_add_u32 s41, s41, 8040448
    v_mov_b32 v14, s32
    v_mov_b32 v15, s33
    s_cmp_eq_u32 s34, 0
    s_cbranch_scc1 slow_49
    s_waitcnt vmcnt(4)
    buffer_store_dwordx2 v[14:15], off, s[4:7], s41
join_50:
    s_waitcnt lgkmcnt(0)
    s_barrier
    ds_read_b128 v[80:83], v220
    ds_read_b128 a[224:227], v218 offset:4096
    ds_read_b128 a[228:231], v218 offset:10240
    ds_read_b128 a[232:235], v219 offset:16384
    ds_read_b128 a[236:239], v219 offset:22528
    s_mov_b64 exec, s[30:31]
    ds_read_b128 v[84:87], v221 offset:1024
    ds_read_b128 v[88:91], v221 offset:1536
    ds_read_b128 v[96:99], v221 offset:7168
    ds_read_b128 v[100:103], v221 offset:7680
    s_mov_b64 exec, -1
    ds_read_b128 v[92:95], v220 offset:6144
    s_waitcnt lgkmcnt(8)
    v_mfma_f32_32x32x16_bf16 v[176:191], v[80:83], a[224:227], 0
    s_waitcnt lgkmcnt(7)
    v_mfma_f32_32x32x16_bf16 v[192:207], v[80:83], a[228:231], 0
    s_waitcnt lgkmcnt(6)
    v_mfma_f32_32x32x16_bf16 v[208:223], v[80:83], a[232:235], 0
    s_nop 7
    v_exp_f32 v176, v176
    v_exp_f32 v177, v177
    v_exp_f32 v178, v178
    s_xor_b32 s16, s22, 4
    s_and_b32 s16, s16, 6
    s_lshl_b32 s17, s13, 4
    s_add_u32 s17, s17, s23
    s_lshl_b32 s17, s17, 3
    s_add_u32 s17, s17, s16
    s_lshl_b32 s17, s17, 3
    s_add_u32 s26, s17, 8040448
    v_and_b32 v12, 8, v0
    buffer_load_dwordx2 v[8:9], v12, s[4:7], s26 offen sc1
    v_exp_f32 v179, v179
    v_exp_f32 v180, v180
    v_exp_f32 v181, v181
    s_waitcnt lgkmcnt(5)
    v_mfma_f32_32x32x16_bf16 v[224:239], v[80:83], a[236:239], 0
    v_exp_f32 v182, v182
    v_exp_f32 v183, v183
    v_exp_f32 v184, v184
    v_exp_f32 v185, v185
    s_waitcnt lgkmcnt(1)
    v_smfmac_f32_32x32x32_bf16 v[16:31], v[84:87], v[176:183], v250
    s_waitcnt lgkmcnt(0)
    s_lshl_b32 s41, s23, 4
    s_lshr_b32 s17, s22, 2
    s_add_u32 s41, s41, s17
    s_lshl_b32 s41, s41, 7
    s_add_u32 s41, s41, 8245248
    v_mov_b32 v13, 0
    v_mov_b32 v14, s32
    v_mov_b32 v15, s33
    s_waitcnt vmcnt(2)
    s_barrier
    s_cmp_lg_u32 s12, 0
    s_cbranch_scc1 pw_51
    s_mov_b64 exec, 1
    buffer_store_dwordx2 v[14:15], v13, s[4:7], s41 offen sc1
    s_mov_b64 exec, -1
pw_51:
    v_exp_f32 v186, v186
    v_exp_f32 v187, v187
    v_exp_f32 v188, v188
    v_exp_f32 v189, v189
    v_exp_f32 v190, v190
    v_exp_f32 v191, v191
    v_exp_f32 v192, v192
    v_exp_f32 v193, v193
    v_smfmac_f32_32x32x32_bf16 v[16:31], v[88:91], v[184:191], v250
    v_exp_f32 v194, v194
    v_exp_f32 v195, v195
    v_exp_f32 v196, v196
    v_exp_f32 v197, v197
    v_mfma_f32_32x32x16_bf16 v[176:191], v[92:95], a[224:227], 0
    v_exp_f32 v198, v198
    v_exp_f32 v199, v199
    v_exp_f32 v200, v200
    v_exp_f32 v201, v201
    v_smfmac_f32_32x32x32_bf16 v[32:47], v[84:87], v[192:199], v250
    v_exp_f32 v202, v202
    v_exp_f32 v203, v203
    v_exp_f32 v204, v204
    v_exp_f32 v205, v205
    v_exp_f32 v206, v206
    v_exp_f32 v207, v207
    v_exp_f32 v208, v208
    v_exp_f32 v209, v209
    v_smfmac_f32_32x32x32_bf16 v[32:47], v[88:91], v[200:207], v250
    v_exp_f32 v210, v210
    v_exp_f32 v211, v211
    v_exp_f32 v212, v212
    v_exp_f32 v213, v213
    v_mfma_f32_32x32x16_bf16 v[192:207], v[92:95], a[228:231], 0
    v_exp_f32 v214, v214
    v_exp_f32 v215, v215
    v_exp_f32 v216, v216
    v_exp_f32 v217, v217
    v_smfmac_f32_32x32x32_bf16 v[48:63], v[84:87], v[208:215], v250
    s_waitcnt vmcnt(0)
    v_cmp_ne_u64 vcc, s[32:33], v[8:9]
    s_nop 0
    s_cbranch_vccnz ap_52
apok_53:
    buffer_load_dwordx4 v[104:107], v248, s[4:7], s66 offen offset:0 sc1
    buffer_load_dwordx4 v[116:119], v248, s[4:7], s67 offen offset:0 sc1
    s_mov_b64 exec, s[30:31]
    buffer_load_dwordx4 v[108:111], v249, s[4:7], s66 offen offset:1024 sc1
    buffer_load_dwordx4 v[112:115], v249, s[4:7], s66 offen offset:1536 sc1
    buffer_load_dwordx4 v[120:123], v249, s[4:7], s67 offen offset:1024 sc1
    buffer_load_dwordx4 v[124:127], v249, s[4:7], s67 offen offset:1536 sc1
    s_mov_b64 exec, -1
    v_exp_f32 v218, v218
    v_exp_f32 v219, v219
    v_exp_f32 v220, v220
    v_exp_f32 v221, v221
    v_exp_f32 v222, v222
    v_exp_f32 v223, v223
    v_exp_f32 v224, v224
    v_exp_f32 v225, v225
    v_smfmac_f32_32x32x32_bf16 v[48:63], v[88:91], v[216:223], v250
    v_exp_f32 v226, v226
    v_exp_f32 v227, v227
    v_exp_f32 v228, v228
    v_exp_f32 v229, v229
    v_mfma_f32_32x32x16_bf16 v[208:223], v[92:95], a[232:235], 0
    v_exp_f32 v230, v230
    v_exp_f32 v231, v231
    v_exp_f32 v232, v232
    v_exp_f32 v233, v233
    v_smfmac_f32_32x32x32_bf16 v[64:79], v[84:87], v[224:231], v250
    buffer_load_dwordx2 v[10:11], v253, s[4:7], s68 offen sc1
    v_exp_f32 v234, v234
    v_exp_f32 v235, v235
    v_exp_f32 v236, v236
    v_exp_f32 v237, v237
    v_exp_f32 v238, v238
    v_exp_f32 v239, v239
    v_exp_f32 v176, v176
    v_exp_f32 v177, v177
    v_smfmac_f32_32x32x32_bf16 v[64:79], v[88:91], v[232:239], v250
    v_exp_f32 v178, v178
    v_exp_f32 v179, v179
    v_exp_f32 v180, v180
    v_exp_f32 v181, v181
    v_mfma_f32_32x32x16_bf16 v[224:239], v[92:95], a[236:239], 0
    v_exp_f32 v182, v182
    v_exp_f32 v183, v183
    v_exp_f32 v184, v184
    v_exp_f32 v185, v185
    v_smfmac_f32_32x32x32_bf16 v[16:31], v[96:99], v[176:183], v250
    v_exp_f32 v186, v186
    v_exp_f32 v187, v187
    v_exp_f32 v188, v188
    v_exp_f32 v189, v189
    v_exp_f32 v190, v190
    v_exp_f32 v191, v191
    v_exp_f32 v192, v192
    v_exp_f32 v193, v193
    v_smfmac_f32_32x32x32_bf16 v[16:31], v[100:103], v[184:191], v250
    v_exp_f32 v194, v194
    v_exp_f32 v195, v195
    v_exp_f32 v196, v196
    v_exp_f32 v197, v197
    s_waitcnt vmcnt(1)
    v_mfma_f32_32x32x16_bf16 v[176:191], v[104:107], a[224:227], 0
    v_exp_f32 v198, v198
    v_exp_f32 v199, v199
    v_exp_f32 v200, v200
    v_exp_f32 v201, v201
    v_smfmac_f32_32x32x32_bf16 v[32:47], v[96:99], v[192:199], v250
    v_exp_f32 v202, v202
    v_exp_f32 v203, v203
    v_exp_f32 v204, v204
    v_exp_f32 v205, v205
    v_exp_f32 v206, v206
    v_exp_f32 v207, v207
    v_exp_f32 v208, v208
    v_exp_f32 v209, v209
    v_smfmac_f32_32x32x32_bf16 v[32:47], v[100:103], v[200:207], v250
    v_exp_f32 v210, v210
    v_exp_f32 v211, v211
    v_exp_f32 v212, v212
    v_exp_f32 v213, v213
    v_mfma_f32_32x32x16_bf16 v[192:207], v[104:107], a[228:231], 0
    v_exp_f32 v214, v214
    v_exp_f32 v215, v215
    v_exp_f32 v216, v216
    v_exp_f32 v217, v217
    v_smfmac_f32_32x32x32_bf16 v[48:63], v[96:99], v[208:215], v250
    s_waitcnt vmcnt(0)
    v_cmp_ne_u64 vcc, s[32:33], v[10:11]
    s_nop 0
    s_and_b32 s19, vcc_lo, 0xc
    s_cbranch_scc1 ap_54
apok_55:
    s_xor_b32 s24, s69, 16384
    buffer_load_dwordx4 v[128:131], v248, s[4:7], s24 offen offset:0 sc1
    buffer_load_dwordx4 v[140:143], v248, s[4:7], s24 offen offset:2048 sc1
    s_mov_b64 exec, s[30:31]
    buffer_load_dwordx4 v[132:135], v249, s[4:7], s24 offen offset:1024 sc1
    buffer_load_dwordx4 v[136:139], v249, s[4:7], s24 offen offset:1536 sc1
    buffer_load_dwordx4 v[144:147], v249, s[4:7], s24 offen offset:3072 sc1
    buffer_load_dwordx4 v[148:151], v249, s[4:7], s24 offen offset:3584 sc1
    s_mov_b64 exec, -1
    v_exp_f32 v218, v218
    v_exp_f32 v219, v219
    v_exp_f32 v220, v220
    v_exp_f32 v221, v221
    v_exp_f32 v222, v222
    v_exp_f32 v223, v223
    v_exp_f32 v224, v224
    v_exp_f32 v225, v225
    v_smfmac_f32_32x32x32_bf16 v[48:63], v[100:103], v[216:223], v250
    v_exp_f32 v226, v226
    v_exp_f32 v227, v227
    v_exp_f32 v228, v228
    v_exp_f32 v229, v229
    v_mfma_f32_32x32x16_bf16 v[208:223], v[104:107], a[232:235], 0
    v_exp_f32 v230, v230
    v_exp_f32 v231, v231
    v_exp_f32 v232, v232
    v_exp_f32 v233, v233
    v_smfmac_f32_32x32x32_bf16 v[64:79], v[96:99], v[224:231], v250
    s_xor_b32 s24, s69, 24576
    buffer_load_dwordx4 v[152:155], v248, s[4:7], s24 offen offset:0 sc1
    buffer_load_dwordx4 v[164:167], v248, s[4:7], s24 offen offset:2048 sc1
    s_mov_b64 exec, s[30:31]
    buffer_load_dwordx4 v[156:159], v249, s[4:7], s24 offen offset:1024 sc1
    buffer_load_dwordx4 v[160:163], v249, s[4:7], s24 offen offset:1536 sc1
    buffer_load_dwordx4 v[168:171], v249, s[4:7], s24 offen offset:3072 sc1
    buffer_load_dwordx4 v[172:175], v249, s[4:7], s24 offen offset:3584 sc1
    s_mov_b64 exec, -1
    v_exp_f32 v234, v234
    v_exp_f32 v235, v235
    v_exp_f32 v236, v236
    v_exp_f32 v237, v237
    v_exp_f32 v238, v238
    v_exp_f32 v239, v239
    v_exp_f32 v176, v176
    v_exp_f32 v177, v177
    v_smfmac_f32_32x32x32_bf16 v[64:79], v[100:103], v[232:239], v250
    v_exp_f32 v178, v178
    v_exp_f32 v179, v179
    v_exp_f32 v180, v180
    v_exp_f32 v181, v181
    v_mfma_f32_32x32x16_bf16 v[224:239], v[104:107], a[236:239], 0
    v_exp_f32 v182, v182
    v_exp_f32 v183, v183
    v_exp_f32 v184, v184
    v_exp_f32 v185, v185
    v_smfmac_f32_32x32x32_bf16 v[16:31], v[108:111], v[176:183], v250
    v_exp_f32 v186, v186
    v_exp_f32 v187, v187
    v_exp_f32 v188, v188
    v_exp_f32 v189, v189
    v_exp_f32 v190, v190
    v_exp_f32 v191, v191
    v_exp_f32 v192, v192
    v_exp_f32 v193, v193
    v_smfmac_f32_32x32x32_bf16 v[16:31], v[112:115], v[184:191], v250
    v_exp_f32 v194, v194
    v_exp_f32 v195, v195
    v_exp_f32 v196, v196
    v_exp_f32 v197, v197
    v_mfma_f32_32x32x16_bf16 v[176:191], v[116:119], a[224:227], 0
    v_exp_f32 v198, v198
    v_exp_f32 v199, v199
    v_exp_f32 v200, v200
    v_exp_f32 v201, v201
    v_smfmac_f32_32x32x32_bf16 v[32:47], v[108:111], v[192:199], v250
    buffer_load_dwordx2 v[8:9], v253, s[4:7], s68 offen sc1
    s_getpc_b64 s[90:91]
pc_56:
    s_min_u32 s40, s85, L_end-pc_56-1024
    s_add_u32 s90, s90, s40
    s_addc_u32 s91, s91, 0
    global_load_dword v5, v1, s[90:91] offset:0
    v_exp_f32 v202, v202
    v_exp_f32 v203, v203
    v_exp_f32 v204, v204
    v_exp_f32 v205, v205
    v_exp_f32 v206, v206
    v_exp_f32 v207, v207
    v_exp_f32 v208, v208
    v_exp_f32 v209, v209
    v_smfmac_f32_32x32x32_bf16 v[32:47], v[112:115], v[200:207], v250
    v_exp_f32 v210, v210
    v_exp_f32 v211, v211
    v_exp_f32 v212, v212
    v_exp_f32 v213, v213
    v_mfma_f32_32x32x16_bf16 v[192:207], v[116:119], a[228:231], 0
    v_exp_f32 v214, v214
    v_exp_f32 v215, v215
    v_exp_f32 v216, v216
    v_exp_f32 v217, v217
    v_smfmac_f32_32x32x32_bf16 v[48:63], v[108:111], v[208:215], v250
    v_exp_f32 v218, v218
    v_exp_f32 v219, v219
    v_exp_f32 v220, v220
    v_exp_f32 v221, v221
    v_exp_f32 v222, v222
    v_exp_f32 v223, v223
    v_exp_f32 v224, v224
    v_exp_f32 v225, v225
    v_smfmac_f32_32x32x32_bf16 v[48:63], v[112:115], v[216:223], v250
    v_exp_f32 v226, v226
    v_exp_f32 v227, v227
    v_exp_f32 v228, v228
    v_exp_f32 v229, v229
    v_mfma_f32_32x32x16_bf16 v[208:223], v[116:119], a[232:235], 0
    v_exp_f32 v230, v230
    v_exp_f32 v231, v231
    v_exp_f32 v232, v232
    v_exp_f32 v233, v233
    v_smfmac_f32_32x32x32_bf16 v[64:79], v[108:111], v[224:231], v250
    v_exp_f32 v234, v234
    v_exp_f32 v235, v235
    v_exp_f32 v236, v236
    v_exp_f32 v237, v237
    v_exp_f32 v238, v238
    v_exp_f32 v239, v239
    v_exp_f32 v176, v176
    v_exp_f32 v177, v177
    v_smfmac_f32_32x32x32_bf16 v[64:79], v[112:115], v[232:239], v250
    v_exp_f32 v178, v178
    v_exp_f32 v179, v179
    v_exp_f32 v180, v180
    v_exp_f32 v181, v181
    v_mfma_f32_32x32x16_bf16 v[224:239], v[116:119], a[236:239], 0
    v_exp_f32 v182, v182
    v_exp_f32 v183, v183
    v_exp_f32 v184, v184
    v_exp_f32 v185, v185
    v_smfmac_f32_32x32x32_bf16 v[16:31], v[120:123], v[176:183], v250
    s_waitcnt vmcnt(1)
    v_cmp_ne_u64 vcc, s[32:33], v[8:9]
    s_nop 0
    s_and_b32 s19, vcc_lo, 0xf0
    s_cbranch_scc1 ap_57
apok_58:
    s_xor_b32 s24, s69, 32768
    buffer_load_dwordx4 v[80:83], v248, s[4:7], s24 offen offset:0 sc1
    buffer_load_dwordx4 v[92:95], v248, s[4:7], s24 offen offset:2048 sc1
    s_mov_b64 exec, s[30:31]
    buffer_load_dwordx4 v[84:87], v249, s[4:7], s24 offen offset:1024 sc1
    buffer_load_dwordx4 v[88:91], v249, s[4:7], s24 offen offset:1536 sc1
    buffer_load_dwordx4 v[96:99], v249, s[4:7], s24 offen offset:3072 sc1
    buffer_load_dwordx4 v[100:103], v249, s[4:7], s24 offen offset:3584 sc1
    s_mov_b64 exec, -1
    v_exp_f32 v186, v186
    v_exp_f32 v187, v187
    v_exp_f32 v188, v188
    v_exp_f32 v189, v189
    v_exp_f32 v190, v190
    v_exp_f32 v191, v191
    v_exp_f32 v192, v192
    v_exp_f32 v193, v193
    v_smfmac_f32_32x32x32_bf16 v[16:31], v[124:127], v[184:191], v250
    v_exp_f32 v194, v194
    v_exp_f32 v195, v195
    v_exp_f32 v196, v196
    v_exp_f32 v197, v197
    v_mfma_f32_32x32x16_bf16 v[176:191], v[128:131], a[224:227], 0
    v_exp_f32 v198, v198
    v_exp_f32 v199, v199
    v_exp_f32 v200, v200
    v_exp_f32 v201, v201
    v_smfmac_f32_32x32x32_bf16 v[32:47], v[120:123], v[192:199], v250
    v_exp_f32 v202, v202
    v_exp_f32 v203, v203
    v_exp_f32 v204, v204
    v_exp_f32 v205, v205
    v_exp_f32 v206, v206
    v_exp_f32 v207, v207
    v_exp_f32 v208, v208
    v_exp_f32 v209, v209
    v_smfmac_f32_32x32x32_bf16 v[32:47], v[124:127], v[200:207], v250
    v_exp_f32 v210, v210
    v_exp_f32 v211, v211
    v_exp_f32 v212, v212
    v_exp_f32 v213, v213
    v_mfma_f32_32x32x16_bf16 v[192:207], v[128:131], a[228:231], 0
    v_exp_f32 v214, v214
    v_exp_f32 v215, v215
    v_exp_f32 v216, v216
    v_exp_f32 v217, v217
    v_smfmac_f32_32x32x32_bf16 v[48:63], v[120:123], v[208:215], v250
    v_exp_f32 v218, v218
    v_exp_f32 v219, v219
    v_exp_f32 v220, v220
    v_exp_f32 v221, v221
    v_exp_f32 v222, v222
    v_exp_f32 v223, v223
    v_exp_f32 v224, v224
    v_exp_f32 v225, v225
    v_smfmac_f32_32x32x32_bf16 v[48:63], v[124:127], v[216:223], v250
    v_exp_f32 v226, v226
    v_exp_f32 v227, v227
    v_exp_f32 v228, v228
    v_exp_f32 v229, v229
    v_mfma_f32_32x32x16_bf16 v[208:223], v[128:131], a[232:235], 0
    v_exp_f32 v230, v230
    v_exp_f32 v231, v231
    v_exp_f32 v232, v232
    v_exp_f32 v233, v233
    v_smfmac_f32_32x32x32_bf16 v[64:79], v[120:123], v[224:231], v250
    v_exp_f32 v234, v234
    v_exp_f32 v235, v235
    v_exp_f32 v236, v236
    v_exp_f32 v237, v237
    v_exp_f32 v238, v238
    v_exp_f32 v239, v239
    v_exp_f32 v176, v176
    v_exp_f32 v177, v177
    v_smfmac_f32_32x32x32_bf16 v[64:79], v[124:127], v[232:239], v250
    v_exp_f32 v178, v178
    v_exp_f32 v179, v179
    v_exp_f32 v180, v180
    v_exp_f32 v181, v181
    v_mfma_f32_32x32x16_bf16 v[224:239], v[128:131], a[236:239], 0
    v_exp_f32 v182, v182
    v_exp_f32 v183, v183
    v_exp_f32 v184, v184
    v_exp_f32 v185, v185
    v_smfmac_f32_32x32x32_bf16 v[16:31], v[132:135], v[176:183], v250
    s_xor_b32 s24, s69, 40960
    buffer_load_dwordx4 v[104:107], v248, s[4:7], s24 offen offset:0 sc1
    buffer_load_dwordx4 v[116:119], v248, s[4:7], s24 offen offset:2048 sc1
    s_mov_b64 exec, s[30:31]
    buffer_load_dwordx4 v[108:111], v249, s[4:7], s24 offen offset:1024 sc1
    buffer_load_dwordx4 v[112:115], v249, s[4:7], s24 offen offset:1536 sc1
    buffer_load_dwordx4 v[120:123], v249, s[4:7], s24 offen offset:3072 sc1
    buffer_load_dwordx4 v[124:127], v249, s[4:7], s24 offen offset:3584 sc1
    s_mov_b64 exec, -1
    v_exp_f32 v186, v186
    v_exp_f32 v187, v187
    v_exp_f32 v188, v188
    v_exp_f32 v189, v189
    v_exp_f32 v190, v190
    v_exp_f32 v191, v191
    v_exp_f32 v192, v192
    v_exp_f32 v193, v193
    v_smfmac_f32_32x32x32_bf16 v[16:31], v[136:139], v[184:191], v250
    v_exp_f32 v194, v194
    v_exp_f32 v195, v195
    v_exp_f32 v196, v196
    v_exp_f32 v197, v197
    v_mfma_f32_32x32x16_bf16 v[176:191], v[140:143], a[224:227], 0
    v_exp_f32 v198, v198
    v_exp_f32 v199, v199
    v_exp_f32 v200, v200
    v_exp_f32 v201, v201
    v_smfmac_f32_32x32x32_bf16 v[32:47], v[132:135], v[192:199], v250
    v_exp_f32 v202, v202
    v_exp_f32 v203, v203
    v_exp_f32 v204, v204
    v_exp_f32 v205, v205
    v_exp_f32 v206, v206
    v_exp_f32 v207, v207
    v_exp_f32 v208, v208
    v_exp_f32 v209, v209
    v_smfmac_f32_32x32x32_bf16 v[32:47], v[136:139], v[200:207], v250
    v_exp_f32 v210, v210
    v_exp_f32 v211, v211
    v_exp_f32 v212, v212
    v_exp_f32 v213, v213
    v_mfma_f32_32x32x16_bf16 v[192:207], v[140:143], a[228:231], 0
    v_exp_f32 v214, v214
    v_exp_f32 v215, v215
    v_exp_f32 v216, v216
    v_exp_f32 v217, v217
    v_smfmac_f32_32x32x32_bf16 v[48:63], v[132:135], v[208:215], v250
    v_exp_f32 v218, v218
    v_exp_f32 v219, v219
    v_exp_f32 v220, v220
    v_exp_f32 v221, v221
    v_exp_f32 v222, v222
    v_exp_f32 v223, v223
    v_exp_f32 v224, v224
    v_exp_f32 v225, v225
    v_smfmac_f32_32x32x32_bf16 v[48:63], v[136:139], v[216:223], v250
    v_exp_f32 v226, v226
    v_exp_f32 v227, v227
    v_exp_f32 v228, v228
    v_exp_f32 v229, v229
    v_mfma_f32_32x32x16_bf16 v[208:223], v[140:143], a[232:235], 0
    v_exp_f32 v230, v230
    v_exp_f32 v231, v231
    v_exp_f32 v232, v232
    v_exp_f32 v233, v233
    v_smfmac_f32_32x32x32_bf16 v[64:79], v[132:135], v[224:231], v250
    v_exp_f32 v234, v234
    v_exp_f32 v235, v235
    v_exp_f32 v236, v236
    v_exp_f32 v237, v237
    v_exp_f32 v238, v238
    v_exp_f32 v239, v239
    v_exp_f32 v176, v176
    v_exp_f32 v177, v177
    v_smfmac_f32_32x32x32_bf16 v[64:79], v[136:139], v[232:239], v250
    v_exp_f32 v178, v178
    v_exp_f32 v179, v179
    v_exp_f32 v180, v180
    v_exp_f32 v181, v181
    v_mfma_f32_32x32x16_bf16 v[224:239], v[140:143], a[236:239], 0
    v_exp_f32 v182, v182
    v_exp_f32 v183, v183
    v_exp_f32 v184, v184
    v_exp_f32 v185, v185
    v_smfmac_f32_32x32x32_bf16 v[16:31], v[144:147], v[176:183], v250
    v_exp_f32 v186, v186
    v_exp_f32 v187, v187
    v_exp_f32 v188, v188
    v_exp_f32 v189, v189
    v_exp_f32 v190, v190
    v_exp_f32 v191, v191
    v_exp_f32 v192, v192
    v_exp_f32 v193, v193
    v_smfmac_f32_32x32x32_bf16 v[16:31], v[148:151], v[184:191], v250
    v_exp_f32 v194, v194
    v_exp_f32 v195, v195
    v_exp_f32 v196, v196
    v_exp_f32 v197, v197
    v_mfma_f32_32x32x16_bf16 v[176:191], v[152:155], a[224:227], 0
    v_exp_f32 v198, v198
    v_exp_f32 v199, v199
    v_exp_f32 v200, v200
    v_exp_f32 v201, v201
    v_smfmac_f32_32x32x32_bf16 v[32:47], v[144:147], v[192:199], v250
    v_exp_f32 v202, v202
    v_exp_f32 v203, v203
    v_exp_f32 v204, v204
    v_exp_f32 v205, v205
    v_exp_f32 v206, v206
    v_exp_f32 v207, v207
    v_exp_f32 v208, v208
    v_exp_f32 v209, v209
    v_smfmac_f32_32x32x32_bf16 v[32:47], v[148:151], v[200:207], v250
    v_exp_f32 v210, v210
    v_exp_f32 v211, v211
    v_exp_f32 v212, v212
    v_exp_f32 v213, v213
    v_mfma_f32_32x32x16_bf16 v[192:207], v[152:155], a[228:231], 0
    v_exp_f32 v214, v214
    v_exp_f32 v215, v215
    v_exp_f32 v216, v216
    v_exp_f32 v217, v217
    v_smfmac_f32_32x32x32_bf16 v[48:63], v[144:147], v[208:215], v250
    v_exp_f32 v218, v218
    v_exp_f32 v219, v219
    v_exp_f32 v220, v220
    v_exp_f32 v221, v221
    v_exp_f32 v222, v222
    v_exp_f32 v223, v223
    v_exp_f32 v224, v224
    v_exp_f32 v225, v225
    v_smfmac_f32_32x32x32_bf16 v[48:63], v[148:151], v[216:223], v250
    v_exp_f32 v226, v226
    v_exp_f32 v227, v227
    v_exp_f32 v228, v228
    v_exp_f32 v229, v229
    v_mfma_f32_32x32x16_bf16 v[208:223], v[152:155], a[232:235], 0
    v_exp_f32 v230, v230
    v_exp_f32 v231, v231
    v_exp_f32 v232, v232
    v_exp_f32 v233, v233
    v_smfmac_f32_32x32x32_bf16 v[64:79], v[144:147], v[224:231], v250
    v_exp_f32 v234, v234
    v_exp_f32 v235, v235
    v_exp_f32 v236, v236
    v_exp_f32 v237, v237
    v_exp_f32 v238, v238
    v_exp_f32 v239, v239
    v_exp_f32 v176, v176
    v_exp_f32 v177, v177
    v_smfmac_f32_32x32x32_bf16 v[64:79], v[148:151], v[232:239], v250
    v_exp_f32 v178, v178
    v_exp_f32 v179, v179
    v_exp_f32 v180, v180
    v_exp_f32 v181, v181
    v_mfma_f32_32x32x16_bf16 v[224:239], v[152:155], a[236:239], 0
    v_exp_f32 v182, v182
    v_exp_f32 v183, v183
    v_exp_f32 v184, v184
    v_exp_f32 v185, v185
    v_smfmac_f32_32x32x32_bf16 v[16:31], v[156:159], v[176:183], v250
    s_xor_b32 s24, s69, 49152
    buffer_load_dwordx4 v[128:131], v248, s[4:7], s24 offen offset:0 sc1
    buffer_load_dwordx4 v[140:143], v248, s[4:7], s24 offen offset:2048 sc1
    s_mov_b64 exec, s[30:31]
    buffer_load_dwordx4 v[132:135], v249, s[4:7], s24 offen offset:1024 sc1
    buffer_load_dwordx4 v[136:139], v249, s[4:7], s24 offen offset:1536 sc1
    buffer_load_dwordx4 v[144:147], v249, s[4:7], s24 offen offset:3072 sc1
    buffer_load_dwordx4 v[148:151], v249, s[4:7], s24 offen offset:3584 sc1
    s_mov_b64 exec, -1
    v_exp_f32 v186, v186
    v_exp_f32 v187, v187
    v_exp_f32 v188, v188
    v_exp_f32 v189, v189
    v_exp_f32 v190, v190
    v_exp_f32 v191, v191
    v_exp_f32 v192, v192
    v_exp_f32 v193, v193
    v_smfmac_f32_32x32x32_bf16 v[16:31], v[160:163], v[184:191], v250
    v_exp_f32 v194, v194
    v_exp_f32 v195, v195
    v_exp_f32 v196, v196
    v_exp_f32 v197, v197
    v_mfma_f32_32x32x16_bf16 v[176:191], v[164:167], a[224:227], 0
    v_exp_f32 v198, v198
    v_exp_f32 v199, v199
    v_exp_f32 v200, v200
    v_exp_f32 v201, v201
    v_smfmac_f32_32x32x32_bf16 v[32:47], v[156:159], v[192:199], v250
    v_exp_f32 v202, v202
    v_exp_f32 v203, v203
    v_exp_f32 v204, v204
    v_exp_f32 v205, v205
    v_exp_f32 v206, v206
    v_exp_f32 v207, v207
    v_exp_f32 v208, v208
    v_exp_f32 v209, v209
    v_smfmac_f32_32x32x32_bf16 v[32:47], v[160:163], v[200:207], v250
    v_exp_f32 v210, v210
    v_exp_f32 v211, v211
    v_exp_f32 v212, v212
    v_exp_f32 v213, v213
    v_mfma_f32_32x32x16_bf16 v[192:207], v[164:167], a[228:231], 0
    v_exp_f32 v214, v214
    v_exp_f32 v215, v215
    v_exp_f32 v216, v216
    v_exp_f32 v217, v217
    v_smfmac_f32_32x32x32_bf16 v[48:63], v[156:159], v[208:215], v250
    v_exp_f32 v218, v218
    v_exp_f32 v219, v219
    v_exp_f32 v220, v220
    v_exp_f32 v221, v221
    v_exp_f32 v222, v222
    v_exp_f32 v223, v223
    v_exp_f32 v224, v224
    v_exp_f32 v225, v225
    v_smfmac_f32_32x32x32_bf16 v[48:63], v[160:163], v[216:223], v250
    v_exp_f32 v226, v226
    v_exp_f32 v227, v227
    v_exp_f32 v228, v228
    v_exp_f32 v229, v229
    v_mfma_f32_32x32x16_bf16 v[208:223], v[164:167], a[232:235], 0
    v_exp_f32 v230, v230
    v_exp_f32 v231, v231
    v_exp_f32 v232, v232
    v_exp_f32 v233, v233
    v_smfmac_f32_32x32x32_bf16 v[64:79], v[156:159], v[224:231], v250
    v_exp_f32 v234, v234
    v_exp_f32 v235, v235
    v_exp_f32 v236, v236
    v_exp_f32 v237, v237
    v_exp_f32 v238, v238
    v_exp_f32 v239, v239
    v_exp_f32 v176, v176
    v_exp_f32 v177, v177
    v_smfmac_f32_32x32x32_bf16 v[64:79], v[160:163], v[232:239], v250
    v_exp_f32 v178, v178
    v_exp_f32 v179, v179
    v_exp_f32 v180, v180
    v_exp_f32 v181, v181
    v_mfma_f32_32x32x16_bf16 v[224:239], v[164:167], a[236:239], 0
    v_exp_f32 v182, v182
    v_exp_f32 v183, v183
    v_exp_f32 v184, v184
    v_exp_f32 v185, v185
    v_smfmac_f32_32x32x32_bf16 v[16:31], v[168:171], v[176:183], v250
    v_exp_f32 v186, v186
    v_exp_f32 v187, v187
    v_exp_f32 v188, v188
    v_exp_f32 v189, v189
    v_exp_f32 v190, v190
    v_exp_f32 v191, v191
    v_exp_f32 v192, v192
    v_exp_f32 v193, v193
    v_smfmac_f32_32x32x32_bf16 v[16:31], v[172:175], v[184:191], v250
    v_exp_f32 v194, v194
    v_exp_f32 v195, v195
    v_exp_f32 v196, v196
    v_exp_f32 v197, v197
    s_waitcnt vmcnt(12)
    v_mfma_f32_32x32x16_bf16 v[176:191], v[80:83], a[224:227], 0
    v_exp_f32 v198, v198
    v_exp_f32 v199, v199
    v_exp_f32 v200, v200
    v_exp_f32 v201, v201
    v_smfmac_f32_32x32x32_bf16 v[32:47], v[168:171], v[192:199], v250
    v_exp_f32 v202, v202
    v_exp_f32 v203, v203
    v_exp_f32 v204, v204
    v_exp_f32 v205, v205
    v_exp_f32 v206, v206
    v_exp_f32 v207, v207
    v_exp_f32 v208, v208
    v_exp_f32 v209, v209
    v_smfmac_f32_32x32x32_bf16 v[32:47], v[172:175], v[200:207], v250
    v_exp_f32 v210, v210
    v_exp_f32 v211, v211
    v_exp_f32 v212, v212
    v_exp_f32 v213, v213
    v_mfma_f32_32x32x16_bf16 v[192:207], v[80:83], a[228:231], 0
    v_exp_f32 v214, v214
    v_exp_f32 v215, v215
    v_exp_f32 v216, v216
    v_exp_f32 v217, v217
    v_smfmac_f32_32x32x32_bf16 v[48:63], v[168:171], v[208:215], v250
    v_exp_f32 v218, v218
    v_exp_f32 v219, v219
    v_exp_f32 v220, v220
    v_exp_f32 v221, v221
    v_exp_f32 v222, v222
    v_exp_f32 v223, v223
    v_exp_f32 v224, v224
    v_exp_f32 v225, v225
    v_smfmac_f32_32x32x32_bf16 v[48:63], v[172:175], v[216:223], v250
    v_exp_f32 v226, v226
    v_exp_f32 v227, v227
    v_exp_f32 v228, v228
    v_exp_f32 v229, v229
    v_mfma_f32_32x32x16_bf16 v[208:223], v[80:83], a[232:235], 0
    v_exp_f32 v230, v230
    v_exp_f32 v231, v231
    v_exp_f32 v232, v232
    v_exp_f32 v233, v233
    v_smfmac_f32_32x32x32_bf16 v[64:79], v[168:171], v[224:231], v250
    v_exp_f32 v234, v234
    v_exp_f32 v235, v235
    v_exp_f32 v236, v236
    v_exp_f32 v237, v237
    v_exp_f32 v238, v238
    v_exp_f32 v239, v239
    v_exp_f32 v176, v176
    v_exp_f32 v177, v177
    v_smfmac_f32_32x32x32_bf16 v[64:79], v[172:175], v[232:239], v250
    v_exp_f32 v178, v178
    v_exp_f32 v179, v179
    v_exp_f32 v180, v180
    v_exp_f32 v181, v181
    v_mfma_f32_32x32x16_bf16 v[224:239], v[80:83], a[236:239], 0
    v_exp_f32 v182, v182
    v_exp_f32 v183, v183
    v_exp_f32 v184, v184
    v_exp_f32 v185, v185
    v_smfmac_f32_32x32x32_bf16 v[16:31], v[84:87], v[176:183], v250
    s_xor_b32 s24, s69, 57344
    buffer_load_dwordx4 v[152:155], v248, s[4:7], s24 offen offset:0 sc1
    buffer_load_dwordx4 v[164:167], v248, s[4:7], s24 offen offset:2048 sc1
    s_mov_b64 exec, s[30:31]
    buffer_load_dwordx4 v[156:159], v249, s[4:7], s24 offen offset:1024 sc1
    buffer_load_dwordx4 v[160:163], v249, s[4:7], s24 offen offset:1536 sc1
    buffer_load_dwordx4 v[168:171], v249, s[4:7], s24 offen offset:3072 sc1
    buffer_load_dwordx4 v[172:175], v249, s[4:7], s24 offen offset:3584 sc1
    s_mov_b64 exec, -1
    v_exp_f32 v186, v186
    v_exp_f32 v187, v187
    v_exp_f32 v188, v188
    v_exp_f32 v189, v189
    v_exp_f32 v190, v190
    v_exp_f32 v191, v191
    v_exp_f32 v192, v192
    v_exp_f32 v193, v193
    v_smfmac_f32_32x32x32_bf16 v[16:31], v[88:91], v[184:191], v250
    v_exp_f32 v194, v194
    v_exp_f32 v195, v195
    v_exp_f32 v196, v196
    v_exp_f32 v197, v197
    v_mfma_f32_32x32x16_bf16 v[176:191], v[92:95], a[224:227], 0
    v_exp_f32 v198, v198
    v_exp_f32 v199, v199
    v_exp_f32 v200, v200
    v_exp_f32 v201, v201
    v_smfmac_f32_32x32x32_bf16 v[32:47], v[84:87], v[192:199], v250
    v_exp_f32 v202, v202
    v_exp_f32 v203, v203
    v_exp_f32 v204, v204
    v_exp_f32 v205, v205
    v_exp_f32 v206, v206
    v_exp_f32 v207, v207
    v_exp_f32 v208, v208
    v_exp_f32 v209, v209
    v_smfmac_f32_32x32x32_bf16 v[32:47], v[88:91], v[200:207], v250
    v_exp_f32 v210, v210
    v_exp_f32 v211, v211
    v_exp_f32 v212, v212
    v_exp_f32 v213, v213
    v_mfma_f32_32x32x16_bf16 v[192:207], v[92:95], a[228:231], 0
    v_exp_f32 v214, v214
    v_exp_f32 v215, v215
    v_exp_f32 v216, v216
    v_exp_f32 v217, v217
    v_smfmac_f32_32x32x32_bf16 v[48:63], v[84:87], v[208:215], v250
    v_exp_f32 v218, v218
    v_exp_f32 v219, v219
    v_exp_f32 v220, v220
    v_exp_f32 v221, v221
    v_exp_f32 v222, v222
    v_exp_f32 v223, v223
    v_exp_f32 v224, v224
    v_exp_f32 v225, v225
    v_smfmac_f32_32x32x32_bf16 v[48:63], v[88:91], v[216:223], v250
    v_exp_f32 v226, v226
    v_exp_f32 v227, v227
    v_exp_f32 v228, v228
    v_exp_f32 v229, v229
    v_mfma_f32_32x32x16_bf16 v[208:223], v[92:95], a[232:235], 0
    v_exp_f32 v230, v230
    v_exp_f32 v231, v231
    v_exp_f32 v232, v232
    v_exp_f32 v233, v233
    v_smfmac_f32_32x32x32_bf16 v[64:79], v[84:87], v[224:231], v250
    buffer_load_dwordx2 v[8:9], v253, s[4:7], s68 offen sc1
    v_exp_f32 v234, v234
    v_exp_f32 v235, v235
    v_exp_f32 v236, v236
    v_exp_f32 v237, v237
    v_exp_f32 v238, v238
    v_exp_f32 v239, v239
    v_exp_f32 v176, v176
    v_exp_f32 v177, v177
    v_smfmac_f32_32x32x32_bf16 v[64:79], v[88:91], v[232:239], v250
    v_exp_f32 v178, v178
    v_exp_f32 v179, v179
    v_exp_f32 v180, v180
    v_exp_f32 v181, v181
    v_mfma_f32_32x32x16_bf16 v[224:239], v[92:95], a[236:239], 0
    v_exp_f32 v182, v182
    v_exp_f32 v183, v183
    v_exp_f32 v184, v184
    v_exp_f32 v185, v185
    v_smfmac_f32_32x32x32_bf16 v[16:31], v[96:99], v[176:183], v250
    v_exp_f32 v186, v186
    v_exp_f32 v187, v187
    v_exp_f32 v188, v188
    v_exp_f32 v189, v189
    v_exp_f32 v190, v190
    v_exp_f32 v191, v191
    v_exp_f32 v192, v192
    v_exp_f32 v193, v193
    v_smfmac_f32_32x32x32_bf16 v[16:31], v[100:103], v[184:191], v250
    v_exp_f32 v194, v194
    v_exp_f32 v195, v195
    v_exp_f32 v196, v196
    v_exp_f32 v197, v197
    s_waitcnt vmcnt(13)
    v_mfma_f32_32x32x16_bf16 v[176:191], v[104:107], a[224:227], 0
    v_exp_f32 v198, v198
    v_exp_f32 v199, v199
    v_exp_f32 v200, v200
    v_exp_f32 v201, v201
    v_smfmac_f32_32x32x32_bf16 v[32:47], v[96:99], v[192:199], v250
    v_exp_f32 v202, v202
    v_exp_f32 v203, v203
    v_exp_f32 v204, v204
    v_exp_f32 v205, v205
    v_exp_f32 v206, v206
    v_exp_f32 v207, v207
    v_exp_f32 v208, v208
    v_exp_f32 v209, v209
    v_smfmac_f32_32x32x32_bf16 v[32:47], v[100:103], v[200:207], v250
    v_exp_f32 v210, v210
    v_exp_f32 v211, v211
    v_exp_f32 v212, v212
    v_exp_f32 v213, v213
    v_mfma_f32_32x32x16_bf16 v[192:207], v[104:107], a[228:231], 0
    v_exp_f32 v214, v214
    v_exp_f32 v215, v215
    v_exp_f32 v216, v216
    v_exp_f32 v217, v217
    v_smfmac_f32_32x32x32_bf16 v[48:63], v[96:99], v[208:215], v250
    v_exp_f32 v218, v218
    v_exp_f32 v219, v219
    v_exp_f32 v220, v220
    v_exp_f32 v221, v221
    v_exp_f32 v222, v222
    v_exp_f32 v223, v223
    v_exp_f32 v224, v224
    v_exp_f32 v225, v225
    v_smfmac_f32_32x32x32_bf16 v[48:63], v[100:103], v[216:223], v250
    v_exp_f32 v226, v226
    v_exp_f32 v227, v227
    v_exp_f32 v228, v228
    v_exp_f32 v229, v229
    v_mfma_f32_32x32x16_bf16 v[208:223], v[104:107], a[232:235], 0
    v_exp_f32 v230, v230
    v_exp_f32 v231, v231
    v_exp_f32 v232, v232
    v_exp_f32 v233, v233
    v_smfmac_f32_32x32x32_bf16 v[64:79], v[96:99], v[224:231], v250
    v_exp_f32 v234, v234
    v_exp_f32 v235, v235
    v_exp_f32 v236, v236
    v_exp_f32 v237, v237
    v_exp_f32 v238, v238
    v_exp_f32 v239, v239
    v_exp_f32 v176, v176
    v_exp_f32 v177, v177
    v_smfmac_f32_32x32x32_bf16 v[64:79], v[100:103], v[232:239], v250
    v_exp_f32 v178, v178
    v_exp_f32 v179, v179
    v_exp_f32 v180, v180
    v_exp_f32 v181, v181
    v_mfma_f32_32x32x16_bf16 v[224:239], v[104:107], a[236:239], 0
    v_exp_f32 v182, v182
    v_exp_f32 v183, v183
    v_exp_f32 v184, v184
    v_exp_f32 v185, v185
    v_smfmac_f32_32x32x32_bf16 v[16:31], v[108:111], v[176:183], v250
    s_waitcnt vmcnt(0)
    v_cmp_ne_u64 vcc, s[32:33], v[8:9]
    s_nop 0
    s_cbranch_vccnz ap_59
apok_60:
    s_xor_b32 s24, s69, 65536
    buffer_load_dwordx4 v[80:83], v248, s[4:7], s24 offen offset:0 sc1
    buffer_load_dwordx4 v[92:95], v248, s[4:7], s24 offen offset:2048 sc1
    s_mov_b64 exec, s[30:31]
    buffer_load_dwordx4 v[84:87], v249, s[4:7], s24 offen offset:1024 sc1
    buffer_load_dwordx4 v[88:91], v249, s[4:7], s24 offen offset:1536 sc1
    buffer_load_dwordx4 v[96:99], v249, s[4:7], s24 offen offset:3072 sc1
    buffer_load_dwordx4 v[100:103], v249, s[4:7], s24 offen offset:3584 sc1
    s_mov_b64 exec, -1
    v_exp_f32 v186, v186
    v_exp_f32 v187, v187
    v_exp_f32 v188, v188
    v_exp_f32 v189, v189
    v_exp_f32 v190, v190
    v_exp_f32 v191, v191
    v_exp_f32 v192, v192
    v_exp_f32 v193, v193
    v_smfmac_f32_32x32x32_bf16 v[16:31], v[112:115], v[184:191], v250
    v_exp_f32 v194, v194
    v_exp_f32 v195, v195
    v_exp_f32 v196, v196
    v_exp_f32 v197, v197
    v_mfma_f32_32x32x16_bf16 v[176:191], v[116:119], a[224:227], 0
    v_exp_f32 v198, v198
    v_exp_f32 v199, v199
    v_exp_f32 v200, v200
    v_exp_f32 v201, v201
    v_smfmac_f32_32x32x32_bf16 v[32:47], v[108:111], v[192:199], v250
    v_exp_f32 v202, v202
    v_exp_f32 v203, v203
    v_exp_f32 v204, v204
    v_exp_f32 v205, v205
    v_exp_f32 v206, v206
    v_exp_f32 v207, v207
    v_exp_f32 v208, v208
    v_exp_f32 v209, v209
    v_smfmac_f32_32x32x32_bf16 v[32:47], v[112:115], v[200:207], v250
    v_exp_f32 v210, v210
    v_exp_f32 v211, v211
    v_exp_f32 v212, v212
    v_exp_f32 v213, v213
    v_mfma_f32_32x32x16_bf16 v[192:207], v[116:119], a[228:231], 0
    v_exp_f32 v214, v214
    v_exp_f32 v215, v215
    v_exp_f32 v216, v216
    v_exp_f32 v217, v217
    v_smfmac_f32_32x32x32_bf16 v[48:63], v[108:111], v[208:215], v250
    v_exp_f32 v218, v218
    v_exp_f32 v219, v219
    v_exp_f32 v220, v220
    v_exp_f32 v221, v221
    v_exp_f32 v222, v222
    v_exp_f32 v223, v223
    v_exp_f32 v224, v224
    v_exp_f32 v225, v225
    v_smfmac_f32_32x32x32_bf16 v[48:63], v[112:115], v[216:223], v250
    v_exp_f32 v226, v226
    v_exp_f32 v227, v227
    v_exp_f32 v228, v228
    v_exp_f32 v229, v229
    v_mfma_f32_32x32x16_bf16 v[208:223], v[116:119], a[232:235], 0
    v_exp_f32 v230, v230
    v_exp_f32 v231, v231
    v_exp_f32 v232, v232
    v_exp_f32 v233, v233
    v_smfmac_f32_32x32x32_bf16 v[64:79], v[108:111], v[224:231], v250
    v_exp_f32 v234, v234
    v_exp_f32 v235, v235
    v_exp_f32 v236, v236
    v_exp_f32 v237, v237
    v_exp_f32 v238, v238
    v_exp_f32 v239, v239
    v_exp_f32 v176, v176
    v_exp_f32 v177, v177
    v_smfmac_f32_32x32x32_bf16 v[64:79], v[112:115], v[232:239], v250
    v_exp_f32 v178, v178
    v_exp_f32 v179, v179
    v_exp_f32 v180, v180
    v_exp_f32 v181, v181
    v_mfma_f32_32x32x16_bf16 v[224:239], v[116:119], a[236:239], 0
    v_exp_f32 v182, v182
    v_exp_f32 v183, v183
    v_exp_f32 v184, v184
    v_exp_f32 v185, v185
    v_smfmac_f32_32x32x32_bf16 v[16:31], v[120:123], v[176:183], v250
    s_add_u32 m0, s97, 0
    s_add_u32 s21, s36, s97
    buffer_load_dwordx4 v1, s[4:7], s21 offen offset:0 sc1 lds
    buffer_load_dwordx4 v1, s[4:7], s21 offen offset:1024 sc1 lds
    buffer_load_dwordx4 v1, s[4:7], s21 offen offset:2048 sc1 lds
    buffer_load_dwordx4 v1, s[4:7], s21 offen offset:3072 sc1 lds
    v_exp_f32 v186, v186
    v_exp_f32 v187, v187
    v_exp_f32 v188, v188
    v_exp_f32 v189, v189
    v_exp_f32 v190, v190
    v_exp_f32 v191, v191
    v_exp_f32 v192, v192
    v_exp_f32 v193, v193
    v_smfmac_f32_32x32x32_bf16 v[16:31], v[124:127], v[184:191], v250
    v_exp_f32 v194, v194
    v_exp_f32 v195, v195
    v_exp_f32 v196, v196
    v_exp_f32 v197, v197
    v_mfma_f32_32x32x16_bf16 v[176:191], v[128:131], a[224:227], 0
    v_exp_f32 v198, v198
    v_exp_f32 v199, v199
    v_exp_f32 v200, v200
    v_exp_f32 v201, v201
    v_smfmac_f32_32x32x32_bf16 v[32:47], v[120:123], v[192:199], v250
    v_exp_f32 v202, v202
    v_exp_f32 v203, v203
    v_exp_f32 v204, v204
    v_exp_f32 v205, v205
    v_exp_f32 v206, v206
    v_exp_f32 v207, v207
    v_exp_f32 v208, v208
    v_exp_f32 v209, v209
    v_smfmac_f32_32x32x32_bf16 v[32:47], v[124:127], v[200:207], v250
    v_exp_f32 v210, v210
    v_exp_f32 v211, v211
    v_exp_f32 v212, v212
    v_exp_f32 v213, v213
    v_mfma_f32_32x32x16_bf16 v[192:207], v[128:131], a[228:231], 0
    v_exp_f32 v214, v214
    v_exp_f32 v215, v215
    v_exp_f32 v216, v216
    v_exp_f32 v217, v217
    v_smfmac_f32_32x32x32_bf16 v[48:63], v[120:123], v[208:215], v250
    v_exp_f32 v218, v218
    v_exp_f32 v219, v219
    v_exp_f32 v220, v220
    v_exp_f32 v221, v221
    v_exp_f32 v222, v222
    v_exp_f32 v223, v223
    v_exp_f32 v224, v224
    v_exp_f32 v225, v225
    v_smfmac_f32_32x32x32_bf16 v[48:63], v[124:127], v[216:223], v250
    v_exp_f32 v226, v226
    v_exp_f32 v227, v227
    v_exp_f32 v228, v228
    v_exp_f32 v229, v229
    v_mfma_f32_32x32x16_bf16 v[208:223], v[128:131], a[232:235], 0
    v_exp_f32 v230, v230
    v_exp_f32 v231, v231
    v_exp_f32 v232, v232
    v_exp_f32 v233, v233
    v_smfmac_f32_32x32x32_bf16 v[64:79], v[120:123], v[224:231], v250
    v_exp_f32 v234, v234
    v_exp_f32 v235, v235
    v_exp_f32 v236, v236
    v_exp_f32 v237, v237
    v_exp_f32 v238, v238
    v_exp_f32 v239, v239
    v_exp_f32 v176, v176
    v_exp_f32 v177, v177
    v_smfmac_f32_32x32x32_bf16 v[64:79], v[124:127], v[232:239], v250
    v_exp_f32 v178, v178
    v_exp_f32 v179, v179
    v_exp_f32 v180, v180
    v_exp_f32 v181, v181
    v_mfma_f32_32x32x16_bf16 v[224:239], v[128:131], a[236:239], 0
    v_exp_f32 v182, v182
    v_exp_f32 v183, v183
    v_exp_f32 v184, v184
    v_exp_f32 v185, v185
    v_smfmac_f32_32x32x32_bf16 v[16:31], v[132:135], v[176:183], v250
    s_xor_b32 s24, s69, 73728
    buffer_load_dwordx4 v[104:107], v248, s[4:7], s24 offen offset:0 sc1
    buffer_load_dwordx4 v[116:119], v248, s[4:7], s24 offen offset:2048 sc1
    s_mov_b64 exec, s[30:31]
    buffer_load_dwordx4 v[108:111], v249, s[4:7], s24 offen offset:1024 sc1
    buffer_load_dwordx4 v[112:115], v249, s[4:7], s24 offen offset:1536 sc1
    buffer_load_dwordx4 v[120:123], v249, s[4:7], s24 offen offset:3072 sc1
    buffer_load_dwordx4 v[124:127], v249, s[4:7], s24 offen offset:3584 sc1
    s_mov_b64 exec, -1
    v_exp_f32 v186, v186
    v_exp_f32 v187, v187
    v_exp_f32 v188, v188
    v_exp_f32 v189, v189
    v_exp_f32 v190, v190
    v_exp_f32 v191, v191
    v_exp_f32 v192, v192
    v_exp_f32 v193, v193
    v_smfmac_f32_32x32x32_bf16 v[16:31], v[136:139], v[184:191], v250
    v_exp_f32 v194, v194
    v_exp_f32 v195, v195
    v_exp_f32 v196, v196
    v_exp_f32 v197, v197
    v_mfma_f32_32x32x16_bf16 v[176:191], v[140:143], a[224:227], 0
    v_exp_f32 v198, v198
    v_exp_f32 v199, v199
    v_exp_f32 v200, v200
    v_exp_f32 v201, v201
    v_smfmac_f32_32x32x32_bf16 v[32:47], v[132:135], v[192:199], v250
    v_exp_f32 v202, v202
    v_exp_f32 v203, v203
    v_exp_f32 v204, v204
    v_exp_f32 v205, v205
    v_exp_f32 v206, v206
    v_exp_f32 v207, v207
    v_exp_f32 v208, v208
    v_exp_f32 v209, v209
    v_smfmac_f32_32x32x32_bf16 v[32:47], v[136:139], v[200:207], v250
    v_exp_f32 v210, v210
    v_exp_f32 v211, v211
    v_exp_f32 v212, v212
    v_exp_f32 v213, v213
    v_mfma_f32_32x32x16_bf16 v[192:207], v[140:143], a[228:231], 0
    v_exp_f32 v214, v214
    v_exp_f32 v215, v215
    v_exp_f32 v216, v216
    v_exp_f32 v217, v217
    v_smfmac_f32_32x32x32_bf16 v[48:63], v[132:135], v[208:215], v250
    s_add_u32 m0, s97, 16384
    s_add_u32 s21, s21, 16384
    buffer_load_dwordx4 v1, s[4:7], s21 offen offset:0 sc1 lds
    buffer_load_dwordx4 v1, s[4:7], s21 offen offset:1024 sc1 lds
    buffer_load_dwordx4 v1, s[4:7], s21 offen offset:2048 sc1 lds
    buffer_load_dwordx4 v1, s[4:7], s21 offen offset:3072 sc1 lds
    v_exp_f32 v218, v218
    v_exp_f32 v219, v219
    v_exp_f32 v220, v220
    v_exp_f32 v221, v221
    v_exp_f32 v222, v222
    v_exp_f32 v223, v223
    v_exp_f32 v224, v224
    v_exp_f32 v225, v225
    v_smfmac_f32_32x32x32_bf16 v[48:63], v[136:139], v[216:223], v250
    v_exp_f32 v226, v226
    v_exp_f32 v227, v227
    v_exp_f32 v228, v228
    v_exp_f32 v229, v229
    v_mfma_f32_32x32x16_bf16 v[208:223], v[140:143], a[232:235], 0
    v_exp_f32 v230, v230
    v_exp_f32 v231, v231
    v_exp_f32 v232, v232
    v_exp_f32 v233, v233
    v_smfmac_f32_32x32x32_bf16 v[64:79], v[132:135], v[224:231], v250
    v_exp_f32 v234, v234
    v_exp_f32 v235, v235
    v_exp_f32 v236, v236
    v_exp_f32 v237, v237
    v_exp_f32 v238, v238
    v_exp_f32 v239, v239
    v_exp_f32 v176, v176
    v_exp_f32 v177, v177
    v_smfmac_f32_32x32x32_bf16 v[64:79], v[136:139], v[232:239], v250
    v_exp_f32 v178, v178
    v_exp_f32 v179, v179
    v_exp_f32 v180, v180
    v_exp_f32 v181, v181
    v_mfma_f32_32x32x16_bf16 v[224:239], v[140:143], a[236:239], 0
    v_exp_f32 v182, v182
    v_exp_f32 v183, v183
    v_exp_f32 v184, v184
    v_exp_f32 v185, v185
    v_smfmac_f32_32x32x32_bf16 v[16:31], v[144:147], v[176:183], v250
    v_exp_f32 v186, v186
    v_exp_f32 v187, v187
    v_exp_f32 v188, v188
    v_exp_f32 v189, v189
    v_exp_f32 v190, v190
    v_exp_f32 v191, v191
    v_exp_f32 v192, v192
    v_exp_f32 v193, v193
    v_smfmac_f32_32x32x32_bf16 v[16:31], v[148:151], v[184:191], v250
    v_exp_f32 v194, v194
    v_exp_f32 v195, v195
    v_exp_f32 v196, v196
    v_exp_f32 v197, v197
    v_mfma_f32_32x32x16_bf16 v[176:191], v[152:155], a[224:227], 0
    v_exp_f32 v198, v198
    v_exp_f32 v199, v199
    v_exp_f32 v200, v200
    v_exp_f32 v201, v201
    v_smfmac_f32_32x32x32_bf16 v[32:47], v[144:147], v[192:199], v250
    v_exp_f32 v202, v202
    v_exp_f32 v203, v203
    v_exp_f32 v204, v204
    v_exp_f32 v205, v205
    v_exp_f32 v206, v206
    v_exp_f32 v207, v207
    v_exp_f32 v208, v208
    v_exp_f32 v209, v209
    v_smfmac_f32_32x32x32_bf16 v[32:47], v[148:151], v[200:207], v250
    v_exp_f32 v210, v210
    v_exp_f32 v211, v211
    v_exp_f32 v212, v212
    v_exp_f32 v213, v213
    v_mfma_f32_32x32x16_bf16 v[192:207], v[152:155], a[228:231], 0
    v_exp_f32 v214, v214
    v_exp_f32 v215, v215
    v_exp_f32 v216, v216
    v_exp_f32 v217, v217
    v_smfmac_f32_32x32x32_bf16 v[48:63], v[144:147], v[208:215], v250
    v_exp_f32 v218, v218
    v_exp_f32 v219, v219
    v_exp_f32 v220, v220
    v_exp_f32 v221, v221
    v_exp_f32 v222, v222
    v_exp_f32 v223, v223
    v_exp_f32 v224, v224
    v_exp_f32 v225, v225
    v_smfmac_f32_32x32x32_bf16 v[48:63], v[148:151], v[216:223], v250
    v_exp_f32 v226, v226
    v_exp_f32 v227, v227
    v_exp_f32 v228, v228
    v_exp_f32 v229, v229
    v_mfma_f32_32x32x16_bf16 v[208:223], v[152:155], a[232:235], 0
    v_exp_f32 v230, v230
    v_exp_f32 v231, v231
    v_exp_f32 v232, v232
    v_exp_f32 v233, v233
    v_smfmac_f32_32x32x32_bf16 v[64:79], v[144:147], v[224:231], v250
    v_exp_f32 v234, v234
    v_exp_f32 v235, v235
    v_exp_f32 v236, v236
    v_exp_f32 v237, v237
    v_exp_f32 v238, v238
    v_exp_f32 v239, v239
    v_exp_f32 v176, v176
    v_exp_f32 v177, v177
    v_smfmac_f32_32x32x32_bf16 v[64:79], v[148:151], v[232:239], v250
    v_exp_f32 v178, v178
    v_exp_f32 v179, v179
    v_exp_f32 v180, v180
    v_exp_f32 v181, v181
    v_mfma_f32_32x32x16_bf16 v[224:239], v[152:155], a[236:239], 0
    v_exp_f32 v182, v182
    v_exp_f32 v183, v183
    v_exp_f32 v184, v184
    v_exp_f32 v185, v185
    v_smfmac_f32_32x32x32_bf16 v[16:31], v[156:159], v[176:183], v250
    s_xor_b32 s24, s69, 81920
    buffer_load_dwordx4 v[128:131], v248, s[4:7], s24 offen offset:0 sc1
    buffer_load_dwordx4 v[140:143], v248, s[4:7], s24 offen offset:2048 sc1
    s_mov_b64 exec, s[30:31]
    buffer_load_dwordx4 v[132:135], v249, s[4:7], s24 offen offset:1024 sc1
    buffer_load_dwordx4 v[136:139], v249, s[4:7], s24 offen offset:1536 sc1
    buffer_load_dwordx4 v[144:147], v249, s[4:7], s24 offen offset:3072 sc1
    buffer_load_dwordx4 v[148:151], v249, s[4:7], s24 offen offset:3584 sc1
    s_mov_b64 exec, -1
    s_add_u32 m0, s97, 32768
    s_add_u32 s21, s21, 16384
    buffer_load_dwordx4 v1, s[4:7], s21 offen offset:0 sc1 lds
    buffer_load_dwordx4 v1, s[4:7], s21 offen offset:1024 sc1 lds
    buffer_load_dwordx4 v1, s[4:7], s21 offen offset:2048 sc1 lds
    buffer_load_dwordx4 v1, s[4:7], s21 offen offset:3072 sc1 lds
    v_exp_f32 v186, v186
    v_exp_f32 v187, v187
    v_exp_f32 v188, v188
    v_exp_f32 v189, v189
    v_exp_f32 v190, v190
    v_exp_f32 v191, v191
    v_exp_f32 v192, v192
    v_exp_f32 v193, v193
    v_smfmac_f32_32x32x32_bf16 v[16:31], v[160:163], v[184:191], v250
    v_exp_f32 v194, v194
    v_exp_f32 v195, v195
    v_exp_f32 v196, v196
    v_exp_f32 v197, v197
    v_mfma_f32_32x32x16_bf16 v[176:191], v[164:167], a[224:227], 0
    v_exp_f32 v198, v198
    v_exp_f32 v199, v199
    v_exp_f32 v200, v200
    v_exp_f32 v201, v201
    v_smfmac_f32_32x32x32_bf16 v[32:47], v[156:159], v[192:199], v250
    v_exp_f32 v202, v202
    v_exp_f32 v203, v203
    v_exp_f32 v204, v204
    v_exp_f32 v205, v205
    v_exp_f32 v206, v206
    v_exp_f32 v207, v207
    v_exp_f32 v208, v208
    v_exp_f32 v209, v209
    v_smfmac_f32_32x32x32_bf16 v[32:47], v[160:163], v[200:207], v250
    v_exp_f32 v210, v210
    v_exp_f32 v211, v211
    v_exp_f32 v212, v212
    v_exp_f32 v213, v213
    v_mfma_f32_32x32x16_bf16 v[192:207], v[164:167], a[228:231], 0
    v_exp_f32 v214, v214
    v_exp_f32 v215, v215
    v_exp_f32 v216, v216
    v_exp_f32 v217, v217
    v_smfmac_f32_32x32x32_bf16 v[48:63], v[156:159], v[208:215], v250
    v_exp_f32 v218, v218
    v_exp_f32 v219, v219
    v_exp_f32 v220, v220
    v_exp_f32 v221, v221
    v_exp_f32 v222, v222
    v_exp_f32 v223, v223
    v_exp_f32 v224, v224
    v_exp_f32 v225, v225
    v_smfmac_f32_32x32x32_bf16 v[48:63], v[160:163], v[216:223], v250
    v_exp_f32 v226, v226
    v_exp_f32 v227, v227
    v_exp_f32 v228, v228
    v_exp_f32 v229, v229
    v_mfma_f32_32x32x16_bf16 v[208:223], v[164:167], a[232:235], 0
    v_exp_f32 v230, v230
    v_exp_f32 v231, v231
    v_exp_f32 v232, v232
    v_exp_f32 v233, v233
    v_smfmac_f32_32x32x32_bf16 v[64:79], v[156:159], v[224:231], v250
    v_exp_f32 v234, v234
    v_exp_f32 v235, v235
    v_exp_f32 v236, v236
    v_exp_f32 v237, v237
    v_exp_f32 v238, v238
    v_exp_f32 v239, v239
    v_exp_f32 v176, v176
    v_exp_f32 v177, v177
    v_smfmac_f32_32x32x32_bf16 v[64:79], v[160:163], v[232:239], v250
    v_exp_f32 v178, v178
    v_exp_f32 v179, v179
    v_exp_f32 v180, v180
    v_exp_f32 v181, v181
    v_mfma_f32_32x32x16_bf16 v[224:239], v[164:167], a[236:239], 0
    v_exp_f32 v182, v182
    v_exp_f32 v183, v183
    v_exp_f32 v184, v184
    v_exp_f32 v185, v185
    v_smfmac_f32_32x32x32_bf16 v[16:31], v[168:171], v[176:183], v250
    v_exp_f32 v186, v186
    v_exp_f32 v187, v187
    v_exp_f32 v188, v188
    v_exp_f32 v189, v189
    v_exp_f32 v190, v190
    v_exp_f32 v191, v191
    v_exp_f32 v192, v192
    v_exp_f32 v193, v193
    v_smfmac_f32_32x32x32_bf16 v[16:31], v[172:175], v[184:191], v250
    v_exp_f32 v194, v194
    v_exp_f32 v195, v195
    v_exp_f32 v196, v196
    v_exp_f32 v197, v197
    s_waitcnt vmcnt(24)
    v_mfma_f32_32x32x16_bf16 v[176:191], v[80:83], a[224:227], 0
    v_exp_f32 v198, v198
    v_exp_f32 v199, v199
    v_exp_f32 v200, v200
    v_exp_f32 v201, v201
    v_smfmac_f32_32x32x32_bf16 v[32:47], v[168:171], v[192:199], v250
    v_exp_f32 v202, v202
    v_exp_f32 v203, v203
    v_exp_f32 v204, v204
    v_exp_f32 v205, v205
    v_exp_f32 v206, v206
    v_exp_f32 v207, v207
    v_exp_f32 v208, v208
    v_exp_f32 v209, v209
    v_smfmac_f32_32x32x32_bf16 v[32:47], v[172:175], v[200:207], v250
    v_exp_f32 v210, v210
    v_exp_f32 v211, v211
    v_exp_f32 v212, v212
    v_exp_f32 v213, v213
    v_mfma_f32_32x32x16_bf16 v[192:207], v[80:83], a[228:231], 0
    v_exp_f32 v214, v214
    v_exp_f32 v215, v215
    v_exp_f32 v216, v216
    v_exp_f32 v217, v217
    v_smfmac_f32_32x32x32_bf16 v[48:63], v[168:171], v[208:215], v250
    s_add_u32 m0, s97, 49152
    s_add_u32 s21, s21, 16384
    buffer_load_dwordx4 v1, s[4:7], s21 offen offset:0 sc1 lds
    buffer_load_dwordx4 v1, s[4:7], s21 offen offset:1024 sc1 lds
    buffer_load_dwordx4 v1, s[4:7], s21 offen offset:2048 sc1 lds
    buffer_load_dwordx4 v1, s[4:7], s21 offen offset:3072 sc1 lds
    v_exp_f32 v218, v218
    v_exp_f32 v219, v219
    v_exp_f32 v220, v220
    v_exp_f32 v221, v221
    v_exp_f32 v222, v222
    v_exp_f32 v223, v223
    v_exp_f32 v224, v224
    v_exp_f32 v225, v225
    v_smfmac_f32_32x32x32_bf16 v[48:63], v[172:175], v[216:223], v250
    v_exp_f32 v226, v226
    v_exp_f32 v227, v227
    v_exp_f32 v228, v228
    v_exp_f32 v229, v229
    v_mfma_f32_32x32x16_bf16 v[208:223], v[80:83], a[232:235], 0
    v_exp_f32 v230, v230
    v_exp_f32 v231, v231
    v_exp_f32 v232, v232
    v_exp_f32 v233, v233
    v_smfmac_f32_32x32x32_bf16 v[64:79], v[168:171], v[224:231], v250
    v_exp_f32 v234, v234
    v_exp_f32 v235, v235
    v_exp_f32 v236, v236
    v_exp_f32 v237, v237
    v_exp_f32 v238, v238
    v_exp_f32 v239, v239
    v_exp_f32 v176, v176
    v_exp_f32 v177, v177
    v_smfmac_f32_32x32x32_bf16 v[64:79], v[172:175], v[232:239], v250
    v_exp_f32 v178, v178
    v_exp_f32 v179, v179
    v_exp_f32 v180, v180
    v_exp_f32 v181, v181
    v_mfma_f32_32x32x16_bf16 v[224:239], v[80:83], a[236:239], 0
    v_exp_f32 v182, v182
    v_exp_f32 v183, v183
    v_exp_f32 v184, v184
    v_exp_f32 v185, v185
    v_smfmac_f32_32x32x32_bf16 v[16:31], v[84:87], v[176:183], v250
    s_xor_b32 s24, s69, 90112
    buffer_load_dwordx4 v[152:155], v248, s[4:7], s24 offen offset:0 sc1
    buffer_load_dwordx4 v[164:167], v248, s[4:7], s24 offen offset:2048 sc1
    s_mov_b64 exec, s[30:31]
    buffer_load_dwordx4 v[156:159], v249, s[4:7], s24 offen offset:1024 sc1
    buffer_load_dwordx4 v[160:163], v249, s[4:7], s24 offen offset:1536 sc1
    buffer_load_dwordx4 v[168:171], v249, s[4:7], s24 offen offset:3072 sc1
    buffer_load_dwordx4 v[172:175], v249, s[4:7], s24 offen offset:3584 sc1
    s_mov_b64 exec, -1
    v_exp_f32 v186, v186
    v_exp_f32 v187, v187
    v_exp_f32 v188, v188
    v_exp_f32 v189, v189
    v_exp_f32 v190, v190
    v_exp_f32 v191, v191
    v_exp_f32 v192, v192
    v_exp_f32 v193, v193
    v_smfmac_f32_32x32x32_bf16 v[16:31], v[88:91], v[184:191], v250
    v_exp_f32 v194, v194
    v_exp_f32 v195, v195
    v_exp_f32 v196, v196
    v_exp_f32 v197, v197
    v_mfma_f32_32x32x16_bf16 v[176:191], v[92:95], a[224:227], 0
    v_exp_f32 v198, v198
    v_exp_f32 v199, v199
    v_exp_f32 v200, v200
    v_exp_f32 v201, v201
    v_smfmac_f32_32x32x32_bf16 v[32:47], v[84:87], v[192:199], v250
    v_exp_f32 v202, v202
    v_exp_f32 v203, v203
    v_exp_f32 v204, v204
    v_exp_f32 v205, v205
    v_exp_f32 v206, v206
    v_exp_f32 v207, v207
    v_exp_f32 v208, v208
    v_exp_f32 v209, v209
    v_smfmac_f32_32x32x32_bf16 v[32:47], v[88:91], v[200:207], v250
    v_exp_f32 v210, v210
    v_exp_f32 v211, v211
    v_exp_f32 v212, v212
    v_exp_f32 v213, v213
    v_mfma_f32_32x32x16_bf16 v[192:207], v[92:95], a[228:231], 0
    v_exp_f32 v214, v214
    v_exp_f32 v215, v215
    v_exp_f32 v216, v216
    v_exp_f32 v217, v217
    v_smfmac_f32_32x32x32_bf16 v[48:63], v[84:87], v[208:215], v250
    v_exp_f32 v218, v218
    v_exp_f32 v219, v219
    v_exp_f32 v220, v220
    v_exp_f32 v221, v221
    v_exp_f32 v222, v222
    v_exp_f32 v223, v223
    v_exp_f32 v224, v224
    v_exp_f32 v225, v225
    v_smfmac_f32_32x32x32_bf16 v[48:63], v[88:91], v[216:223], v250
    v_exp_f32 v226, v226
    v_exp_f32 v227, v227
    v_exp_f32 v228, v228
    v_exp_f32 v229, v229
    v_mfma_f32_32x32x16_bf16 v[208:223], v[92:95], a[232:235], 0
    v_exp_f32 v230, v230
    v_exp_f32 v231, v231
    v_exp_f32 v232, v232
    v_exp_f32 v233, v233
    v_smfmac_f32_32x32x32_bf16 v[64:79], v[84:87], v[224:231], v250
    v_exp_f32 v234, v234
    v_exp_f32 v235, v235
    v_exp_f32 v236, v236
    v_exp_f32 v237, v237
    v_exp_f32 v238, v238
    v_exp_f32 v239, v239
    v_exp_f32 v176, v176
    v_exp_f32 v177, v177
    v_smfmac_f32_32x32x32_bf16 v[64:79], v[88:91], v[232:239], v250
    v_exp_f32 v178, v178
    v_exp_f32 v179, v179
    v_exp_f32 v180, v180
    v_exp_f32 v181, v181
    v_mfma_f32_32x32x16_bf16 v[224:239], v[92:95], a[236:239], 0
    v_exp_f32 v182, v182
    v_exp_f32 v183, v183
    v_exp_f32 v184, v184
    v_exp_f32 v185, v185
    v_smfmac_f32_32x32x32_bf16 v[16:31], v[96:99], v[176:183], v250
    s_add_u32 m0, s97, 65536
    s_add_u32 s21, s37, s97
    buffer_load_dwordx4 v1, s[4:7], s21 offen offset:0 sc1 lds
    buffer_load_dwordx4 v1, s[4:7], s21 offen offset:1024 sc1 lds
    buffer_load_dwordx4 v1, s[4:7], s21 offen offset:2048 sc1 lds
    buffer_load_dwordx4 v1, s[4:7], s21 offen offset:3072 sc1 lds
    v_exp_f32 v186, v186
    v_exp_f32 v187, v187
    v_exp_f32 v188, v188
    v_exp_f32 v189, v189
    v_exp_f32 v190, v190
    v_exp_f32 v191, v191
    v_exp_f32 v192, v192
    v_exp_f32 v193, v193
    v_smfmac_f32_32x32x32_bf16 v[16:31], v[100:103], v[184:191], v250
    v_exp_f32 v194, v194
    v_exp_f32 v195, v195
    v_exp_f32 v196, v196
    v_exp_f32 v197, v197
    s_waitcnt vmcnt(28)
    v_mfma_f32_32x32x16_bf16 v[176:191], v[104:107], a[224:227], 0
    v_exp_f32 v198, v198
    v_exp_f32 v199, v199
    v_exp_f32 v200, v200
    v_exp_f32 v201, v201
    v_smfmac_f32_32x32x32_bf16 v[32:47], v[96:99], v[192:199], v250
    v_exp_f32 v202, v202
    v_exp_f32 v203, v203
    v_exp_f32 v204, v204
    v_exp_f32 v205, v205
    v_exp_f32 v206, v206
    v_exp_f32 v207, v207
    v_exp_f32 v208, v208
    v_exp_f32 v209, v209
    v_smfmac_f32_32x32x32_bf16 v[32:47], v[100:103], v[200:207], v250
    v_exp_f32 v210, v210
    v_exp_f32 v211, v211
    v_exp_f32 v212, v212
    v_exp_f32 v213, v213
    v_mfma_f32_32x32x16_bf16 v[192:207], v[104:107], a[228:231], 0
    v_exp_f32 v214, v214
    v_exp_f32 v215, v215
    v_exp_f32 v216, v216
    v_exp_f32 v217, v217
    v_smfmac_f32_32x32x32_bf16 v[48:63], v[96:99], v[208:215], v250
    v_exp_f32 v218, v218
    v_exp_f32 v219, v219
    v_exp_f32 v220, v220
    v_exp_f32 v221, v221
    v_exp_f32 v222, v222
    v_exp_f32 v223, v223
    v_exp_f32 v224, v224
    v_exp_f32 v225, v225
    v_smfmac_f32_32x32x32_bf16 v[48:63], v[100:103], v[216:223], v250
    v_exp_f32 v226, v226
    v_exp_f32 v227, v227
    v_exp_f32 v228, v228
    v_exp_f32 v229, v229
    v_mfma_f32_32x32x16_bf16 v[208:223], v[104:107], a[232:235], 0
    v_exp_f32 v230, v230
    v_exp_f32 v231, v231
    v_exp_f32 v232, v232
    v_exp_f32 v233, v233
    v_smfmac_f32_32x32x32_bf16 v[64:79], v[96:99], v[224:231], v250
    v_exp_f32 v234, v234
    v_exp_f32 v235, v235
    v_exp_f32 v236, v236
    v_exp_f32 v237, v237
    v_exp_f32 v238, v238
    v_exp_f32 v239, v239
    v_exp_f32 v176, v176
    v_exp_f32 v177, v177
    v_smfmac_f32_32x32x32_bf16 v[64:79], v[100:103], v[232:239], v250
    v_exp_f32 v178, v178
    v_exp_f32 v179, v179
    v_exp_f32 v180, v180
    v_exp_f32 v181, v181
    v_mfma_f32_32x32x16_bf16 v[224:239], v[104:107], a[236:239], 0
    v_exp_f32 v182, v182
    v_exp_f32 v183, v183
    v_exp_f32 v184, v184
    v_exp_f32 v185, v185
    v_smfmac_f32_32x32x32_bf16 v[16:31], v[108:111], v[176:183], v250
    s_xor_b32 s24, s69, 98304
    buffer_load_dwordx4 v[80:83], v248, s[4:7], s24 offen offset:0 sc1
    buffer_load_dwordx4 v[92:95], v248, s[4:7], s24 offen offset:2048 sc1
    s_mov_b64 exec, s[30:31]
    buffer_load_dwordx4 v[84:87], v249, s[4:7], s24 offen offset:1024 sc1
    buffer_load_dwordx4 v[88:91], v249, s[4:7], s24 offen offset:1536 sc1
    buffer_load_dwordx4 v[96:99], v249, s[4:7], s24 offen offset:3072 sc1
    buffer_load_dwordx4 v[100:103], v249, s[4:7], s24 offen offset:3584 sc1
    s_mov_b64 exec, -1
    v_exp_f32 v186, v186
    v_exp_f32 v187, v187
    v_exp_f32 v188, v188
    v_exp_f32 v189, v189
    v_exp_f32 v190, v190
    v_exp_f32 v191, v191
    v_exp_f32 v192, v192
    v_exp_f32 v193, v193
    v_smfmac_f32_32x32x32_bf16 v[16:31], v[112:115], v[184:191], v250
    v_exp_f32 v194, v194
    v_exp_f32 v195, v195
    v_exp_f32 v196, v196
    v_exp_f32 v197, v197
    v_mfma_f32_32x32x16_bf16 v[176:191], v[116:119], a[224:227], 0
    v_exp_f32 v198, v198
    v_exp_f32 v199, v199
    v_exp_f32 v200, v200
    v_exp_f32 v201, v201
    v_smfmac_f32_32x32x32_bf16 v[32:47], v[108:111], v[192:199], v250
    v_exp_f32 v202, v202
    v_exp_f32 v203, v203
    v_exp_f32 v204, v204
    v_exp_f32 v205, v205
    v_exp_f32 v206, v206
    v_exp_f32 v207, v207
    v_exp_f32 v208, v208
    v_exp_f32 v209, v209
    v_smfmac_f32_32x32x32_bf16 v[32:47], v[112:115], v[200:207], v250
    v_exp_f32 v210, v210
    v_exp_f32 v211, v211
    v_exp_f32 v212, v212
    v_exp_f32 v213, v213
    v_mfma_f32_32x32x16_bf16 v[192:207], v[116:119], a[228:231], 0
    v_exp_f32 v214, v214
    v_exp_f32 v215, v215
    v_exp_f32 v216, v216
    v_exp_f32 v217, v217
    v_smfmac_f32_32x32x32_bf16 v[48:63], v[108:111], v[208:215], v250
    s_add_u32 m0, s97, 81920
    s_add_u32 s21, s21, 16384
    buffer_load_dwordx4 v1, s[4:7], s21 offen offset:0 sc1 lds
    buffer_load_dwordx4 v1, s[4:7], s21 offen offset:1024 sc1 lds
    buffer_load_dwordx4 v1, s[4:7], s21 offen offset:2048 sc1 lds
    buffer_load_dwordx4 v1, s[4:7], s21 offen offset:3072 sc1 lds
    v_exp_f32 v218, v218
    v_exp_f32 v219, v219
    v_exp_f32 v220, v220
    v_exp_f32 v221, v221
    v_exp_f32 v222, v222
    v_exp_f32 v223, v223
    v_exp_f32 v224, v224
    v_exp_f32 v225, v225
    v_smfmac_f32_32x32x32_bf16 v[48:63], v[112:115], v[216:223], v250
    v_exp_f32 v226, v226
    v_exp_f32 v227, v227
    v_exp_f32 v228, v228
    v_exp_f32 v229, v229
    v_mfma_f32_32x32x16_bf16 v[208:223], v[116:119], a[232:235], 0
    v_exp_f32 v230, v230
    v_exp_f32 v231, v231
    v_exp_f32 v232, v232
    v_exp_f32 v233, v233
    v_smfmac_f32_32x32x32_bf16 v[64:79], v[108:111], v[224:231], v250
    v_exp_f32 v234, v234
    v_exp_f32 v235, v235
    v_exp_f32 v236, v236
    v_exp_f32 v237, v237
    v_exp_f32 v238, v238
    v_exp_f32 v239, v239
    v_exp_f32 v176, v176
    v_exp_f32 v177, v177
    v_smfmac_f32_32x32x32_bf16 v[64:79], v[112:115], v[232:239], v250
    v_exp_f32 v178, v178
    v_exp_f32 v179, v179
    v_exp_f32 v180, v180
    v_exp_f32 v181, v181
    v_mfma_f32_32x32x16_bf16 v[224:239], v[116:119], a[236:239], 0
    v_exp_f32 v182, v182
    v_exp_f32 v183, v183
    v_exp_f32 v184, v184
    v_exp_f32 v185, v185
    v_smfmac_f32_32x32x32_bf16 v[16:31], v[120:123], v[176:183], v250
    v_exp_f32 v186, v186
    v_exp_f32 v187, v187
    v_exp_f32 v188, v188
    v_exp_f32 v189, v189
    v_exp_f32 v190, v190
    v_exp_f32 v191, v191
    v_exp_f32 v192, v192
    v_exp_f32 v193, v193
    v_smfmac_f32_32x32x32_bf16 v[16:31], v[124:127], v[184:191], v250
    v_exp_f32 v194, v194
    v_exp_f32 v195, v195
    v_exp_f32 v196, v196
    v_exp_f32 v197, v197
    s_waitcnt vmcnt(28)
    v_mfma_f32_32x32x16_bf16 v[176:191], v[128:131], a[224:227], 0
    v_exp_f32 v198, v198
    v_exp_f32 v199, v199
    v_exp_f32 v200, v200
    v_exp_f32 v201, v201
    v_smfmac_f32_32x32x32_bf16 v[32:47], v[120:123], v[192:199], v250
    v_exp_f32 v202, v202
    v_exp_f32 v203, v203
    v_exp_f32 v204, v204
    v_exp_f32 v205, v205
    v_exp_f32 v206, v206
    v_exp_f32 v207, v207
    v_exp_f32 v208, v208
    v_exp_f32 v209, v209
    v_smfmac_f32_32x32x32_bf16 v[32:47], v[124:127], v[200:207], v250
    v_exp_f32 v210, v210
    v_exp_f32 v211, v211
    v_exp_f32 v212, v212
    v_exp_f32 v213, v213
    v_mfma_f32_32x32x16_bf16 v[192:207], v[128:131], a[228:231], 0
    v_exp_f32 v214, v214
    v_exp_f32 v215, v215
    v_exp_f32 v216, v216
    v_exp_f32 v217, v217
    v_smfmac_f32_32x32x32_bf16 v[48:63], v[120:123], v[208:215], v250
    v_exp_f32 v218, v218
    v_exp_f32 v219, v219
    v_exp_f32 v220, v220
    v_exp_f32 v221, v221
    v_exp_f32 v222, v222
    v_exp_f32 v223, v223
    v_exp_f32 v224, v224
    v_exp_f32 v225, v225
    v_smfmac_f32_32x32x32_bf16 v[48:63], v[124:127], v[216:223], v250
    v_exp_f32 v226, v226
    v_exp_f32 v227, v227
    v_exp_f32 v228, v228
    v_exp_f32 v229, v229
    v_mfma_f32_32x32x16_bf16 v[208:223], v[128:131], a[232:235], 0
    v_exp_f32 v230, v230
    v_exp_f32 v231, v231
    v_exp_f32 v232, v232
    v_exp_f32 v233, v233
    v_smfmac_f32_32x32x32_bf16 v[64:79], v[120:123], v[224:231], v250
    v_exp_f32 v234, v234
    v_exp_f32 v235, v235
    v_exp_f32 v236, v236
    v_exp_f32 v237, v237
    v_exp_f32 v238, v238
    v_exp_f32 v239, v239
    v_exp_f32 v176, v176
    v_exp_f32 v177, v177
    v_smfmac_f32_32x32x32_bf16 v[64:79], v[124:127], v[232:239], v250
    v_exp_f32 v178, v178
    v_exp_f32 v179, v179
    v_exp_f32 v180, v180
    v_exp_f32 v181, v181
    v_mfma_f32_32x32x16_bf16 v[224:239], v[128:131], a[236:239], 0
    v_exp_f32 v182, v182
    v_exp_f32 v183, v183
    v_exp_f32 v184, v184
    v_exp_f32 v185, v185
    v_smfmac_f32_32x32x32_bf16 v[16:31], v[132:135], v[176:183], v250
    s_xor_b32 s24, s69, 106496
    buffer_load_dwordx4 v[104:107], v248, s[4:7], s24 offen offset:0 sc1
    buffer_load_dwordx4 v[116:119], v248, s[4:7], s24 offen offset:2048 sc1
    s_mov_b64 exec, s[30:31]
    buffer_load_dwordx4 v[108:111], v249, s[4:7], s24 offen offset:1024 sc1
    buffer_load_dwordx4 v[112:115], v249, s[4:7], s24 offen offset:1536 sc1
    buffer_load_dwordx4 v[120:123], v249, s[4:7], s24 offen offset:3072 sc1
    buffer_load_dwordx4 v[124:127], v249, s[4:7], s24 offen offset:3584 sc1
    s_mov_b64 exec, -1
    s_add_u32 m0, s97, 98304
    s_add_u32 s21, s21, 16384
    buffer_load_dwordx4 v1, s[4:7], s21 offen offset:0 sc1 lds
    buffer_load_dwordx4 v1, s[4:7], s21 offen offset:1024 sc1 lds
    buffer_load_dwordx4 v1, s[4:7], s21 offen offset:2048 sc1 lds
    buffer_load_dwordx4 v1, s[4:7], s21 offen offset:3072 sc1 lds
    v_exp_f32 v186, v186
    v_exp_f32 v187, v187
    v_exp_f32 v188, v188
    v_exp_f32 v189, v189
    v_exp_f32 v190, v190
    v_exp_f32 v191, v191
    v_exp_f32 v192, v192
    v_exp_f32 v193, v193
    v_smfmac_f32_32x32x32_bf16 v[16:31], v[136:139], v[184:191], v250
    v_exp_f32 v194, v194
    v_exp_f32 v195, v195
    v_exp_f32 v196, v196
    v_exp_f32 v197, v197
    v_mfma_f32_32x32x16_bf16 v[176:191], v[140:143], a[224:227], 0
    v_exp_f32 v198, v198
    v_exp_f32 v199, v199
    v_exp_f32 v200, v200
    v_exp_f32 v201, v201
    v_smfmac_f32_32x32x32_bf16 v[32:47], v[132:135], v[192:199], v250
    v_exp_f32 v202, v202
    v_exp_f32 v203, v203
    v_exp_f32 v204, v204
    v_exp_f32 v205, v205
    v_exp_f32 v206, v206
    v_exp_f32 v207, v207
    v_exp_f32 v208, v208
    v_exp_f32 v209, v209
    v_smfmac_f32_32x32x32_bf16 v[32:47], v[136:139], v[200:207], v250
    v_exp_f32 v210, v210
    v_exp_f32 v211, v211
    v_exp_f32 v212, v212
    v_exp_f32 v213, v213
    v_mfma_f32_32x32x16_bf16 v[192:207], v[140:143], a[228:231], 0
    v_exp_f32 v214, v214
    v_exp_f32 v215, v215
    v_exp_f32 v216, v216
    v_exp_f32 v217, v217
    v_smfmac_f32_32x32x32_bf16 v[48:63], v[132:135], v[208:215], v250
    v_exp_f32 v218, v218
    v_exp_f32 v219, v219
    v_exp_f32 v220, v220
    v_exp_f32 v221, v221
    v_exp_f32 v222, v222
    v_exp_f32 v223, v223
    v_exp_f32 v224, v224
    v_exp_f32 v225, v225
    v_smfmac_f32_32x32x32_bf16 v[48:63], v[136:139], v[216:223], v250
    v_exp_f32 v226, v226
    v_exp_f32 v227, v227
    v_exp_f32 v228, v228
    v_exp_f32 v229, v229
    v_mfma_f32_32x32x16_bf16 v[208:223], v[140:143], a[232:235], 0
    v_exp_f32 v230, v230
    v_exp_f32 v231, v231
    v_exp_f32 v232, v232
    v_exp_f32 v233, v233
    v_smfmac_f32_32x32x32_bf16 v[64:79], v[132:135], v[224:231], v250
    v_exp_f32 v234, v234
    v_exp_f32 v235, v235
    v_exp_f32 v236, v236
    v_exp_f32 v237, v237
    v_exp_f32 v238, v238
    v_exp_f32 v239, v239
    v_exp_f32 v176, v176
    v_exp_f32 v177, v177
    v_smfmac_f32_32x32x32_bf16 v[64:79], v[136:139], v[232:239], v250
    v_exp_f32 v178, v178
    v_exp_f32 v179, v179
    v_exp_f32 v180, v180
    v_exp_f32 v181, v181
    v_mfma_f32_32x32x16_bf16 v[224:239], v[140:143], a[236:239], 0
    v_exp_f32 v182, v182
    v_exp_f32 v183, v183
    v_exp_f32 v184, v184
    v_exp_f32 v185, v185
    v_smfmac_f32_32x32x32_bf16 v[16:31], v[144:147], v[176:183], v250
    v_exp_f32 v186, v186
    v_exp_f32 v187, v187
    v_exp_f32 v188, v188
    v_exp_f32 v189, v189
    v_exp_f32 v190, v190
    v_exp_f32 v191, v191
    v_exp_f32 v192, v192
    v_exp_f32 v193, v193
    v_smfmac_f32_32x32x32_bf16 v[16:31], v[148:151], v[184:191], v250
    v_exp_f32 v194, v194
    v_exp_f32 v195, v195
    v_exp_f32 v196, v196
    v_exp_f32 v197, v197
    s_waitcnt vmcnt(24)
    v_mfma_f32_32x32x16_bf16 v[176:191], v[152:155], a[224:227], 0
    v_exp_f32 v198, v198
    v_exp_f32 v199, v199
    v_exp_f32 v200, v200
    v_exp_f32 v201, v201
    v_smfmac_f32_32x32x32_bf16 v[32:47], v[144:147], v[192:199], v250
    v_exp_f32 v202, v202
    v_exp_f32 v203, v203
    v_exp_f32 v204, v204
    v_exp_f32 v205, v205
    v_exp_f32 v206, v206
    v_exp_f32 v207, v207
    v_exp_f32 v208, v208
    v_exp_f32 v209, v209
    v_smfmac_f32_32x32x32_bf16 v[32:47], v[148:151], v[200:207], v250
    v_exp_f32 v210, v210
    v_exp_f32 v211, v211
    v_exp_f32 v212, v212
    v_exp_f32 v213, v213
    v_mfma_f32_32x32x16_bf16 v[192:207], v[152:155], a[228:231], 0
    v_exp_f32 v214, v214
    v_exp_f32 v215, v215
    v_exp_f32 v216, v216
    v_exp_f32 v217, v217
    v_smfmac_f32_32x32x32_bf16 v[48:63], v[144:147], v[208:215], v250
    s_add_u32 m0, s97, 114688
    s_add_u32 s21, s21, 16384
    buffer_load_dwordx4 v1, s[4:7], s21 offen offset:0 sc1 lds
    buffer_load_dwordx4 v1, s[4:7], s21 offen offset:1024 sc1 lds
    buffer_load_dwordx4 v1, s[4:7], s21 offen offset:2048 sc1 lds
    buffer_load_dwordx4 v1, s[4:7], s21 offen offset:3072 sc1 lds
    v_exp_f32 v218, v218
    v_exp_f32 v219, v219
    v_exp_f32 v220, v220
    v_exp_f32 v221, v221
    v_exp_f32 v222, v222
    v_exp_f32 v223, v223
    v_exp_f32 v224, v224
    v_exp_f32 v225, v225
    v_smfmac_f32_32x32x32_bf16 v[48:63], v[148:151], v[216:223], v250
    v_exp_f32 v226, v226
    v_exp_f32 v227, v227
    v_exp_f32 v228, v228
    v_exp_f32 v229, v229
    v_mfma_f32_32x32x16_bf16 v[208:223], v[152:155], a[232:235], 0
    v_exp_f32 v230, v230
    v_exp_f32 v231, v231
    v_exp_f32 v232, v232
    v_exp_f32 v233, v233
    v_smfmac_f32_32x32x32_bf16 v[64:79], v[144:147], v[224:231], v250
    v_exp_f32 v234, v234
    v_exp_f32 v235, v235
    v_exp_f32 v236, v236
    v_exp_f32 v237, v237
    v_exp_f32 v238, v238
    v_exp_f32 v239, v239
    v_exp_f32 v176, v176
    v_exp_f32 v177, v177
    v_smfmac_f32_32x32x32_bf16 v[64:79], v[148:151], v[232:239], v250
    v_exp_f32 v178, v178
    v_exp_f32 v179, v179
    v_exp_f32 v180, v180
    v_exp_f32 v181, v181
    v_mfma_f32_32x32x16_bf16 v[224:239], v[152:155], a[236:239], 0
    v_exp_f32 v182, v182
    v_exp_f32 v183, v183
    v_exp_f32 v184, v184
    v_exp_f32 v185, v185
    v_smfmac_f32_32x32x32_bf16 v[16:31], v[156:159], v[176:183], v250
    s_xor_b32 s24, s69, 114688
    buffer_load_dwordx4 v[128:131], v248, s[4:7], s24 offen offset:0 sc1
    buffer_load_dwordx4 v[140:143], v248, s[4:7], s24 offen offset:2048 sc1
    s_mov_b64 exec, s[30:31]
    buffer_load_dwordx4 v[132:135], v249, s[4:7], s24 offen offset:1024 sc1
    buffer_load_dwordx4 v[136:139], v249, s[4:7], s24 offen offset:1536 sc1
    buffer_load_dwordx4 v[144:147], v249, s[4:7], s24 offen offset:3072 sc1
    buffer_load_dwordx4 v[148:151], v249, s[4:7], s24 offen offset:3584 sc1
    s_mov_b64 exec, -1
    v_exp_f32 v186, v186
    v_exp_f32 v187, v187
    v_exp_f32 v188, v188
    v_exp_f32 v189, v189
    v_exp_f32 v190, v190
    v_exp_f32 v191, v191
    v_exp_f32 v192, v192
    v_exp_f32 v193, v193
    v_smfmac_f32_32x32x32_bf16 v[16:31], v[160:163], v[184:191], v250
    v_exp_f32 v194, v194
    v_exp_f32 v195, v195
    v_exp_f32 v196, v196
    v_exp_f32 v197, v197
    v_mfma_f32_32x32x16_bf16 v[176:191], v[164:167], a[224:227], 0
    v_exp_f32 v198, v198
    v_exp_f32 v199, v199
    v_exp_f32 v200, v200
    v_exp_f32 v201, v201
    v_smfmac_f32_32x32x32_bf16 v[32:47], v[156:159], v[192:199], v250
    v_exp_f32 v202, v202
    v_exp_f32 v203, v203
    v_exp_f32 v204, v204
    v_exp_f32 v205, v205
    v_exp_f32 v206, v206
    v_exp_f32 v207, v207
    v_exp_f32 v208, v208
    v_exp_f32 v209, v209
    v_smfmac_f32_32x32x32_bf16 v[32:47], v[160:163], v[200:207], v250
    v_exp_f32 v210, v210
    v_exp_f32 v211, v211
    v_exp_f32 v212, v212
    v_exp_f32 v213, v213
    v_mfma_f32_32x32x16_bf16 v[192:207], v[164:167], a[228:231], 0
    v_exp_f32 v214, v214
    v_exp_f32 v215, v215
    v_exp_f32 v216, v216
    v_exp_f32 v217, v217
    v_smfmac_f32_32x32x32_bf16 v[48:63], v[156:159], v[208:215], v250
    v_exp_f32 v218, v218
    v_exp_f32 v219, v219
    v_exp_f32 v220, v220
    v_exp_f32 v221, v221
    v_exp_f32 v222, v222
    v_exp_f32 v223, v223
    v_exp_f32 v224, v224
    v_exp_f32 v225, v225
    v_smfmac_f32_32x32x32_bf16 v[48:63], v[160:163], v[216:223], v250
    v_exp_f32 v226, v226
    v_exp_f32 v227, v227
    v_exp_f32 v228, v228
    v_exp_f32 v229, v229
    v_mfma_f32_32x32x16_bf16 v[208:223], v[164:167], a[232:235], 0
    v_exp_f32 v230, v230
    v_exp_f32 v231, v231
    v_exp_f32 v232, v232
    v_exp_f32 v233, v233
    v_smfmac_f32_32x32x32_bf16 v[64:79], v[156:159], v[224:231], v250
    v_exp_f32 v234, v234
    v_exp_f32 v235, v235
    v_exp_f32 v236, v236
    v_exp_f32 v237, v237
    v_exp_f32 v238, v238
    v_exp_f32 v239, v239
    v_exp_f32 v176, v176
    v_exp_f32 v177, v177
    v_smfmac_f32_32x32x32_bf16 v[64:79], v[160:163], v[232:239], v250
    v_exp_f32 v178, v178
    v_exp_f32 v179, v179
    v_exp_f32 v180, v180
    v_exp_f32 v181, v181
    v_mfma_f32_32x32x16_bf16 v[224:239], v[164:167], a[236:239], 0
    v_exp_f32 v182, v182
    v_exp_f32 v183, v183
    v_exp_f32 v184, v184
    v_exp_f32 v185, v185
    v_smfmac_f32_32x32x32_bf16 v[16:31], v[168:171], v[176:183], v250
    s_getpc_b64 s[90:91]
pc_61:
    s_min_u32 s40, s85, L_end-pc_61-1024
    s_add_u32 s90, s90, s40
    s_addc_u32 s91, s91, 0
    global_load_dword v5, v1, s[90:91] offset:0
    v_exp_f32 v186, v186
    v_exp_f32 v187, v187
    v_exp_f32 v188, v188
    v_exp_f32 v189, v189
    v_exp_f32 v190, v190
    v_exp_f32 v191, v191
    v_exp_f32 v192, v192
    v_exp_f32 v193, v193
    v_smfmac_f32_32x32x32_bf16 v[16:31], v[172:175], v[184:191], v250
    v_exp_f32 v194, v194
    v_exp_f32 v195, v195
    v_exp_f32 v196, v196
    v_exp_f32 v197, v197
    s_waitcnt vmcnt(25)
    v_mfma_f32_32x32x16_bf16 v[176:191], v[80:83], a[224:227], 0
    v_exp_f32 v198, v198
    v_exp_f32 v199, v199
    v_exp_f32 v200, v200
    v_exp_f32 v201, v201
    v_smfmac_f32_32x32x32_bf16 v[32:47], v[168:171], v[192:199], v250
    v_exp_f32 v202, v202
    v_exp_f32 v203, v203
    v_exp_f32 v204, v204
    v_exp_f32 v205, v205
    v_exp_f32 v206, v206
    v_exp_f32 v207, v207
    v_exp_f32 v208, v208
    v_exp_f32 v209, v209
    v_smfmac_f32_32x32x32_bf16 v[32:47], v[172:175], v[200:207], v250
    v_exp_f32 v210, v210
    v_exp_f32 v211, v211
    v_exp_f32 v212, v212
    v_exp_f32 v213, v213
    v_mfma_f32_32x32x16_bf16 v[192:207], v[80:83], a[228:231], 0
    v_exp_f32 v214, v214
    v_exp_f32 v215, v215
    v_exp_f32 v216, v216
    v_exp_f32 v217, v217
    v_smfmac_f32_32x32x32_bf16 v[48:63], v[168:171], v[208:215], v250
    v_exp_f32 v218, v218
    v_exp_f32 v219, v219
    v_exp_f32 v220, v220
    v_exp_f32 v221, v221
    v_exp_f32 v222, v222
    v_exp_f32 v223, v223
    v_exp_f32 v224, v224
    v_exp_f32 v225, v225
    v_smfmac_f32_32x32x32_bf16 v[48:63], v[172:175], v[216:223], v250
    v_exp_f32 v226, v226
    v_exp_f32 v227, v227
    v_exp_f32 v228, v228
    v_exp_f32 v229, v229
    v_mfma_f32_32x32x16_bf16 v[208:223], v[80:83], a[232:235], 0
    v_exp_f32 v230, v230
    v_exp_f32 v231, v231
    v_exp_f32 v232, v232
    v_exp_f32 v233, v233
    v_smfmac_f32_32x32x32_bf16 v[64:79], v[168:171], v[224:231], v250
    v_exp_f32 v234, v234
    v_exp_f32 v235, v235
    v_exp_f32 v236, v236
    v_exp_f32 v237, v237
    v_exp_f32 v238, v238
    v_exp_f32 v239, v239
    v_exp_f32 v176, v176
    v_exp_f32 v177, v177
    v_smfmac_f32_32x32x32_bf16 v[64:79], v[172:175], v[232:239], v250
    v_exp_f32 v178, v178
    v_exp_f32 v179, v179
    v_exp_f32 v180, v180
    v_exp_f32 v181, v181
    v_mfma_f32_32x32x16_bf16 v[224:239], v[80:83], a[236:239], 0
    v_exp_f32 v182, v182
    v_exp_f32 v183, v183
    v_exp_f32 v184, v184
    v_exp_f32 v185, v185
    v_smfmac_f32_32x32x32_bf16 v[16:31], v[84:87], v[176:183], v250
    s_xor_b32 s24, s69, 122880
    buffer_load_dwordx4 v[152:155], v248, s[4:7], s24 offen offset:0 sc1
    buffer_load_dwordx4 v[164:167], v248, s[4:7], s24 offen offset:2048 sc1
    s_mov_b64 exec, s[30:31]
    buffer_load_dwordx4 v[156:159], v249, s[4:7], s24 offen offset:1024 sc1
    buffer_load_dwordx4 v[160:163], v249, s[4:7], s24 offen offset:1536 sc1
    buffer_load_dwordx4 v[168:171], v249, s[4:7], s24 offen offset:3072 sc1
    buffer_load_dwordx4 v[172:175], v249, s[4:7], s24 offen offset:3584 sc1
    s_mov_b64 exec, -1
    v_and_b32 v4, 3968, v251
    buffer_load_dword v5, v4, s[4:7], s73 offen sc1
    v_exp_f32 v186, v186
    v_exp_f32 v187, v187
    v_exp_f32 v188, v188
    v_exp_f32 v189, v189
    v_exp_f32 v190, v190
    v_exp_f32 v191, v191
    v_exp_f32 v192, v192
    v_exp_f32 v193, v193
    v_smfmac_f32_32x32x32_bf16 v[16:31], v[88:91], v[184:191], v250
    v_exp_f32 v194, v194
    v_exp_f32 v195, v195
    v_exp_f32 v196, v196
    v_exp_f32 v197, v197
    v_mfma_f32_32x32x16_bf16 v[176:191], v[92:95], a[224:227], 0
    v_exp_f32 v198, v198
    v_exp_f32 v199, v199
    v_exp_f32 v200, v200
    v_exp_f32 v201, v201
    v_smfmac_f32_32x32x32_bf16 v[32:47], v[84:87], v[192:199], v250
    s_add_u32 s17, s100, 8388608
    buffer_load_dwordx4 v[240:243], v1, s[4:7], s17 offen sc1
    buffer_load_dwordx4 v[244:247], v1, s[4:7], s17 offen offset:1024 sc1
    v_exp_f32 v202, v202
    v_exp_f32 v203, v203
    v_exp_f32 v204, v204
    v_exp_f32 v205, v205
    v_exp_f32 v206, v206
    v_exp_f32 v207, v207
    v_exp_f32 v208, v208
    v_exp_f32 v209, v209
    v_smfmac_f32_32x32x32_bf16 v[32:47], v[88:91], v[200:207], v250
    v_exp_f32 v210, v210
    v_exp_f32 v211, v211
    v_exp_f32 v212, v212
    v_exp_f32 v213, v213
    v_mfma_f32_32x32x16_bf16 v[192:207], v[92:95], a[228:231], 0
    v_exp_f32 v214, v214
    v_exp_f32 v215, v215
    v_exp_f32 v216, v216
    v_exp_f32 v217, v217
    v_smfmac_f32_32x32x32_bf16 v[48:63], v[84:87], v[208:215], v250
    s_add_u32 s73, s73, 4096
    buffer_load_dword v5, v4, s[4:7], s73 offen sc1
    v_exp_f32 v218, v218
    v_exp_f32 v219, v219
    v_exp_f32 v220, v220
    v_exp_f32 v221, v221
    v_exp_f32 v222, v222
    v_exp_f32 v223, v223
    v_exp_f32 v224, v224
    v_exp_f32 v225, v225
    v_smfmac_f32_32x32x32_bf16 v[48:63], v[88:91], v[216:223], v250
    v_exp_f32 v226, v226
    v_exp_f32 v227, v227
    v_exp_f32 v228, v228
    v_exp_f32 v229, v229
    v_mfma_f32_32x32x16_bf16 v[208:223], v[92:95], a[232:235], 0
    v_exp_f32 v230, v230
    v_exp_f32 v231, v231
    v_exp_f32 v232, v232
    v_exp_f32 v233, v233
    v_smfmac_f32_32x32x32_bf16 v[64:79], v[84:87], v[224:231], v250
    v_exp_f32 v234, v234
    v_exp_f32 v235, v235
    v_exp_f32 v236, v236
    v_exp_f32 v237, v237
    v_exp_f32 v238, v238
    v_exp_f32 v239, v239
    v_exp_f32 v176, v176
    v_exp_f32 v177, v177
    v_smfmac_f32_32x32x32_bf16 v[64:79], v[88:91], v[232:239], v250
    v_exp_f32 v178, v178
    v_exp_f32 v179, v179
    v_exp_f32 v180, v180
    v_exp_f32 v181, v181
    v_mfma_f32_32x32x16_bf16 v[224:239], v[92:95], a[236:239], 0
    v_exp_f32 v182, v182
    v_exp_f32 v183, v183
    v_exp_f32 v184, v184
    v_exp_f32 v185, v185
    v_smfmac_f32_32x32x32_bf16 v[16:31], v[96:99], v[176:183], v250
    s_add_u32 s73, s73, 4096
    buffer_load_dword v5, v4, s[4:7], s73 offen sc1
    v_exp_f32 v186, v186
    v_exp_f32 v187, v187
    v_exp_f32 v188, v188
    v_exp_f32 v189, v189
    v_exp_f32 v190, v190
    v_exp_f32 v191, v191
    v_exp_f32 v192, v192
    v_exp_f32 v193, v193
    v_smfmac_f32_32x32x32_bf16 v[16:31], v[100:103], v[184:191], v250
    v_exp_f32 v194, v194
    v_exp_f32 v195, v195
    v_exp_f32 v196, v196
    v_exp_f32 v197, v197
    s_waitcnt vmcnt(26)
    v_mfma_f32_32x32x16_bf16 v[176:191], v[104:107], a[224:227], 0
    v_exp_f32 v198, v198
    v_exp_f32 v199, v199
    v_exp_f32 v200, v200
    v_exp_f32 v201, v201
    v_smfmac_f32_32x32x32_bf16 v[32:47], v[96:99], v[192:199], v250
    v_exp_f32 v202, v202
    v_exp_f32 v203, v203
    v_exp_f32 v204, v204
    v_exp_f32 v205, v205
    v_exp_f32 v206, v206
    v_exp_f32 v207, v207
    v_exp_f32 v208, v208
    v_exp_f32 v209, v209
    v_smfmac_f32_32x32x32_bf16 v[32:47], v[100:103], v[200:207], v250
    v_exp_f32 v210, v210
    v_exp_f32 v211, v211
    v_exp_f32 v212, v212
    v_exp_f32 v213, v213
    v_mfma_f32_32x32x16_bf16 v[192:207], v[104:107], a[228:231], 0
    v_exp_f32 v214, v214
    v_exp_f32 v215, v215
    v_exp_f32 v216, v216
    v_exp_f32 v217, v217
    v_smfmac_f32_32x32x32_bf16 v[48:63], v[96:99], v[208:215], v250
    v_and_b32 v4, 3968, v251
    buffer_load_dword v5, v4, s[4:7], s72 offen sc1
    v_exp_f32 v218, v218
    v_exp_f32 v219, v219
    v_exp_f32 v220, v220
    v_exp_f32 v221, v221
    v_exp_f32 v222, v222
    v_exp_f32 v223, v223
    v_exp_f32 v224, v224
    v_exp_f32 v225, v225
    v_smfmac_f32_32x32x32_bf16 v[48:63], v[100:103], v[216:223], v250
    v_exp_f32 v226, v226
    v_exp_f32 v227, v227
    v_exp_f32 v228, v228
    v_exp_f32 v229, v229
    v_mfma_f32_32x32x16_bf16 v[208:223], v[104:107], a[232:235], 0
    v_exp_f32 v230, v230
    v_exp_f32 v231, v231
    v_exp_f32 v232, v232
    v_exp_f32 v233, v233
    v_smfmac_f32_32x32x32_bf16 v[64:79], v[96:99], v[224:231], v250
    v_exp_f32 v234, v234
    v_exp_f32 v235, v235
    v_exp_f32 v236, v236
    v_exp_f32 v237, v237
    v_exp_f32 v238, v238
    v_exp_f32 v239, v239
    v_exp_f32 v176, v176
    v_exp_f32 v177, v177
    v_smfmac_f32_32x32x32_bf16 v[64:79], v[100:103], v[232:239], v250
    v_exp_f32 v178, v178
    v_exp_f32 v179, v179
    v_exp_f32 v180, v180
    v_exp_f32 v181, v181
    v_mfma_f32_32x32x16_bf16 v[224:239], v[104:107], a[236:239], 0
    v_exp_f32 v182, v182
    v_exp_f32 v183, v183
    v_exp_f32 v184, v184
    v_exp_f32 v185, v185
    v_smfmac_f32_32x32x32_bf16 v[16:31], v[108:111], v[176:183], v250
    v_exp_f32 v186, v186
    v_exp_f32 v187, v187
    v_exp_f32 v188, v188
    v_exp_f32 v189, v189
    v_exp_f32 v190, v190
    v_exp_f32 v191, v191
    v_exp_f32 v192, v192
    v_exp_f32 v193, v193
    v_smfmac_f32_32x32x32_bf16 v[16:31], v[112:115], v[184:191], v250
    v_exp_f32 v194, v194
    v_exp_f32 v195, v195
    v_exp_f32 v196, v196
    v_exp_f32 v197, v197
    v_mfma_f32_32x32x16_bf16 v[176:191], v[116:119], a[224:227], 0
    v_exp_f32 v198, v198
    v_exp_f32 v199, v199
    v_exp_f32 v200, v200
    v_exp_f32 v201, v201
    v_smfmac_f32_32x32x32_bf16 v[32:47], v[108:111], v[192:199], v250
    s_add_u32 s72, s72, 4096
    buffer_load_dword v5, v4, s[4:7], s72 offen sc1
    v_exp_f32 v202, v202
    v_exp_f32 v203, v203
    v_exp_f32 v204, v204
    v_exp_f32 v205, v205
    v_exp_f32 v206, v206
    v_exp_f32 v207, v207
    v_exp_f32 v208, v208
    v_exp_f32 v209, v209
    v_smfmac_f32_32x32x32_bf16 v[32:47], v[112:115], v[200:207], v250
    v_exp_f32 v210, v210
    v_exp_f32 v211, v211
    v_exp_f32 v212, v212
    v_exp_f32 v213, v213
    v_mfma_f32_32x32x16_bf16 v[192:207], v[116:119], a[228:231], 0
    v_exp_f32 v214, v214
    v_exp_f32 v215, v215
    v_exp_f32 v216, v216
    v_exp_f32 v217, v217
    v_smfmac_f32_32x32x32_bf16 v[48:63], v[108:111], v[208:215], v250
    buffer_load_dword v5, v252, s[4:7], 0 offen sc1
    v_exp_f32 v218, v218
    v_exp_f32 v219, v219
    v_exp_f32 v220, v220
    v_exp_f32 v221, v221
    v_exp_f32 v222, v222
    v_exp_f32 v223, v223
    v_exp_f32 v224, v224
    v_exp_f32 v225, v225
    v_smfmac_f32_32x32x32_bf16 v[48:63], v[112:115], v[216:223], v250
    v_exp_f32 v226, v226
    v_exp_f32 v227, v227
    v_exp_f32 v228, v228
    v_exp_f32 v229, v229
    v_mfma_f32_32x32x16_bf16 v[208:223], v[116:119], a[232:235], 0
    v_exp_f32 v230, v230
    v_exp_f32 v231, v231
    v_exp_f32 v232, v232
    v_exp_f32 v233, v233
    v_smfmac_f32_32x32x32_bf16 v[64:79], v[108:111], v[224:231], v250
    v_exp_f32 v234, v234
    v_exp_f32 v235, v235
    v_exp_f32 v236, v236
    v_exp_f32 v237, v237
    v_exp_f32 v238, v238
    v_exp_f32 v239, v239
    v_exp_f32 v176, v176
    v_exp_f32 v177, v177
    v_smfmac_f32_32x32x32_bf16 v[64:79], v[112:115], v[232:239], v250
    v_exp_f32 v178, v178
    v_exp_f32 v179, v179
    v_exp_f32 v180, v180
    v_exp_f32 v181, v181
    v_mfma_f32_32x32x16_bf16 v[224:239], v[116:119], a[236:239], 0
    v_exp_f32 v182, v182
    v_exp_f32 v183, v183
    v_exp_f32 v184, v184
    v_exp_f32 v185, v185
    v_smfmac_f32_32x32x32_bf16 v[16:31], v[120:123], v[176:183], v250
    v_exp_f32 v186, v186
    v_exp_f32 v187, v187
    v_exp_f32 v188, v188
    v_exp_f32 v189, v189
    v_exp_f32 v190, v190
    v_exp_f32 v191, v191
    v_exp_f32 v192, v192
    v_exp_f32 v193, v193
    v_smfmac_f32_32x32x32_bf16 v[16:31], v[124:127], v[184:191], v250
    v_exp_f32 v194, v194
    v_exp_f32 v195, v195
    v_exp_f32 v196, v196
    v_exp_f32 v197, v197
    s_waitcnt vmcnt(15)
    v_mfma_f32_32x32x16_bf16 v[176:191], v[128:131], a[224:227], 0
    v_exp_f32 v198, v198
    v_exp_f32 v199, v199
    v_exp_f32 v200, v200
    v_exp_f32 v201, v201
    v_smfmac_f32_32x32x32_bf16 v[32:47], v[120:123], v[192:199], v250
    v_exp_f32 v202, v202
    v_exp_f32 v203, v203
    v_exp_f32 v204, v204
    v_exp_f32 v205, v205
    v_exp_f32 v206, v206
    v_exp_f32 v207, v207
    v_exp_f32 v208, v208
    v_exp_f32 v209, v209
    v_smfmac_f32_32x32x32_bf16 v[32:47], v[124:127], v[200:207], v250
    v_exp_f32 v210, v210
    v_exp_f32 v211, v211
    v_exp_f32 v212, v212
    v_exp_f32 v213, v213
    v_mfma_f32_32x32x16_bf16 v[192:207], v[128:131], a[228:231], 0
    v_exp_f32 v214, v214
    v_exp_f32 v215, v215
    v_exp_f32 v216, v216
    v_exp_f32 v217, v217
    v_smfmac_f32_32x32x32_bf16 v[48:63], v[120:123], v[208:215], v250
    v_exp_f32 v218, v218
    v_exp_f32 v219, v219
    v_exp_f32 v220, v220
    v_exp_f32 v221, v221
    v_exp_f32 v222, v222
    v_exp_f32 v223, v223
    v_exp_f32 v224, v224
    v_exp_f32 v225, v225
    v_smfmac_f32_32x32x32_bf16 v[48:63], v[124:127], v[216:223], v250
    v_exp_f32 v226, v226
    v_exp_f32 v227, v227
    v_exp_f32 v228, v228
    v_exp_f32 v229, v229
    v_mfma_f32_32x32x16_bf16 v[208:223], v[128:131], a[232:235], 0
    v_exp_f32 v230, v230
    v_exp_f32 v231, v231
    v_exp_f32 v232, v232
    v_exp_f32 v233, v233
    v_smfmac_f32_32x32x32_bf16 v[64:79], v[120:123], v[224:231], v250
    v_exp_f32 v234, v234
    v_exp_f32 v235, v235
    v_exp_f32 v236, v236
    v_exp_f32 v237, v237
    v_exp_f32 v238, v238
    v_exp_f32 v239, v239
    v_exp_f32 v176, v176
    v_exp_f32 v177, v177
    v_smfmac_f32_32x32x32_bf16 v[64:79], v[124:127], v[232:239], v250
    v_exp_f32 v178, v178
    v_exp_f32 v179, v179
    v_exp_f32 v180, v180
    v_exp_f32 v181, v181
    v_mfma_f32_32x32x16_bf16 v[224:239], v[128:131], a[236:239], 0
    v_exp_f32 v182, v182
    v_exp_f32 v183, v183
    v_exp_f32 v184, v184
    v_exp_f32 v185, v185
    v_smfmac_f32_32x32x32_bf16 v[16:31], v[132:135], v[176:183], v250
    s_mul_i32 s16, s12, 6144
    s_add_u32 s16, s16, 139264
    v_add_u32 v13, s16, v1
    s_xor_b32 s16, s12, 2
    s_mul_i32 s16, s16, 6144
    s_add_u32 s16, s16, 139264
    v_add_u32 v10, s16, v1
    v_exp_f32 v186, v186
    v_exp_f32 v187, v187
    v_exp_f32 v188, v188
    v_exp_f32 v189, v189
    v_exp_f32 v190, v190
    v_exp_f32 v191, v191
    v_exp_f32 v192, v192
    v_exp_f32 v193, v193
    v_smfmac_f32_32x32x32_bf16 v[16:31], v[136:139], v[184:191], v250
    v_exp_f32 v194, v194
    v_exp_f32 v195, v195
    v_exp_f32 v196, v196
    v_exp_f32 v197, v197
    v_mfma_f32_32x32x16_bf16 v[176:191], v[140:143], a[232:235], 0
    v_exp_f32 v198, v198
    v_exp_f32 v199, v199
    v_exp_f32 v200, v200
    v_exp_f32 v201, v201
    v_smfmac_f32_32x32x32_bf16 v[32:47], v[132:135], v[192:199], v250
    v_exp_f32 v202, v202
    v_exp_f32 v203, v203
    v_exp_f32 v204, v204
    v_exp_f32 v205, v205
    v_exp_f32 v206, v206
    v_exp_f32 v207, v207
    v_exp_f32 v208, v208
    v_exp_f32 v209, v209
    v_smfmac_f32_32x32x32_bf16 v[32:47], v[136:139], v[200:207], v250
    v_exp_f32 v210, v210
    v_exp_f32 v211, v211
    v_exp_f32 v212, v212
    v_exp_f32 v213, v213
    s_waitcnt vmcnt(8)
    v_mfma_f32_32x32x16_bf16 v[192:207], v[152:155], a[232:235], 0
    v_exp_f32 v214, v214
    v_exp_f32 v215, v215
    v_exp_f32 v216, v216
    v_exp_f32 v217, v217
    v_smfmac_f32_32x32x32_bf16 v[48:63], v[132:135], v[208:215], v250
    v_exp_f32 v218, v218
    v_exp_f32 v219, v219
    v_exp_f32 v220, v220
    v_exp_f32 v221, v221
    v_exp_f32 v222, v222
    v_exp_f32 v223, v223
    v_exp_f32 v224, v224
    v_exp_f32 v225, v225
    v_smfmac_f32_32x32x32_bf16 v[48:63], v[136:139], v[216:223], v250
    v_exp_f32 v226, v226
    v_exp_f32 v227, v227
    v_exp_f32 v228, v228
    v_exp_f32 v229, v229
    v_mfma_f32_32x32x16_bf16 v[208:223], v[164:167], a[232:235], 0
    v_exp_f32 v230, v230
    v_exp_f32 v231, v231
    v_exp_f32 v232, v232
    v_exp_f32 v233, v233
    v_smfmac_f32_32x32x32_bf16 v[64:79], v[132:135], v[224:231], v250
    v_exp_f32 v234, v234
    v_exp_f32 v235, v235
    v_exp_f32 v236, v236
    v_exp_f32 v237, v237
    v_exp_f32 v238, v238
    v_exp_f32 v239, v239
    v_exp_f32 v176, v176
    v_exp_f32 v177, v177
    v_smfmac_f32_32x32x32_bf16 v[64:79], v[136:139], v[232:239], v250
    v_exp_f32 v178, v178
    v_exp_f32 v179, v179
    v_exp_f32 v180, v180
    v_exp_f32 v181, v181
    v_mfma_f32_32x32x16_bf16 v[224:239], v[140:143], a[236:239], 0
    v_exp_f32 v182, v182
    v_exp_f32 v183, v183
    v_exp_f32 v184, v184
    v_exp_f32 v185, v185
    v_smfmac_f32_32x32x32_bf16 v[48:63], v[144:147], v[176:183], v250
    v_exp_f32 v186, v186
    v_exp_f32 v187, v187
    v_exp_f32 v188, v188
    v_exp_f32 v189, v189
    v_exp_f32 v190, v190
    v_exp_f32 v191, v191
    v_exp_f32 v192, v192
    v_exp_f32 v193, v193
    v_smfmac_f32_32x32x32_bf16 v[48:63], v[148:151], v[184:191], v250
    v_exp_f32 v194, v194
    v_exp_f32 v195, v195
    v_exp_f32 v196, v196
    v_exp_f32 v197, v197
    v_mfma_f32_32x32x16_bf16 v[176:191], v[152:155], a[236:239], 0
    v_exp_f32 v198, v198
    v_exp_f32 v199, v199
    v_exp_f32 v200, v200
    v_exp_f32 v201, v201
    v_smfmac_f32_32x32x32_bf16 v[48:63], v[156:159], v[192:199], v250
    v_exp_f32 v202, v202
    v_exp_f32 v203, v203
    v_exp_f32 v204, v204
    v_exp_f32 v205, v205
    v_exp_f32 v206, v206
    v_exp_f32 v207, v207
    v_exp_f32 v208, v208
    v_exp_f32 v209, v209
    v_smfmac_f32_32x32x32_bf16 v[48:63], v[160:163], v[200:207], v250
    v_exp_f32 v210, v210
    v_exp_f32 v211, v211
    v_exp_f32 v212, v212
    v_exp_f32 v213, v213
    v_mfma_f32_32x32x16_bf16 v[192:207], v[164:167], a[236:239], 0
    v_exp_f32 v214, v214
    v_exp_f32 v215, v215
    v_exp_f32 v216, v216
    v_exp_f32 v217, v217
    v_smfmac_f32_32x32x32_bf16 v[48:63], v[168:171], v[208:215], v250
    v_exp_f32 v218, v218
    v_exp_f32 v219, v219
    v_exp_f32 v220, v220
    v_exp_f32 v221, v221
    v_exp_f32 v222, v222
    v_exp_f32 v223, v223
    v_exp_f32 v224, v224
    v_exp_f32 v225, v225
    v_smfmac_f32_32x32x32_bf16 v[48:63], v[172:175], v[216:223], v250
    v_exp_f32 v226, v226
    v_exp_f32 v227, v227
    v_exp_f32 v228, v228
    v_exp_f32 v229, v229
    v_mfma_f32_32x32x16_bf16 v[208:223], v[140:143], a[224:227], 0
    v_exp_f32 v230, v230
    v_exp_f32 v231, v231
    v_exp_f32 v232, v232
    v_exp_f32 v233, v233
    v_smfmac_f32_32x32x32_bf16 v[64:79], v[144:147], v[224:231], v250
    v_exp_f32 v234, v234
    v_exp_f32 v235, v235
    v_exp_f32 v236, v236
    v_exp_f32 v237, v237
    v_exp_f32 v238, v238
    v_exp_f32 v239, v239
    v_exp_f32 v176, v176
    v_exp_f32 v177, v177
    v_smfmac_f32_32x32x32_bf16 v[64:79], v[148:151], v[232:239], v250
    ds_write_b128 v10, v[48:51] offset:0
    ds_write_b128 v10, v[52:55] offset:1024
    ds_write_b32 v10, v56 offset:2048
    v_exp_f32 v178, v178
    v_exp_f32 v179, v179
    v_exp_f32 v180, v180
    v_exp_f32 v181, v181
    v_mfma_f32_32x32x16_bf16 v[224:239], v[152:155], a[224:227], 0
    v_exp_f32 v182, v182
    v_exp_f32 v183, v183
    v_exp_f32 v184, v184
    v_exp_f32 v185, v185
    v_smfmac_f32_32x32x32_bf16 v[64:79], v[156:159], v[176:183], v250
    v_exp_f32 v186, v186
    v_exp_f32 v187, v187
    v_exp_f32 v188, v188
    v_exp_f32 v189, v189
    v_exp_f32 v190, v190
    v_exp_f32 v191, v191
    v_exp_f32 v192, v192
    v_exp_f32 v193, v193
    v_smfmac_f32_32x32x32_bf16 v[64:79], v[160:163], v[184:191], v250
    v_exp_f32 v194, v194
    v_exp_f32 v195, v195
    v_exp_f32 v196, v196
    v_exp_f32 v197, v197
    v_mfma_f32_32x32x16_bf16 v[176:191], v[164:167], a[224:227], 0
    v_exp_f32 v198, v198
    v_exp_f32 v199, v199
    v_exp_f32 v200, v200
    v_exp_f32 v201, v201
    v_smfmac_f32_32x32x32_bf16 v[64:79], v[168:171], v[192:199], v250
    v_exp_f32 v202, v202
    v_exp_f32 v203, v203
    v_exp_f32 v204, v204
    v_exp_f32 v205, v205
    v_exp_f32 v206, v206
    v_exp_f32 v207, v207
    v_exp_f32 v208, v208
    v_exp_f32 v209, v209
    v_smfmac_f32_32x32x32_bf16 v[64:79], v[172:175], v[200:207], v250
    v_exp_f32 v210, v210
    v_exp_f32 v211, v211
    v_exp_f32 v212, v212
    v_exp_f32 v213, v213
    v_mfma_f32_32x32x16_bf16 v[192:207], v[140:143], a[228:231], 0
    v_exp_f32 v214, v214
    v_exp_f32 v215, v215
    v_exp_f32 v216, v216
    v_exp_f32 v217, v217
    v_smfmac_f32_32x32x32_bf16 v[16:31], v[144:147], v[208:215], v250
    v_exp_f32 v218, v218
    v_exp_f32 v219, v219
    v_exp_f32 v220, v220
    v_exp_f32 v221, v221
    v_exp_f32 v222, v222
    v_exp_f32 v223, v223
    v_exp_f32 v224, v224
    v_exp_f32 v225, v225
    v_smfmac_f32_32x32x32_bf16 v[16:31], v[148:151], v[216:223], v250
    ds_write_b128 v10, v[64:67] offset:3072
    ds_write_b128 v10, v[68:71] offset:4096
    ds_write_b32 v10, v72 offset:5120
    v_exp_f32 v226, v226
    v_exp_f32 v227, v227
    v_exp_f32 v228, v228
    v_exp_f32 v229, v229
    v_mfma_f32_32x32x16_bf16 v[208:223], v[152:155], a[228:231], 0
    v_exp_f32 v230, v230
    v_exp_f32 v231, v231
    v_exp_f32 v232, v232
    v_exp_f32 v233, v233
    v_smfmac_f32_32x32x32_bf16 v[16:31], v[156:159], v[224:231], v250
    v_exp_f32 v234, v234
    v_exp_f32 v235, v235
    v_exp_f32 v236, v236
    v_exp_f32 v237, v237
    v_exp_f32 v238, v238
    v_exp_f32 v239, v239
    v_exp_f32 v176, v176
    v_exp_f32 v177, v177
    v_smfmac_f32_32x32x32_bf16 v[16:31], v[160:163], v[232:239], v250
    v_exp_f32 v178, v178
    v_exp_f32 v179, v179
    v_exp_f32 v180, v180
    v_exp_f32 v181, v181
    v_mfma_f32_32x32x16_bf16 v[224:239], v[164:167], a[228:231], 0
    v_exp_f32 v182, v182
    v_exp_f32 v183, v183
    v_exp_f32 v184, v184
    v_exp_f32 v185, v185
    v_smfmac_f32_32x32x32_bf16 v[16:31], v[168:171], v[176:183], v250
    v_exp_f32 v186, v186
    v_exp_f32 v187, v187
    v_exp_f32 v188, v188
    v_exp_f32 v189, v189
    v_exp_f32 v190, v190
    v_exp_f32 v191, v191
    v_exp_f32 v192, v192
    v_exp_f32 v193, v193
    v_smfmac_f32_32x32x32_bf16 v[16:31], v[172:175], v[184:191], v250
    v_exp_f32 v194, v194
    v_exp_f32 v195, v195
    v_exp_f32 v196, v196
    v_exp_f32 v197, v197
    v_exp_f32 v198, v198
    v_exp_f32 v199, v199
    v_exp_f32 v200, v200
    v_exp_f32 v201, v201
    v_smfmac_f32_32x32x32_bf16 v[32:47], v[144:147], v[192:199], v250
    v_exp_f32 v202, v202
    v_exp_f32 v203, v203
    v_exp_f32 v204, v204
    v_exp_f32 v205, v205
    v_exp_f32 v206, v206
    v_exp_f32 v207, v207
    v_exp_f32 v208, v208
    v_exp_f32 v209, v209
    v_smfmac_f32_32x32x32_bf16 v[32:47], v[148:151], v[200:207], v250
    v_exp_f32 v210, v210
    v_exp_f32 v211, v211
    v_exp_f32 v212, v212
    v_exp_f32 v213, v213
    v_exp_f32 v214, v214
    v_exp_f32 v215, v215
    v_exp_f32 v216, v216
    v_exp_f32 v217, v217
    v_smfmac_f32_32x32x32_bf16 v[32:47], v[156:159], v[208:215], v250
    s_waitcnt lgkmcnt(0)
    s_barrier
    ds_read_b32 v56, v13 offset:2048
    ds_read_b128 v[48:51], v13 offset:0
    ds_read_b128 v[52:55], v13 offset:1024
    ds_read_b32 v72, v13 offset:5120
    ds_read_b128 v[64:67], v13 offset:3072
    ds_read_b128 v[68:71], v13 offset:4096
    v_exp_f32 v218, v218
    v_exp_f32 v219, v219
    v_exp_f32 v220, v220
    v_exp_f32 v221, v221
    v_exp_f32 v222, v222
    v_exp_f32 v223, v223
    v_exp_f32 v224, v224
    v_exp_f32 v225, v225
    v_smfmac_f32_32x32x32_bf16 v[32:47], v[160:163], v[216:223], v250
    v_exp_f32 v226, v226
    v_exp_f32 v227, v227
    v_exp_f32 v228, v228
    v_exp_f32 v229, v229
    v_exp_f32 v230, v230
    v_exp_f32 v231, v231
    v_exp_f32 v232, v232
    v_exp_f32 v233, v233
    v_smfmac_f32_32x32x32_bf16 v[32:47], v[168:171], v[224:231], v250
    v_exp_f32 v234, v234
    v_exp_f32 v235, v235
    v_exp_f32 v236, v236
    v_exp_f32 v237, v237
    v_exp_f32 v238, v238
    v_exp_f32 v239, v239
    s_nop 1
    v_smfmac_f32_32x32x32_bf16 v[32:47], v[172:175], v[232:239], v250
    s_waitcnt lgkmcnt(3)
    v_add_f32 v24, v24, v56
    v_rcp_f32 v25, v24
    v_add_f32 v16, v16, v48
    v_add_f32 v17, v17, v49
    v_add_f32 v18, v18, v50
    v_add_f32 v19, v19, v51
    v_add_f32 v20, v20, v52
    v_add_f32 v21, v21, v53
    v_add_f32 v22, v22, v54
    v_add_f32 v23, v23, v55
    v_mul_f32 v16, v16, v25
    v_mul_f32 v17, v17, v25
    v_cvt_pk_bf16_f32 v28, v16, v17
    v_mul_f32 v18, v18, v25
    v_mul_f32 v19, v19, v25
    v_cvt_pk_bf16_f32 v29, v18, v19
    v_mul_f32 v20, v20, v25
    v_mul_f32 v21, v21, v25
    v_cvt_pk_bf16_f32 v30, v20, v21
    v_mul_f32 v22, v22, v25
    v_mul_f32 v23, v23, v25
    v_cvt_pk_bf16_f32 v31, v22, v23
    buffer_store_dwordx4 v[28:31], v1, s[4:7], s64 offen
    s_waitcnt lgkmcnt(0)
    v_add_f32 v40, v40, v72
    v_rcp_f32 v41, v40
    v_add_f32 v32, v32, v64
    v_add_f32 v33, v33, v65
    v_add_f32 v34, v34, v66
    v_add_f32 v35, v35, v67
    v_add_f32 v36, v36, v68
    v_add_f32 v37, v37, v69
    v_add_f32 v38, v38, v70
    v_add_f32 v39, v39, v71
    v_mul_f32 v32, v32, v41
    v_mul_f32 v33, v33, v41
    v_cvt_pk_bf16_f32 v44, v32, v33
    v_mul_f32 v34, v34, v41
    v_mul_f32 v35, v35, v41
    v_cvt_pk_bf16_f32 v45, v34, v35
    v_mul_f32 v36, v36, v41
    v_mul_f32 v37, v37, v41
    v_cvt_pk_bf16_f32 v46, v36, v37
    v_mul_f32 v38, v38, v41
    v_mul_f32 v39, v39, v41
    v_cvt_pk_bf16_f32 v47, v38, v39
    buffer_store_dwordx4 v[44:47], v1, s[4:7], s65 offen
    v_add_f32 v16, v16, v17
    v_add_f32 v18, v18, v19
    v_add_f32 v20, v20, v21
    v_add_f32 v22, v22, v23
    v_add_f32 v16, v16, v18
    v_add_f32 v20, v20, v22
    v_add_f32 v16, v16, v20
    v_fma_f32 v24, v16, 0, v24
    v_subrev_u32 v24, 0x21800000, v24
    v_add_f32 v32, v32, v33
    v_add_f32 v34, v34, v35
    v_add_f32 v36, v36, v37
    v_add_f32 v38, v38, v39
    v_add_f32 v32, v32, v34
    v_add_f32 v36, v36, v38
    v_add_f32 v32, v32, v36
    v_fma_f32 v40, v32, 0, v40
    v_subrev_u32 v40, 0x21800000, v40
    v_max_u32 v24, v24, v40
    v_cmp_lt_u32 vcc, 0x3c000000, v24
    s_nop 0
    s_cbranch_vccnz fb_62
fbret_63:
    s_waitcnt vmcnt(2)
    s_mov_b32 s41, s79
    s_sub_u32 s21, s21, s97
    s_add_u32 s21, s21, 12288
L_wo1:
    s_lshr_b32 s22, s100, 15
    s_lshr_b32 s26, s12, 1
    s_mul_i32 s20, s22, 114688
    s_lshl_b32 s16, s26, 14
    s_add_u32 s20, s20, s16
    s_add_u32 s20, s20, 10485760
    s_lshl_b32 s16, s26, 11
    v_add_u32 v3, s16, v1
    v_add_u32 v4, 0x10000, v3
    v_add_u32 v5, 0x20000, v3
    s_barrier
    ds_read_b128 a[224:227], v3 offset:1024
    ds_read_b128 a[228:231], v3 offset:0
    ds_read_b128 a[232:235], v3 offset:5120
    ds_read_b128 a[236:239], v3 offset:4096
    v_mov_b32 v14, s32
    v_mov_b32 v15, s33
    s_cmp_eq_u32 s34, 0
    s_cbranch_scc1 slow_64
    s_waitcnt vmcnt(0)
    buffer_store_dwordx2 v[14:15], off, s[4:7], s41
join_65:
    s_and_b32 s41, s22, 0xfe
    s_add_u32 s41, s41, s26
    s_lshl_b32 s41, s41, 7
    s_add_u32 s41, s41, 8105984
    s_xor_b32 s16, s12, 2
    s_lshl_b32 s16, s16, 12
    s_add_u32 s16, s16, 147456
    v_add_u32 v6, s16, v1
    s_lshl_b32 s16, s12, 12
    s_add_u32 s16, s16, 147456
    v_add_u32 v7, s16, v1
    v_lshlrev_b32 v120, 16, v240
    v_and_b32 v121, 0xffff0000, v240
    v_lshlrev_b32 v122, 16, v241
    v_and_b32 v123, 0xffff0000, v241
    v_lshlrev_b32 v124, 16, v242
    v_and_b32 v125, 0xffff0000, v242
    v_lshlrev_b32 v126, 16, v243
    v_and_b32 v127, 0xffff0000, v243
    v_lshlrev_b32 v128, 16, v244
    v_and_b32 v129, 0xffff0000, v244
    v_lshlrev_b32 v130, 16, v245
    v_and_b32 v131, 0xffff0000, v245
    v_lshlrev_b32 v132, 16, v246
    v_and_b32 v133, 0xffff0000, v246
    v_lshlrev_b32 v134, 16, v247
    v_and_b32 v135, 0xffff0000, v247
    s_branch nr_66
ap_47:
    s_mov_b32 s40, 0x40000
ap_47_l:
    buffer_load_dwordx2 v[14:15], v13, s[4:7], s41 offen sc1
    s_sub_u32 s40, s40, 1
    s_cbranch_scc1 L_abort
    s_waitcnt vmcnt(0)
    v_cmp_ne_u64 vcc, s[32:33], v[14:15]
    s_nop 0
    s_cbranch_vccnz ap_47_l
    s_branch apok_48
ap_52:
    s_mov_b32 s40, 0x40000
ap_52_l:
    buffer_load_dwordx2 v[8:9], v12, s[4:7], s26 offen sc1
    s_sub_u32 s40, s40, 1
    s_cbranch_scc1 L_abort
    s_waitcnt vmcnt(0)
    v_cmp_ne_u64 vcc, s[32:33], v[8:9]
    s_nop 0
    s_cbranch_vccnz ap_52_l
    s_branch apok_53
ap_54:
    s_mov_b32 s40, 0x40000
ap_54_l:
    buffer_load_dwordx2 v[10:11], v253, s[4:7], s68 offen sc1
    s_sub_u32 s40, s40, 1
    s_cbranch_scc1 L_abort
    s_waitcnt vmcnt(0)
    v_cmp_ne_u64 vcc, s[32:33], v[10:11]
    s_nop 0
    s_and_b32 s19, vcc_lo, 0xc
    s_cbranch_scc1 ap_54_l
    s_branch apok_55
ap_57:
    s_mov_b32 s40, 0x40000
ap_57_l:
    buffer_load_dwordx2 v[8:9], v253, s[4:7], s68 offen sc1
    s_sub_u32 s40, s40, 1
    s_cbranch_scc1 L_abort
    s_waitcnt vmcnt(0)
    v_cmp_ne_u64 vcc, s[32:33], v[8:9]
    s_nop 0
    s_and_b32 s19, vcc_lo, 0xf0
    s_cbranch_scc1 ap_57_l
    s_branch apok_58
ap_59:
    s_mov_b32 s40, 0x40000
ap_59_l:
    buffer_load_dwordx2 v[8:9], v253, s[4:7], s68 offen sc1
    s_sub_u32 s40, s40, 1
    s_cbranch_scc1 L_abort
    s_waitcnt vmcnt(0)
    v_cmp_ne_u64 vcc, s[32:33], v[8:9]
    s_nop 0
    s_cbranch_vccnz ap_59_l
    s_branch apok_60
nr_66:
    v_and_b32 v13, 15, v0
    v_lshlrev_b32 v13, 3, v13
    s_mov_b32 s40, 0x40000
poll_67:
    buffer_load_dwordx2 v[14:15], v13, s[4:7], s41 offen sc1
    s_sub_u32 s40, s40, 1
    s_cbranch_scc1 L_abort
    s_waitcnt vmcnt(0)
    v_cmp_ne_u64 vcc, s[32:33], v[14:15]
    s_nop 0
    s_cbranch_vccnz poll_67
    buffer_load_dwordx4 v[16:19], v1, s[4:7], s20 offen offset:0 sc1
    buffer_load_dwordx4 v[20:23], v1, s[4:7], s20 offen offset:1024 sc1
    buffer_load_dwordx4 v[24:27], v1, s[4:7], s20 offen offset:2048 sc1
    buffer_load_dwordx4 v[28:31], v1, s[4:7], s20 offen offset:3072 sc1
    s_add_u32 s20, s20, 4096
    buffer_load_dwordx4 v[32:35], v1, s[4:7], s20 offen offset:0 sc1
    buffer_load_dwordx4 v[36:39], v1, s[4:7], s20 offen offset:1024 sc1
    buffer_load_dwordx4 v[40:43], v1, s[4:7], s20 offen offset:2048 sc1
    buffer_load_dwordx4 v[44:47], v1, s[4:7], s20 offen offset:3072 sc1
    s_add_u32 s20, s20, 4096
    buffer_load_dwordx4 v[48:51], v1, s[4:7], s20 offen offset:0 sc1
    buffer_load_dwordx4 v[52:55], v1, s[4:7], s20 offen offset:1024 sc1
    s_waitcnt vmcnt(9) lgkmcnt(2)
    v_mfma_f32_32x32x16_bf16 v[96:111], a[224:227], v[16:19], 0
    ds_read_b128 a[240:243], v3 offset:9216
    ds_read_b128 a[244:247], v3 offset:8192
    v_mfma_f32_32x32x16_bf16 v[80:95], a[228:231], v[16:19], 0
    buffer_load_dwordx4 v[56:59], v1, s[4:7], s20 offen offset:2048 sc1
    s_waitcnt vmcnt(9) lgkmcnt(2)
    v_mfma_f32_32x32x16_bf16 v[96:111], a[232:235], v[20:23], v[96:111]
    ds_read_b128 a[248:251], v3 offset:13312
    ds_read_b128 a[252:255], v3 offset:12288
    v_mfma_f32_32x32x16_bf16 v[80:95], a[236:239], v[20:23], v[80:95]
    buffer_load_dwordx4 v[60:63], v1, s[4:7], s20 offen offset:3072 sc1
    s_waitcnt vmcnt(9) lgkmcnt(2)
    v_mfma_f32_32x32x16_bf16 v[96:111], a[240:243], v[24:27], v[96:111]
    ds_read_b128 a[224:227], v3 offset:17408
    ds_read_b128 a[228:231], v3 offset:16384
    v_mfma_f32_32x32x16_bf16 v[80:95], a[244:247], v[24:27], v[80:95]
    s_add_u32 s20, s20, 4096
    buffer_load_dwordx4 v[64:67], v1, s[4:7], s20 offen offset:0 sc1
    s_waitcnt vmcnt(9) lgkmcnt(2)
    v_mfma_f32_32x32x16_bf16 v[96:111], a[248:251], v[28:31], v[96:111]
    ds_read_b128 a[232:235], v3 offset:21504
    ds_read_b128 a[236:239], v3 offset:20480
    v_mfma_f32_32x32x16_bf16 v[80:95], a[252:255], v[28:31], v[80:95]
    buffer_load_dwordx4 v[68:71], v1, s[4:7], s20 offen offset:1024 sc1
    s_waitcnt vmcnt(9) lgkmcnt(2)
    v_mfma_f32_32x32x16_bf16 v[96:111], a[224:227], v[32:35], v[96:111]
    ds_read_b128 a[240:243], v3 offset:25600
    ds_read_b128 a[244:247], v3 offset:24576
    v_mfma_f32_32x32x16_bf16 v[80:95], a[228:231], v[32:35], v[80:95]
    buffer_load_dwordx4 v[72:75], v1, s[4:7], s20 offen offset:2048 sc1
    s_waitcnt vmcnt(9) lgkmcnt(2)
    v_mfma_f32_32x32x16_bf16 v[96:111], a[232:235], v[36:39], v[96:111]
    ds_read_b128 a[248:251], v3 offset:29696
    ds_read_b128 a[252:255], v3 offset:28672
    v_mfma_f32_32x32x16_bf16 v[80:95], a[236:239], v[36:39], v[80:95]
    buffer_load_dwordx4 v[76:79], v1, s[4:7], s20 offen offset:3072 sc1
    s_waitcnt vmcnt(9) lgkmcnt(2)
    v_mfma_f32_32x32x16_bf16 v[96:111], a[240:243], v[40:43], v[96:111]
    ds_read_b128 a[224:227], v3 offset:33792
    ds_read_b128 a[228:231], v3 offset:37888
    v_mfma_f32_32x32x16_bf16 v[80:95], a[244:247], v[40:43], v[80:95]
    s_add_u32 m0, s15, 131072
    s_add_u32 s21, s21, 4096
    buffer_load_dwordx4 v2, s[4:7], s21 offen sc1 lds
    s_waitcnt vmcnt(9) lgkmcnt(2)
    v_mfma_f32_32x32x16_bf16 v[96:111], a[248:251], v[44:47], v[96:111]
    ds_read_b128 a[232:235], v3 offset:41984
    ds_read_b128 a[236:239], v3 offset:46080
    v_mfma_f32_32x32x16_bf16 v[80:95], a[252:255], v[44:47], v[80:95]
    s_add_u32 m0, s15, 135168
    s_add_u32 s21, s21, 4096
    buffer_load_dwordx4 v2, s[4:7], s21 offen sc1 lds
    s_waitcnt vmcnt(8) lgkmcnt(2)
    v_mfma_f32_32x32x16_bf16 v[96:111], a[224:227], v[48:51], v[96:111]
    ds_read_b128 a[240:243], v3 offset:50176
    ds_read_b128 a[244:247], v3 offset:54272
    v_mfma_f32_32x32x16_bf16 v[96:111], a[228:231], v[52:55], v[96:111]
    s_add_u32 m0, s15, 139264
    s_add_u32 s21, s21, 4096
    buffer_load_dwordx4 v2, s[4:7], s21 offen sc1 lds
    s_waitcnt vmcnt(7) lgkmcnt(2)
    v_mfma_f32_32x32x16_bf16 v[96:111], a[232:235], v[56:59], v[96:111]
    ds_read_b128 a[248:251], v3 offset:58368
    ds_read_b128 a[252:255], v3 offset:62464
    v_mfma_f32_32x32x16_bf16 v[96:111], a[236:239], v[60:63], v[96:111]
    s_add_u32 m0, s15, 143360
    s_add_u32 s21, s21, 4096
    buffer_load_dwordx4 v2, s[4:7], s21 offen sc1 lds
    s_waitcnt vmcnt(6) lgkmcnt(2)
    v_mfma_f32_32x32x16_bf16 v[96:111], a[240:243], v[64:67], v[96:111]
    ds_read_b128 a[224:227], v3 offset:32768
    ds_read_b128 a[228:231], v3 offset:36864
    v_mfma_f32_32x32x16_bf16 v[96:111], a[244:247], v[68:71], v[96:111]
    s_waitcnt vmcnt(4) lgkmcnt(2)
    v_mfma_f32_32x32x16_bf16 v[96:111], a[248:251], v[72:75], v[96:111]
    ds_read_b128 a[232:235], v3 offset:40960
    ds_read_b128 a[236:239], v3 offset:45056
    v_mfma_f32_32x32x16_bf16 v[96:111], a[252:255], v[76:79], v[96:111]
    s_waitcnt lgkmcnt(2)
    v_mfma_f32_32x32x16_bf16 v[80:95], a[224:227], v[48:51], v[80:95]
    ds_read_b128 a[240:243], v3 offset:49152
    ds_read_b128 a[244:247], v3 offset:53248
    v_mfma_f32_32x32x16_bf16 v[80:95], a[228:231], v[52:55], v[80:95]
    ds_read_b128 a[248:251], v3 offset:57344
    ds_read_b128 a[252:255], v3 offset:61440
    s_nop 4
    ds_write_b128 v6, v[96:99] offset:0
    ds_write_b128 v6, v[100:103] offset:1024
    ds_write_b128 v6, v[104:107] offset:2048
    ds_write_b128 v6, v[108:111] offset:3072
    s_waitcnt lgkmcnt(8)
    v_mfma_f32_32x32x16_bf16 v[80:95], a[232:235], v[56:59], v[80:95]
    v_mfma_f32_32x32x16_bf16 v[80:95], a[236:239], v[60:63], v[80:95]
    s_waitcnt lgkmcnt(6)
    v_mfma_f32_32x32x16_bf16 v[80:95], a[240:243], v[64:67], v[80:95]
    s_waitcnt lgkmcnt(0)
    s_barrier
    ds_read_b128 v[96:99], v7 offset:0
    ds_read_b128 v[100:103], v7 offset:1024
    ds_read_b128 v[104:107], v7 offset:2048
    ds_read_b128 v[108:111], v7 offset:3072
    v_mfma_f32_32x32x16_bf16 v[80:95], a[244:247], v[68:71], v[80:95]
    s_add_u32 m0, s15, 0
    s_add_u32 s21, s21, 4096
    buffer_load_dwordx4 v2, s[4:7], s21 offen sc1 lds
    v_mfma_f32_32x32x16_bf16 v[80:95], a[248:251], v[72:75], v[80:95]
    v_mfma_f32_32x32x16_bf16 v[80:95], a[252:255], v[76:79], v[80:95]
    s_add_u32 m0, s15, 4096
    s_add_u32 s21, s21, 4096
    buffer_load_dwordx4 v2, s[4:7], s21 offen sc1 lds
    s_waitcnt lgkmcnt(0)
    v_add_f32 v120, v120, v96
    v_add_f32 v121, v121, v97
    v_add_f32 v122, v122, v98
    v_add_f32 v123, v123, v99
    v_add_f32 v124, v124, v100
    v_add_f32 v125, v125, v101
    v_add_f32 v126, v126, v102
    v_add_f32 v127, v127, v103
    v_add_f32 v128, v128, v104
    v_add_f32 v129, v129, v105
    v_add_f32 v130, v130, v106
    v_add_f32 v131, v131, v107
    v_add_f32 v132, v132, v108
    v_add_f32 v133, v133, v109
    v_add_f32 v134, v134, v110
    v_add_f32 v135, v135, v111
    v_add_f32 v80, v80, v120
    v_add_f32 v81, v81, v121
    v_cvt_pk_bf16_f32 v136, v80, v81
    v_add_f32 v82, v82, v122
    v_add_f32 v83, v83, v123
    v_cvt_pk_bf16_f32 v137, v82, v83
    v_add_f32 v84, v84, v124
    v_add_f32 v85, v85, v125
    v_cvt_pk_bf16_f32 v138, v84, v85
    v_add_f32 v86, v86, v126
    v_add_f32 v87, v87, v127
    v_cvt_pk_bf16_f32 v139, v86, v87
    v_add_f32 v88, v88, v128
    v_add_f32 v89, v89, v129
    v_cvt_pk_bf16_f32 v140, v88, v89
    v_add_f32 v90, v90, v130
    v_add_f32 v91, v91, v131
    v_cvt_pk_bf16_f32 v141, v90, v91
    v_add_f32 v92, v92, v132
    v_add_f32 v93, v93, v133
    v_cvt_pk_bf16_f32 v142, v92, v93
    v_add_f32 v94, v94, v134
    v_add_f32 v95, v95, v135
    v_cvt_pk_bf16_f32 v143, v94, v95
    s_add_u32 s17, s100, 8388608
    buffer_store_dwordx4 v[136:139], v1, s[4:7], s17 offen
    buffer_store_dwordx4 v[140:143], v1, s[4:7], s17 offen offset:1024
    v_add_f32 v10, v80, v82
    v_mul_f32 v11, v80, v80
    v_add_f32 v8, v81, v83
    v_mul_f32 v9, v81, v81
    v_fmac_f32 v11, v82, v82
    v_fmac_f32 v9, v83, v83
    v_add_f32 v10, v10, v84
    v_fmac_f32 v11, v84, v84
    v_add_f32 v8, v8, v85
    v_fmac_f32 v9, v85, v85
    s_add_u32 m0, s15, 8192
    s_add_u32 s21, s21, 4096
    buffer_load_dwordx4 v2, s[4:7], s21 offen sc1 lds
    s_add_u32 m0, s15, 12288
    s_add_u32 s21, s21, 4096
    buffer_load_dwordx4 v2, s[4:7], s21 offen sc1 lds
    s_add_u32 m0, s15, 16384
    s_add_u32 s21, s21, 4096
    buffer_load_dwordx4 v2, s[4:7], s21 offen sc1 lds
    s_add_u32 m0, s15, 20480
    s_add_u32 s21, s21, 4096
    buffer_load_dwordx4 v2, s[4:7], s21 offen sc1 lds
    s_add_u32 m0, s15, 24576
    s_add_u32 s21, s21, 4096
    buffer_load_dwordx4 v2, s[4:7], s21 offen sc1 lds
    v_add_f32 v10, v10, v86
    v_fmac_f32 v11, v86, v86
    v_add_f32 v8, v8, v87
    v_fmac_f32 v9, v87, v87
    v_add_f32 v10, v10, v88
    v_fmac_f32 v11, v88, v88
    v_add_f32 v8, v8, v89
    v_fmac_f32 v9, v89, v89
    v_add_f32 v10, v10, v90
    v_fmac_f32 v11, v90, v90
    v_add_f32 v8, v8, v91
    v_fmac_f32 v9, v91, v91
    s_add_u32 m0, s15, 28672
    s_add_u32 s21, s21, 4096
    buffer_load_dwordx4 v2, s[4:7], s21 offen sc1 lds
    s_add_u32 m0, s15, 32768
    s_add_u32 s21, s21, 4096
    buffer_load_dwordx4 v2, s[4:7], s21 offen sc1 lds
    s_add_u32 m0, s15, 36864
    s_add_u32 s21, s21, 4096
    buffer_load_dwordx4 v2, s[4:7], s21 offen sc1 lds
    s_add_u32 m0, s15, 40960
    s_add_u32 s21, s21, 4096
    buffer_load_dwordx4 v2, s[4:7], s21 offen sc1 lds
    s_add_u32 m0, s15, 45056
    s_add_u32 s21, s21, 4096
    buffer_load_dwordx4 v2, s[4:7], s21 offen sc1 lds
    v_add_f32 v10, v10, v92
    v_fmac_f32 v11, v92, v92
    v_add_f32 v8, v8, v93
    v_fmac_f32 v9, v93, v93
    v_add_f32 v10, v10, v94
    v_fmac_f32 v11, v94, v94
    v_add_f32 v8, v8, v95
    v_fmac_f32 v9, v95, v95
    v_add_f32 v10, v10, v8
    v_add_f32 v11, v11, v9
    v_mov_b32 v8, v10
    v_mov_b32 v9, v11
    s_nop 0
    v_permlane32_swap_b32 v10, v8
    v_permlane32_swap_b32 v11, v9
    v_add_f32 v10, v10, v8
    v_add_f32 v11, v11, v9
    s_mov_b32 exec_hi, 0
    buffer_store_dwordx2 v[10:11], v1, s[4:7], s29 offen
    s_mov_b64 exec, -1
    s_lshr_b32 s41, s100, 8
    s_add_u32 s41, s41, 8114176
    v_mov_b32 v14, s32
    v_mov_b32 v15, s33
    s_cmp_eq_u32 s34, 0
    s_cbranch_scc1 slow_68
    s_waitcnt vmcnt(11)
    buffer_store_dwordx2 v[14:15], off, s[4:7], s41
join_69:
    s_add_u32 s41, s41, 40960
    s_lshl_b32 s16, s2, 2
    s_lshl_b32 s22, s13, 3
    s_add_u32 s22, s22, s16
    s_add_u32 s22, s22, s12
    s_and_b32 s23, s14, 15
    s_lshl_b32 s20, s22, 15
    s_add_u32 s20, s20, 8388608
    v_mov_b32 v3, v1
    v_add_u32 v4, 0x10000, v3
    v_add_u32 v5, 0x20000, v3
    v_bfe_u32 v8, v0, 4, 2
    v_lshlrev_b32 v8, 9, v8
    v_and_b32 v9, 15, v0
    v_lshl_add_u32 v12, v9, 4, v8
    v_and_b32 v9, 3, v0
    v_bfe_u32 v10, v0, 2, 1
    v_lshl_or_b32 v9, v10, 3, v9
    v_bfe_u32 v10, v0, 3, 1
    v_lshl_or_b32 v9, v10, 2, v9
    v_lshl_add_u32 v3, v9, 4, v8
    v_add_u32 v4, 0x10000, v3
    v_add_u32 v5, 0x20000, v3
    s_barrier
    ds_read_b128 a[224:227], v4 offset:0
    ds_read_b128 a[228:231], v4 offset:256
    ds_read_b128 a[232:235], v4 offset:2048
    ds_read_b128 a[236:239], v4 offset:2304
    ds_read_b128 a[240:243], v4 offset:4096
    s_add_u32 m0, s15, 49152
    s_add_u32 s21, s21, 4096
    buffer_load_dwordx4 v2, s[4:7], s21 offen sc1 lds
    s_add_u32 m0, s15, 53248
    s_add_u32 s21, s21, 4096
    buffer_load_dwordx4 v2, s[4:7], s21 offen sc1 lds
    v_mov_b32 v14, s32
    v_mov_b32 v15, s33
    s_cmp_eq_u32 s34, 0
    s_cbranch_scc1 slow_70
    s_waitcnt vmcnt(3)
    buffer_store_dwordx2 v[14:15], off, s[4:7], s41
join_71:
    s_lshl_b32 s28, s22, 12
    s_add_u32 s28, s28, 17825792
    s_mul_i32 s26, s22, 112
    s_mul_i32 s18, s23, 7
    s_add_u32 s26, s26, s18
    s_lshl_b32 s26, s26, 10
    s_add_u32 s26, s26, 10485760
    s_add_u32 s27, s26, 4096
    s_lshl_b32 s41, s22, 7
    s_add_u32 s41, s41, 8114176
    v_and_b32 v13, 15, v0
    v_lshlrev_b32 v13, 3, v13
    s_mov_b32 s40, 0x40000
poll_72:
    buffer_load_dwordx2 v[14:15], v13, s[4:7], s41 offen sc1
    s_sub_u32 s40, s40, 1
    s_cbranch_scc1 L_abort
    s_waitcnt vmcnt(0)
    v_cmp_ne_u64 vcc, s[32:33], v[14:15]
    s_nop 0
    s_cbranch_vccnz poll_72
    s_add_u32 s41, s41, 40960
    buffer_load_dwordx4 v[16:19], v12, s[4:7], s20 offen offset:0 sc1
    buffer_load_dwordx4 v[20:23], v12, s[4:7], s20 offen offset:256 sc1
    buffer_load_dwordx4 v[24:27], v12, s[4:7], s20 offen offset:2048 sc1
    buffer_load_dwordx4 v[28:31], v12, s[4:7], s20 offen offset:2304 sc1
    s_add_u32 s20, s20, 4096
    buffer_load_dwordx4 v[32:35], v12, s[4:7], s20 offen offset:0 sc1
    buffer_load_dwordx4 v[36:39], v12, s[4:7], s20 offen offset:256 sc1
    s_waitcnt vmcnt(4) lgkmcnt(3)
    v_mfma_f32_16x16x32_bf16 v[144:147], a[224:227], v[16:19], 0
    ds_read_b128 a[244:247], v4 offset:4352
    v_mfma_f32_16x16x32_bf16 v[148:151], a[224:227], v[20:23], 0
    buffer_load_dwordx4 v[40:43], v12, s[4:7], s20 offen offset:2048 sc1
    v_mfma_f32_16x16x32_bf16 v[152:155], a[228:231], v[16:19], 0
    ds_read_b128 a[248:251], v4 offset:6144
    s_waitcnt lgkmcnt(3)
    v_mfma_f32_16x16x32_bf16 v[156:159], a[228:231], v[20:23], 0
    v_mfma_f32_16x16x32_bf16 v[160:163], a[232:235], v[16:19], 0
    ds_read_b128 a[252:255], v4 offset:6400
    v_mfma_f32_16x16x32_bf16 v[164:167], a[232:235], v[20:23], 0
    buffer_load_dwordx4 v[44:47], v12, s[4:7], s20 offen offset:2304 sc1
    v_mfma_f32_16x16x32_bf16 v[168:171], a[236:239], v[16:19], 0
    ds_read_b128 a[224:227], v4 offset:8192
    s_waitcnt lgkmcnt(3)
    v_mfma_f32_16x16x32_bf16 v[172:175], a[236:239], v[20:23], 0
    v_mfma_f32_16x16x32_bf16 v[176:179], a[240:243], v[16:19], 0
    ds_read_b128 a[228:231], v4 offset:8448
    v_mfma_f32_16x16x32_bf16 v[180:183], a[240:243], v[20:23], 0
    s_add_u32 s20, s20, 4096
    buffer_load_dwordx4 v[48:51], v12, s[4:7], s20 offen offset:0 sc1
    v_mfma_f32_16x16x32_bf16 v[184:187], a[244:247], v[16:19], 0
    ds_read_b128 a[232:235], v4 offset:10240
    s_waitcnt vmcnt(5) lgkmcnt(3)
    v_mfma_f32_16x16x32_bf16 v[188:191], a[244:247], v[20:23], 0
    v_mfma_f32_16x16x32_bf16 v[144:147], a[248:251], v[24:27], v[144:147]
    ds_read_b128 a[236:239], v4 offset:10496
    v_mfma_f32_16x16x32_bf16 v[148:151], a[248:251], v[28:31], v[148:151]
    buffer_load_dwordx4 v[52:55], v12, s[4:7], s20 offen offset:256 sc1
    v_mfma_f32_16x16x32_bf16 v[152:155], a[252:255], v[24:27], v[152:155]
    ds_read_b128 a[240:243], v4 offset:12288
    s_waitcnt lgkmcnt(3)
    v_mfma_f32_16x16x32_bf16 v[156:159], a[252:255], v[28:31], v[156:159]
    v_mfma_f32_16x16x32_bf16 v[160:163], a[224:227], v[24:27], v[160:163]
    ds_read_b128 a[244:247], v4 offset:12544
    v_mfma_f32_16x16x32_bf16 v[164:167], a[224:227], v[28:31], v[164:167]
    buffer_load_dwordx4 v[56:59], v12, s[4:7], s20 offen offset:2048 sc1
    v_mfma_f32_16x16x32_bf16 v[168:171], a[228:231], v[24:27], v[168:171]
    ds_read_b128 a[248:251], v4 offset:14336
    s_waitcnt lgkmcnt(3)
    v_mfma_f32_16x16x32_bf16 v[172:175], a[228:231], v[28:31], v[172:175]
    v_mfma_f32_16x16x32_bf16 v[176:179], a[232:235], v[24:27], v[176:179]
    ds_read_b128 a[252:255], v4 offset:14592
    v_mfma_f32_16x16x32_bf16 v[180:183], a[232:235], v[28:31], v[180:183]
    s_add_u32 m0, s99, 57344
    s_add_u32 s21, s21, 4096
    s_add_u32 s21, s21, s15
    v_mfma_f32_16x16x32_bf16 v[184:187], a[236:239], v[24:27], v[184:187]
    ds_read_b128 a[224:227], v4 offset:16384
    s_waitcnt vmcnt(5) lgkmcnt(3)
    v_mfma_f32_16x16x32_bf16 v[188:191], a[236:239], v[28:31], v[188:191]
    buffer_load_dwordx4 v2, s[4:7], s21 offen sc1 lds
    v_mfma_f32_16x16x32_bf16 v[144:147], a[240:243], v[32:35], v[144:147]
    ds_read_b128 a[228:231], v4 offset:16640
    v_mfma_f32_16x16x32_bf16 v[148:151], a[240:243], v[36:39], v[148:151]
    buffer_load_dwordx2 v[14:15], v13, s[4:7], s41 offen sc1
    buffer_load_dwordx4 v[60:63], v12, s[4:7], s20 offen offset:2304 sc1
    v_mfma_f32_16x16x32_bf16 v[152:155], a[244:247], v[32:35], v[152:155]
    ds_read_b128 a[232:235], v4 offset:18432
    s_waitcnt lgkmcnt(3)
    v_mfma_f32_16x16x32_bf16 v[156:159], a[244:247], v[36:39], v[156:159]
    v_mfma_f32_16x16x32_bf16 v[160:163], a[248:251], v[32:35], v[160:163]
    ds_read_b128 a[236:239], v4 offset:18688
    v_mfma_f32_16x16x32_bf16 v[164:167], a[248:251], v[36:39], v[164:167]
    s_add_u32 s20, s20, 4096
    buffer_load_dwordx4 v[64:67], v12, s[4:7], s20 offen offset:0 sc1
    v_mfma_f32_16x16x32_bf16 v[168:171], a[252:255], v[32:35], v[168:171]
    ds_read_b128 a[240:243], v4 offset:20480
    s_waitcnt lgkmcnt(3)
    v_mfma_f32_16x16x32_bf16 v[172:175], a[252:255], v[36:39], v[172:175]
    v_mfma_f32_16x16x32_bf16 v[176:179], a[224:227], v[32:35], v[176:179]
    ds_read_b128 a[244:247], v4 offset:20736
    v_mfma_f32_16x16x32_bf16 v[180:183], a[224:227], v[36:39], v[180:183]
    buffer_load_dwordx4 v2, s[4:7], s21 offen offset:1024 sc1 lds
    v_mfma_f32_16x16x32_bf16 v[184:187], a[228:231], v[32:35], v[184:187]
    ds_read_b128 a[248:251], v4 offset:22528
    s_waitcnt vmcnt(8) lgkmcnt(3)
    v_mfma_f32_16x16x32_bf16 v[188:191], a[228:231], v[36:39], v[188:191]
    v_mfma_f32_16x16x32_bf16 v[144:147], a[232:235], v[40:43], v[144:147]
    ds_read_b128 a[252:255], v4 offset:22784
    v_mfma_f32_16x16x32_bf16 v[148:151], a[232:235], v[44:47], v[148:151]
    buffer_load_dwordx4 v[68:71], v12, s[4:7], s20 offen offset:256 sc1
    v_mfma_f32_16x16x32_bf16 v[152:155], a[236:239], v[40:43], v[152:155]
    ds_read_b128 a[224:227], v4 offset:24576
    s_waitcnt lgkmcnt(3)
    v_mfma_f32_16x16x32_bf16 v[156:159], a[236:239], v[44:47], v[156:159]
    v_mfma_f32_16x16x32_bf16 v[160:163], a[240:243], v[40:43], v[160:163]
    ds_read_b128 a[228:231], v4 offset:24832
    v_mfma_f32_16x16x32_bf16 v[164:167], a[240:243], v[44:47], v[164:167]
    buffer_load_dwordx4 v[72:75], v12, s[4:7], s20 offen offset:2048 sc1
    v_mfma_f32_16x16x32_bf16 v[168:171], a[244:247], v[40:43], v[168:171]
    ds_read_b128 a[232:235], v4 offset:26624
    s_waitcnt lgkmcnt(3)
    v_mfma_f32_16x16x32_bf16 v[172:175], a[244:247], v[44:47], v[172:175]
    v_mfma_f32_16x16x32_bf16 v[176:179], a[248:251], v[40:43], v[176:179]
    ds_read_b128 a[236:239], v4 offset:26880
    v_mfma_f32_16x16x32_bf16 v[180:183], a[248:251], v[44:47], v[180:183]
    buffer_load_dwordx4 v[76:79], v12, s[4:7], s20 offen offset:2304 sc1
    v_mfma_f32_16x16x32_bf16 v[184:187], a[252:255], v[40:43], v[184:187]
    ds_read_b128 a[240:243], v4 offset:28672
    s_waitcnt vmcnt(9) lgkmcnt(3)
    v_mfma_f32_16x16x32_bf16 v[188:191], a[252:255], v[44:47], v[188:191]
    v_mfma_f32_16x16x32_bf16 v[144:147], a[224:227], v[48:51], v[144:147]
    ds_read_b128 a[244:247], v4 offset:28928
    v_mfma_f32_16x16x32_bf16 v[148:151], a[224:227], v[52:55], v[148:151]
    s_add_u32 s20, s20, 4096
    buffer_load_dwordx4 v[80:83], v12, s[4:7], s20 offen offset:0 sc1
    v_mfma_f32_16x16x32_bf16 v[152:155], a[228:231], v[48:51], v[152:155]
    ds_read_b128 a[248:251], v4 offset:30720
    s_waitcnt lgkmcnt(3)
    v_mfma_f32_16x16x32_bf16 v[156:159], a[228:231], v[52:55], v[156:159]
    v_mfma_f32_16x16x32_bf16 v[160:163], a[232:235], v[48:51], v[160:163]
    ds_read_b128 a[252:255], v4 offset:30976
    v_mfma_f32_16x16x32_bf16 v[164:167], a[232:235], v[52:55], v[164:167]
    buffer_load_dwordx4 v[84:87], v12, s[4:7], s20 offen offset:256 sc1
    v_mfma_f32_16x16x32_bf16 v[168:171], a[236:239], v[48:51], v[168:171]
    ds_read_b128 a[224:227], v4 offset:32768
    s_waitcnt lgkmcnt(3)
    v_mfma_f32_16x16x32_bf16 v[172:175], a[236:239], v[52:55], v[172:175]
    v_mfma_f32_16x16x32_bf16 v[176:179], a[240:243], v[48:51], v[176:179]
    ds_read_b128 a[228:231], v4 offset:33024
    v_mfma_f32_16x16x32_bf16 v[180:183], a[240:243], v[52:55], v[180:183]
    buffer_load_dwordx4 v[88:91], v12, s[4:7], s20 offen offset:2048 sc1
    v_mfma_f32_16x16x32_bf16 v[184:187], a[244:247], v[48:51], v[184:187]
    ds_read_b128 a[232:235], v4 offset:34816
    s_waitcnt vmcnt(8) lgkmcnt(3)
    v_mfma_f32_16x16x32_bf16 v[188:191], a[244:247], v[52:55], v[188:191]
    v_mfma_f32_16x16x32_bf16 v[144:147], a[248:251], v[56:59], v[144:147]
    ds_read_b128 a[236:239], v4 offset:35072
    v_mfma_f32_16x16x32_bf16 v[148:151], a[248:251], v[60:63], v[148:151]
    v_cmp_ne_u64 vcc, s[32:33], v[14:15]
    s_nop 0
    s_cbranch_vccnz ap_73
apok_74:
    buffer_load_dwordx4 v[92:95], v12, s[4:7], s20 offen offset:2304 sc1
    v_mfma_f32_16x16x32_bf16 v[152:155], a[252:255], v[56:59], v[152:155]
    ds_read_b128 a[240:243], v4 offset:36864
    s_waitcnt lgkmcnt(3)
    v_mfma_f32_16x16x32_bf16 v[156:159], a[252:255], v[60:63], v[156:159]
    v_mfma_f32_16x16x32_bf16 v[160:163], a[224:227], v[56:59], v[160:163]
    ds_read_b128 a[244:247], v4 offset:37120
    v_mfma_f32_16x16x32_bf16 v[164:167], a[224:227], v[60:63], v[164:167]
    buffer_load_dwordx4 v[224:227], v1, s[4:7], s28 offen offset:0 sc1
    v_mfma_f32_16x16x32_bf16 v[168:171], a[228:231], v[56:59], v[168:171]
    ds_read_b128 a[248:251], v4 offset:38912
    s_waitcnt lgkmcnt(3)
    v_mfma_f32_16x16x32_bf16 v[172:175], a[228:231], v[60:63], v[172:175]
    v_mfma_f32_16x16x32_bf16 v[176:179], a[232:235], v[56:59], v[176:179]
    ds_read_b128 a[252:255], v4 offset:39168
    v_mfma_f32_16x16x32_bf16 v[180:183], a[232:235], v[60:63], v[180:183]
    buffer_load_dwordx4 v[228:231], v1, s[4:7], s28 offen offset:1024 sc1
    v_and_b32 v13, 0xf0, v3
    v_mfma_f32_16x16x32_bf16 v[184:187], a[236:239], v[56:59], v[184:187]
    ds_read_b128 a[224:227], v4 offset:40960
    s_waitcnt vmcnt(8) lgkmcnt(3)
    v_mfma_f32_16x16x32_bf16 v[188:191], a[236:239], v[60:63], v[188:191]
    v_bfe_u32 v7, v0, 5, 1
    v_lshl_add_u32 v13, v7, 9, v13
    v_mfma_f32_16x16x32_bf16 v[144:147], a[240:243], v[64:67], v[144:147]
    ds_read_b128 a[228:231], v4 offset:41216
    v_bfe_u32 v7, v0, 4, 1
    v_mfma_f32_16x16x32_bf16 v[148:151], a[240:243], v[68:71], v[148:151]
    s_add_u32 s20, s20, 4096
    buffer_load_dwordx4 v[96:99], v12, s[4:7], s20 offen offset:0 sc1
    v_lshl_add_u32 v13, v7, 3, v13
    v_mfma_f32_16x16x32_bf16 v[152:155], a[244:247], v[64:67], v[152:155]
    ds_read_b128 a[232:235], v4 offset:43008
    s_waitcnt lgkmcnt(3)
    v_mfma_f32_16x16x32_bf16 v[156:159], a[244:247], v[68:71], v[156:159]
    v_add_u32 v13, 16384, v13
    s_lshl_b32 s41, s22, 4
    v_mfma_f32_16x16x32_bf16 v[160:163], a[248:251], v[64:67], v[160:163]
    ds_read_b128 a[236:239], v4 offset:43264
    s_add_u32 s41, s41, s23
    v_mfma_f32_16x16x32_bf16 v[164:167], a[248:251], v[68:71], v[164:167]
    buffer_load_dwordx4 v[232:235], v1, s[4:7], s28 offen offset:2048 sc1
    s_lshl_b32 s41, s41, 3
    v_mfma_f32_16x16x32_bf16 v[168:171], a[252:255], v[64:67], v[168:171]
    ds_read_b128 a[240:243], v4 offset:45056
    s_waitcnt lgkmcnt(3)
    v_mfma_f32_16x16x32_bf16 v[172:175], a[252:255], v[68:71], v[172:175]
    s_add_u32 s41, s41, 8179712
    v_mov_b32 v14, s32
    v_mfma_f32_16x16x32_bf16 v[176:179], a[224:227], v[64:67], v[176:179]
    ds_read_b128 a[244:247], v4 offset:45312
    v_mov_b32 v15, s33
    v_mfma_f32_16x16x32_bf16 v[180:183], a[224:227], v[68:71], v[180:183]
    buffer_load_dwordx4 v[236:239], v1, s[4:7], s28 offen offset:3072 sc1
    s_lshr_b32 s16, s100, 15
    v_mfma_f32_16x16x32_bf16 v[184:187], a[228:231], v[64:67], v[184:187]
    ds_read_b128 a[248:251], v4 offset:47104
    s_waitcnt vmcnt(9) lgkmcnt(3)
    v_mfma_f32_16x16x32_bf16 v[188:191], a[228:231], v[68:71], v[188:191]
    s_mul_i32 s17, s12, 28672
    s_add_u32 s17, s17, 10485760
    v_mfma_f32_16x16x32_bf16 v[144:147], a[232:235], v[72:75], v[144:147]
    ds_read_b128 a[252:255], v4 offset:47360
    s_mul_i32 s24, s16, 114688
    v_mfma_f32_16x16x32_bf16 v[148:151], a[232:235], v[76:79], v[148:151]
    buffer_load_dwordx4 v[100:103], v12, s[4:7], s20 offen offset:256 sc1
    s_add_u32 s24, s24, s17
    v_mfma_f32_16x16x32_bf16 v[152:155], a[236:239], v[72:75], v[152:155]
    ds_read_b128 a[224:227], v4 offset:49152
    s_waitcnt lgkmcnt(3)
    v_mfma_f32_16x16x32_bf16 v[156:159], a[236:239], v[76:79], v[156:159]
    s_xor_b32 s18, s16, 1
    s_mul_i32 s39, s18, 114688
    v_mfma_f32_16x16x32_bf16 v[160:163], a[240:243], v[72:75], v[160:163]
    ds_read_b128 a[228:231], v4 offset:49408
    s_add_u32 s39, s39, s17
    v_mfma_f32_16x16x32_bf16 v[164:167], a[240:243], v[76:79], v[164:167]
    buffer_load_dwordx4 v[104:107], v12, s[4:7], s20 offen offset:2048 sc1
    s_and_b32 s25, s16, 0xfe
    v_mfma_f32_16x16x32_bf16 v[168:171], a[244:247], v[72:75], v[168:171]
    ds_read_b128 a[232:235], v4 offset:51200
    s_waitcnt lgkmcnt(3)
    v_mfma_f32_16x16x32_bf16 v[172:175], a[244:247], v[76:79], v[172:175]
    s_lshl_b32 s25, s25, 7
    s_lshl_b32 s17, s12, 5
    v_mfma_f32_16x16x32_bf16 v[176:179], a[248:251], v[72:75], v[176:179]
    ds_read_b128 a[236:239], v4 offset:51456
    s_add_u32 s25, s25, s17
    v_mfma_f32_16x16x32_bf16 v[180:183], a[248:251], v[76:79], v[180:183]
    buffer_load_dwordx4 v[108:111], v12, s[4:7], s20 offen offset:2304 sc1
    s_add_u32 s25, s25, 8179712
    v_mfma_f32_16x16x32_bf16 v[184:187], a[252:255], v[72:75], v[184:187]
    ds_read_b128 a[240:243], v4 offset:53248
    s_waitcnt vmcnt(10) lgkmcnt(3)
    v_mfma_f32_16x16x32_bf16 v[188:191], a[252:255], v[76:79], v[188:191]
    s_getpc_b64 s[90:91]
pc_75:
    s_min_u32 s19, s85, L_end-pc_75-1024
    s_barrier
    v_mfma_f32_16x16x32_bf16 v[144:147], a[224:227], v[80:83], v[144:147]
    ds_read_b128 a[244:247], v4 offset:53504
    s_add_u32 s90, s90, s19
    s_addc_u32 s91, s91, 0
    v_mfma_f32_16x16x32_bf16 v[148:151], a[224:227], v[84:87], v[148:151]
    s_add_u32 s20, s20, 4096
    buffer_load_dwordx4 v[112:115], v12, s[4:7], s20 offen offset:0 sc1
    v_mfma_f32_16x16x32_bf16 v[152:155], a[228:231], v[80:83], v[152:155]
    ds_read_b128 a[248:251], v4 offset:55296
    s_waitcnt lgkmcnt(3)
    v_mfma_f32_16x16x32_bf16 v[156:159], a[228:231], v[84:87], v[156:159]
    v_mfma_f32_16x16x32_bf16 v[160:163], a[232:235], v[80:83], v[160:163]
    ds_read_b128 a[252:255], v4 offset:55552
    v_mfma_f32_16x16x32_bf16 v[164:167], a[232:235], v[84:87], v[164:167]
    s_add_u32 m0, s99, 65536
    s_add_u32 s21, s21, 8192
    v_mfma_f32_16x16x32_bf16 v[168:171], a[236:239], v[80:83], v[168:171]
    ds_read_b128 a[224:227], v4 offset:57344
    s_waitcnt lgkmcnt(3)
    v_mfma_f32_16x16x32_bf16 v[172:175], a[236:239], v[84:87], v[172:175]
    buffer_load_dwordx4 v2, s[4:7], s21 offen sc1 lds
    v_mfma_f32_16x16x32_bf16 v[176:179], a[240:243], v[80:83], v[176:179]
    ds_read_b128 a[228:231], v4 offset:57600
    v_mfma_f32_16x16x32_bf16 v[180:183], a[240:243], v[84:87], v[180:183]
    buffer_load_dwordx4 v2, s[4:7], s21 offen offset:1024 sc1 lds
    v_mfma_f32_16x16x32_bf16 v[184:187], a[244:247], v[80:83], v[184:187]
    ds_read_b128 a[232:235], v4 offset:59392
    s_waitcnt vmcnt(11) lgkmcnt(3)
    v_mfma_f32_16x16x32_bf16 v[188:191], a[244:247], v[84:87], v[188:191]
    v_mfma_f32_16x16x32_bf16 v[144:147], a[248:251], v[88:91], v[144:147]
    ds_read_b128 a[236:239], v4 offset:59648
    v_mfma_f32_16x16x32_bf16 v[148:151], a[248:251], v[92:95], v[148:151]
    buffer_load_dwordx4 v[116:119], v12, s[4:7], s20 offen offset:256 sc1
    v_mfma_f32_16x16x32_bf16 v[152:155], a[252:255], v[88:91], v[152:155]
    ds_read_b128 a[240:243], v4 offset:61440
    s_waitcnt lgkmcnt(3)
    v_mfma_f32_16x16x32_bf16 v[156:159], a[252:255], v[92:95], v[156:159]
    v_mfma_f32_16x16x32_bf16 v[160:163], a[224:227], v[88:91], v[160:163]
    ds_read_b128 a[244:247], v4 offset:61696
    v_mfma_f32_16x16x32_bf16 v[164:167], a[224:227], v[92:95], v[164:167]
    buffer_load_dwordx4 v[120:123], v12, s[4:7], s20 offen offset:2048 sc1
    v_mfma_f32_16x16x32_bf16 v[168:171], a[228:231], v[88:91], v[168:171]
    ds_read_b128 a[248:251], v4 offset:63488
    s_waitcnt lgkmcnt(3)
    v_mfma_f32_16x16x32_bf16 v[172:175], a[228:231], v[92:95], v[172:175]
    v_mfma_f32_16x16x32_bf16 v[176:179], a[232:235], v[88:91], v[176:179]
    ds_read_b128 a[252:255], v4 offset:63744
    v_mfma_f32_16x16x32_bf16 v[180:183], a[232:235], v[92:95], v[180:183]
    s_add_u32 m0, s99, 73728
    s_add_u32 s21, s21, 8192
    v_mfma_f32_16x16x32_bf16 v[184:187], a[236:239], v[88:91], v[184:187]
    ds_read_b128 a[224:227], v5 offset:0
    s_waitcnt vmcnt(7) lgkmcnt(3)
    v_mfma_f32_16x16x32_bf16 v[188:191], a[236:239], v[92:95], v[188:191]
    buffer_load_dwordx4 v2, s[4:7], s21 offen sc1 lds
    v_mfma_f32_16x16x32_bf16 v[144:147], a[240:243], v[96:99], v[144:147]
    ds_read_b128 a[228:231], v5 offset:256
    v_mfma_f32_16x16x32_bf16 v[148:151], a[240:243], v[100:103], v[148:151]
    buffer_load_dwordx4 v[124:127], v12, s[4:7], s20 offen offset:2304 sc1
    v_mfma_f32_16x16x32_bf16 v[152:155], a[244:247], v[96:99], v[152:155]
    ds_read_b128 a[232:235], v5 offset:2048
    s_waitcnt lgkmcnt(3)
    v_mfma_f32_16x16x32_bf16 v[156:159], a[244:247], v[100:103], v[156:159]
    v_mfma_f32_16x16x32_bf16 v[160:163], a[248:251], v[96:99], v[160:163]
    ds_read_b128 a[236:239], v5 offset:2304
    v_mfma_f32_16x16x32_bf16 v[164:167], a[248:251], v[100:103], v[164:167]
    s_add_u32 s20, s20, 4096
    buffer_load_dwordx4 v[128:131], v12, s[4:7], s20 offen offset:0 sc1
    v_mfma_f32_16x16x32_bf16 v[168:171], a[252:255], v[96:99], v[168:171]
    ds_read_b128 a[240:243], v5 offset:4096
    s_waitcnt lgkmcnt(3)
    v_mfma_f32_16x16x32_bf16 v[172:175], a[252:255], v[100:103], v[172:175]
    v_mfma_f32_16x16x32_bf16 v[176:179], a[224:227], v[96:99], v[176:179]
    ds_read_b128 a[244:247], v5 offset:4352
    v_mfma_f32_16x16x32_bf16 v[180:183], a[224:227], v[100:103], v[180:183]
    s_xor_b32 s19, s22, 4
    s_lshr_b32 s19, s19, 1
    s_lshl_b32 s19, s19, 8
    s_add_u32 s19, s19, 8105984
    v_and_b32 v252, 31, v0
    v_lshlrev_b32 v252, 3, v252
    buffer_load_dwordx2 v[252:253], v252, s[4:7], s19 offen sc1
    buffer_load_dwordx4 v2, s[4:7], s21 offen offset:1024 sc1 lds
    v_add_f32 v224, v224, v232
    v_mfma_f32_16x16x32_bf16 v[184:187], a[228:231], v[96:99], v[184:187]
    ds_read_b128 a[248:251], v5 offset:6144
    s_waitcnt vmcnt(10) lgkmcnt(3)
    v_mfma_f32_16x16x32_bf16 v[188:191], a[228:231], v[100:103], v[188:191]
    v_add_f32 v225, v225, v233
    v_add_f32 v226, v226, v234
    v_mfma_f32_16x16x32_bf16 v[144:147], a[232:235], v[104:107], v[144:147]
    ds_read_b128 a[252:255], v5 offset:6400
    v_add_f32 v227, v227, v235
    v_mfma_f32_16x16x32_bf16 v[148:151], a[232:235], v[108:111], v[148:151]
    buffer_load_dwordx4 v[132:135], v12, s[4:7], s20 offen offset:256 sc1
    v_add_f32 v228, v228, v236
    v_mfma_f32_16x16x32_bf16 v[152:155], a[236:239], v[104:107], v[152:155]
    ds_read_b128 a[224:227], v5 offset:8192
    s_waitcnt lgkmcnt(3)
    v_mfma_f32_16x16x32_bf16 v[156:159], a[236:239], v[108:111], v[156:159]
    v_add_f32 v229, v229, v237
    v_add_f32 v230, v230, v238
    v_mfma_f32_16x16x32_bf16 v[160:163], a[240:243], v[104:107], v[160:163]
    ds_read_b128 a[228:231], v5 offset:8448
    v_add_f32 v231, v231, v239
    v_mfma_f32_16x16x32_bf16 v[164:167], a[240:243], v[108:111], v[164:167]
    buffer_load_dwordx4 v[136:139], v12, s[4:7], s20 offen offset:2048 sc1
    v_add_f32 v224, v224, v228
    v_mfma_f32_16x16x32_bf16 v[168:171], a[244:247], v[104:107], v[168:171]
    ds_read_b128 a[232:235], v5 offset:10240
    s_waitcnt lgkmcnt(3)
    v_mfma_f32_16x16x32_bf16 v[172:175], a[244:247], v[108:111], v[172:175]
    v_add_f32 v225, v225, v229
    v_add_f32 v226, v226, v230
    v_mfma_f32_16x16x32_bf16 v[176:179], a[248:251], v[104:107], v[176:179]
    ds_read_b128 a[236:239], v5 offset:10496
    v_add_f32 v227, v227, v231
    v_mfma_f32_16x16x32_bf16 v[180:183], a[248:251], v[108:111], v[180:183]
    s_add_u32 m0, s99, 81920
    s_add_u32 s21, s21, 8192
    v_mfma_f32_16x16x32_bf16 v[184:187], a[252:255], v[104:107], v[184:187]
    ds_read_b128 a[240:243], v5 offset:12288
    s_waitcnt vmcnt(8) lgkmcnt(3)
    v_mfma_f32_16x16x32_bf16 v[188:191], a[252:255], v[108:111], v[188:191]
    buffer_load_dwordx4 v2, s[4:7], s21 offen sc1 lds
    v_add_f32 v224, v224, v226
    v_mfma_f32_16x16x32_bf16 v[144:147], a[224:227], v[112:115], v[144:147]
    ds_read_b128 a[244:247], v5 offset:12544
    v_add_f32 v225, v225, v227
    v_mfma_f32_16x16x32_bf16 v[148:151], a[224:227], v[116:119], v[148:151]
    buffer_load_dwordx4 v[140:143], v12, s[4:7], s20 offen offset:2304 sc1
    v_mov_b32 v226, v224
    v_mfma_f32_16x16x32_bf16 v[152:155], a[228:231], v[112:115], v[152:155]
    ds_read_b128 a[248:251], v5 offset:14336
    s_waitcnt lgkmcnt(3)
    v_mfma_f32_16x16x32_bf16 v[156:159], a[228:231], v[116:119], v[156:159]
    v_mov_b32 v227, v225
    v_permlane32_swap_b32 v224, v226
    v_mfma_f32_16x16x32_bf16 v[160:163], a[232:235], v[112:115], v[160:163]
    ds_read_b128 a[252:255], v5 offset:14592
    v_permlane32_swap_b32 v225, v227
    v_mfma_f32_16x16x32_bf16 v[164:167], a[232:235], v[116:119], v[164:167]
    buffer_load_dwordx4 v2, s[4:7], s21 offen offset:1024 sc1 lds
    v_add_f32 v224, v224, v226
    v_mfma_f32_16x16x32_bf16 v[168:171], a[236:239], v[112:115], v[168:171]
    ds_read_b128 a[224:227], v3 offset:0
    s_waitcnt lgkmcnt(3)
    v_mfma_f32_16x16x32_bf16 v[172:175], a[236:239], v[116:119], v[172:175]
    v_add_f32 v225, v225, v227
    v_mul_f32 v224, 0xbb000000, v224
    v_mfma_f32_16x16x32_bf16 v[176:179], a[240:243], v[112:115], v[176:179]
    ds_read_b128 a[228:231], v3 offset:256
    v_mul_f32 v225, 0x3b000000, v225
    v_mfma_f32_16x16x32_bf16 v[180:183], a[240:243], v[116:119], v[180:183]
    s_add_u32 m0, s99, 90112
    s_add_u32 s21, s21, 8192
    v_mfma_f32_16x16x32_bf16 v[184:187], a[244:247], v[112:115], v[184:187]
    ds_read_b128 a[232:235], v3 offset:2048
    s_waitcnt vmcnt(8) lgkmcnt(3)
    v_mfma_f32_16x16x32_bf16 v[188:191], a[244:247], v[116:119], v[188:191]
    buffer_load_dwordx4 v2, s[4:7], s21 offen sc1 lds
    v_fma_f32 v225, -v224, v224, v225
    v_mfma_f32_16x16x32_bf16 v[144:147], a[248:251], v[120:123], v[144:147]
    ds_read_b128 a[236:239], v3 offset:2304
    v_max_f32 v225, 0, v225
    v_mfma_f32_16x16x32_bf16 v[148:151], a[248:251], v[124:127], v[148:151]
    buffer_load_dwordx4 v2, s[4:7], s21 offen offset:1024 sc1 lds
    v_cvt_pk_bf16_f32 v225, v225, 0
    v_mfma_f32_16x16x32_bf16 v[152:155], a[252:255], v[120:123], v[152:155]
    ds_read_b128 a[240:243], v3 offset:4096
    s_waitcnt lgkmcnt(3)
    v_mfma_f32_16x16x32_bf16 v[156:159], a[252:255], v[124:127], v[156:159]
    v_lshlrev_b32 v225, 16, v225
    v_add_f32 v225, 0x3727c5ac, v225
    s_barrier
    v_mfma_f32_16x16x32_bf16 v[160:163], a[224:227], v[120:123], v[160:163]
    ds_read_b128 a[244:247], v3 offset:4352
    v_cvt_pk_bf16_f32 v225, v225, 0
    v_mfma_f32_16x16x32_bf16 v[164:167], a[224:227], v[124:127], v[164:167]
    s_add_u32 m0, s99, 98304
    s_add_u32 s21, s21, 8192
    v_mfma_f32_16x16x32_bf16 v[168:171], a[228:231], v[120:123], v[168:171]
    ds_read_b128 a[248:251], v3 offset:6144
    s_waitcnt lgkmcnt(3)
    v_mfma_f32_16x16x32_bf16 v[172:175], a[228:231], v[124:127], v[172:175]
    buffer_load_dwordx4 v2, s[4:7], s21 offen sc1 lds
    v_lshlrev_b32 v225, 16, v225
    v_mfma_f32_16x16x32_bf16 v[176:179], a[232:235], v[120:123], v[176:179]
    ds_read_b128 a[252:255], v3 offset:6400
    v_sqrt_f32 v225, v225
    v_mfma_f32_16x16x32_bf16 v[180:183], a[232:235], v[124:127], v[180:183]
    buffer_load_dwordx4 v2, s[4:7], s21 offen offset:1024 sc1 lds
    v_cvt_pk_bf16_f32 v8, v224, v224
    v_mfma_f32_16x16x32_bf16 v[184:187], a[236:239], v[120:123], v[184:187]
    ds_read_b128 a[224:227], v3 offset:8192
    s_waitcnt vmcnt(8) lgkmcnt(3)
    v_mfma_f32_16x16x32_bf16 v[188:191], a[236:239], v[124:127], v[188:191]
    v_cvt_pk_bf16_f32 v225, v225, 0
    v_lshlrev_b32 v225, 16, v225
    v_mfma_f32_16x16x32_bf16 v[144:147], a[240:243], v[128:131], v[144:147]
    ds_read_b128 a[228:231], v3 offset:8448
    v_rcp_f32 v6, v225
    v_mfma_f32_16x16x32_bf16 v[148:151], a[240:243], v[132:135], v[148:151]
    s_add_u32 m0, s99, 106496
    s_add_u32 s21, s21, 8192
    v_mfma_f32_16x16x32_bf16 v[152:155], a[244:247], v[128:131], v[152:155]
    ds_read_b128 a[232:235], v3 offset:10240
    s_waitcnt lgkmcnt(3)
    v_mfma_f32_16x16x32_bf16 v[156:159], a[244:247], v[132:135], v[156:159]
    buffer_load_dwordx4 v2, s[4:7], s21 offen sc1 lds
    v_mov_b32 v9, 0
    v_mfma_f32_16x16x32_bf16 v[160:163], a[248:251], v[128:131], v[160:163]
    ds_read_b128 a[236:239], v3 offset:10496
    v_mov_b32 v10, v8
    v_mfma_f32_16x16x32_bf16 v[164:167], a[248:251], v[132:135], v[164:167]
    buffer_load_dwordx4 v2, s[4:7], s21 offen offset:1024 sc1 lds
    v_mov_b32 v11, 0
    v_mfma_f32_16x16x32_bf16 v[168:171], a[252:255], v[128:131], v[168:171]
    ds_read_b128 a[240:243], v3 offset:12288
    s_waitcnt lgkmcnt(3)
    v_mfma_f32_16x16x32_bf16 v[172:175], a[252:255], v[132:135], v[172:175]
    v_mul_f32 v6, v6, v6
    v_permlane16_swap_b32 v8, v10
    v_mfma_f32_16x16x32_bf16 v[176:179], a[224:227], v[128:131], v[176:179]
    ds_read_b128 a[244:247], v3 offset:12544
    v_mov_b32 v7, v6
    v_mfma_f32_16x16x32_bf16 v[180:183], a[224:227], v[132:135], v[180:183]
    s_add_u32 m0, s99, 114688
    s_add_u32 s21, s21, 8192
    v_mfma_f32_16x16x32_bf16 v[184:187], a[228:231], v[128:131], v[184:187]
    ds_read_b128 a[248:251], v3 offset:14336
    s_waitcnt vmcnt(7) lgkmcnt(3)
    v_mfma_f32_16x16x32_bf16 v[188:191], a[228:231], v[132:135], v[188:191]
    buffer_load_dwordx4 v2, s[4:7], s21 offen sc1 lds
    v_permlane16_swap_b32 v6, v7
    v_mfma_f32_16x16x32_bf16 v[144:147], a[232:235], v[136:139], v[144:147]
    ds_read_b128 a[252:255], v3 offset:14592
    v_mfma_f32_16x16x32_bf16 v[148:151], a[232:235], v[140:143], v[148:151]
    buffer_load_dwordx4 v2, s[4:7], s21 offen offset:1024 sc1 lds
    v_mfma_f32_16x16x32_bf16 v[152:155], a[236:239], v[136:139], v[152:155]
    ds_read_b64 a[224:225], v13 offset:0
    ds_read_b64 a[226:227], v13 offset:256
    s_waitcnt lgkmcnt(4)
    v_mfma_f32_16x16x32_bf16 v[156:159], a[236:239], v[140:143], v[156:159]
    v_mfma_f32_16x16x32_bf16 v[160:163], a[240:243], v[136:139], v[160:163]
    ds_read_b64 a[228:229], v13 offset:1024
    ds_read_b64 a[230:231], v13 offset:1280
    v_mfma_f32_16x16x32_bf16 v[164:167], a[240:243], v[140:143], v[164:167]
    s_add_u32 m0, s99, 122880
    s_add_u32 s21, s21, 8192
    v_mfma_f32_16x16x32_bf16 v[168:171], a[244:247], v[136:139], v[168:171]
    ds_read_b64 a[232:233], v13 offset:2048
    ds_read_b64 a[234:235], v13 offset:2304
    s_waitcnt lgkmcnt(6)
    v_mfma_f32_16x16x32_bf16 v[172:175], a[244:247], v[140:143], v[172:175]
    buffer_load_dwordx4 v2, s[4:7], s21 offen sc1 lds
    v_mfma_f32_16x16x32_bf16 v[176:179], a[248:251], v[136:139], v[176:179]
    ds_read_b128 a[236:239], v3 offset:20480
    v_mfma_f32_16x16x32_bf16 v[180:183], a[248:251], v[140:143], v[180:183]
    buffer_load_dwordx4 v2, s[4:7], s21 offen offset:1024 sc1 lds
    v_mfma_f32_16x16x32_bf16 v[184:187], a[252:255], v[136:139], v[184:187]
    ds_read_b128 a[240:243], v3 offset:20736
    s_waitcnt lgkmcnt(4)
    v_mfma_f32_16x16x32_bf16 v[188:191], a[252:255], v[140:143], v[188:191]
    v_mfma_f32_16x16x16_bf16 v[144:147], a[224:225], v[8:9], v[144:147]
    ds_read_b128 a[244:247], v3 offset:22528
    v_mfma_f32_16x16x16_bf16 v[148:151], a[224:225], v[10:11], v[148:151]
    v_mfma_f32_16x16x16_bf16 v[152:155], a[226:227], v[8:9], v[152:155]
    v_mfma_f32_16x16x16_bf16 v[156:159], a[226:227], v[10:11], v[156:159]
    s_add_u32 m0, s99, 131072
    s_add_u32 s21, s21, 8192
    v_mfma_f32_16x16x16_bf16 v[160:163], a[228:229], v[8:9], v[160:163]
    ds_read_b128 a[248:251], v3 offset:22784
    s_waitcnt lgkmcnt(3)
    v_mfma_f32_16x16x16_bf16 v[164:167], a[228:229], v[10:11], v[164:167]
    buffer_load_dwordx4 v2, s[4:7], s21 offen sc1 lds
    v_mfma_f32_16x16x16_bf16 v[168:171], a[230:231], v[8:9], v[168:171]
    v_mfma_f32_16x16x16_bf16 v[172:175], a[230:231], v[10:11], v[172:175]
    v_mfma_f32_16x16x16_bf16 v[176:179], a[232:233], v[8:9], v[176:179]
    ds_read_b128 a[252:255], v3 offset:24576
    v_mfma_f32_16x16x16_bf16 v[180:183], a[232:233], v[10:11], v[180:183]
    v_mfma_f32_16x16x16_bf16 v[184:187], a[234:235], v[8:9], v[184:187]
    v_mfma_f32_16x16x16_bf16 v[188:191], a[234:235], v[10:11], v[188:191]
    v_cmp_ne_u64 vcc, s[32:33], v[252:253]
    s_nop 0
    s_cbranch_vccnz ap_76
apok_77:
    buffer_load_dwordx4 v2, s[4:7], s21 offen offset:1024 sc1 lds
    v_mfma_f32_16x16x32_bf16 v[192:195], a[236:239], v[16:19], 0
    ds_read_b128 a[224:227], v3 offset:24832
    s_waitcnt lgkmcnt(3)
    v_mfma_f32_16x16x32_bf16 v[196:199], a[236:239], v[20:23], 0
    v_mfma_f32_16x16x32_bf16 v[200:203], a[240:243], v[16:19], 0
    ds_read_b128 a[228:231], v3 offset:26624
    v_mfma_f32_16x16x32_bf16 v[204:207], a[240:243], v[20:23], 0
    global_load_dword v255, v1, s[90:91]
    v_mul_f32 v144, v144, v6
    v_mul_f32 v145, v145, v6
    v_mfma_f32_16x16x32_bf16 v[208:211], a[244:247], v[16:19], 0
    ds_read_b128 a[232:235], v3 offset:26880
    s_waitcnt lgkmcnt(3)
    v_mfma_f32_16x16x32_bf16 v[212:215], a[244:247], v[20:23], 0
    v_mul_f32 v146, v146, v6
    v_mul_f32 v147, v147, v6
    v_mfma_f32_16x16x32_bf16 v[216:219], a[248:251], v[16:19], 0
    ds_read_b128 a[236:239], v3 offset:28672
    v_mul_f32 v144, v144, v152
    v_mfma_f32_16x16x32_bf16 v[220:223], a[248:251], v[20:23], 0
    v_mul_f32 v145, v145, v153
    v_mul_f32 v146, v146, v154
    v_mfma_f32_16x16x32_bf16 v[192:195], a[252:255], v[24:27], v[192:195]
    ds_read_b128 a[240:243], v3 offset:28928
    s_waitcnt lgkmcnt(3)
    v_mfma_f32_16x16x32_bf16 v[196:199], a[252:255], v[28:31], v[196:199]
    v_mul_f32 v147, v147, v155
    v_cvt_pk_bf16_f32 v152, v144, v145
    v_mfma_f32_16x16x32_bf16 v[200:203], a[224:227], v[24:27], v[200:203]
    ds_read_b128 a[244:247], v3 offset:30720
    v_cvt_pk_bf16_f32 v153, v146, v147
    v_mfma_f32_16x16x32_bf16 v[204:207], a[224:227], v[28:31], v[204:207]
    v_mul_f32 v148, v148, v7
    v_mul_f32 v149, v149, v7
    v_mfma_f32_16x16x32_bf16 v[208:211], a[228:231], v[24:27], v[208:211]
    ds_read_b128 a[248:251], v3 offset:30976
    s_waitcnt lgkmcnt(3)
    v_mfma_f32_16x16x32_bf16 v[212:215], a[228:231], v[28:31], v[212:215]
    v_mul_f32 v150, v150, v7
    v_mul_f32 v151, v151, v7
    v_mfma_f32_16x16x32_bf16 v[216:219], a[232:235], v[24:27], v[216:219]
    ds_read_b128 a[252:255], v3 offset:32768
    v_mul_f32 v148, v148, v156
    v_mfma_f32_16x16x32_bf16 v[220:223], a[232:235], v[28:31], v[220:223]
    v_mul_f32 v149, v149, v157
    v_mul_f32 v150, v150, v158
    v_mfma_f32_16x16x32_bf16 v[192:195], a[236:239], v[32:35], v[192:195]
    ds_read_b128 a[224:227], v3 offset:33024
    s_waitcnt lgkmcnt(3)
    v_mfma_f32_16x16x32_bf16 v[196:199], a[236:239], v[36:39], v[196:199]
    v_mul_f32 v151, v151, v159
    v_cvt_pk_bf16_f32 v154, v148, v149
    v_mfma_f32_16x16x32_bf16 v[200:203], a[240:243], v[32:35], v[200:203]
    ds_read_b128 a[228:231], v3 offset:34816
    v_cvt_pk_bf16_f32 v155, v150, v151
    v_mfma_f32_16x16x32_bf16 v[204:207], a[240:243], v[36:39], v[204:207]
    v_permlane16_swap_b32 v152, v154
    v_permlane16_swap_b32 v153, v155
    v_mfma_f32_16x16x32_bf16 v[208:211], a[244:247], v[32:35], v[208:211]
    ds_read_b128 a[232:235], v3 offset:35072
    s_waitcnt lgkmcnt(3)
    v_mfma_f32_16x16x32_bf16 v[212:215], a[244:247], v[36:39], v[212:215]
    buffer_store_dwordx4 v[152:155], v1, s[4:7], s26 offen offset:0
    v_mul_f32 v160, v160, v6
    v_mfma_f32_16x16x32_bf16 v[216:219], a[248:251], v[32:35], v[216:219]
    ds_read_b128 a[236:239], v3 offset:36864
    v_mul_f32 v161, v161, v6
    v_mfma_f32_16x16x32_bf16 v[220:223], a[248:251], v[36:39], v[220:223]
    v_mul_f32 v162, v162, v6
    v_mul_f32 v163, v163, v6
    v_mfma_f32_16x16x32_bf16 v[192:195], a[252:255], v[40:43], v[192:195]
    ds_read_b128 a[240:243], v3 offset:37120
    s_waitcnt lgkmcnt(3)
    v_mfma_f32_16x16x32_bf16 v[196:199], a[252:255], v[44:47], v[196:199]
    v_mul_f32 v160, v160, v168
    v_mul_f32 v161, v161, v169
    s_barrier
    v_mfma_f32_16x16x32_bf16 v[200:203], a[224:227], v[40:43], v[200:203]
    ds_read_b128 a[244:247], v3 offset:38912
    v_mul_f32 v162, v162, v170
    v_mfma_f32_16x16x32_bf16 v[204:207], a[224:227], v[44:47], v[204:207]
    s_add_u32 m0, s99, 139264
    s_add_u32 s21, s21, 8192
    v_mfma_f32_16x16x32_bf16 v[208:211], a[228:231], v[40:43], v[208:211]
    ds_read_b128 a[248:251], v3 offset:39168
    s_waitcnt lgkmcnt(3)
    v_mfma_f32_16x16x32_bf16 v[212:215], a[228:231], v[44:47], v[212:215]
    buffer_load_dwordx4 v2, s[4:7], s21 offen sc1 lds
    v_mul_f32 v163, v163, v171
    v_mfma_f32_16x16x32_bf16 v[216:219], a[232:235], v[40:43], v[216:219]
    ds_read_b128 a[252:255], v3 offset:40960
    v_cvt_pk_bf16_f32 v168, v160, v161
    v_mfma_f32_16x16x32_bf16 v[220:223], a[232:235], v[44:47], v[220:223]
    buffer_load_dwordx4 v2, s[4:7], s21 offen offset:1024 sc1 lds
    v_cvt_pk_bf16_f32 v169, v162, v163
    v_mfma_f32_16x16x32_bf16 v[192:195], a[236:239], v[48:51], v[192:195]
    ds_read_b128 a[224:227], v3 offset:41216
    s_waitcnt lgkmcnt(3)
    v_mfma_f32_16x16x32_bf16 v[196:199], a[236:239], v[52:55], v[196:199]
    v_mul_f32 v164, v164, v7
    v_mul_f32 v165, v165, v7
    v_mfma_f32_16x16x32_bf16 v[200:203], a[240:243], v[48:51], v[200:203]
    ds_read_b128 a[228:231], v3 offset:43008
    v_mul_f32 v166, v166, v7
    v_mfma_f32_16x16x32_bf16 v[204:207], a[240:243], v[52:55], v[204:207]
    s_add_u32 m0, s99, 0
    s_add_u32 s21, s21, 8192
    v_mfma_f32_16x16x32_bf16 v[208:211], a[244:247], v[48:51], v[208:211]
    ds_read_b128 a[232:235], v3 offset:43264
    s_waitcnt lgkmcnt(3)
    v_mfma_f32_16x16x32_bf16 v[212:215], a[244:247], v[52:55], v[212:215]
    buffer_load_dwordx4 v2, s[4:7], s21 offen sc1 lds
    v_mul_f32 v167, v167, v7
    v_mfma_f32_16x16x32_bf16 v[216:219], a[248:251], v[48:51], v[216:219]
    ds_read_b128 a[236:239], v3 offset:45056
    v_mul_f32 v164, v164, v172
    v_mfma_f32_16x16x32_bf16 v[220:223], a[248:251], v[52:55], v[220:223]
    buffer_load_dwordx4 v2, s[4:7], s21 offen offset:1024 sc1 lds
    v_mul_f32 v165, v165, v173
    v_mfma_f32_16x16x32_bf16 v[192:195], a[252:255], v[56:59], v[192:195]
    ds_read_b128 a[240:243], v3 offset:45312
    s_waitcnt lgkmcnt(3)
    v_mfma_f32_16x16x32_bf16 v[196:199], a[252:255], v[60:63], v[196:199]
    v_mul_f32 v166, v166, v174
    v_mul_f32 v167, v167, v175
    v_mfma_f32_16x16x32_bf16 v[200:203], a[224:227], v[56:59], v[200:203]
    ds_read_b128 a[244:247], v3 offset:47104
    v_cvt_pk_bf16_f32 v170, v164, v165
    v_mfma_f32_16x16x32_bf16 v[204:207], a[224:227], v[60:63], v[204:207]
    v_cvt_pk_bf16_f32 v171, v166, v167
    v_permlane16_swap_b32 v168, v170
    v_mfma_f32_16x16x32_bf16 v[208:211], a[228:231], v[56:59], v[208:211]
    ds_read_b128 a[248:251], v3 offset:47360
    s_waitcnt lgkmcnt(3)
    v_mfma_f32_16x16x32_bf16 v[212:215], a[228:231], v[60:63], v[212:215]
    v_permlane16_swap_b32 v169, v171
    v_mfma_f32_16x16x32_bf16 v[216:219], a[232:235], v[56:59], v[216:219]
    ds_read_b128 a[252:255], v3 offset:49152
    v_mfma_f32_16x16x32_bf16 v[220:223], a[232:235], v[60:63], v[220:223]
    buffer_store_dwordx4 v[168:171], v1, s[4:7], s26 offen offset:1024
    v_mul_f32 v176, v176, v6
    v_mfma_f32_16x16x32_bf16 v[192:195], a[236:239], v[64:67], v[192:195]
    ds_read_b128 a[224:227], v3 offset:49408
    s_waitcnt lgkmcnt(3)
    v_mfma_f32_16x16x32_bf16 v[196:199], a[236:239], v[68:71], v[196:199]
    v_mul_f32 v177, v177, v6
    v_mul_f32 v178, v178, v6
    v_mfma_f32_16x16x32_bf16 v[200:203], a[240:243], v[64:67], v[200:203]
    ds_read_b128 a[228:231], v3 offset:51200
    v_mul_f32 v179, v179, v6
    v_mfma_f32_16x16x32_bf16 v[204:207], a[240:243], v[68:71], v[204:207]
    v_mul_f32 v176, v176, v184
    v_mul_f32 v177, v177, v185
    v_mfma_f32_16x16x32_bf16 v[208:211], a[244:247], v[64:67], v[208:211]
    ds_read_b128 a[232:235], v3 offset:51456
    s_waitcnt lgkmcnt(3)
    v_mfma_f32_16x16x32_bf16 v[212:215], a[244:247], v[68:71], v[212:215]
    v_mul_f32 v178, v178, v186
    v_mul_f32 v179, v179, v187
    v_mfma_f32_16x16x32_bf16 v[216:219], a[248:251], v[64:67], v[216:219]
    ds_read_b128 a[236:239], v3 offset:53248
    v_cvt_pk_bf16_f32 v184, v176, v177
    v_mfma_f32_16x16x32_bf16 v[220:223], a[248:251], v[68:71], v[220:223]
    v_cvt_pk_bf16_f32 v185, v178, v179
    v_mul_f32 v180, v180, v7
    v_mfma_f32_16x16x32_bf16 v[192:195], a[252:255], v[72:75], v[192:195]
    ds_read_b128 a[240:243], v3 offset:53504
    s_waitcnt lgkmcnt(3)
    v_mfma_f32_16x16x32_bf16 v[196:199], a[252:255], v[76:79], v[196:199]
    v_mul_f32 v181, v181, v7
    v_mul_f32 v182, v182, v7
    v_mfma_f32_16x16x32_bf16 v[200:203], a[224:227], v[72:75], v[200:203]
    ds_read_b128 a[244:247], v3 offset:55296
    v_mul_f32 v183, v183, v7
    v_mfma_f32_16x16x32_bf16 v[204:207], a[224:227], v[76:79], v[204:207]
    v_mul_f32 v180, v180, v188
    v_mul_f32 v181, v181, v189
    v_mfma_f32_16x16x32_bf16 v[208:211], a[228:231], v[72:75], v[208:211]
    ds_read_b128 a[248:251], v3 offset:55552
    s_waitcnt lgkmcnt(3)
    v_mfma_f32_16x16x32_bf16 v[212:215], a[228:231], v[76:79], v[212:215]
    v_mul_f32 v182, v182, v190
    v_mul_f32 v183, v183, v191
    v_mfma_f32_16x16x32_bf16 v[216:219], a[232:235], v[72:75], v[216:219]
    ds_read_b128 a[252:255], v3 offset:57344
    v_cvt_pk_bf16_f32 v186, v180, v181
    v_mfma_f32_16x16x32_bf16 v[220:223], a[232:235], v[76:79], v[220:223]
    v_cvt_pk_bf16_f32 v187, v182, v183
    v_permlane16_swap_b32 v184, v186
    v_mfma_f32_16x16x32_bf16 v[192:195], a[236:239], v[80:83], v[192:195]
    ds_read_b128 a[224:227], v3 offset:57600
    s_waitcnt lgkmcnt(3)
    v_mfma_f32_16x16x32_bf16 v[196:199], a[236:239], v[84:87], v[196:199]
    v_permlane16_swap_b32 v185, v187
    v_mfma_f32_16x16x32_bf16 v[200:203], a[240:243], v[80:83], v[200:203]
    ds_read_b128 a[228:231], v3 offset:59392
    v_mfma_f32_16x16x32_bf16 v[204:207], a[240:243], v[84:87], v[204:207]
    buffer_store_dwordx4 v[184:187], v1, s[4:7], s26 offen offset:2048
    v_lshlrev_b32 v12, 3, v0
    v_mfma_f32_16x16x32_bf16 v[208:211], a[244:247], v[80:83], v[208:211]
    ds_read_b128 a[232:235], v3 offset:59648
    s_waitcnt lgkmcnt(3)
    v_mfma_f32_16x16x32_bf16 v[212:215], a[244:247], v[84:87], v[212:215]
    v_and_b32 v12, 0x98, v12
    v_mfma_f32_16x16x32_bf16 v[216:219], a[248:251], v[80:83], v[216:219]
    ds_read_b128 a[236:239], v3 offset:61440
    v_mfma_f32_16x16x32_bf16 v[220:223], a[248:251], v[84:87], v[220:223]
    v_mfma_f32_16x16x32_bf16 v[192:195], a[252:255], v[88:91], v[192:195]
    ds_read_b128 a[240:243], v3 offset:61696
    s_waitcnt lgkmcnt(3)
    v_mfma_f32_16x16x32_bf16 v[196:199], a[252:255], v[92:95], v[196:199]
    v_mfma_f32_16x16x32_bf16 v[200:203], a[224:227], v[88:91], v[200:203]
    ds_read_b128 a[244:247], v3 offset:63488
    v_mfma_f32_16x16x32_bf16 v[204:207], a[224:227], v[92:95], v[204:207]
    v_mfma_f32_16x16x32_bf16 v[208:211], a[228:231], v[88:91], v[208:211]
    ds_read_b128 a[248:251], v3 offset:63744
    s_waitcnt lgkmcnt(3)
    v_mfma_f32_16x16x32_bf16 v[212:215], a[228:231], v[92:95], v[212:215]
    v_mfma_f32_16x16x32_bf16 v[216:219], a[232:235], v[88:91], v[216:219]
    ds_read_b128 a[252:255], v4 offset:0
    v_mfma_f32_16x16x32_bf16 v[220:223], a[232:235], v[92:95], v[220:223]
    v_mfma_f32_16x16x32_bf16 v[192:195], a[236:239], v[96:99], v[192:195]
    ds_read_b128 a[224:227], v4 offset:256
    s_waitcnt lgkmcnt(3)
    v_mfma_f32_16x16x32_bf16 v[196:199], a[236:239], v[100:103], v[196:199]
    v_mfma_f32_16x16x32_bf16 v[200:203], a[240:243], v[96:99], v[200:203]
    ds_read_b128 a[228:231], v4 offset:2048
    v_mfma_f32_16x16x32_bf16 v[204:207], a[240:243], v[100:103], v[204:207]
    v_mfma_f32_16x16x32_bf16 v[208:211], a[244:247], v[96:99], v[208:211]
    ds_read_b128 a[232:235], v4 offset:2304
    s_waitcnt lgkmcnt(3)
    v_mfma_f32_16x16x32_bf16 v[212:215], a[244:247], v[100:103], v[212:215]
    v_mfma_f32_16x16x32_bf16 v[216:219], a[248:251], v[96:99], v[216:219]
    ds_read_b128 a[236:239], v4 offset:4096
    v_mfma_f32_16x16x32_bf16 v[220:223], a[248:251], v[100:103], v[220:223]
    v_mfma_f32_16x16x32_bf16 v[192:195], a[252:255], v[104:107], v[192:195]
    ds_read_b128 a[240:243], v4 offset:4352
    s_waitcnt lgkmcnt(3)
    v_mfma_f32_16x16x32_bf16 v[196:199], a[252:255], v[108:111], v[196:199]
    s_waitcnt vmcnt(16)
    s_barrier
    v_mfma_f32_16x16x32_bf16 v[200:203], a[224:227], v[104:107], v[200:203]
    ds_read_b128 a[244:247], v4 offset:6144
    v_mfma_f32_16x16x32_bf16 v[204:207], a[224:227], v[108:111], v[204:207]
    v_mfma_f32_16x16x32_bf16 v[208:211], a[228:231], v[104:107], v[208:211]
    ds_read_b128 a[248:251], v4 offset:6400
    s_waitcnt lgkmcnt(3)
    v_mfma_f32_16x16x32_bf16 v[212:215], a[228:231], v[108:111], v[212:215]
    v_mfma_f32_16x16x32_bf16 v[216:219], a[232:235], v[104:107], v[216:219]
    ds_read_b128 a[252:255], v4 offset:8192
    v_mfma_f32_16x16x32_bf16 v[220:223], a[232:235], v[108:111], v[220:223]
    v_mfma_f32_16x16x32_bf16 v[192:195], a[236:239], v[112:115], v[192:195]
    ds_read_b128 a[224:227], v4 offset:8448
    s_waitcnt lgkmcnt(3)
    v_mfma_f32_16x16x32_bf16 v[196:199], a[236:239], v[116:119], v[196:199]
    v_mfma_f32_16x16x32_bf16 v[200:203], a[240:243], v[112:115], v[200:203]
    ds_read_b128 a[228:231], v4 offset:10240
    v_mfma_f32_16x16x32_bf16 v[204:207], a[240:243], v[116:119], v[204:207]
    v_mfma_f32_16x16x32_bf16 v[208:211], a[244:247], v[112:115], v[208:211]
    ds_read_b128 a[232:235], v4 offset:10496
    s_waitcnt lgkmcnt(3)
    v_mfma_f32_16x16x32_bf16 v[212:215], a[244:247], v[116:119], v[212:215]
    v_mfma_f32_16x16x32_bf16 v[216:219], a[248:251], v[112:115], v[216:219]
    ds_read_b128 a[236:239], v4 offset:12288
    v_mfma_f32_16x16x32_bf16 v[220:223], a[248:251], v[116:119], v[220:223]
    v_mfma_f32_16x16x32_bf16 v[192:195], a[252:255], v[120:123], v[192:195]
    ds_read_b128 a[240:243], v4 offset:12544
    s_waitcnt lgkmcnt(3)
    v_mfma_f32_16x16x32_bf16 v[196:199], a[252:255], v[124:127], v[196:199]
    v_mfma_f32_16x16x32_bf16 v[200:203], a[224:227], v[120:123], v[200:203]
    ds_read_b128 a[244:247], v4 offset:14336
    v_mfma_f32_16x16x32_bf16 v[204:207], a[224:227], v[124:127], v[204:207]
    v_mfma_f32_16x16x32_bf16 v[208:211], a[228:231], v[120:123], v[208:211]
    ds_read_b128 a[248:251], v4 offset:14592
    s_waitcnt lgkmcnt(3)
    v_mfma_f32_16x16x32_bf16 v[212:215], a[228:231], v[124:127], v[212:215]
    v_mfma_f32_16x16x32_bf16 v[216:219], a[232:235], v[120:123], v[216:219]
    ds_read_b128 a[252:255], v4 offset:16384
    v_mfma_f32_16x16x32_bf16 v[220:223], a[232:235], v[124:127], v[220:223]
    v_mfma_f32_16x16x32_bf16 v[192:195], a[236:239], v[128:131], v[192:195]
    ds_read_b128 a[224:227], v4 offset:16640
    s_waitcnt lgkmcnt(3)
    v_mfma_f32_16x16x32_bf16 v[196:199], a[236:239], v[132:135], v[196:199]
    v_mfma_f32_16x16x32_bf16 v[200:203], a[240:243], v[128:131], v[200:203]
    ds_read_b128 a[228:231], v4 offset:18432
    v_mfma_f32_16x16x32_bf16 v[204:207], a[240:243], v[132:135], v[204:207]
    s_cmp_eq_u32 s34, 0
    s_cbranch_scc1 slow_78
    s_waitcnt vmcnt(0)
    buffer_store_dwordx2 v[14:15], off, s[4:7], s41
join_79:
    s_add_u32 s41, s41, 8192
    v_mfma_f32_16x16x32_bf16 v[208:211], a[244:247], v[128:131], v[208:211]
    ds_read_b128 a[232:235], v4 offset:18688
    s_waitcnt lgkmcnt(3)
    v_mfma_f32_16x16x32_bf16 v[212:215], a[244:247], v[132:135], v[212:215]
    v_mfma_f32_16x16x32_bf16 v[216:219], a[248:251], v[128:131], v[216:219]
    v_add_u32 v13, 69632, v13
    ds_read_b64 a[236:237], v13 offset:0
    ds_read_b64 a[238:239], v13 offset:256
    v_mfma_f32_16x16x32_bf16 v[220:223], a[248:251], v[132:135], v[220:223]
    v_mfma_f32_16x16x32_bf16 v[192:195], a[252:255], v[136:139], v[192:195]
    ds_read_b64 a[240:241], v13 offset:1024
    ds_read_b64 a[242:243], v13 offset:1280
    s_waitcnt lgkmcnt(5)
    v_mfma_f32_16x16x32_bf16 v[196:199], a[252:255], v[140:143], v[196:199]
    v_mfma_f32_16x16x32_bf16 v[200:203], a[224:227], v[136:139], v[200:203]
    ds_read_b128 a[244:247], v4 offset:22528
    v_mfma_f32_16x16x32_bf16 v[204:207], a[224:227], v[140:143], v[204:207]
    v_mfma_f32_16x16x32_bf16 v[208:211], a[228:231], v[136:139], v[208:211]
    ds_read_b128 a[248:251], v4 offset:22784
    s_waitcnt lgkmcnt(4)
    v_mfma_f32_16x16x32_bf16 v[212:215], a[228:231], v[140:143], v[212:215]
    v_mfma_f32_16x16x32_bf16 v[216:219], a[232:235], v[136:139], v[216:219]
    ds_read_b128 a[252:255], v4 offset:24576
    v_mfma_f32_16x16x32_bf16 v[220:223], a[232:235], v[140:143], v[220:223]
    v_mfma_f32_16x16x16_bf16 v[192:195], a[236:237], v[8:9], v[192:195]
    ds_read_b128 a[224:227], v4 offset:24832
    s_waitcnt lgkmcnt(3)
    v_mfma_f32_16x16x16_bf16 v[196:199], a[236:237], v[10:11], v[196:199]
    v_mfma_f32_16x16x16_bf16 v[200:203], a[238:239], v[8:9], v[200:203]
    v_mfma_f32_16x16x16_bf16 v[204:207], a[238:239], v[10:11], v[204:207]
    v_mfma_f32_16x16x16_bf16 v[208:211], a[240:241], v[8:9], v[208:211]
    ds_read_b128 a[228:231], v4 offset:26624
    v_mfma_f32_16x16x16_bf16 v[212:215], a[240:241], v[10:11], v[212:215]
    v_mfma_f32_16x16x16_bf16 v[216:219], a[242:243], v[8:9], v[216:219]
    v_mfma_f32_16x16x16_bf16 v[220:223], a[242:243], v[10:11], v[220:223]
    v_mfma_f32_16x16x32_bf16 v[224:227], a[244:247], v[16:19], 0
    ds_read_b128 a[232:235], v4 offset:26880
    s_waitcnt lgkmcnt(3)
    v_mfma_f32_16x16x32_bf16 v[228:231], a[244:247], v[20:23], 0
    v_mfma_f32_16x16x32_bf16 v[232:235], a[248:251], v[16:19], 0
    ds_read_b128 a[236:239], v4 offset:28672
    v_mfma_f32_16x16x32_bf16 v[236:239], a[248:251], v[20:23], 0
    v_mfma_f32_16x16x32_bf16 v[240:243], a[252:255], v[16:19], 0
    ds_read_b128 a[240:243], v4 offset:28928
    s_waitcnt lgkmcnt(3)
    v_mfma_f32_16x16x32_bf16 v[244:247], a[252:255], v[20:23], 0
    v_mul_f32 v192, v192, v6
    v_mul_f32 v193, v193, v6
    v_mfma_f32_16x16x32_bf16 v[248:251], a[224:227], v[16:19], 0
    ds_read_b128 a[244:247], v4 offset:30720
    v_mul_f32 v194, v194, v6
    v_mfma_f32_16x16x32_bf16 v[252:255], a[224:227], v[20:23], 0
    v_mul_f32 v195, v195, v6
    v_mul_f32 v192, v192, v200
    v_mfma_f32_16x16x32_bf16 v[224:227], a[228:231], v[24:27], v[224:227]
    ds_read_b128 a[248:251], v4 offset:30976
    s_waitcnt lgkmcnt(3)
    v_mfma_f32_16x16x32_bf16 v[228:231], a[228:231], v[28:31], v[228:231]
    v_mul_f32 v193, v193, v201
    v_mul_f32 v194, v194, v202
    v_mfma_f32_16x16x32_bf16 v[232:235], a[232:235], v[24:27], v[232:235]
    ds_read_b128 a[252:255], v4 offset:32768
    v_mul_f32 v195, v195, v203
    v_mfma_f32_16x16x32_bf16 v[236:239], a[232:235], v[28:31], v[236:239]
    v_cvt_pk_bf16_f32 v200, v192, v193
    v_cvt_pk_bf16_f32 v201, v194, v195
    v_mfma_f32_16x16x32_bf16 v[240:243], a[236:239], v[24:27], v[240:243]
    ds_read_b128 a[224:227], v4 offset:33024
    s_waitcnt lgkmcnt(3)
    v_mfma_f32_16x16x32_bf16 v[244:247], a[236:239], v[28:31], v[244:247]
    v_mul_f32 v196, v196, v7
    v_mul_f32 v197, v197, v7
    v_mfma_f32_16x16x32_bf16 v[248:251], a[240:243], v[24:27], v[248:251]
    ds_read_b128 a[228:231], v4 offset:34816
    v_mul_f32 v198, v198, v7
    v_mfma_f32_16x16x32_bf16 v[252:255], a[240:243], v[28:31], v[252:255]
    v_mul_f32 v199, v199, v7
    v_mul_f32 v196, v196, v204
    v_mfma_f32_16x16x32_bf16 v[224:227], a[244:247], v[32:35], v[224:227]
    ds_read_b128 a[232:235], v4 offset:35072
    s_waitcnt lgkmcnt(3)
    v_mfma_f32_16x16x32_bf16 v[228:231], a[244:247], v[36:39], v[228:231]
    v_mul_f32 v197, v197, v205
    v_mul_f32 v198, v198, v206
    v_mfma_f32_16x16x32_bf16 v[232:235], a[248:251], v[32:35], v[232:235]
    ds_read_b128 a[236:239], v4 offset:36864
    v_mul_f32 v199, v199, v207
    v_mfma_f32_16x16x32_bf16 v[236:239], a[248:251], v[36:39], v[236:239]
    buffer_load_dwordx2 v[14:15], v12, s[4:7], s25 offen sc1
    v_cvt_pk_bf16_f32 v202, v196, v197
    v_cvt_pk_bf16_f32 v203, v198, v199
    v_mfma_f32_16x16x32_bf16 v[240:243], a[252:255], v[32:35], v[240:243]
    ds_read_b128 a[240:243], v4 offset:37120
    s_waitcnt lgkmcnt(3)
    v_mfma_f32_16x16x32_bf16 v[244:247], a[252:255], v[36:39], v[244:247]
    v_permlane16_swap_b32 v200, v202
    v_permlane16_swap_b32 v201, v203
    s_barrier
    v_mfma_f32_16x16x32_bf16 v[248:251], a[224:227], v[32:35], v[248:251]
    ds_read_b128 a[244:247], v4 offset:38912
    v_mfma_f32_16x16x32_bf16 v[252:255], a[224:227], v[36:39], v[252:255]
    buffer_store_dwordx4 v[200:203], v1, s[4:7], s26 offen offset:3072
    v_mul_f32 v208, v208, v6
    v_mfma_f32_16x16x32_bf16 v[224:227], a[228:231], v[40:43], v[224:227]
    ds_read_b128 a[248:251], v4 offset:39168
    s_waitcnt lgkmcnt(3)
    v_mfma_f32_16x16x32_bf16 v[228:231], a[228:231], v[44:47], v[228:231]
    v_mul_f32 v209, v209, v6
    v_mul_f32 v210, v210, v6
    v_mfma_f32_16x16x32_bf16 v[232:235], a[232:235], v[40:43], v[232:235]
    ds_read_b128 a[252:255], v4 offset:40960
    v_mul_f32 v211, v211, v6
    v_mfma_f32_16x16x32_bf16 v[236:239], a[232:235], v[44:47], v[236:239]
    v_mul_f32 v208, v208, v216
    v_mul_f32 v209, v209, v217
    v_mfma_f32_16x16x32_bf16 v[240:243], a[236:239], v[40:43], v[240:243]
    ds_read_b128 a[224:227], v4 offset:41216
    s_waitcnt lgkmcnt(3)
    v_mfma_f32_16x16x32_bf16 v[244:247], a[236:239], v[44:47], v[244:247]
    v_mul_f32 v210, v210, v218
    v_mul_f32 v211, v211, v219
    v_mfma_f32_16x16x32_bf16 v[248:251], a[240:243], v[40:43], v[248:251]
    ds_read_b128 a[228:231], v4 offset:43008
    v_cvt_pk_bf16_f32 v216, v208, v209
    v_mfma_f32_16x16x32_bf16 v[252:255], a[240:243], v[44:47], v[252:255]
    v_cvt_pk_bf16_f32 v217, v210, v211
    v_mul_f32 v212, v212, v7
    v_mfma_f32_16x16x32_bf16 v[224:227], a[244:247], v[48:51], v[224:227]
    ds_read_b128 a[232:235], v4 offset:43264
    s_waitcnt lgkmcnt(3)
    v_mfma_f32_16x16x32_bf16 v[228:231], a[244:247], v[52:55], v[228:231]
    v_mul_f32 v213, v213, v7
    v_mul_f32 v214, v214, v7
    v_mfma_f32_16x16x32_bf16 v[232:235], a[248:251], v[48:51], v[232:235]
    ds_read_b128 a[236:239], v4 offset:45056
    v_mul_f32 v215, v215, v7
    v_mfma_f32_16x16x32_bf16 v[236:239], a[248:251], v[52:55], v[236:239]
    v_mul_f32 v212, v212, v220
    v_mul_f32 v213, v213, v221
    v_mfma_f32_16x16x32_bf16 v[240:243], a[252:255], v[48:51], v[240:243]
    ds_read_b128 a[240:243], v4 offset:45312
    s_waitcnt lgkmcnt(3)
    v_mfma_f32_16x16x32_bf16 v[244:247], a[252:255], v[52:55], v[244:247]
    v_mul_f32 v214, v214, v222
    v_mul_f32 v215, v215, v223
    v_mfma_f32_16x16x32_bf16 v[248:251], a[224:227], v[48:51], v[248:251]
    ds_read_b128 a[244:247], v4 offset:47104
    v_cvt_pk_bf16_f32 v218, v212, v213
    v_mfma_f32_16x16x32_bf16 v[252:255], a[224:227], v[52:55], v[252:255]
    v_cvt_pk_bf16_f32 v219, v214, v215
    v_permlane16_swap_b32 v216, v218
    v_mfma_f32_16x16x32_bf16 v[224:227], a[228:231], v[56:59], v[224:227]
    ds_read_b128 a[248:251], v4 offset:47360
    s_waitcnt lgkmcnt(3)
    v_mfma_f32_16x16x32_bf16 v[228:231], a[228:231], v[60:63], v[228:231]
    v_permlane16_swap_b32 v217, v219
    v_mfma_f32_16x16x32_bf16 v[232:235], a[232:235], v[56:59], v[232:235]
    ds_read_b128 a[252:255], v4 offset:49152
    v_mfma_f32_16x16x32_bf16 v[236:239], a[232:235], v[60:63], v[236:239]
    buffer_store_dwordx4 v[216:219], v1, s[4:7], s27 offen offset:0
    v_mfma_f32_16x16x32_bf16 v[240:243], a[236:239], v[56:59], v[240:243]
    ds_read_b128 a[224:227], v4 offset:49408
    s_waitcnt lgkmcnt(3)
    v_mfma_f32_16x16x32_bf16 v[244:247], a[236:239], v[60:63], v[244:247]
    v_mfma_f32_16x16x32_bf16 v[248:251], a[240:243], v[56:59], v[248:251]
    ds_read_b128 a[228:231], v4 offset:51200
    v_mfma_f32_16x16x32_bf16 v[252:255], a[240:243], v[60:63], v[252:255]
    s_waitcnt vmcnt(2)
    v_cmp_ne_u64 vcc, s[32:33], v[14:15]
    s_nop 0
    s_cbranch_vccnz ap_80
apok_81:
    s_add_u32 s25, s25, 8192
    v_mov_b32 v14, s32
    v_mfma_f32_16x16x32_bf16 v[224:227], a[244:247], v[64:67], v[224:227]
    ds_read_b128 a[232:235], v4 offset:51456
    s_waitcnt lgkmcnt(3)
    v_mfma_f32_16x16x32_bf16 v[228:231], a[244:247], v[68:71], v[228:231]
    v_mov_b32 v15, s33
    v_mfma_f32_16x16x32_bf16 v[232:235], a[248:251], v[64:67], v[232:235]
    ds_read_b128 a[236:239], v4 offset:53248
    v_mfma_f32_16x16x32_bf16 v[236:239], a[248:251], v[68:71], v[236:239]
    buffer_load_dwordx4 v[144:147], v1, s[4:7], s24 offen offset:0 sc1
    v_mfma_f32_16x16x32_bf16 v[240:243], a[252:255], v[64:67], v[240:243]
    ds_read_b128 a[240:243], v4 offset:53504
    s_waitcnt lgkmcnt(3)
    v_mfma_f32_16x16x32_bf16 v[244:247], a[252:255], v[68:71], v[244:247]
    v_mfma_f32_16x16x32_bf16 v[248:251], a[224:227], v[64:67], v[248:251]
    ds_read_b128 a[244:247], v4 offset:55296
    v_mfma_f32_16x16x32_bf16 v[252:255], a[224:227], v[68:71], v[252:255]
    buffer_load_dwordx4 v[148:151], v1, s[4:7], s39 offen offset:0 sc1
    v_mfma_f32_16x16x32_bf16 v[224:227], a[228:231], v[72:75], v[224:227]
    ds_read_b128 a[248:251], v4 offset:55552
    s_waitcnt lgkmcnt(3)
    v_mfma_f32_16x16x32_bf16 v[228:231], a[228:231], v[76:79], v[228:231]
    v_mfma_f32_16x16x32_bf16 v[232:235], a[232:235], v[72:75], v[232:235]
    ds_read_b128 a[252:255], v4 offset:57344
    v_mfma_f32_16x16x32_bf16 v[236:239], a[232:235], v[76:79], v[236:239]
    buffer_load_dwordx4 v[152:155], v1, s[4:7], s24 offen offset:1024 sc1
    v_mfma_f32_16x16x32_bf16 v[240:243], a[236:239], v[72:75], v[240:243]
    ds_read_b128 a[224:227], v4 offset:57600
    s_waitcnt lgkmcnt(3)
    v_mfma_f32_16x16x32_bf16 v[244:247], a[236:239], v[76:79], v[244:247]
    v_mfma_f32_16x16x32_bf16 v[248:251], a[240:243], v[72:75], v[248:251]
    ds_read_b128 a[228:231], v4 offset:59392
    v_mfma_f32_16x16x32_bf16 v[252:255], a[240:243], v[76:79], v[252:255]
    buffer_load_dwordx4 v[156:159], v1, s[4:7], s39 offen offset:1024 sc1
    v_mfma_f32_16x16x32_bf16 v[224:227], a[244:247], v[80:83], v[224:227]
    ds_read_b128 a[232:235], v4 offset:59648
    s_waitcnt lgkmcnt(3)
    v_mfma_f32_16x16x32_bf16 v[228:231], a[244:247], v[84:87], v[228:231]
    v_mfma_f32_16x16x32_bf16 v[232:235], a[248:251], v[80:83], v[232:235]
    ds_read_b128 a[236:239], v4 offset:61440
    v_mfma_f32_16x16x32_bf16 v[236:239], a[248:251], v[84:87], v[236:239]
    buffer_load_dwordx4 v[160:163], v1, s[4:7], s24 offen offset:2048 sc1
    v_mfma_f32_16x16x32_bf16 v[240:243], a[252:255], v[80:83], v[240:243]
    ds_read_b128 a[240:243], v4 offset:61696
    s_waitcnt lgkmcnt(3)
    v_mfma_f32_16x16x32_bf16 v[244:247], a[252:255], v[84:87], v[244:247]
    s_barrier
    v_mfma_f32_16x16x32_bf16 v[248:251], a[224:227], v[80:83], v[248:251]
    ds_read_b128 a[244:247], v4 offset:63488
    v_mfma_f32_16x16x32_bf16 v[252:255], a[224:227], v[84:87], v[252:255]
    buffer_load_dwordx4 v[164:167], v1, s[4:7], s39 offen offset:2048 sc1
    v_mfma_f32_16x16x32_bf16 v[224:227], a[228:231], v[88:91], v[224:227]
    ds_read_b128 a[248:251], v4 offset:63744
    s_waitcnt lgkmcnt(3)
    v_mfma_f32_16x16x32_bf16 v[228:231], a[228:231], v[92:95], v[228:231]
    v_mfma_f32_16x16x32_bf16 v[232:235], a[232:235], v[88:91], v[232:235]
    ds_read_b128 a[252:255], v5 offset:0
    v_mfma_f32_16x16x32_bf16 v[236:239], a[232:235], v[92:95], v[236:239]
    s_add_u32 s24, s24, 7168
    buffer_load_dwordx4 v[168:171], v1, s[4:7], s24 offen offset:0 sc1
    v_mfma_f32_16x16x32_bf16 v[240:243], a[236:239], v[88:91], v[240:243]
    ds_read_b128 a[224:227], v5 offset:256
    s_waitcnt lgkmcnt(3)
    v_mfma_f32_16x16x32_bf16 v[244:247], a[236:239], v[92:95], v[244:247]
    v_mfma_f32_16x16x32_bf16 v[248:251], a[240:243], v[88:91], v[248:251]
    ds_read_b128 a[228:231], v5 offset:2048
    v_mfma_f32_16x16x32_bf16 v[252:255], a[240:243], v[92:95], v[252:255]
    s_add_u32 s39, s39, 7168
    buffer_load_dwordx4 v[172:175], v1, s[4:7], s39 offen offset:0 sc1
    v_mfma_f32_16x16x32_bf16 v[224:227], a[244:247], v[96:99], v[224:227]
    ds_read_b128 a[232:235], v5 offset:2304
    s_waitcnt lgkmcnt(3)
    v_mfma_f32_16x16x32_bf16 v[228:231], a[244:247], v[100:103], v[228:231]
    v_mfma_f32_16x16x32_bf16 v[232:235], a[248:251], v[96:99], v[232:235]
    ds_read_b128 a[236:239], v5 offset:4096
    v_mfma_f32_16x16x32_bf16 v[236:239], a[248:251], v[100:103], v[236:239]
    s_cmp_eq_u32 s34, 0
    s_cbranch_scc1 slow_82
    s_waitcnt vmcnt(8)
    buffer_store_dwordx2 v[14:15], off, s[4:7], s41
join_83:
    buffer_load_dwordx4 v[176:179], v1, s[4:7], s24 offen offset:1024 sc1
    s_add_u32 s41, s41, 8192
    v_mfma_f32_16x16x32_bf16 v[240:243], a[252:255], v[96:99], v[240:243]
    ds_read_b128 a[240:243], v5 offset:4352
    s_waitcnt lgkmcnt(3)
    v_mfma_f32_16x16x32_bf16 v[244:247], a[252:255], v[100:103], v[244:247]
    v_mfma_f32_16x16x32_bf16 v[248:251], a[224:227], v[96:99], v[248:251]
    ds_read_b128 a[244:247], v5 offset:6144
    v_mfma_f32_16x16x32_bf16 v[252:255], a[224:227], v[100:103], v[252:255]
    buffer_load_dwordx4 v[180:183], v1, s[4:7], s39 offen offset:1024 sc1
    v_mfma_f32_16x16x32_bf16 v[224:227], a[228:231], v[104:107], v[224:227]
    ds_read_b128 a[248:251], v5 offset:6400
    s_waitcnt lgkmcnt(3)
    v_mfma_f32_16x16x32_bf16 v[228:231], a[228:231], v[108:111], v[228:231]
    v_mfma_f32_16x16x32_bf16 v[232:235], a[232:235], v[104:107], v[232:235]
    ds_read_b128 a[252:255], v5 offset:8192
    v_mfma_f32_16x16x32_bf16 v[236:239], a[232:235], v[108:111], v[236:239]
    buffer_load_dwordx4 v[184:187], v1, s[4:7], s24 offen offset:2048 sc1
    v_mfma_f32_16x16x32_bf16 v[240:243], a[236:239], v[104:107], v[240:243]
    ds_read_b128 a[224:227], v5 offset:8448
    s_waitcnt lgkmcnt(3)
    v_mfma_f32_16x16x32_bf16 v[244:247], a[236:239], v[108:111], v[244:247]
    v_mfma_f32_16x16x32_bf16 v[248:251], a[240:243], v[104:107], v[248:251]
    ds_read_b128 a[228:231], v5 offset:10240
    v_mfma_f32_16x16x32_bf16 v[252:255], a[240:243], v[108:111], v[252:255]
    buffer_load_dwordx4 v[188:191], v1, s[4:7], s39 offen offset:2048 sc1
    v_mfma_f32_16x16x32_bf16 v[224:227], a[244:247], v[112:115], v[224:227]
    ds_read_b128 a[232:235], v5 offset:10496
    s_waitcnt lgkmcnt(3)
    v_mfma_f32_16x16x32_bf16 v[228:231], a[244:247], v[116:119], v[228:231]
    v_mfma_f32_16x16x32_bf16 v[232:235], a[248:251], v[112:115], v[232:235]
    ds_read_b128 a[236:239], v5 offset:12288
    v_mfma_f32_16x16x32_bf16 v[236:239], a[248:251], v[116:119], v[236:239]
    s_add_u32 s24, s24, 7168
    buffer_load_dwordx4 v[192:195], v1, s[4:7], s24 offen offset:0 sc1
    v_mfma_f32_16x16x32_bf16 v[240:243], a[252:255], v[112:115], v[240:243]
    ds_read_b128 a[240:243], v5 offset:12544
    s_waitcnt lgkmcnt(3)
    v_mfma_f32_16x16x32_bf16 v[244:247], a[252:255], v[116:119], v[244:247]
    v_mfma_f32_16x16x32_bf16 v[248:251], a[224:227], v[112:115], v[248:251]
    ds_read_b128 a[244:247], v5 offset:14336
    v_mfma_f32_16x16x32_bf16 v[252:255], a[224:227], v[116:119], v[252:255]
    s_add_u32 s39, s39, 7168
    buffer_load_dwordx4 v[196:199], v1, s[4:7], s39 offen offset:0 sc1
    v_mfma_f32_16x16x32_bf16 v[224:227], a[228:231], v[120:123], v[224:227]
    ds_read_b128 a[248:251], v5 offset:14592
    s_waitcnt lgkmcnt(3)
    v_mfma_f32_16x16x32_bf16 v[228:231], a[228:231], v[124:127], v[228:231]
    v_mfma_f32_16x16x32_bf16 v[232:235], a[232:235], v[120:123], v[232:235]
    ds_read_b128 a[252:255], v3 offset:0
    v_mfma_f32_16x16x32_bf16 v[236:239], a[232:235], v[124:127], v[236:239]
    buffer_load_dwordx4 v[200:203], v1, s[4:7], s24 offen offset:1024 sc1
    v_mfma_f32_16x16x32_bf16 v[240:243], a[236:239], v[120:123], v[240:243]
    ds_read_b128 a[224:227], v3 offset:256
    s_waitcnt lgkmcnt(3)
    v_mfma_f32_16x16x32_bf16 v[244:247], a[236:239], v[124:127], v[244:247]
    v_mfma_f32_16x16x32_bf16 v[248:251], a[240:243], v[120:123], v[248:251]
    ds_read_b128 a[228:231], v3 offset:2048
    v_mfma_f32_16x16x32_bf16 v[252:255], a[240:243], v[124:127], v[252:255]
    buffer_load_dwordx4 v[204:207], v1, s[4:7], s39 offen offset:1024 sc1
    v_mfma_f32_16x16x32_bf16 v[224:227], a[244:247], v[128:131], v[224:227]
    ds_read_b128 a[232:235], v3 offset:2304
    s_waitcnt lgkmcnt(3)
    v_mfma_f32_16x16x32_bf16 v[228:231], a[244:247], v[132:135], v[228:231]
    v_mfma_f32_16x16x32_bf16 v[232:235], a[248:251], v[128:131], v[232:235]
    ds_read_b128 a[236:239], v3 offset:4096
    v_mfma_f32_16x16x32_bf16 v[236:239], a[248:251], v[132:135], v[236:239]
    buffer_load_dwordx4 v[208:211], v1, s[4:7], s24 offen offset:2048 sc1
    v_mfma_f32_16x16x32_bf16 v[240:243], a[252:255], v[128:131], v[240:243]
    ds_read_b128 a[240:243], v3 offset:4352
    s_waitcnt lgkmcnt(3)
    v_mfma_f32_16x16x32_bf16 v[244:247], a[252:255], v[132:135], v[244:247]
    v_mfma_f32_16x16x32_bf16 v[248:251], a[224:227], v[128:131], v[248:251]
    v_add_u32 v13, -79872, v13
    ds_read_b64 a[244:245], v13 offset:0
    ds_read_b64 a[246:247], v13 offset:256
    v_mfma_f32_16x16x32_bf16 v[252:255], a[224:227], v[132:135], v[252:255]
    buffer_load_dwordx4 v[212:215], v1, s[4:7], s39 offen offset:2048 sc1
    v_mfma_f32_16x16x32_bf16 v[224:227], a[228:231], v[136:139], v[224:227]
    ds_read_b64 a[248:249], v13 offset:1024
    ds_read_b64 a[250:251], v13 offset:1280
    s_waitcnt lgkmcnt(5)
    v_mfma_f32_16x16x32_bf16 v[228:231], a[228:231], v[140:143], v[228:231]
    v_mfma_f32_16x16x32_bf16 v[232:235], a[232:235], v[136:139], v[232:235]
    v_mfma_f32_16x16x32_bf16 v[236:239], a[232:235], v[140:143], v[236:239]
    buffer_load_dwordx2 v[14:15], v12, s[4:7], s25 offen sc1
    s_add_u32 s24, s24, 7168
    buffer_load_dwordx4 v[216:219], v1, s[4:7], s24 offen offset:0 sc1
    v_mfma_f32_16x16x32_bf16 v[240:243], a[236:239], v[136:139], v[240:243]
    s_waitcnt lgkmcnt(2)
    v_mfma_f32_16x16x32_bf16 v[244:247], a[236:239], v[140:143], v[244:247]
    v_mfma_f32_16x16x32_bf16 v[248:251], a[240:243], v[136:139], v[248:251]
    v_mfma_f32_16x16x32_bf16 v[252:255], a[240:243], v[140:143], v[252:255]
    s_add_u32 s39, s39, 7168
    buffer_load_dwordx4 v[220:223], v1, s[4:7], s39 offen offset:0 sc1
    v_mfma_f32_16x16x16_bf16 v[224:227], a[244:245], v[8:9], v[224:227]
    s_waitcnt lgkmcnt(0)
    v_mfma_f32_16x16x16_bf16 v[228:231], a[244:245], v[10:11], v[228:231]
    v_mfma_f32_16x16x16_bf16 v[232:235], a[246:247], v[8:9], v[232:235]
    v_mfma_f32_16x16x16_bf16 v[236:239], a[246:247], v[10:11], v[236:239]
    v_mfma_f32_16x16x16_bf16 v[240:243], a[248:249], v[8:9], v[240:243]
    v_mfma_f32_16x16x16_bf16 v[244:247], a[248:249], v[10:11], v[244:247]
    v_mfma_f32_16x16x16_bf16 v[248:251], a[250:251], v[8:9], v[248:251]
    v_mfma_f32_16x16x16_bf16 v[252:255], a[250:251], v[10:11], v[252:255]
    s_add_u32 s21, s21, 4096
    s_sub_u32 s21, s21, s15
    v_mul_f32 v224, v224, v6
    v_mul_f32 v225, v225, v6
    v_mul_f32 v226, v226, v6
    v_mul_f32 v227, v227, v6
    v_mul_f32 v224, v224, v232
    buffer_load_dwordx4 v[80:83], v1, s[4:7], s24 offen offset:1024 sc1
    v_mul_f32 v225, v225, v233
    v_mul_f32 v226, v226, v234
    v_mul_f32 v227, v227, v235
    v_cvt_pk_bf16_f32 v232, v224, v225
    v_cvt_pk_bf16_f32 v233, v226, v227
    v_mul_f32 v228, v228, v7
    v_mul_f32 v229, v229, v7
    v_mul_f32 v230, v230, v7
    v_mul_f32 v231, v231, v7
    v_mul_f32 v228, v228, v236
    buffer_load_dwordx4 v[84:87], v1, s[4:7], s39 offen offset:1024 sc1
    v_mul_f32 v229, v229, v237
    v_mul_f32 v230, v230, v238
    v_mul_f32 v231, v231, v239
    v_cvt_pk_bf16_f32 v234, v228, v229
    v_cvt_pk_bf16_f32 v235, v230, v231
    s_nop 0
    v_permlane16_swap_b32 v232, v234
    v_permlane16_swap_b32 v233, v235
    buffer_store_dwordx4 v[232:235], v1, s[4:7], s27 offen offset:1024
    v_mul_f32 v240, v240, v6
    v_mul_f32 v241, v241, v6
    v_mul_f32 v242, v242, v6
    v_mul_f32 v243, v243, v6
    v_mul_f32 v240, v240, v248
    buffer_load_dwordx4 v[88:91], v1, s[4:7], s24 offen offset:2048 sc1
    v_mul_f32 v241, v241, v249
    v_mul_f32 v242, v242, v250
    v_mul_f32 v243, v243, v251
    v_cvt_pk_bf16_f32 v248, v240, v241
    v_cvt_pk_bf16_f32 v249, v242, v243
    v_mul_f32 v244, v244, v7
    v_mul_f32 v245, v245, v7
    v_mul_f32 v246, v246, v7
    v_mul_f32 v247, v247, v7
    v_mul_f32 v244, v244, v252
    buffer_load_dwordx4 v[92:95], v1, s[4:7], s39 offen offset:2048 sc1
    v_mul_f32 v245, v245, v253
    v_mul_f32 v246, v246, v254
    v_mul_f32 v247, v247, v255
    v_cvt_pk_bf16_f32 v250, v244, v245
    v_cvt_pk_bf16_f32 v251, v246, v247
    s_nop 0
    v_permlane16_swap_b32 v248, v250
    v_permlane16_swap_b32 v249, v251
    buffer_store_dwordx4 v[248:251], v1, s[4:7], s27 offen offset:2048
    s_waitcnt vmcnt(26)
    v_mfma_f32_32x32x16_bf16 v[64:79], a[4:7], v[148:151], 0
    v_mfma_f32_32x32x16_bf16 v[48:63], a[4:7], v[144:147], 0
    v_mfma_f32_32x32x16_bf16 v[32:47], a[0:3], v[148:151], 0
    v_mfma_f32_32x32x16_bf16 v[16:31], a[0:3], v[144:147], 0
    s_waitcnt vmcnt(8)
    v_cmp_ne_u64 vcc, s[32:33], v[14:15]
    s_nop 0
    s_cbranch_vccnz ap_84
apok_85:
    s_add_u32 s25, s25, 8192
    v_mfma_f32_32x32x16_bf16 v[64:79], a[12:15], v[156:159], v[64:79]
    s_sub_u32 s24, s24, 18432
    buffer_load_dwordx4 v[96:99], v1, s[4:7], s24 offen offset:0 sc1
    v_mfma_f32_32x32x16_bf16 v[48:63], a[12:15], v[152:155], v[48:63]
    v_mfma_f32_32x32x16_bf16 v[32:47], a[8:11], v[156:159], v[32:47]
    s_sub_u32 s39, s39, 18432
    buffer_load_dwordx4 v[100:103], v1, s[4:7], s39 offen offset:0 sc1
    v_mfma_f32_32x32x16_bf16 v[16:31], a[8:11], v[152:155], v[16:31]
    v_mfma_f32_32x32x16_bf16 v[64:79], a[20:23], v[164:167], v[64:79]
    buffer_load_dwordx4 v[104:107], v1, s[4:7], s24 offen offset:1024 sc1
    v_mfma_f32_32x32x16_bf16 v[48:63], a[20:23], v[160:163], v[48:63]
    v_mfma_f32_32x32x16_bf16 v[32:47], a[16:19], v[164:167], v[32:47]
    buffer_load_dwordx4 v[108:111], v1, s[4:7], s39 offen offset:1024 sc1
    v_mfma_f32_32x32x16_bf16 v[16:31], a[16:19], v[160:163], v[16:31]
    v_mfma_f32_32x32x16_bf16 v[64:79], a[60:63], v[172:175], v[64:79]
    s_add_u32 s24, s24, 7168
    buffer_load_dwordx4 v[112:115], v1, s[4:7], s24 offen offset:0 sc1
    v_mfma_f32_32x32x16_bf16 v[48:63], a[60:63], v[168:171], v[48:63]
    v_mfma_f32_32x32x16_bf16 v[32:47], a[56:59], v[172:175], v[32:47]
    s_add_u32 s39, s39, 7168
    buffer_load_dwordx4 v[116:119], v1, s[4:7], s39 offen offset:0 sc1
    v_mfma_f32_32x32x16_bf16 v[16:31], a[56:59], v[168:171], v[16:31]
    v_mov_b32 v14, s32
    v_mov_b32 v15, s33
    s_cmp_eq_u32 s34, 0
    s_cbranch_scc1 slow_86
    s_waitcnt vmcnt(6)
    buffer_store_dwordx2 v[14:15], off, s[4:7], s41
join_87:
    v_mfma_f32_32x32x16_bf16 v[64:79], a[68:71], v[180:183], v[64:79]
    buffer_load_dwordx4 v[120:123], v1, s[4:7], s24 offen offset:1024 sc1
    v_mfma_f32_32x32x16_bf16 v[48:63], a[68:71], v[176:179], v[48:63]
    v_mfma_f32_32x32x16_bf16 v[32:47], a[64:67], v[180:183], v[32:47]
    buffer_load_dwordx4 v[124:127], v1, s[4:7], s39 offen offset:1024 sc1
    v_mfma_f32_32x32x16_bf16 v[16:31], a[64:67], v[176:179], v[16:31]
    v_mfma_f32_32x32x16_bf16 v[64:79], a[76:79], v[188:191], v[64:79]
    s_add_u32 s24, s24, 7168
    buffer_load_dwordx4 v[128:131], v1, s[4:7], s24 offen offset:0 sc1
    v_mfma_f32_32x32x16_bf16 v[48:63], a[76:79], v[184:187], v[48:63]
    v_mfma_f32_32x32x16_bf16 v[32:47], a[72:75], v[188:191], v[32:47]
    s_add_u32 s39, s39, 7168
    buffer_load_dwordx4 v[132:135], v1, s[4:7], s39 offen offset:0 sc1
    v_mfma_f32_32x32x16_bf16 v[16:31], a[72:75], v[184:187], v[16:31]
    v_mfma_f32_32x32x16_bf16 v[64:79], a[116:119], v[196:199], v[64:79]
    buffer_load_dwordx4 v[136:139], v1, s[4:7], s24 offen offset:1024 sc1
    v_mfma_f32_32x32x16_bf16 v[48:63], a[116:119], v[192:195], v[48:63]
    v_mfma_f32_32x32x16_bf16 v[32:47], a[112:115], v[196:199], v[32:47]
    buffer_load_dwordx4 v[140:143], v1, s[4:7], s39 offen offset:1024 sc1
    v_mfma_f32_32x32x16_bf16 v[16:31], a[112:115], v[192:195], v[16:31]
    buffer_load_dwordx2 v[14:15], v12, s[4:7], s25 offen sc1
    s_add_u32 s17, s100, 8388608
    buffer_load_dwordx4 v[240:243], v1, s[4:7], s17 offen sc1
    buffer_load_dwordx4 v[244:247], v1, s[4:7], s17 offen offset:1024 sc1
    v_mfma_f32_32x32x16_bf16 v[64:79], a[124:127], v[204:207], v[64:79]
    s_add_u32 s24, s24, 7168
    buffer_load_dwordx4 v[144:147], v1, s[4:7], s24 offen offset:0 sc1
    v_mfma_f32_32x32x16_bf16 v[48:63], a[124:127], v[200:203], v[48:63]
    v_mfma_f32_32x32x16_bf16 v[32:47], a[120:123], v[204:207], v[32:47]
    s_add_u32 s39, s39, 7168
    buffer_load_dwordx4 v[148:151], v1, s[4:7], s39 offen offset:0 sc1
    v_mfma_f32_32x32x16_bf16 v[16:31], a[120:123], v[200:203], v[16:31]
    v_mfma_f32_32x32x16_bf16 v[64:79], a[132:135], v[212:215], v[64:79]
    buffer_load_dwordx4 v[152:155], v1, s[4:7], s24 offen offset:1024 sc1
    v_mfma_f32_32x32x16_bf16 v[48:63], a[132:135], v[208:211], v[48:63]
    v_mfma_f32_32x32x16_bf16 v[32:47], a[128:131], v[212:215], v[32:47]
    buffer_load_dwordx4 v[156:159], v1, s[4:7], s39 offen offset:1024 sc1
    v_mfma_f32_32x32x16_bf16 v[16:31], a[128:131], v[208:211], v[16:31]
    v_mfma_f32_32x32x16_bf16 v[64:79], a[172:175], v[220:223], v[64:79]
    v_mfma_f32_32x32x16_bf16 v[48:63], a[172:175], v[216:219], v[48:63]
    v_mfma_f32_32x32x16_bf16 v[32:47], a[168:171], v[220:223], v[32:47]
    v_mfma_f32_32x32x16_bf16 v[16:31], a[168:171], v[216:219], v[16:31]
    v_mfma_f32_32x32x16_bf16 v[64:79], a[180:183], v[84:87], v[64:79]
    v_mfma_f32_32x32x16_bf16 v[48:63], a[180:183], v[80:83], v[48:63]
    v_mfma_f32_32x32x16_bf16 v[32:47], a[176:179], v[84:87], v[32:47]
    v_mfma_f32_32x32x16_bf16 v[16:31], a[176:179], v[80:83], v[16:31]
    v_mfma_f32_32x32x16_bf16 v[64:79], a[188:191], v[92:95], v[64:79]
    v_mfma_f32_32x32x16_bf16 v[48:63], a[188:191], v[88:91], v[48:63]
    v_mfma_f32_32x32x16_bf16 v[32:47], a[184:187], v[92:95], v[32:47]
    v_mfma_f32_32x32x16_bf16 v[16:31], a[184:187], v[88:91], v[16:31]
    s_waitcnt vmcnt(6)
    v_cmp_ne_u64 vcc, s[32:33], v[14:15]
    s_nop 0
    s_cbranch_vccnz ap_88
apok_89:
    s_sub_u32 s24, s24, 19456
    buffer_load_dwordx4 v[160:163], v1, s[4:7], s24 offen offset:0 sc1
    s_sub_u32 s39, s39, 19456
    buffer_load_dwordx4 v[164:167], v1, s[4:7], s39 offen offset:0 sc1
    buffer_load_dwordx4 v[168:171], v1, s[4:7], s24 offen offset:1024 sc1
    v_mfma_f32_32x32x16_bf16 v[64:79], a[28:31], v[100:103], v[64:79]
    buffer_load_dwordx4 v[172:175], v1, s[4:7], s39 offen offset:1024 sc1
    v_mfma_f32_32x32x16_bf16 v[48:63], a[28:31], v[96:99], v[48:63]
    v_mfma_f32_32x32x16_bf16 v[32:47], a[24:27], v[100:103], v[32:47]
    s_add_u32 s24, s24, 7168
    buffer_load_dwordx4 v[176:179], v1, s[4:7], s24 offen offset:0 sc1
    v_mfma_f32_32x32x16_bf16 v[16:31], a[24:27], v[96:99], v[16:31]
    v_mfma_f32_32x32x16_bf16 v[64:79], a[36:39], v[108:111], v[64:79]
    s_add_u32 s39, s39, 7168
    buffer_load_dwordx4 v[180:183], v1, s[4:7], s39 offen offset:0 sc1
    v_mfma_f32_32x32x16_bf16 v[48:63], a[36:39], v[104:107], v[48:63]
    v_mfma_f32_32x32x16_bf16 v[32:47], a[32:35], v[108:111], v[32:47]
    buffer_load_dwordx4 v[184:187], v1, s[4:7], s24 offen offset:1024 sc1
    v_mfma_f32_32x32x16_bf16 v[16:31], a[32:35], v[104:107], v[16:31]
    s_barrier
    v_mfma_f32_32x32x16_bf16 v[64:79], a[84:87], v[116:119], v[64:79]
    buffer_load_dwordx4 v[188:191], v1, s[4:7], s39 offen offset:1024 sc1
    v_mfma_f32_32x32x16_bf16 v[48:63], a[84:87], v[112:115], v[48:63]
    s_waitcnt vmcnt(12)
    s_xor_b32 s16, s12, 1
    s_mul_i32 s16, s16, 12288
    s_add_u32 s16, s16, 110592
    v_add_u32 v6, s16, v1
    v_mfma_f32_32x32x16_bf16 v[32:47], a[80:83], v[116:119], v[32:47]
    s_add_u32 s24, s24, 7168
    buffer_load_dwordx4 v[192:195], v1, s[4:7], s24 offen offset:0 sc1
    v_mfma_f32_32x32x16_bf16 v[16:31], a[80:83], v[112:115], v[16:31]
    s_xor_b32 s16, s12, 2
    s_mul_i32 s16, s16, 12288
    s_add_u32 s16, s16, 114688
    v_add_u32 v7, s16, v1
    v_mfma_f32_32x32x16_bf16 v[64:79], a[92:95], v[124:127], v[64:79]
    s_add_u32 s39, s39, 7168
    buffer_load_dwordx4 v[196:199], v1, s[4:7], s39 offen offset:0 sc1
    v_mfma_f32_32x32x16_bf16 v[48:63], a[92:95], v[120:123], v[48:63]
    s_xor_b32 s16, s12, 3
    s_mul_i32 s16, s16, 12288
    s_add_u32 s16, s16, 118784
    v_add_u32 v8, s16, v1
    v_mfma_f32_32x32x16_bf16 v[32:47], a[88:91], v[124:127], v[32:47]
    buffer_load_dwordx4 v[200:203], v1, s[4:7], s24 offen offset:1024 sc1
    v_mfma_f32_32x32x16_bf16 v[16:31], a[88:91], v[120:123], v[16:31]
    s_mul_i32 s16, s12, 12288
    s_add_u32 s16, s16, 110592
    v_add_u32 v9, s16, v1
    s_and_b32 s16, s12, 1
    v_mfma_f32_32x32x16_bf16 v[64:79], a[140:143], v[132:135], v[64:79]
    buffer_load_dwordx4 v[204:207], v1, s[4:7], s39 offen offset:1024 sc1
    v_mfma_f32_32x32x16_bf16 v[48:63], a[140:143], v[128:131], v[48:63]
    s_mul_i32 s16, s16, 4608
    s_lshr_b32 s18, s12, 1
    s_lshl_b32 s18, s18, 6
    s_add_u32 s16, s16, s18
    v_mfma_f32_32x32x16_bf16 v[32:47], a[136:139], v[132:135], v[32:47]
    s_add_u32 s24, s24, 7168
    buffer_load_dwordx4 v[208:211], v1, s[4:7], s24 offen offset:0 sc1
    v_mfma_f32_32x32x16_bf16 v[64:79], a[148:151], v[140:143], v[64:79]
    v_and_b32 v10, 31, v0
    v_mul_u32_u24 v10, 144, v10
    v_bfe_u32 v11, v0, 5, 1
    v_lshl_add_u32 v10, v11, 4, v10
    v_mfma_f32_32x32x16_bf16 v[48:63], a[148:151], v[136:139], v[48:63]
    s_add_u32 s39, s39, 7168
    buffer_load_dwordx4 v[212:215], v1, s[4:7], s39 offen offset:0 sc1
    v_mfma_f32_32x32x16_bf16 v[32:47], a[144:147], v[140:143], v[32:47]
    v_add_u32 v10, s16, v10
    s_mul_i32 s16, s12, 2304
    v_bfe_u32 v13, v0, 3, 3
    v_mul_u32_u24 v11, 144, v13
    s_waitcnt vmcnt(16)
    v_mfma_f32_32x32x16_bf16 v[64:79], a[196:199], v[148:151], v[64:79]
    buffer_load_dwordx4 v[216:219], v1, s[4:7], s24 offen offset:1024 sc1
    v_mfma_f32_32x32x16_bf16 v[48:63], a[196:199], v[144:147], v[48:63]
    v_and_b32 v5, 7, v0
    v_lshl_add_u32 v11, v5, 4, v11
    v_add_u32 v11, s16, v11
    v_lshlrev_b32 v13, 10, v13
    v_mfma_f32_32x32x16_bf16 v[32:47], a[192:195], v[148:151], v[32:47]
    buffer_load_dwordx4 v[220:223], v1, s[4:7], s39 offen offset:1024 sc1
    s_waitcnt vmcnt(16)
    v_mfma_f32_32x32x16_bf16 v[64:79], a[204:207], v[156:159], v[64:79]
    v_lshl_add_u32 v13, v5, 4, v13
    s_and_b32 s16, s100, 0xffff0000
    s_lshl_b32 s18, s12, 14
    s_add_u32 s16, s16, s18
    v_mfma_f32_32x32x16_bf16 v[48:63], a[204:207], v[152:155], v[48:63]
    s_and_b32 s18, s14, 7
    s_lshl_b32 s18, s18, 7
    s_add_u32 s16, s16, s18
    s_add_u32 s18, s16, 8192
    v_mfma_f32_32x32x16_bf16 v[32:47], a[200:203], v[156:159], v[32:47]
    v_lshlrev_b32 v224, 16, v240
    v_and_b32 v225, 0xffff0000, v240
    v_lshlrev_b32 v226, 16, v241
    v_and_b32 v227, 0xffff0000, v241
    s_waitcnt vmcnt(14)
    v_mfma_f32_32x32x16_bf16 v[64:79], a[44:47], v[164:167], v[64:79]
    v_lshlrev_b32 v228, 16, v242
    v_and_b32 v229, 0xffff0000, v242
    v_lshlrev_b32 v230, 16, v243
    v_and_b32 v231, 0xffff0000, v243
    s_waitcnt vmcnt(12)
    v_mfma_f32_32x32x16_bf16 v[64:79], a[52:55], v[172:175], v[64:79]
    v_lshlrev_b32 v232, 16, v244
    v_and_b32 v233, 0xffff0000, v244
    v_lshlrev_b32 v234, 16, v245
    v_and_b32 v235, 0xffff0000, v245
    s_waitcnt vmcnt(10)
    v_mfma_f32_32x32x16_bf16 v[64:79], a[100:103], v[180:183], v[64:79]
    v_lshlrev_b32 v236, 16, v246
    v_and_b32 v237, 0xffff0000, v246
    v_lshlrev_b32 v238, 16, v247
    v_and_b32 v239, 0xffff0000, v247
    s_waitcnt vmcnt(8)
    v_mfma_f32_32x32x16_bf16 v[64:79], a[108:111], v[188:191], v[64:79]
    s_waitcnt vmcnt(6)
    v_mfma_f32_32x32x16_bf16 v[64:79], a[156:159], v[196:199], v[64:79]
    s_waitcnt vmcnt(4)
    v_mfma_f32_32x32x16_bf16 v[64:79], a[164:167], v[204:207], v[64:79]
    s_waitcnt vmcnt(2)
    v_mfma_f32_32x32x16_bf16 v[64:79], a[212:215], v[212:215], v[64:79]
    s_waitcnt vmcnt(0)
    v_mfma_f32_32x32x16_bf16 v[64:79], a[220:223], v[220:223], v[64:79]
    s_lshl_b32 s17, s14, 2
    s_add_u32 s17, s17, s12
    s_and_b32 s17, s17, 127
    s_cbranch_scc1 wb_90
    buffer_wbl2 sc1
wb_90:
    v_mfma_f32_32x32x16_bf16 v[48:63], a[44:47], v[160:163], v[48:63]
    v_mfma_f32_32x32x16_bf16 v[48:63], a[52:55], v[168:171], v[48:63]
    s_nop 5
    ds_write_b128 v8, v[64:67] offset:0
    v_mfma_f32_32x32x16_bf16 v[48:63], a[100:103], v[176:179], v[48:63]
    v_mfma_f32_32x32x16_bf16 v[48:63], a[108:111], v[184:187], v[48:63]
    ds_write_b128 v8, v[68:71] offset:1024
    v_mfma_f32_32x32x16_bf16 v[48:63], a[156:159], v[192:195], v[48:63]
    v_mfma_f32_32x32x16_bf16 v[48:63], a[164:167], v[200:203], v[48:63]
    ds_write_b128 v8, v[72:75] offset:2048
    v_mfma_f32_32x32x16_bf16 v[48:63], a[212:215], v[208:211], v[48:63]
    v_mfma_f32_32x32x16_bf16 v[48:63], a[220:223], v[216:219], v[48:63]
    ds_write_b128 v8, v[76:79] offset:3072
    v_mfma_f32_32x32x16_bf16 v[32:47], a[40:43], v[164:167], v[32:47]
    v_mfma_f32_32x32x16_bf16 v[32:47], a[48:51], v[172:175], v[32:47]
    s_nop 8
    ds_write_b128 v7, v[48:51] offset:0
    v_mfma_f32_32x32x16_bf16 v[32:47], a[96:99], v[180:183], v[32:47]
    v_mfma_f32_32x32x16_bf16 v[32:47], a[104:107], v[188:191], v[32:47]
    ds_write_b128 v7, v[52:55] offset:1024
    v_mfma_f32_32x32x16_bf16 v[32:47], a[152:155], v[196:199], v[32:47]
    v_mfma_f32_32x32x16_bf16 v[32:47], a[160:163], v[204:207], v[32:47]
    ds_write_b128 v7, v[56:59] offset:2048
    v_mfma_f32_32x32x16_bf16 v[32:47], a[208:211], v[212:215], v[32:47]
    v_mfma_f32_32x32x16_bf16 v[32:47], a[216:219], v[220:223], v[32:47]
    ds_write_b128 v7, v[60:63] offset:3072
    v_mfma_f32_32x32x16_bf16 v[16:31], a[136:139], v[128:131], v[16:31]
    s_waitcnt lgkmcnt(0)
    s_barrier
    ds_read_b128 v[64:67], v9 offset:8192
    ds_read_b128 v[68:71], v9 offset:9216
    ds_read_b128 v[72:75], v9 offset:10240
    ds_read_b128 v[76:79], v9 offset:11264
    ds_read_b128 v[48:51], v9 offset:4096
    ds_read_b128 v[52:55], v9 offset:5120
    ds_read_b128 v[56:59], v9 offset:6144
    ds_read_b128 v[60:63], v9 offset:7168
    v_mfma_f32_32x32x16_bf16 v[16:31], a[144:147], v[136:139], v[16:31]
    ds_write_b128 v6, v[32:35] offset:0
    v_mfma_f32_32x32x16_bf16 v[16:31], a[192:195], v[144:147], v[16:31]
    s_waitcnt lgkmcnt(5)
    v_add_f32 v224, v224, v64
    v_add_f32 v225, v225, v65
    v_add_f32 v226, v226, v66
    v_add_f32 v227, v227, v67
    v_add_f32 v228, v228, v68
    v_mfma_f32_32x32x16_bf16 v[16:31], a[200:203], v[152:155], v[16:31]
    ds_write_b128 v6, v[36:39] offset:1024
    v_add_f32 v229, v229, v69
    v_add_f32 v230, v230, v70
    v_add_f32 v231, v231, v71
    v_add_f32 v232, v232, v72
    v_add_f32 v233, v233, v73
    v_mfma_f32_32x32x16_bf16 v[16:31], a[40:43], v[160:163], v[16:31]
    v_add_f32 v234, v234, v74
    v_add_f32 v235, v235, v75
    v_add_f32 v236, v236, v76
    v_add_f32 v237, v237, v77
    v_add_f32 v238, v238, v78
    v_mfma_f32_32x32x16_bf16 v[16:31], a[48:51], v[168:171], v[16:31]
    ds_write_b128 v6, v[40:43] offset:2048
    v_add_f32 v239, v239, v79
    s_waitcnt lgkmcnt(3)
    v_add_f32 v224, v224, v48
    v_add_f32 v225, v225, v49
    v_add_f32 v226, v226, v50
    v_add_f32 v227, v227, v51
    v_mfma_f32_32x32x16_bf16 v[16:31], a[96:99], v[176:179], v[16:31]
    v_add_f32 v228, v228, v52
    v_add_f32 v229, v229, v53
    v_add_f32 v230, v230, v54
    v_add_f32 v231, v231, v55
    v_add_f32 v232, v232, v56
    v_mfma_f32_32x32x16_bf16 v[16:31], a[104:107], v[184:187], v[16:31]
    ds_write_b128 v6, v[44:47] offset:3072
    v_add_f32 v233, v233, v57
    v_add_f32 v234, v234, v58
    v_add_f32 v235, v235, v59
    v_add_f32 v236, v236, v60
    v_add_f32 v237, v237, v61
    v_mfma_f32_32x32x16_bf16 v[16:31], a[152:155], v[192:195], v[16:31]
    v_add_f32 v238, v238, v62
    v_add_f32 v239, v239, v63
    v_mfma_f32_32x32x16_bf16 v[16:31], a[160:163], v[200:203], v[16:31]
    s_waitcnt lgkmcnt(0)
    s_barrier
    ds_read_b128 v[32:35], v9 offset:0
    ds_read_b128 v[36:39], v9 offset:1024
    ds_read_b128 v[40:43], v9 offset:2048
    ds_read_b128 v[44:47], v9 offset:3072
    v_mfma_f32_32x32x16_bf16 v[16:31], a[208:211], v[208:211], v[16:31]
    v_mfma_f32_32x32x16_bf16 v[16:31], a[216:219], v[216:219], v[16:31]
    s_waitcnt lgkmcnt(0)
    v_add_f32 v224, v224, v32
    v_add_f32 v225, v225, v33
    v_add_f32 v226, v226, v34
    v_add_f32 v227, v227, v35
    v_add_f32 v228, v228, v36
    v_add_f32 v229, v229, v37
    v_add_f32 v230, v230, v38
    v_add_f32 v231, v231, v39
    v_add_f32 v232, v232, v40
    v_add_f32 v233, v233, v41
    v_add_f32 v234, v234, v42
    v_add_f32 v235, v235, v43
    v_add_f32 v236, v236, v44
    v_add_f32 v237, v237, v45
    v_add_f32 v238, v238, v46
    v_add_f32 v239, v239, v47
    v_add_f32 v16, v16, v224
    v_add_f32 v17, v17, v225
    v_cvt_pk_bf16_f32 v240, v16, v17
    v_add_f32 v18, v18, v226
    v_add_f32 v19, v19, v227
    v_cvt_pk_bf16_f32 v241, v18, v19
    v_add_f32 v20, v20, v228
    v_add_f32 v21, v21, v229
    v_cvt_pk_bf16_f32 v242, v20, v21
    v_add_f32 v22, v22, v230
    v_add_f32 v23, v23, v231
    v_cvt_pk_bf16_f32 v243, v22, v23
    ds_write_b128 v10, v[240:243] offset:0
    v_add_f32 v24, v24, v232
    v_add_f32 v25, v25, v233
    v_cvt_pk_bf16_f32 v244, v24, v25
    v_add_f32 v26, v26, v234
    v_add_f32 v27, v27, v235
    v_cvt_pk_bf16_f32 v245, v26, v27
    v_add_f32 v28, v28, v236
    v_add_f32 v29, v29, v237
    v_cvt_pk_bf16_f32 v246, v28, v29
    v_add_f32 v30, v30, v238
    v_add_f32 v31, v31, v239
    v_cvt_pk_bf16_f32 v247, v30, v31
    ds_write_b128 v10, v[244:247] offset:32
    s_waitcnt lgkmcnt(0)
    s_barrier
    ds_read_b128 v[240:243], v11
    ds_read_b128 v[244:247], v11 offset:1152
    s_waitcnt lgkmcnt(1)
    buffer_store_dwordx4 v[240:243], v13, s[8:11], s16 offen sc1
    s_waitcnt lgkmcnt(0)
    buffer_store_dwordx4 v[244:247], v13, s[8:11], s18 offen sc1
    s_add_u32 s16, s101, s12
    s_cmp_lg_u32 s16, 0
    s_cbranch_scc1 L_fin
    s_mov_b32 s41, 7995392
    v_mov_b32 v14, s32
    v_mov_b32 v15, s33
    buffer_store_dwordx2 v[14:15], off, s[4:7], s41 sc1
L_fin:
    s_waitcnt vmcnt(0)
L_abort:
    s_endpgm
ap_73:
    s_mov_b32 s40, 0x40000
ap_73_l:
    buffer_load_dwordx2 v[14:15], v13, s[4:7], s41 offen sc1
    s_sub_u32 s40, s40, 1
    s_cbranch_scc1 L_abort
    s_waitcnt vmcnt(0)
    v_cmp_ne_u64 vcc, s[32:33], v[14:15]
    s_nop 0
    s_cbranch_vccnz ap_73_l
    s_branch apok_74
ap_76:
    s_mov_b32 s40, 0x40000
ap_76_l:
    v_and_b32 v252, 31, v0
    v_lshlrev_b32 v252, 3, v252
    buffer_load_dwordx2 v[252:253], v252, s[4:7], s19 offen sc1
    s_sub_u32 s40, s40, 1
    s_cbranch_scc1 L_abort
    s_waitcnt vmcnt(0)
    v_cmp_ne_u64 vcc, s[32:33], v[252:253]
    s_nop 0
    s_cbranch_vccnz ap_76_l
    s_branch apok_77
ap_80:
    s_mov_b32 s40, 0x40000
ap_80_l:
    buffer_load_dwordx2 v[14:15], v12, s[4:7], s25 offen sc1
    s_sub_u32 s40, s40, 1
    s_cbranch_scc1 L_abort
    s_waitcnt vmcnt(0)
    v_cmp_ne_u64 vcc, s[32:33], v[14:15]
    s_nop 0
    s_cbranch_vccnz ap_80_l
    s_branch apok_81
ap_84:
    s_mov_b32 s40, 0x40000
ap_84_l:
    buffer_load_dwordx2 v[14:15], v12, s[4:7], s25 offen sc1
    s_sub_u32 s40, s40, 1
    s_cbranch_scc1 L_abort
    s_waitcnt vmcnt(0)
    v_cmp_ne_u64 vcc, s[32:33], v[14:15]
    s_nop 0
    s_cbranch_vccnz ap_84_l
    s_branch apok_85
ap_88:
    s_mov_b32 s40, 0x40000
ap_88_l:
    buffer_load_dwordx2 v[14:15], v12, s[4:7], s25 offen sc1
    s_sub_u32 s40, s40, 1
    s_cbranch_scc1 L_abort
    s_waitcnt vmcnt(0)
    v_cmp_ne_u64 vcc, s[32:33], v[14:15]
    s_nop 0
    s_cbranch_vccnz ap_88_l
    s_branch apok_89
fb_15:
    s_waitcnt vmcnt(0)
    s_and_b32 s16, s69, 0xfffe0000
    v_add_u32 v248, s16, v248
    v_add_u32 v249, s16, v249
    v_mov_b32 v208, 0xff800000
    s_mov_b32 s24, 0
fb_15_a0:
    buffer_load_dwordx4 v[80:83], v248, s[4:7], s24 offen sc1
    s_waitcnt vmcnt(0)
    v_mfma_f32_32x32x16_bf16 v[176:191], v[80:83], a[224:227], 0
    s_nop 11
    v_max3_f32 v208, v208, v176, v177
    v_max3_f32 v208, v208, v178, v179
    v_max3_f32 v208, v208, v180, v181
    v_max3_f32 v208, v208, v182, v183
    v_max3_f32 v208, v208, v184, v185
    v_max3_f32 v208, v208, v186, v187
    v_max3_f32 v208, v208, v188, v189
    v_max3_f32 v208, v208, v190, v191
    s_add_u32 s24, s24, 2048
    s_cmp_lt_u32 s24, 131072
    s_cbranch_scc1 fb_15_a0
    v_mov_b32 v209, v208
    s_nop 1
    v_permlane32_swap_b32 v208, v209
    v_max_f32 v208, v208, v209
    v_sub_f32 v192, 0, v208
    v_sub_f32 v193, 0, v208
    v_sub_f32 v194, 0, v208
    v_sub_f32 v195, 0, v208
    v_sub_f32 v196, 0, v208
    v_sub_f32 v197, 0, v208
    v_sub_f32 v198, 0, v208
    v_sub_f32 v199, 0, v208
    v_sub_f32 v200, 0, v208
    v_sub_f32 v201, 0, v208
    v_sub_f32 v202, 0, v208
    v_sub_f32 v203, 0, v208
    v_sub_f32 v204, 0, v208
    v_sub_f32 v205, 0, v208
    v_sub_f32 v206, 0, v208
    v_sub_f32 v207, 0, v208
    v_mov_b32 v16, 0
    v_mov_b32 v17, 0
    v_mov_b32 v18, 0
    v_mov_b32 v19, 0
    v_mov_b32 v20, 0
    v_mov_b32 v21, 0
    v_mov_b32 v22, 0
    v_mov_b32 v23, 0
    v_mov_b32 v24, 0
    v_mov_b32 v25, 0
    v_mov_b32 v26, 0
    v_mov_b32 v27, 0
    v_mov_b32 v28, 0
    v_mov_b32 v29, 0
    v_mov_b32 v30, 0
    v_mov_b32 v31, 0
    s_mov_b32 s24, 0
fb_15_b0:
    buffer_load_dwordx4 v[80:83], v248, s[4:7], s24 offen sc1
    s_mov_b64 exec, s[30:31]
    buffer_load_dwordx4 v[84:87], v249, s[4:7], s24 offen offset:1024 sc1
    buffer_load_dwordx4 v[88:91], v249, s[4:7], s24 offen offset:1536 sc1
    s_mov_b64 exec, -1
    s_waitcnt vmcnt(0)
    v_mfma_f32_32x32x16_bf16 v[176:191], v[80:83], a[224:227], v[192:207]
    s_nop 11
    v_exp_f32 v176, v176
    v_exp_f32 v177, v177
    v_exp_f32 v178, v178
    v_exp_f32 v179, v179
    v_exp_f32 v180, v180
    v_exp_f32 v181, v181
    v_exp_f32 v182, v182
    v_exp_f32 v183, v183
    v_exp_f32 v184, v184
    v_exp_f32 v185, v185
    v_exp_f32 v186, v186
    v_exp_f32 v187, v187
    v_exp_f32 v188, v188
    v_exp_f32 v189, v189
    v_exp_f32 v190, v190
    v_exp_f32 v191, v191
    v_smfmac_f32_32x32x32_bf16 v[16:31], v[84:87], v[176:183], v250
    s_nop 0
    v_smfmac_f32_32x32x32_bf16 v[16:31], v[88:91], v[184:191], v250
    s_nop 15
    s_add_u32 s24, s24, 2048
    s_cmp_lt_u32 s24, 131072
    s_cbranch_scc1 fb_15_b0
    v_rcp_f32 v25, v24
    s_nop 0
    v_mul_f32 v16, v16, v25
    v_mul_f32 v17, v17, v25
    v_cvt_pk_bf16_f32 v28, v16, v17
    v_mul_f32 v18, v18, v25
    v_mul_f32 v19, v19, v25
    v_cvt_pk_bf16_f32 v29, v18, v19
    v_mul_f32 v20, v20, v25
    v_mul_f32 v21, v21, v25
    v_cvt_pk_bf16_f32 v30, v20, v21
    v_mul_f32 v22, v22, v25
    v_mul_f32 v23, v23, v25
    v_cvt_pk_bf16_f32 v31, v22, v23
    buffer_store_dwordx4 v[28:31], v1, s[4:7], s64 offen
    v_mov_b32 v208, 0xff800000
    s_mov_b32 s24, 0
fb_15_a1:
    buffer_load_dwordx4 v[80:83], v248, s[4:7], s24 offen sc1
    s_waitcnt vmcnt(0)
    v_mfma_f32_32x32x16_bf16 v[176:191], v[80:83], a[228:231], 0
    s_nop 11
    v_max3_f32 v208, v208, v176, v177
    v_max3_f32 v208, v208, v178, v179
    v_max3_f32 v208, v208, v180, v181
    v_max3_f32 v208, v208, v182, v183
    v_max3_f32 v208, v208, v184, v185
    v_max3_f32 v208, v208, v186, v187
    v_max3_f32 v208, v208, v188, v189
    v_max3_f32 v208, v208, v190, v191
    s_add_u32 s24, s24, 2048
    s_cmp_lt_u32 s24, 131072
    s_cbranch_scc1 fb_15_a1
    v_mov_b32 v209, v208
    s_nop 1
    v_permlane32_swap_b32 v208, v209
    v_max_f32 v208, v208, v209
    v_sub_f32 v192, 0, v208
    v_sub_f32 v193, 0, v208
    v_sub_f32 v194, 0, v208
    v_sub_f32 v195, 0, v208
    v_sub_f32 v196, 0, v208
    v_sub_f32 v197, 0, v208
    v_sub_f32 v198, 0, v208
    v_sub_f32 v199, 0, v208
    v_sub_f32 v200, 0, v208
    v_sub_f32 v201, 0, v208
    v_sub_f32 v202, 0, v208
    v_sub_f32 v203, 0, v208
    v_sub_f32 v204, 0, v208
    v_sub_f32 v205, 0, v208
    v_sub_f32 v206, 0, v208
    v_sub_f32 v207, 0, v208
    v_mov_b32 v32, 0
    v_mov_b32 v33, 0
    v_mov_b32 v34, 0
    v_mov_b32 v35, 0
    v_mov_b32 v36, 0
    v_mov_b32 v37, 0
    v_mov_b32 v38, 0
    v_mov_b32 v39, 0
    v_mov_b32 v40, 0
    v_mov_b32 v41, 0
    v_mov_b32 v42, 0
    v_mov_b32 v43, 0
    v_mov_b32 v44, 0
    v_mov_b32 v45, 0
    v_mov_b32 v46, 0
    v_mov_b32 v47, 0
    s_mov_b32 s24, 0
fb_15_b1:
    buffer_load_dwordx4 v[80:83], v248, s[4:7], s24 offen sc1
    s_mov_b64 exec, s[30:31]
    buffer_load_dwordx4 v[84:87], v249, s[4:7], s24 offen offset:1024 sc1
    buffer_load_dwordx4 v[88:91], v249, s[4:7], s24 offen offset:1536 sc1
    s_mov_b64 exec, -1
    s_waitcnt vmcnt(0)
    v_mfma_f32_32x32x16_bf16 v[176:191], v[80:83], a[228:231], v[192:207]
    s_nop 11
    v_exp_f32 v176, v176
    v_exp_f32 v177, v177
    v_exp_f32 v178, v178
    v_exp_f32 v179, v179
    v_exp_f32 v180, v180
    v_exp_f32 v181, v181
    v_exp_f32 v182, v182
    v_exp_f32 v183, v183
    v_exp_f32 v184, v184
    v_exp_f32 v185, v185
    v_exp_f32 v186, v186
    v_exp_f32 v187, v187
    v_exp_f32 v188, v188
    v_exp_f32 v189, v189
    v_exp_f32 v190, v190
    v_exp_f32 v191, v191
    v_smfmac_f32_32x32x32_bf16 v[32:47], v[84:87], v[176:183], v250
    s_nop 0
    v_smfmac_f32_32x32x32_bf16 v[32:47], v[88:91], v[184:191], v250
    s_nop 15
    s_add_u32 s24, s24, 2048
    s_cmp_lt_u32 s24, 131072
    s_cbranch_scc1 fb_15_b1
    v_rcp_f32 v41, v40
    s_nop 0
    v_mul_f32 v32, v32, v41
    v_mul_f32 v33, v33, v41
    v_cvt_pk_bf16_f32 v44, v32, v33
    v_mul_f32 v34, v34, v41
    v_mul_f32 v35, v35, v41
    v_cvt_pk_bf16_f32 v45, v34, v35
    v_mul_f32 v36, v36, v41
    v_mul_f32 v37, v37, v41
    v_cvt_pk_bf16_f32 v46, v36, v37
    v_mul_f32 v38, v38, v41
    v_mul_f32 v39, v39, v41
    v_cvt_pk_bf16_f32 v47, v38, v39
    buffer_store_dwordx4 v[44:47], v1, s[4:7], s65 offen
    s_waitcnt vmcnt(0)
    s_branch fbret_16
slow_17:
    s_waitcnt vmcnt(0)
    buffer_wbl2 sc1
    s_waitcnt vmcnt(0)
    buffer_store_dwordx2 v[14:15], off, s[4:7], s41 sc1
    s_branch join_18
slow_21:
    s_waitcnt vmcnt(0)
    buffer_wbl2 sc1
    s_waitcnt vmcnt(0)
    buffer_store_dwordx2 v[14:15], off, s[4:7], s41 sc1
    s_branch join_22
slow_23:
    s_waitcnt vmcnt(0)
    buffer_wbl2 sc1
    s_waitcnt vmcnt(0)
    buffer_store_dwordx2 v[14:15], off, s[4:7], s41 sc1
    s_branch join_24
slow_29:
    s_waitcnt vmcnt(0)
    buffer_wbl2 sc1
    s_waitcnt vmcnt(0)
    buffer_store_dwordx2 v[14:15], off, s[4:7], s41 sc1
    s_branch join_30
slow_33:
    s_waitcnt vmcnt(0)
    buffer_wbl2 sc1
    s_waitcnt vmcnt(0)
    buffer_store_dwordx2 v[14:15], off, s[4:7], s41 sc1
    s_branch join_34
slow_37:
    s_waitcnt vmcnt(0)
    buffer_wbl2 sc1
    s_waitcnt vmcnt(0)
    buffer_store_dwordx2 v[14:15], off, s[4:7], s41 sc1
    s_branch join_38
slow_41:
    s_waitcnt vmcnt(0)
    buffer_wbl2 sc1
    s_waitcnt vmcnt(0)
    buffer_store_dwordx2 v[14:15], off, s[4:7], s41 sc1
    s_branch join_42
slow_43:
    s_waitcnt vmcnt(0)
    buffer_wbl2 sc1
    s_waitcnt vmcnt(0)
    buffer_store_dwordx2 v[14:15], off, s[4:7], s41 sc1
    s_branch join_44
slow_49:
    s_waitcnt vmcnt(0)
    buffer_wbl2 sc1
    s_waitcnt vmcnt(0)
    buffer_store_dwordx2 v[14:15], off, s[4:7], s41 sc1
    s_branch join_50
fb_62:
    s_waitcnt vmcnt(0)
    s_and_b32 s16, s69, 0xfffe0000
    v_add_u32 v248, s16, v248
    v_add_u32 v249, s16, v249
    v_mov_b32 v208, 0xff800000
    s_mov_b32 s24, 0
fb_62_a0:
    buffer_load_dwordx4 v[80:83], v248, s[4:7], s24 offen sc1
    s_waitcnt vmcnt(0)
    v_mfma_f32_32x32x16_bf16 v[176:191], v[80:83], a[224:227], 0
    s_nop 11
    v_max3_f32 v208, v208, v176, v177
    v_max3_f32 v208, v208, v178, v179
    v_max3_f32 v208, v208, v180, v181
    v_max3_f32 v208, v208, v182, v183
    v_max3_f32 v208, v208, v184, v185
    v_max3_f32 v208, v208, v186, v187
    v_max3_f32 v208, v208, v188, v189
    v_max3_f32 v208, v208, v190, v191
    s_add_u32 s24, s24, 2048
    s_cmp_lt_u32 s24, 131072
    s_cbranch_scc1 fb_62_a0
    v_mov_b32 v209, v208
    s_nop 1
    v_permlane32_swap_b32 v208, v209
    v_max_f32 v208, v208, v209
    v_sub_f32 v192, 0, v208
    v_sub_f32 v193, 0, v208
    v_sub_f32 v194, 0, v208
    v_sub_f32 v195, 0, v208
    v_sub_f32 v196, 0, v208
    v_sub_f32 v197, 0, v208
    v_sub_f32 v198, 0, v208
    v_sub_f32 v199, 0, v208
    v_sub_f32 v200, 0, v208
    v_sub_f32 v201, 0, v208
    v_sub_f32 v202, 0, v208
    v_sub_f32 v203, 0, v208
    v_sub_f32 v204, 0, v208
    v_sub_f32 v205, 0, v208
    v_sub_f32 v206, 0, v208
    v_sub_f32 v207, 0, v208
    v_mov_b32 v16, 0
    v_mov_b32 v17, 0
    v_mov_b32 v18, 0
    v_mov_b32 v19, 0
    v_mov_b32 v20, 0
    v_mov_b32 v21, 0
    v_mov_b32 v22, 0
    v_mov_b32 v23, 0
    v_mov_b32 v24, 0
    v_mov_b32 v25, 0
    v_mov_b32 v26, 0
    v_mov_b32 v27, 0
    v_mov_b32 v28, 0
    v_mov_b32 v29, 0
    v_mov_b32 v30, 0
    v_mov_b32 v31, 0
    s_mov_b32 s24, 0
fb_62_b0:
    buffer_load_dwordx4 v[80:83], v248, s[4:7], s24 offen sc1
    s_mov_b64 exec, s[30:31]
    buffer_load_dwordx4 v[84:87], v249, s[4:7], s24 offen offset:1024 sc1
    buffer_load_dwordx4 v[88:91], v249, s[4:7], s24 offen offset:1536 sc1
    s_mov_b64 exec, -1
    s_waitcnt vmcnt(0)
    v_mfma_f32_32x32x16_bf16 v[176:191], v[80:83], a[224:227], v[192:207]
    s_nop 11
    v_exp_f32 v176, v176
    v_exp_f32 v177, v177
    v_exp_f32 v178, v178
    v_exp_f32 v179, v179
    v_exp_f32 v180, v180
    v_exp_f32 v181, v181
    v_exp_f32 v182, v182
    v_exp_f32 v183, v183
    v_exp_f32 v184, v184
    v_exp_f32 v185, v185
    v_exp_f32 v186, v186
    v_exp_f32 v187, v187
    v_exp_f32 v188, v188
    v_exp_f32 v189, v189
    v_exp_f32 v190, v190
    v_exp_f32 v191, v191
    v_smfmac_f32_32x32x32_bf16 v[16:31], v[84:87], v[176:183], v250
    s_nop 0
    v_smfmac_f32_32x32x32_bf16 v[16:31], v[88:91], v[184:191], v250
    s_nop 15
    s_add_u32 s24, s24, 2048
    s_cmp_lt_u32 s24, 131072
    s_cbranch_scc1 fb_62_b0
    v_rcp_f32 v25, v24
    s_nop 0
    v_mul_f32 v16, v16, v25
    v_mul_f32 v17, v17, v25
    v_cvt_pk_bf16_f32 v28, v16, v17
    v_mul_f32 v18, v18, v25
    v_mul_f32 v19, v19, v25
    v_cvt_pk_bf16_f32 v29, v18, v19
    v_mul_f32 v20, v20, v25
    v_mul_f32 v21, v21, v25
    v_cvt_pk_bf16_f32 v30, v20, v21
    v_mul_f32 v22, v22, v25
    v_mul_f32 v23, v23, v25
    v_cvt_pk_bf16_f32 v31, v22, v23
    buffer_store_dwordx4 v[28:31], v1, s[4:7], s64 offen
    v_mov_b32 v208, 0xff800000
    s_mov_b32 s24, 0
fb_62_a1:
    buffer_load_dwordx4 v[80:83], v248, s[4:7], s24 offen sc1
    s_waitcnt vmcnt(0)
    v_mfma_f32_32x32x16_bf16 v[176:191], v[80:83], a[228:231], 0
    s_nop 11
    v_max3_f32 v208, v208, v176, v177
    v_max3_f32 v208, v208, v178, v179
    v_max3_f32 v208, v208, v180, v181
    v_max3_f32 v208, v208, v182, v183
    v_max3_f32 v208, v208, v184, v185
    v_max3_f32 v208, v208, v186, v187
    v_max3_f32 v208, v208, v188, v189
    v_max3_f32 v208, v208, v190, v191
    s_add_u32 s24, s24, 2048
    s_cmp_lt_u32 s24, 131072
    s_cbranch_scc1 fb_62_a1
    v_mov_b32 v209, v208
    s_nop 1
    v_permlane32_swap_b32 v208, v209
    v_max_f32 v208, v208, v209
    v_sub_f32 v192, 0, v208
    v_sub_f32 v193, 0, v208
    v_sub_f32 v194, 0, v208
    v_sub_f32 v195, 0, v208
    v_sub_f32 v196, 0, v208
    v_sub_f32 v197, 0, v208
    v_sub_f32 v198, 0, v208
    v_sub_f32 v199, 0, v208
    v_sub_f32 v200, 0, v208
    v_sub_f32 v201, 0, v208
    v_sub_f32 v202, 0, v208
    v_sub_f32 v203, 0, v208
    v_sub_f32 v204, 0, v208
    v_sub_f32 v205, 0, v208
    v_sub_f32 v206, 0, v208
    v_sub_f32 v207, 0, v208
    v_mov_b32 v32, 0
    v_mov_b32 v33, 0
    v_mov_b32 v34, 0
    v_mov_b32 v35, 0
    v_mov_b32 v36, 0
    v_mov_b32 v37, 0
    v_mov_b32 v38, 0
    v_mov_b32 v39, 0
    v_mov_b32 v40, 0
    v_mov_b32 v41, 0
    v_mov_b32 v42, 0
    v_mov_b32 v43, 0
    v_mov_b32 v44, 0
    v_mov_b32 v45, 0
    v_mov_b32 v46, 0
    v_mov_b32 v47, 0
    s_mov_b32 s24, 0
fb_62_b1:
    buffer_load_dwordx4 v[80:83], v248, s[4:7], s24 offen sc1
    s_mov_b64 exec, s[30:31]
    buffer_load_dwordx4 v[84:87], v249, s[4:7], s24 offen offset:1024 sc1
    buffer_load_dwordx4 v[88:91], v249, s[4:7], s24 offen offset:1536 sc1
    s_mov_b64 exec, -1
    s_waitcnt vmcnt(0)
    v_mfma_f32_32x32x16_bf16 v[176:191], v[80:83], a[228:231], v[192:207]
    s_nop 11
    v_exp_f32 v176, v176
    v_exp_f32 v177, v177
    v_exp_f32 v178, v178
    v_exp_f32 v179, v179
    v_exp_f32 v180, v180
    v_exp_f32 v181, v181
    v_exp_f32 v182, v182
    v_exp_f32 v183, v183
    v_exp_f32 v184, v184
    v_exp_f32 v185, v185
    v_exp_f32 v186, v186
    v_exp_f32 v187, v187
    v_exp_f32 v188, v188
    v_exp_f32 v189, v189
    v_exp_f32 v190, v190
    v_exp_f32 v191, v191
    v_smfmac_f32_32x32x32_bf16 v[32:47], v[84:87], v[176:183], v250
    s_nop 0
    v_smfmac_f32_32x32x32_bf16 v[32:47], v[88:91], v[184:191], v250
    s_nop 15
    s_add_u32 s24, s24, 2048
    s_cmp_lt_u32 s24, 131072
    s_cbranch_scc1 fb_62_b1
    v_rcp_f32 v41, v40
    s_nop 0
    v_mul_f32 v32, v32, v41
    v_mul_f32 v33, v33, v41
    v_cvt_pk_bf16_f32 v44, v32, v33
    v_mul_f32 v34, v34, v41
    v_mul_f32 v35, v35, v41
    v_cvt_pk_bf16_f32 v45, v34, v35
    v_mul_f32 v36, v36, v41
    v_mul_f32 v37, v37, v41
    v_cvt_pk_bf16_f32 v46, v36, v37
    v_mul_f32 v38, v38, v41
    v_mul_f32 v39, v39, v41
    v_cvt_pk_bf16_f32 v47, v38, v39
    buffer_store_dwordx4 v[44:47], v1, s[4:7], s65 offen
    s_waitcnt vmcnt(0)
    s_branch fbret_63
slow_64:
    s_waitcnt vmcnt(0)
    buffer_wbl2 sc1
    s_waitcnt vmcnt(0)
    buffer_store_dwordx2 v[14:15], off, s[4:7], s41 sc1
    s_branch join_65
slow_68:
    s_waitcnt vmcnt(0)
    buffer_wbl2 sc1
    s_waitcnt vmcnt(0)
    buffer_store_dwordx2 v[14:15], off, s[4:7], s41 sc1
    s_branch join_69
slow_70:
    s_waitcnt vmcnt(0)
    buffer_wbl2 sc1
    s_waitcnt vmcnt(0)
    buffer_store_dwordx2 v[14:15], off, s[4:7], s41 sc1
    s_branch join_71
slow_78:
    s_waitcnt vmcnt(0)
    buffer_wbl2 sc1
    s_waitcnt vmcnt(0)
    buffer_store_dwordx2 v[14:15], off, s[4:7], s41 sc1
    s_branch join_79
slow_82:
    s_waitcnt vmcnt(0)
    buffer_wbl2 sc1
    s_waitcnt vmcnt(0)
    buffer_store_dwordx2 v[14:15], off, s[4:7], s41 sc1
    s_branch join_83
slow_86:
    s_waitcnt vmcnt(0)
    buffer_wbl2 sc1
    s_waitcnt vmcnt(0)
    buffer_store_dwordx2 v[14:15], off, s[4:7], s41 sc1
    s_branch join_87
L_end:
.section .rodata,"a"
.p2align 6
.amdhsa_kernel interleave_layers__mha_block__glu_gated_bilinear__prompt_kernel
  .amdhsa_next_free_vgpr 512
  .amdhsa_next_free_sgpr 102
  .amdhsa_accum_offset 256
  .amdhsa_group_segment_fixed_size 0
  .amdhsa_kernarg_size 80
  .amdhsa_user_sgpr_count 2
  .amdhsa_user_sgpr_kernarg_segment_ptr 1
  .amdhsa_system_sgpr_workgroup_id_x 1
.end_amdhsa_kernel
```
